```python
import torch

def _softmax(x, axis=-1):
    return torch.softmax(x, dim=axis)

def _gelu(x):
    return torch.nn.functional.gelu(x, approximate='tanh')

def _silu(x):
    return torch.nn.functional.silu(x)

def _sigmoid(x):
    return torch.sigmoid(x)

def _layernorm(x, axis=-1, eps=1e-05):
    m = x.mean(dim=axis, keepdim=True)
    v = x.var(dim=axis, keepdim=True, unbiased=False)
    return (x - m) / torch.sqrt(v + eps)

def _scatter_add(tgt, idx, src, axis=0):
    return tgt.clone().index_add_(axis, idx, src)

def _segment_sum(src, seg, n):
    out = torch.zeros((n,) + src.shape[1:], dtype=src.dtype)
    return out.index_add_(0, seg, src)

def _pad(x, pw):
    flat = tuple((v for pair in reversed(pw) for v in pair))
    return torch.nn.functional.pad(x, flat)
kernel_name = 'adaLN_cond__mha_block_cached__moe_arch_mod__prompt'

def setup_inputs():

    _w = lambda a: (lambda t: t.to(torch.bfloat16) if t.is_floating_point() else t)(torch.as_tensor(a))

    def _A_setup():
        B, Sq, D = (1, 2048, 512)
        H, Sk, Dh = (32, 2048, 128)
        return {'x': _w((lambda *s: torch.randn(*s, dtype=torch.bfloat16) * 0.1)(B, Sq, D)), 'k_cache': _w((lambda *s: torch.randn(*s, dtype=torch.bfloat16) * 0.8)(B, H, Sk, Dh)), 'v_cache': _w((lambda *s: torch.randn(*s, dtype=torch.bfloat16) * 3.2)(B, H, Sk, Dh)), 'wq': _w((lambda *s: torch.randn(*s, dtype=torch.bfloat16) * 0.8)(D, H * Dh) * D ** (-0.5)), 'wo': _w((lambda *s: torch.randn(*s, dtype=torch.bfloat16) * 3.2)(H * Dh, D) * (H * Dh) ** (-0.5))}
    _A_in = _A_setup()

    def _B_setup():
        B, S, D, F, C = (1, 2048, 512, 1792, 1)
        return {'x': _w((lambda *s: torch.randn(*s, dtype=torch.bfloat16) * 0.1)(B, S, D)), 'w_r': _w((lambda *s: torch.randn(*s, dtype=torch.bfloat16) * 3.2)(D)), 'w_gate': _w((lambda *s: torch.randn(*s, dtype=torch.bfloat16) * 3.2)(D, F)), 'w_up': _w((lambda *s: torch.randn(*s, dtype=torch.bfloat16) * 3.2)(D, F)), 'w_down': _w((lambda *s: torch.randn(*s, dtype=torch.bfloat16) * 3.2)(F, D))}
    _B_in = _B_setup()
    return {'A_x': _A_in['x'], 'A_k_cache': _A_in['k_cache'], 'A_v_cache': _A_in['v_cache'], 'A_wq': _A_in['wq'], 'A_wo': _A_in['wo'], 'B_x': _B_in['x'], 'B_w_r': _B_in['w_r'], 'B_w_gate': _B_in['w_gate'], 'B_w_up': _B_in['w_up'], 'B_w_down': _B_in['w_down'], 'c': _w((lambda *s: torch.randn(*s, dtype=torch.bfloat16) * 0.2)(1, 512) * 8.0), 'w_mod': _w((lambda *s: torch.randn(*s, dtype=torch.bfloat16) * 0.2)(512, 6 * 512) * 512 ** (-0.5) * 8.0)}

def reference(A_x, A_k_cache, A_v_cache, A_wq, A_wo, B_x, B_w_r, B_w_gate, B_w_up, B_w_down, c, w_mod):

    def _A_ref(x, k_cache, v_cache, wq, wo):
        B, Sq, D = x.shape
        H, Dh = (32, 128)
        q = (lambda x, *d: x.permute(*d))((x @ wq).reshape(B, Sq, H, Dh), 0, 2, 1, 3)
        scores = torch.einsum('bhqd,bhkd->bhqk', q, k_cache) * Dh ** (-0.5)
        p = _softmax(scores, axis=-1)
        o = torch.einsum('bhqk,bhkd->bhqd', p, v_cache)
        return (lambda x, *d: x.permute(*d))(o, 0, 2, 1, 3).reshape(B, Sq, H * Dh) @ wo

    def _B_ref(x, w_r, w_gate, w_up, w_down):
        B, S, D = x.shape
        C = 1
        r = x @ w_r
        idx = torch.argsort(-r, axis=-1)[:, :C]
        idx_e = (lambda x, n, axis: torch.repeat_interleave(x, n, dim=axis))(idx.reshape(B, C, 1), D, axis=2)
        x_sel = (lambda x, i, axis: torch.take_along_dim(x, i, dim=axis))(x, idx_e, axis=1)
        g = _silu(x_sel @ w_gate)
        u = x_sel @ w_up
        y = g * u @ w_down
        r_sel = _sigmoid((lambda x, i, axis: torch.take_along_dim(x, i, dim=axis))(r, idx, axis=1))
        y = y * r_sel.reshape(B, C, 1)
        b_off = (torch.arange(B) * S).reshape(B, 1)
        flat_idx = (idx + b_off).reshape(B * C)
        zero = (x * 0.0).reshape(B * S, D)
        upd = _scatter_add(zero, flat_idx, y.reshape(B * C, D), axis=0)
        return x + upd.reshape(B, S, D)
    x = A_x
    mod = (_silu(c) @ w_mod).reshape(c.shape[0], 6, 1, -1)
    sa, ca, ga, sb, cb, gb = (mod[:, 0].clone(), mod[:, 1].clone(), mod[:, 2].clone(), mod[:, 3].clone(), mod[:, 4].clone(), mod[:, 5].clone())
    h = _layernorm(x, axis=-1) * (1 + ca) + sa
    x = x + ga * _A_ref(h, A_k_cache, A_v_cache, A_wq, A_wo)
    h = _layernorm(x, axis=-1) * (1 + cb) + sb
    x = x + gb * _B_ref(h, B_w_r, B_w_gate, B_w_up, B_w_down)
    return x
```

```asm
; @launch grid=(256,1,1) block=(256,1,1) lds=163840
.amdgcn_target "amdgcn-amd-amdhsa--gfx950"
.text
.globl adaLN_cond__mha_block_cached__moe_arch_mod__prompt_kernel
.p2align 8
.type adaLN_cond__mha_block_cached__moe_arch_mod__prompt_kernel,@function
adaLN_cond__mha_block_cached__moe_arch_mod__prompt_kernel:
    s_cmp_ge_u32 s2, 256
    s_cbranch_scc1 F_END
    s_load_dwordx16 s[4:19], s[0:1], 0
    s_load_dwordx8 s[20:27], s[0:1], 64
    s_load_dwordx2 s[28:29], s[0:1], 96
    s_load_dwordx2 s[30:31], s[0:1], 112
    v_and_b32 v1, 63, v0
    v_lshrrev_b32 v2, 6, v0
    v_and_b32 v3, 15, v1
    v_readfirstlane_b32 s76, v2
    v_lshrrev_b32 v4, 4, v1
    s_and_b32 s77, s2, 7
    s_lshl_b32 s77, s77, 2
    s_bfe_u32 s88, s2, 0x20003
    s_add_u32 s77, s77, s88
    s_lshr_b32 s78, s2, 5
    v_lshlrev_b32 v33, 4, v1
    s_cmp_eq_u32 s76, 1
    s_cbranch_scc1 F_MOD
    s_cmp_eq_u32 s76, 3
    s_cbranch_scc1 F_WQ
    v_and_b32 v5, 3, v1
    v_lshrrev_b32 v6, 2, v1
    v_lshlrev_b32 v7, 10, v5
    v_lshl_add_u32 v7, v6, 4, v7
    s_lshl_b32 s88, s78, 8
    s_lshl_b32 s89, s77, 3
    s_add_u32 s88, s88, s89
    s_lshl_b32 s89, s76, 1
    s_add_u32 s88, s88, s89
    s_lshl_b32 s89, s88, 10
    v_lshrrev_b32 v39, 2, v6
    v_lshlrev_b32 v39, 17, v39
    v_and_b32 v6, 3, v6
    v_lshl_add_u32 v39, v6, 6, v39
    v_lshl_add_u32 v39, v5, 4, v39
    s_waitcnt lgkmcnt(0)
    s_mov_b32 s48, s4
    s_mov_b32 s49, s5
    s_mov_b32 s50, 2097152
    s_mov_b32 s51, 0x20000
    buffer_load_dwordx4 v[40:43], v7, s[48:51], s89 offen offset:0
    buffer_load_dwordx4 v[44:47], v7, s[48:51], s89 offen offset:256
    buffer_load_dwordx4 v[48:51], v7, s[48:51], s89 offen offset:512
    buffer_load_dwordx4 v[52:55], v7, s[48:51], s89 offen offset:768
    s_mov_b32 s44, s30
    s_mov_b32 s45, s31
    s_mov_b32 s46, 33554432
    s_mov_b32 s47, 0x20000
    buffer_load_dword v35, off, s[44:47], 0 offset:0 sc1
    s_lshl_b32 s90, s78, 8
    s_lshl_b32 s91, s77, 3
    s_add_u32 s90, s90, s91
    s_add_u32 s90, s90, 4096
    v_and_b32 v6, 3, v1
    v_lshlrev_b32 v6, 11, v6
    buffer_load_dword v104, v6, s[44:47], s90 offen
    s_lshr_b32 s90, s88, 4
    s_lshl_b32 s90, s90, 10
    s_and_b32 s88, s88, 15
    s_lshl_b32 s88, s88, 6
    s_add_u32 s3, s90, s88
    s_add_u32 s3, s3, 1048576
    s_mov_b32 s40, s10
    s_mov_b32 s41, s11
    s_mov_b32 s42, 4194304
    s_mov_b32 s43, 0x20000
    s_lshl_b32 s88, s77, 19
    s_add_u32 s32, s6, s88
    s_addc_u32 s33, s7, 0
    s_mov_b32 s34, 524288
    s_mov_b32 s35, 0x20000
    s_add_u32 s36, s8, s88
    s_addc_u32 s37, s9, 0
    s_mov_b32 s38, 524288
    s_mov_b32 s39, 0x20000
    s_bfe_u32 s89, s2, 0x20001
    s_lshl_b32 s88, s89, 20
    s_add_u32 s52, s12, s88
    s_addc_u32 s53, s13, 0
    s_mov_b32 s54, 1048576
    s_mov_b32 s55, 0x20000
    s_lshr_b32 s86, s2, 3
    s_lshl_b32 s86, s86, 15
    s_lshl_b32 s88, s76, 13
    s_add_u32 s86, s86, s88
    s_mul_i32 s87, s2, 7168
    s_cmp_eq_u32 s76, 0
    s_cselect_b32 s56, s18, s20
    s_cselect_b32 s57, s19, s21
    s_cmp_eq_u32 s76, 2
    s_cselect_b32 s56, s22, s56
    s_cselect_b32 s57, s23, s57
    s_cmp_eq_u32 s76, 3
    s_cselect_b32 s58, 0, 1835008
    s_mov_b32 s59, 0x20000
    s_cmp_lt_u32 s2, 112
    s_cselect_b32 s88, 1835008, 0
    s_mov_b32 s68, s18
    s_mov_b32 s69, s19
    s_mov_b32 s70, s88
    s_mov_b32 s71, 0x20000
    s_mov_b32 s72, s20
    s_mov_b32 s73, s21
    s_mov_b32 s74, s88
    s_mov_b32 s75, 0x20000
    s_mov_b32 s20, s22
    s_mov_b32 s21, s23
    s_mov_b32 s22, s88
    s_mov_b32 s23, 0x20000
    s_mov_b32 s60, s28
    s_mov_b32 s61, s29
    s_mov_b32 s62, 2097152
    s_mov_b32 s63, 0x20000
    s_mov_b32 s64, s16
    s_mov_b32 s65, s17
    s_mov_b32 s66, 1024
    s_mov_b32 s67, 0x20000
    s_mov_b32 s80, 0
    s_mov_b32 s81, 0
    s_lshl_b32 s82, s76, 11
    s_mov_b32 s4, s89
    s_and_b32 s5, s2, 1
    s_lshl_b32 s5, s5, 3
    s_lshr_b32 s88, s2, 5
    s_add_u32 s5, s5, s88
    s_bfe_u32 s6, s2, 0x20003
    s_lshl_b32 s10, s76, 12
    s_lshl_b32 s85, s6, 8
    s_lshl_b32 s83, s78, 4
    s_lshl_b32 s88, s76, 2
    s_add_u32 s83, s83, s88
    s_lshl_b32 s83, s83, 10
    s_lshl_b32 s11, s77, 19
    s_add_u32 s11, s11, s83
    s_add_u32 s11, s11, 8388608
    s_add_u32 s83, s83, 1048576
    s_lshl_b32 s7, s4, 2
    s_add_u32 s7, s7, s6
    s_lshl_b32 s8, s5, 4
    s_add_u32 s8, s8, s7
    s_lshl_b32 s9, s8, 13
    s_and_b32 s14, s2, 7
    s_mul_i32 s14, s14, 14
    s_lshr_b32 s88, s2, 3
    s_add_u32 s14, s14, s88
    s_lshl_b32 s12, s14, 5
    s_add_u32 s13, s12, 7168
    s_lshl_b32 s15, s14, 14
    s_add_u32 s15, s15, s10
    v_add_u32 v5, 0, v4
    v_xor_b32 v5, v5, v3
    v_lshlrev_b32 v5, 4, v5
    v_lshl_add_u32 v8, v3, 8, v5
    v_add_u32 v5, 4, v4
    v_xor_b32 v5, v5, v3
    v_lshlrev_b32 v5, 4, v5
    v_lshl_add_u32 v9, v3, 8, v5
    v_add_u32 v5, 8, v4
    v_xor_b32 v5, v5, v3
    v_lshlrev_b32 v5, 4, v5
    v_lshl_add_u32 v10, v3, 8, v5
    v_add_u32 v5, 12, v4
    v_xor_b32 v5, v5, v3
    v_lshlrev_b32 v5, 4, v5
    v_lshl_add_u32 v11, v3, 8, v5
    v_lshrrev_b32 v6, 2, v3
    v_lshl_add_u32 v7, v4, 2, v6
    v_and_b32 v36, 7, v7
    v_lshlrev_b32 v36, 1, v36
    v_bfe_u32 v37, v3, 1, 1
    v_and_b32 v38, 1, v3
    v_lshlrev_b32 v38, 3, v38
    v_lshl_add_u32 v38, v7, 8, v38
    v_add_u32 v38, 65536, v38
    v_add_u32 v5, 0, v37
    v_xor_b32 v5, v5, v36
    v_lshl_add_u32 v12, v5, 4, v38
    v_add_u32 v5, 2, v37
    v_xor_b32 v5, v5, v36
    v_lshl_add_u32 v13, v5, 4, v38
    v_add_u32 v5, 4, v37
    v_xor_b32 v5, v5, v36
    v_lshl_add_u32 v14, v5, 4, v38
    v_add_u32 v5, 6, v37
    v_xor_b32 v5, v5, v36
    v_lshl_add_u32 v15, v5, 4, v38
    v_add_u32 v5, 8, v37
    v_xor_b32 v5, v5, v36
    v_lshl_add_u32 v16, v5, 4, v38
    v_add_u32 v5, 10, v37
    v_xor_b32 v5, v5, v36
    v_lshl_add_u32 v17, v5, 4, v38
    v_add_u32 v5, 12, v37
    v_xor_b32 v5, v5, v36
    v_lshl_add_u32 v18, v5, 4, v38
    v_add_u32 v5, 14, v37
    v_xor_b32 v5, v5, v36
    v_lshl_add_u32 v19, v5, 4, v38
    v_lshl_add_u32 v7, v2, 3, v4
    v_add_u32 v5, 0, v7
    v_and_b32 v5, 15, v5
    v_xor_b32 v5, v5, v3
    v_lshlrev_b32 v5, 4, v5
    v_lshl_add_u32 v20, v7, 8, v5
    v_add_u32 v5, 0, v4
    v_lshlrev_b32 v5, 1, v5
    v_xor_b32 v5, v5, v3
    v_lshlrev_b32 v5, 4, v5
    v_lshl_add_u32 v22, v7, 8, v5
    v_add_u32 v5, 4, v7
    v_and_b32 v5, 15, v5
    v_xor_b32 v5, v5, v3
    v_lshlrev_b32 v5, 4, v5
    v_lshl_add_u32 v21, v7, 8, v5
    v_add_u32 v5, 4, v4
    v_lshlrev_b32 v5, 1, v5
    v_xor_b32 v5, v5, v3
    v_lshlrev_b32 v5, 4, v5
    v_lshl_add_u32 v23, v7, 8, v5
    v_lshl_add_u32 v7, v4, 3, v6
    v_and_b32 v36, 3, v3
    v_xor_b32 v5, 0, v6
    v_lshl_add_u32 v5, v5, 2, v36
    v_lshlrev_b32 v5, 4, v5
    v_lshl_add_u32 v24, v7, 8, v5
    v_add_u32 v28, 0x10000, v24
    v_xor_b32 v5, 1, v6
    v_lshl_add_u32 v5, v5, 2, v36
    v_lshlrev_b32 v5, 4, v5
    v_lshl_add_u32 v25, v7, 8, v5
    v_add_u32 v29, 0x10000, v25
    v_xor_b32 v5, 2, v6
    v_lshl_add_u32 v5, v5, 2, v36
    v_lshlrev_b32 v5, 4, v5
    v_lshl_add_u32 v26, v7, 8, v5
    v_add_u32 v30, 0x10000, v26
    v_xor_b32 v5, 3, v6
    v_lshl_add_u32 v5, v5, 2, v36
    v_lshlrev_b32 v5, 4, v5
    v_lshl_add_u32 v27, v7, 8, v5
    v_add_u32 v31, 0x10000, v27
    v_lshlrev_b32 v34, 6, v4
    v_add_u32 v34, 131072, v34
    v_lshlrev_b32 v5, 2, v4
    v_xor_b32 v5, v3, v5
    v_lshlrev_b32 v5, 4, v5
    v_lshl_add_u32 v32, v4, 13, v5
    v_mov_b32 v5, 0x3f803f80
    v_accvgpr_write_b32 a252, v5
    v_accvgpr_write_b32 a253, v5
    v_accvgpr_write_b32 a254, v5
    v_accvgpr_write_b32 a255, v5
    s_waitcnt vmcnt(2)
    v_lshlrev_b32 v56, 16, v40
    v_and_b32 v57, 0xffff0000, v40
    v_lshlrev_b32 v58, 16, v41
    v_and_b32 v59, 0xffff0000, v41
    v_lshlrev_b32 v60, 16, v42
    v_and_b32 v61, 0xffff0000, v42
    v_lshlrev_b32 v62, 16, v43
    v_and_b32 v63, 0xffff0000, v43
    v_lshlrev_b32 v64, 16, v44
    v_and_b32 v65, 0xffff0000, v44
    v_lshlrev_b32 v66, 16, v45
    v_and_b32 v67, 0xffff0000, v45
    v_lshlrev_b32 v68, 16, v46
    v_and_b32 v69, 0xffff0000, v46
    v_lshlrev_b32 v70, 16, v47
    v_and_b32 v71, 0xffff0000, v47
    v_lshlrev_b32 v72, 16, v48
    v_and_b32 v73, 0xffff0000, v48
    v_lshlrev_b32 v74, 16, v49
    v_and_b32 v75, 0xffff0000, v49
    v_lshlrev_b32 v76, 16, v50
    v_and_b32 v77, 0xffff0000, v50
    v_lshlrev_b32 v78, 16, v51
    v_and_b32 v79, 0xffff0000, v51
    v_lshlrev_b32 v80, 16, v52
    v_and_b32 v81, 0xffff0000, v52
    v_lshlrev_b32 v82, 16, v53
    v_and_b32 v83, 0xffff0000, v53
    v_lshlrev_b32 v84, 16, v54
    v_and_b32 v85, 0xffff0000, v54
    v_lshlrev_b32 v86, 16, v55
    v_and_b32 v87, 0xffff0000, v55
    v_add_f32 v40, v56, v57
    v_mul_f32 v41, v56, v56
    v_add_f32 v42, v58, v59
    v_mul_f32 v43, v57, v57
    v_add_f32 v40, v40, v60
    v_add_f32 v42, v42, v61
    v_add_f32 v40, v40, v62
    v_add_f32 v42, v42, v63
    v_add_f32 v40, v40, v64
    v_add_f32 v42, v42, v65
    v_add_f32 v40, v40, v66
    v_add_f32 v42, v42, v67
    v_add_f32 v40, v40, v68
    v_add_f32 v42, v42, v69
    v_add_f32 v40, v40, v70
    v_add_f32 v42, v42, v71
    v_add_f32 v40, v40, v72
    v_add_f32 v42, v42, v73
    v_add_f32 v40, v40, v74
    v_add_f32 v42, v42, v75
    v_add_f32 v40, v40, v76
    v_add_f32 v42, v42, v77
    v_add_f32 v40, v40, v78
    v_add_f32 v42, v42, v79
    v_add_f32 v40, v40, v80
    v_add_f32 v42, v42, v81
    v_add_f32 v40, v40, v82
    v_add_f32 v42, v42, v83
    v_add_f32 v40, v40, v84
    v_add_f32 v42, v42, v85
    v_add_f32 v40, v40, v86
    v_add_f32 v42, v42, v87
    v_fmac_f32 v41, v58, v58
    v_fmac_f32 v43, v59, v59
    v_fmac_f32 v41, v60, v60
    v_fmac_f32 v43, v61, v61
    v_fmac_f32 v41, v62, v62
    v_fmac_f32 v43, v63, v63
    v_fmac_f32 v41, v64, v64
    v_fmac_f32 v43, v65, v65
    v_fmac_f32 v41, v66, v66
    v_fmac_f32 v43, v67, v67
    v_fmac_f32 v41, v68, v68
    v_fmac_f32 v43, v69, v69
    v_fmac_f32 v41, v70, v70
    v_fmac_f32 v43, v71, v71
    v_fmac_f32 v41, v72, v72
    v_fmac_f32 v43, v73, v73
    v_fmac_f32 v41, v74, v74
    v_fmac_f32 v43, v75, v75
    v_fmac_f32 v41, v76, v76
    v_fmac_f32 v43, v77, v77
    v_fmac_f32 v41, v78, v78
    v_fmac_f32 v43, v79, v79
    v_fmac_f32 v41, v80, v80
    v_fmac_f32 v43, v81, v81
    v_fmac_f32 v41, v82, v82
    v_fmac_f32 v43, v83, v83
    v_fmac_f32 v41, v84, v84
    v_fmac_f32 v43, v85, v85
    v_fmac_f32 v41, v86, v86
    v_fmac_f32 v43, v87, v87
    v_add_f32 v40, v40, v42
    v_add_f32 v41, v41, v43
    s_nop 1
    v_add_f32_dpp v40, v40, v40 row_ror:4 row_mask:0xf bank_mask:0xf
    v_add_f32_dpp v41, v41, v41 row_ror:4 row_mask:0xf bank_mask:0xf
    s_nop 0
    v_add_f32_dpp v40, v40, v40 row_ror:8 row_mask:0xf bank_mask:0xf
    v_add_f32_dpp v41, v41, v41 row_ror:8 row_mask:0xf bank_mask:0xf
    s_nop 1
    v_mov_b32 v42, v40
    v_mov_b32 v43, v41
    s_nop 0
    v_permlane16_swap_b32 v42, v40
    v_permlane16_swap_b32 v43, v41
    v_add_f32 v40, v40, v42
    v_add_f32 v41, v41, v43
    s_nop 0
    v_mov_b32 v42, v40
    v_mov_b32 v43, v41
    s_nop 0
    v_permlane32_swap_b32 v42, v40
    v_permlane32_swap_b32 v43, v41
    v_add_f32 v40, v40, v42
    v_add_f32 v41, v41, v43
    s_nop 0
    v_mul_f32 v40, 0x3b000000, v40
    v_mul_f32 v41, 0x3b000000, v41
    v_fma_f32 v41, -v40, v40, v41
    v_max_f32 v41, 0, v41
    v_cvt_pk_bf16_f32 v40, v40, v40
    v_and_b32 v40, 0xffff0000, v40
    v_cvt_pk_bf16_f32 v41, v41, v41
    v_and_b32 v41, 0xffff0000, v41
    v_add_f32 v41, 0x3727c5ac, v41
    v_cvt_pk_bf16_f32 v41, v41, v41
    v_and_b32 v41, 0xffff0000, v41
    v_sqrt_f32 v41, v41
    s_nop 0
    v_cvt_pk_bf16_f32 v41, v41, v41
    v_and_b32 v41, 0xffff0000, v41
    v_rcp_f32 v41, v41
    s_nop 0
    v_mul_f32_e64 v40, -v40, v41
    v_fma_f32 v56, v56, v41, v40
    v_fma_f32 v57, v57, v41, v40
    v_fma_f32 v58, v58, v41, v40
    v_fma_f32 v59, v59, v41, v40
    v_fma_f32 v60, v60, v41, v40
    v_fma_f32 v61, v61, v41, v40
    v_fma_f32 v62, v62, v41, v40
    v_fma_f32 v63, v63, v41, v40
    v_cvt_pk_f16_f32 v88, v56, v57
    v_cvt_pk_f16_f32 v89, v58, v59
    v_cvt_pk_f16_f32 v90, v60, v61
    v_cvt_pk_f16_f32 v91, v62, v63
    buffer_store_dwordx4 v[88:91], v39, s[44:47], s3 offen sc1
    s_add_u32 s3, s3, 524288
    v_fma_f32 v64, v64, v41, v40
    v_fma_f32 v65, v65, v41, v40
    v_fma_f32 v66, v66, v41, v40
    v_fma_f32 v67, v67, v41, v40
    v_fma_f32 v68, v68, v41, v40
    v_fma_f32 v69, v69, v41, v40
    v_fma_f32 v70, v70, v41, v40
    v_fma_f32 v71, v71, v41, v40
    v_cvt_pk_f16_f32 v92, v64, v65
    v_cvt_pk_f16_f32 v93, v66, v67
    v_cvt_pk_f16_f32 v94, v68, v69
    v_cvt_pk_f16_f32 v95, v70, v71
    buffer_store_dwordx4 v[92:95], v39, s[44:47], s3 offen sc1
    s_add_u32 s3, s3, 524288
    v_fma_f32 v72, v72, v41, v40
    v_fma_f32 v73, v73, v41, v40
    v_fma_f32 v74, v74, v41, v40
    v_fma_f32 v75, v75, v41, v40
    v_fma_f32 v76, v76, v41, v40
    v_fma_f32 v77, v77, v41, v40
    v_fma_f32 v78, v78, v41, v40
    v_fma_f32 v79, v79, v41, v40
    v_cvt_pk_f16_f32 v96, v72, v73
    v_cvt_pk_f16_f32 v97, v74, v75
    v_cvt_pk_f16_f32 v98, v76, v77
    v_cvt_pk_f16_f32 v99, v78, v79
    buffer_store_dwordx4 v[96:99], v39, s[44:47], s3 offen sc1
    s_add_u32 s3, s3, 524288
    v_fma_f32 v80, v80, v41, v40
    v_fma_f32 v81, v81, v41, v40
    v_fma_f32 v82, v82, v41, v40
    v_fma_f32 v83, v83, v41, v40
    v_fma_f32 v84, v84, v41, v40
    v_fma_f32 v85, v85, v41, v40
    v_fma_f32 v86, v86, v41, v40
    v_fma_f32 v87, v87, v41, v40
    v_cvt_pk_f16_f32 v100, v80, v81
    v_cvt_pk_f16_f32 v101, v82, v83
    v_cvt_pk_f16_f32 v102, v84, v85
    v_cvt_pk_f16_f32 v103, v86, v87
    buffer_store_dwordx4 v[100:103], v39, s[44:47], s3 offen sc1
    s_waitcnt vmcnt(5)
    v_readfirstlane_b32 s79, v35
    s_mul_i32 s79, s79, 0x9E3779B1
    s_add_u32 s79, s79, 0x7F4A7C15
    s_lshl_b32 s88, s78, 8
    s_add_u32 s90, s88, 4096
    s_lshl_b32 s88, s77, 3
    s_lshl_b32 s89, s76, 1
    s_add_u32 s88, s88, s89
    v_lshlrev_b32 v5, 11, v1
    v_add_u32 v5, s88, v5
    v_mov_b32 v6, s79
    s_waitcnt vmcnt(0)
    s_mov_b64 exec, 15
    buffer_store_dword v6, v5, s[44:47], s90 offen sc1
    s_mov_b64 exec, -1
    s_branch F_SYNC
F_MOD:
    v_and_b32 v5, 7, v1
    v_lshrrev_b32 v6, 3, v1
    s_mov_b32 s88, 98304
    v_mul_lo_u32 v7, v6, s88
    v_lshl_add_u32 v7, v5, 4, v7
    v_lshlrev_b32 v39, 5, v5
    v_lshlrev_b32 v6, 5, v6
    s_sub_u32 s88, s2, 64
    s_and_b32 s89, s88, 31
    s_add_u32 s89, s89, 16
    s_lshr_b32 s88, s88, 5
    s_and_b32 s90, s2, 15
    s_lshr_b32 s91, s2, 4
    s_cmp_lt_u32 s2, 64
    s_cselect_b32 s89, s90, s89
    s_cselect_b32 s88, s91, s88
    s_cmp_lt_u32 s2, 192
    s_cselect_b32 s91, 3145728, 0
    s_waitcnt lgkmcnt(0)
    s_mov_b32 s60, s24
    s_mov_b32 s61, s25
    s_mov_b32 s62, 1024
    s_mov_b32 s63, 0x20000
    s_mov_b32 s64, s26
    s_mov_b32 s65, s27
    s_mov_b32 s66, s91
    s_mov_b32 s67, 0x20000
    s_lshl_b32 s90, s88, 8
    buffer_load_dwordx4 v[40:43], v6, s[60:63], s90 offen offset:0
    buffer_load_dwordx4 v[44:47], v6, s[60:63], s90 offen offset:16
    s_mul_i32 s90, s88, 786432
    s_lshl_b32 s91, s89, 7
    s_add_u32 s90, s90, s91
    s_cmp_lt_u32 s2, 64
    s_cbranch_scc1 F_MOD0
    s_waitcnt vmcnt(0)
F_MOD0:
    buffer_load_dwordx4 v[104:107], v7, s[64:67], s90 offen
    s_add_u32 s90, s90, 6144
    buffer_load_dwordx4 v[108:111], v7, s[64:67], s90 offen
    s_add_u32 s90, s90, 6144
    buffer_load_dwordx4 v[112:115], v7, s[64:67], s90 offen
    s_add_u32 s90, s90, 6144
    buffer_load_dwordx4 v[116:119], v7, s[64:67], s90 offen
    s_add_u32 s90, s90, 6144
    buffer_load_dwordx4 v[120:123], v7, s[64:67], s90 offen
    s_add_u32 s90, s90, 6144
    buffer_load_dwordx4 v[124:127], v7, s[64:67], s90 offen
    s_add_u32 s90, s90, 6144
    buffer_load_dwordx4 v[128:131], v7, s[64:67], s90 offen
    s_add_u32 s90, s90, 6144
    buffer_load_dwordx4 v[132:135], v7, s[64:67], s90 offen
    s_add_u32 s90, s90, 6144
    buffer_load_dwordx4 v[136:139], v7, s[64:67], s90 offen
    s_add_u32 s90, s90, 6144
    buffer_load_dwordx4 v[140:143], v7, s[64:67], s90 offen
    s_add_u32 s90, s90, 6144
    buffer_load_dwordx4 v[144:147], v7, s[64:67], s90 offen
    s_add_u32 s90, s90, 6144
    buffer_load_dwordx4 v[148:151], v7, s[64:67], s90 offen
    s_add_u32 s90, s90, 6144
    buffer_load_dwordx4 v[152:155], v7, s[64:67], s90 offen
    s_add_u32 s90, s90, 6144
    buffer_load_dwordx4 v[156:159], v7, s[64:67], s90 offen
    s_add_u32 s90, s90, 6144
    buffer_load_dwordx4 v[160:163], v7, s[64:67], s90 offen
    s_add_u32 s90, s90, 6144
    buffer_load_dwordx4 v[164:167], v7, s[64:67], s90 offen
    s_mov_b32 s44, s30
    s_mov_b32 s45, s31
    s_mov_b32 s46, 33554432
    s_mov_b32 s47, 0x20000
    s_mov_b32 s48, s4
    s_mov_b32 s49, s5
    s_mov_b32 s50, 2097152
    s_mov_b32 s51, 0x20000
    buffer_load_dword v35, off, s[44:47], 0 offset:0 sc1
    s_mul_i32 s3, s88, 12288
    s_lshl_b32 s89, s89, 8
    s_add_u32 s3, s3, s89
    s_add_u32 s3, s3, 65536
    s_mov_b32 s40, s10
    s_mov_b32 s41, s11
    s_mov_b32 s42, 4194304
    s_mov_b32 s43, 0x20000
    s_lshl_b32 s88, s77, 19
    s_add_u32 s32, s6, s88
    s_addc_u32 s33, s7, 0
    s_mov_b32 s34, 524288
    s_mov_b32 s35, 0x20000
    s_add_u32 s36, s8, s88
    s_addc_u32 s37, s9, 0
    s_mov_b32 s38, 524288
    s_mov_b32 s39, 0x20000
    s_bfe_u32 s89, s2, 0x20001
    s_lshl_b32 s88, s89, 20
    s_add_u32 s52, s12, s88
    s_addc_u32 s53, s13, 0
    s_mov_b32 s54, 1048576
    s_mov_b32 s55, 0x20000
    s_lshr_b32 s86, s2, 3
    s_lshl_b32 s86, s86, 15
    s_lshl_b32 s88, s76, 13
    s_add_u32 s86, s86, s88
    s_mul_i32 s87, s2, 7168
    s_cmp_eq_u32 s76, 0
    s_cselect_b32 s56, s18, s20
    s_cselect_b32 s57, s19, s21
    s_cmp_eq_u32 s76, 2
    s_cselect_b32 s56, s22, s56
    s_cselect_b32 s57, s23, s57
    s_cmp_eq_u32 s76, 3
    s_cselect_b32 s58, 0, 1835008
    s_mov_b32 s59, 0x20000
    s_cmp_lt_u32 s2, 112
    s_cselect_b32 s88, 1835008, 0
    s_mov_b32 s68, s18
    s_mov_b32 s69, s19
    s_mov_b32 s70, s88
    s_mov_b32 s71, 0x20000
    s_mov_b32 s72, s20
    s_mov_b32 s73, s21
    s_mov_b32 s74, s88
    s_mov_b32 s75, 0x20000
    s_mov_b32 s20, s22
    s_mov_b32 s21, s23
    s_mov_b32 s22, s88
    s_mov_b32 s23, 0x20000
    s_mov_b32 s60, s28
    s_mov_b32 s61, s29
    s_mov_b32 s62, 2097152
    s_mov_b32 s63, 0x20000
    s_mov_b32 s64, s16
    s_mov_b32 s65, s17
    s_mov_b32 s66, 1024
    s_mov_b32 s67, 0x20000
    s_mov_b32 s80, 0
    s_mov_b32 s81, 0
    s_lshl_b32 s82, s76, 11
    s_mov_b32 s4, s89
    s_and_b32 s5, s2, 1
    s_lshl_b32 s5, s5, 3
    s_lshr_b32 s88, s2, 5
    s_add_u32 s5, s5, s88
    s_bfe_u32 s6, s2, 0x20003
    s_lshl_b32 s10, s76, 12
    s_lshl_b32 s85, s6, 8
    s_lshl_b32 s83, s78, 4
    s_lshl_b32 s88, s76, 2
    s_add_u32 s83, s83, s88
    s_lshl_b32 s83, s83, 10
    s_lshl_b32 s11, s77, 19
    s_add_u32 s11, s11, s83
    s_add_u32 s11, s11, 8388608
    s_add_u32 s83, s83, 1048576
    s_lshl_b32 s7, s4, 2
    s_add_u32 s7, s7, s6
    s_lshl_b32 s8, s5, 4
    s_add_u32 s8, s8, s7
    s_lshl_b32 s9, s8, 13
    s_and_b32 s14, s2, 7
    s_mul_i32 s14, s14, 14
    s_lshr_b32 s88, s2, 3
    s_add_u32 s14, s14, s88
    s_lshl_b32 s12, s14, 5
    s_add_u32 s13, s12, 7168
    s_lshl_b32 s15, s14, 14
    s_add_u32 s15, s15, s10
    s_waitcnt vmcnt(17)
    v_lshlrev_b32 v56, 16, v40
    v_and_b32 v57, 0xffff0000, v40
    v_lshlrev_b32 v58, 16, v41
    v_and_b32 v59, 0xffff0000, v41
    v_lshlrev_b32 v60, 16, v42
    v_and_b32 v61, 0xffff0000, v42
    v_lshlrev_b32 v62, 16, v43
    v_and_b32 v63, 0xffff0000, v43
    v_lshlrev_b32 v64, 16, v44
    v_and_b32 v65, 0xffff0000, v44
    v_lshlrev_b32 v66, 16, v45
    v_and_b32 v67, 0xffff0000, v45
    v_lshlrev_b32 v68, 16, v46
    v_and_b32 v69, 0xffff0000, v46
    v_lshlrev_b32 v70, 16, v47
    v_and_b32 v71, 0xffff0000, v47
    v_mul_f32 v72, 0xbfb8aa3b, v56
    v_mul_f32 v73, 0xbfb8aa3b, v57
    v_mul_f32 v74, 0xbfb8aa3b, v58
    v_mul_f32 v75, 0xbfb8aa3b, v59
    v_mul_f32 v76, 0xbfb8aa3b, v60
    v_mul_f32 v77, 0xbfb8aa3b, v61
    v_mul_f32 v78, 0xbfb8aa3b, v62
    v_mul_f32 v79, 0xbfb8aa3b, v63
    v_mul_f32 v80, 0xbfb8aa3b, v64
    v_mul_f32 v81, 0xbfb8aa3b, v65
    v_mul_f32 v82, 0xbfb8aa3b, v66
    v_mul_f32 v83, 0xbfb8aa3b, v67
    v_mul_f32 v84, 0xbfb8aa3b, v68
    v_mul_f32 v85, 0xbfb8aa3b, v69
    v_mul_f32 v86, 0xbfb8aa3b, v70
    v_mul_f32 v87, 0xbfb8aa3b, v71
    v_exp_f32 v72, v72
    v_exp_f32 v73, v73
    v_exp_f32 v74, v74
    v_exp_f32 v75, v75
    v_exp_f32 v76, v76
    v_exp_f32 v77, v77
    v_exp_f32 v78, v78
    v_exp_f32 v79, v79
    v_exp_f32 v80, v80
    v_exp_f32 v81, v81
    v_exp_f32 v82, v82
    v_exp_f32 v83, v83
    v_exp_f32 v84, v84
    v_exp_f32 v85, v85
    v_exp_f32 v86, v86
    v_exp_f32 v87, v87
    v_add_f32 v72, 1.0, v72
    v_add_f32 v73, 1.0, v73
    v_add_f32 v74, 1.0, v74
    v_add_f32 v75, 1.0, v75
    v_add_f32 v76, 1.0, v76
    v_add_f32 v77, 1.0, v77
    v_add_f32 v78, 1.0, v78
    v_add_f32 v79, 1.0, v79
    v_add_f32 v80, 1.0, v80
    v_add_f32 v81, 1.0, v81
    v_add_f32 v82, 1.0, v82
    v_add_f32 v83, 1.0, v83
    v_add_f32 v84, 1.0, v84
    v_add_f32 v85, 1.0, v85
    v_add_f32 v86, 1.0, v86
    v_add_f32 v87, 1.0, v87
    v_rcp_f32 v72, v72
    v_rcp_f32 v73, v73
    v_rcp_f32 v74, v74
    v_rcp_f32 v75, v75
    v_rcp_f32 v76, v76
    v_rcp_f32 v77, v77
    v_rcp_f32 v78, v78
    v_rcp_f32 v79, v79
    v_rcp_f32 v80, v80
    v_rcp_f32 v81, v81
    v_rcp_f32 v82, v82
    v_rcp_f32 v83, v83
    v_rcp_f32 v84, v84
    v_rcp_f32 v85, v85
    v_rcp_f32 v86, v86
    v_rcp_f32 v87, v87
    v_mul_f32 v56, v56, v72
    v_mul_f32 v57, v57, v73
    v_mul_f32 v58, v58, v74
    v_mul_f32 v59, v59, v75
    v_mul_f32 v60, v60, v76
    v_mul_f32 v61, v61, v77
    v_mul_f32 v62, v62, v78
    v_mul_f32 v63, v63, v79
    v_mul_f32 v64, v64, v80
    v_mul_f32 v65, v65, v81
    v_mul_f32 v66, v66, v82
    v_mul_f32 v67, v67, v83
    v_mul_f32 v68, v68, v84
    v_mul_f32 v69, v69, v85
    v_mul_f32 v70, v70, v86
    v_mul_f32 v71, v71, v87
    v_cvt_pk_bf16_f32 v56, v56, v57
    v_cvt_pk_bf16_f32 v58, v58, v59
    v_cvt_pk_bf16_f32 v60, v60, v61
    v_cvt_pk_bf16_f32 v62, v62, v63
    v_cvt_pk_bf16_f32 v64, v64, v65
    v_cvt_pk_bf16_f32 v66, v66, v67
    v_cvt_pk_bf16_f32 v68, v68, v69
    v_cvt_pk_bf16_f32 v70, v70, v71
    v_and_b32 v57, 0xffff0000, v56
    v_lshlrev_b32 v56, 16, v56
    v_and_b32 v59, 0xffff0000, v58
    v_lshlrev_b32 v58, 16, v58
    v_and_b32 v61, 0xffff0000, v60
    v_lshlrev_b32 v60, 16, v60
    v_and_b32 v63, 0xffff0000, v62
    v_lshlrev_b32 v62, 16, v62
    v_and_b32 v65, 0xffff0000, v64
    v_lshlrev_b32 v64, 16, v64
    v_and_b32 v67, 0xffff0000, v66
    v_lshlrev_b32 v66, 16, v66
    v_and_b32 v69, 0xffff0000, v68
    v_lshlrev_b32 v68, 16, v68
    v_and_b32 v71, 0xffff0000, v70
    v_lshlrev_b32 v70, 16, v70
    s_waitcnt vmcnt(16)
    v_lshlrev_b32 v72, 16, v104
    v_and_b32 v73, 0xffff0000, v104
    v_lshlrev_b32 v74, 16, v105
    v_and_b32 v75, 0xffff0000, v105
    v_lshlrev_b32 v76, 16, v106
    v_and_b32 v77, 0xffff0000, v106
    v_lshlrev_b32 v78, 16, v107
    v_and_b32 v79, 0xffff0000, v107
    v_mul_f32 v40, v56, v72
    v_mul_f32 v41, v56, v73
    v_mul_f32 v42, v56, v74
    v_mul_f32 v43, v56, v75
    v_mul_f32 v44, v56, v76
    v_mul_f32 v45, v56, v77
    v_mul_f32 v46, v56, v78
    v_mul_f32 v47, v56, v79
    s_waitcnt vmcnt(15)
    v_lshlrev_b32 v72, 16, v108
    v_and_b32 v73, 0xffff0000, v108
    v_lshlrev_b32 v74, 16, v109
    v_and_b32 v75, 0xffff0000, v109
    v_lshlrev_b32 v76, 16, v110
    v_and_b32 v77, 0xffff0000, v110
    v_lshlrev_b32 v78, 16, v111
    v_and_b32 v79, 0xffff0000, v111
    v_fmac_f32 v40, v57, v72
    v_fmac_f32 v41, v57, v73
    v_fmac_f32 v42, v57, v74
    v_fmac_f32 v43, v57, v75
    v_fmac_f32 v44, v57, v76
    v_fmac_f32 v45, v57, v77
    v_fmac_f32 v46, v57, v78
    v_fmac_f32 v47, v57, v79
    s_waitcnt vmcnt(14)
    v_lshlrev_b32 v72, 16, v112
    v_and_b32 v73, 0xffff0000, v112
    v_lshlrev_b32 v74, 16, v113
    v_and_b32 v75, 0xffff0000, v113
    v_lshlrev_b32 v76, 16, v114
    v_and_b32 v77, 0xffff0000, v114
    v_lshlrev_b32 v78, 16, v115
    v_and_b32 v79, 0xffff0000, v115
    v_fmac_f32 v40, v58, v72
    v_fmac_f32 v41, v58, v73
    v_fmac_f32 v42, v58, v74
    v_fmac_f32 v43, v58, v75
    v_fmac_f32 v44, v58, v76
    v_fmac_f32 v45, v58, v77
    v_fmac_f32 v46, v58, v78
    v_fmac_f32 v47, v58, v79
    s_waitcnt vmcnt(13)
    v_lshlrev_b32 v72, 16, v116
    v_and_b32 v73, 0xffff0000, v116
    v_lshlrev_b32 v74, 16, v117
    v_and_b32 v75, 0xffff0000, v117
    v_lshlrev_b32 v76, 16, v118
    v_and_b32 v77, 0xffff0000, v118
    v_lshlrev_b32 v78, 16, v119
    v_and_b32 v79, 0xffff0000, v119
    v_fmac_f32 v40, v59, v72
    v_fmac_f32 v41, v59, v73
    v_fmac_f32 v42, v59, v74
    v_fmac_f32 v43, v59, v75
    v_fmac_f32 v44, v59, v76
    v_fmac_f32 v45, v59, v77
    v_fmac_f32 v46, v59, v78
    v_fmac_f32 v47, v59, v79
    s_waitcnt vmcnt(12)
    v_lshlrev_b32 v72, 16, v120
    v_and_b32 v73, 0xffff0000, v120
    v_lshlrev_b32 v74, 16, v121
    v_and_b32 v75, 0xffff0000, v121
    v_lshlrev_b32 v76, 16, v122
    v_and_b32 v77, 0xffff0000, v122
    v_lshlrev_b32 v78, 16, v123
    v_and_b32 v79, 0xffff0000, v123
    v_fmac_f32 v40, v60, v72
    v_fmac_f32 v41, v60, v73
    v_fmac_f32 v42, v60, v74
    v_fmac_f32 v43, v60, v75
    v_fmac_f32 v44, v60, v76
    v_fmac_f32 v45, v60, v77
    v_fmac_f32 v46, v60, v78
    v_fmac_f32 v47, v60, v79
    s_waitcnt vmcnt(11)
    v_lshlrev_b32 v72, 16, v124
    v_and_b32 v73, 0xffff0000, v124
    v_lshlrev_b32 v74, 16, v125
    v_and_b32 v75, 0xffff0000, v125
    v_lshlrev_b32 v76, 16, v126
    v_and_b32 v77, 0xffff0000, v126
    v_lshlrev_b32 v78, 16, v127
    v_and_b32 v79, 0xffff0000, v127
    v_fmac_f32 v40, v61, v72
    v_fmac_f32 v41, v61, v73
    v_fmac_f32 v42, v61, v74
    v_fmac_f32 v43, v61, v75
    v_fmac_f32 v44, v61, v76
    v_fmac_f32 v45, v61, v77
    v_fmac_f32 v46, v61, v78
    v_fmac_f32 v47, v61, v79
    s_waitcnt vmcnt(10)
    v_lshlrev_b32 v72, 16, v128
    v_and_b32 v73, 0xffff0000, v128
    v_lshlrev_b32 v74, 16, v129
    v_and_b32 v75, 0xffff0000, v129
    v_lshlrev_b32 v76, 16, v130
    v_and_b32 v77, 0xffff0000, v130
    v_lshlrev_b32 v78, 16, v131
    v_and_b32 v79, 0xffff0000, v131
    v_fmac_f32 v40, v62, v72
    v_fmac_f32 v41, v62, v73
    v_fmac_f32 v42, v62, v74
    v_fmac_f32 v43, v62, v75
    v_fmac_f32 v44, v62, v76
    v_fmac_f32 v45, v62, v77
    v_fmac_f32 v46, v62, v78
    v_fmac_f32 v47, v62, v79
    s_waitcnt vmcnt(9)
    v_lshlrev_b32 v72, 16, v132
    v_and_b32 v73, 0xffff0000, v132
    v_lshlrev_b32 v74, 16, v133
    v_and_b32 v75, 0xffff0000, v133
    v_lshlrev_b32 v76, 16, v134
    v_and_b32 v77, 0xffff0000, v134
    v_lshlrev_b32 v78, 16, v135
    v_and_b32 v79, 0xffff0000, v135
    v_fmac_f32 v40, v63, v72
    v_fmac_f32 v41, v63, v73
    v_fmac_f32 v42, v63, v74
    v_fmac_f32 v43, v63, v75
    v_fmac_f32 v44, v63, v76
    v_fmac_f32 v45, v63, v77
    v_fmac_f32 v46, v63, v78
    v_fmac_f32 v47, v63, v79
    s_waitcnt vmcnt(8)
    v_lshlrev_b32 v72, 16, v136
    v_and_b32 v73, 0xffff0000, v136
    v_lshlrev_b32 v74, 16, v137
    v_and_b32 v75, 0xffff0000, v137
    v_lshlrev_b32 v76, 16, v138
    v_and_b32 v77, 0xffff0000, v138
    v_lshlrev_b32 v78, 16, v139
    v_and_b32 v79, 0xffff0000, v139
    v_fmac_f32 v40, v64, v72
    v_fmac_f32 v41, v64, v73
    v_fmac_f32 v42, v64, v74
    v_fmac_f32 v43, v64, v75
    v_fmac_f32 v44, v64, v76
    v_fmac_f32 v45, v64, v77
    v_fmac_f32 v46, v64, v78
    v_fmac_f32 v47, v64, v79
    s_waitcnt vmcnt(7)
    v_lshlrev_b32 v72, 16, v140
    v_and_b32 v73, 0xffff0000, v140
    v_lshlrev_b32 v74, 16, v141
    v_and_b32 v75, 0xffff0000, v141
    v_lshlrev_b32 v76, 16, v142
    v_and_b32 v77, 0xffff0000, v142
    v_lshlrev_b32 v78, 16, v143
    v_and_b32 v79, 0xffff0000, v143
    v_fmac_f32 v40, v65, v72
    v_fmac_f32 v41, v65, v73
    v_fmac_f32 v42, v65, v74
    v_fmac_f32 v43, v65, v75
    v_fmac_f32 v44, v65, v76
    v_fmac_f32 v45, v65, v77
    v_fmac_f32 v46, v65, v78
    v_fmac_f32 v47, v65, v79
    s_waitcnt vmcnt(6)
    v_lshlrev_b32 v72, 16, v144
    v_and_b32 v73, 0xffff0000, v144
    v_lshlrev_b32 v74, 16, v145
    v_and_b32 v75, 0xffff0000, v145
    v_lshlrev_b32 v76, 16, v146
    v_and_b32 v77, 0xffff0000, v146
    v_lshlrev_b32 v78, 16, v147
    v_and_b32 v79, 0xffff0000, v147
    v_fmac_f32 v40, v66, v72
    v_fmac_f32 v41, v66, v73
    v_fmac_f32 v42, v66, v74
    v_fmac_f32 v43, v66, v75
    v_fmac_f32 v44, v66, v76
    v_fmac_f32 v45, v66, v77
    v_fmac_f32 v46, v66, v78
    v_fmac_f32 v47, v66, v79
    s_waitcnt vmcnt(5)
    v_lshlrev_b32 v72, 16, v148
    v_and_b32 v73, 0xffff0000, v148
    v_lshlrev_b32 v74, 16, v149
    v_and_b32 v75, 0xffff0000, v149
    v_lshlrev_b32 v76, 16, v150
    v_and_b32 v77, 0xffff0000, v150
    v_lshlrev_b32 v78, 16, v151
    v_and_b32 v79, 0xffff0000, v151
    v_fmac_f32 v40, v67, v72
    v_fmac_f32 v41, v67, v73
    v_fmac_f32 v42, v67, v74
    v_fmac_f32 v43, v67, v75
    v_fmac_f32 v44, v67, v76
    v_fmac_f32 v45, v67, v77
    v_fmac_f32 v46, v67, v78
    v_fmac_f32 v47, v67, v79
    s_waitcnt vmcnt(4)
    v_lshlrev_b32 v72, 16, v152
    v_and_b32 v73, 0xffff0000, v152
    v_lshlrev_b32 v74, 16, v153
    v_and_b32 v75, 0xffff0000, v153
    v_lshlrev_b32 v76, 16, v154
    v_and_b32 v77, 0xffff0000, v154
    v_lshlrev_b32 v78, 16, v155
    v_and_b32 v79, 0xffff0000, v155
    v_fmac_f32 v40, v68, v72
    v_fmac_f32 v41, v68, v73
    v_fmac_f32 v42, v68, v74
    v_fmac_f32 v43, v68, v75
    v_fmac_f32 v44, v68, v76
    v_fmac_f32 v45, v68, v77
    v_fmac_f32 v46, v68, v78
    v_fmac_f32 v47, v68, v79
    s_waitcnt vmcnt(3)
    v_lshlrev_b32 v72, 16, v156
    v_and_b32 v73, 0xffff0000, v156
    v_lshlrev_b32 v74, 16, v157
    v_and_b32 v75, 0xffff0000, v157
    v_lshlrev_b32 v76, 16, v158
    v_and_b32 v77, 0xffff0000, v158
    v_lshlrev_b32 v78, 16, v159
    v_and_b32 v79, 0xffff0000, v159
    v_fmac_f32 v40, v69, v72
    v_fmac_f32 v41, v69, v73
    v_fmac_f32 v42, v69, v74
    v_fmac_f32 v43, v69, v75
    v_fmac_f32 v44, v69, v76
    v_fmac_f32 v45, v69, v77
    v_fmac_f32 v46, v69, v78
    v_fmac_f32 v47, v69, v79
    s_waitcnt vmcnt(2)
    v_lshlrev_b32 v72, 16, v160
    v_and_b32 v73, 0xffff0000, v160
    v_lshlrev_b32 v74, 16, v161
    v_and_b32 v75, 0xffff0000, v161
    v_lshlrev_b32 v76, 16, v162
    v_and_b32 v77, 0xffff0000, v162
    v_lshlrev_b32 v78, 16, v163
    v_and_b32 v79, 0xffff0000, v163
    v_fmac_f32 v40, v70, v72
    v_fmac_f32 v41, v70, v73
    v_fmac_f32 v42, v70, v74
    v_fmac_f32 v43, v70, v75
    v_fmac_f32 v44, v70, v76
    v_fmac_f32 v45, v70, v77
    v_fmac_f32 v46, v70, v78
    v_fmac_f32 v47, v70, v79
    s_waitcnt vmcnt(1)
    v_lshlrev_b32 v72, 16, v164
    v_and_b32 v73, 0xffff0000, v164
    v_lshlrev_b32 v74, 16, v165
    v_and_b32 v75, 0xffff0000, v165
    v_lshlrev_b32 v76, 16, v166
    v_and_b32 v77, 0xffff0000, v166
    v_lshlrev_b32 v78, 16, v167
    v_and_b32 v79, 0xffff0000, v167
    v_fmac_f32 v40, v71, v72
    v_fmac_f32 v41, v71, v73
    v_fmac_f32 v42, v71, v74
    v_fmac_f32 v43, v71, v75
    v_fmac_f32 v44, v71, v76
    v_fmac_f32 v45, v71, v77
    v_fmac_f32 v46, v71, v78
    v_fmac_f32 v47, v71, v79
    s_nop 1
    v_add_f32_dpp v40, v40, v40 row_ror:8 row_mask:0xf bank_mask:0xf
    v_add_f32_dpp v41, v41, v41 row_ror:8 row_mask:0xf bank_mask:0xf
    v_add_f32_dpp v42, v42, v42 row_ror:8 row_mask:0xf bank_mask:0xf
    v_add_f32_dpp v43, v43, v43 row_ror:8 row_mask:0xf bank_mask:0xf
    v_add_f32_dpp v44, v44, v44 row_ror:8 row_mask:0xf bank_mask:0xf
    v_add_f32_dpp v45, v45, v45 row_ror:8 row_mask:0xf bank_mask:0xf
    v_add_f32_dpp v46, v46, v46 row_ror:8 row_mask:0xf bank_mask:0xf
    v_add_f32_dpp v47, v47, v47 row_ror:8 row_mask:0xf bank_mask:0xf
    s_nop 1
    v_mov_b32 v48, v40
    v_mov_b32 v49, v41
    v_mov_b32 v50, v42
    v_mov_b32 v51, v43
    v_mov_b32 v52, v44
    v_mov_b32 v53, v45
    v_mov_b32 v54, v46
    v_mov_b32 v55, v47
    v_permlane16_swap_b32 v48, v40
    v_permlane16_swap_b32 v49, v41
    v_permlane16_swap_b32 v50, v42
    v_permlane16_swap_b32 v51, v43
    v_permlane16_swap_b32 v52, v44
    v_permlane16_swap_b32 v53, v45
    v_permlane16_swap_b32 v54, v46
    v_permlane16_swap_b32 v55, v47
    v_add_f32 v40, v40, v48
    v_add_f32 v41, v41, v49
    v_add_f32 v42, v42, v50
    v_add_f32 v43, v43, v51
    v_add_f32 v44, v44, v52
    v_add_f32 v45, v45, v53
    v_add_f32 v46, v46, v54
    v_add_f32 v47, v47, v55
    v_mov_b32 v48, v40
    v_mov_b32 v49, v41
    v_mov_b32 v50, v42
    v_mov_b32 v51, v43
    v_mov_b32 v52, v44
    v_mov_b32 v53, v45
    v_mov_b32 v54, v46
    v_mov_b32 v55, v47
    v_permlane32_swap_b32 v48, v40
    v_permlane32_swap_b32 v49, v41
    v_permlane32_swap_b32 v50, v42
    v_permlane32_swap_b32 v51, v43
    v_permlane32_swap_b32 v52, v44
    v_permlane32_swap_b32 v53, v45
    v_permlane32_swap_b32 v54, v46
    v_permlane32_swap_b32 v55, v47
    v_add_f32 v40, v40, v48
    v_add_f32 v41, v41, v49
    v_add_f32 v42, v42, v50
    v_add_f32 v43, v43, v51
    v_add_f32 v44, v44, v52
    v_add_f32 v45, v45, v53
    v_add_f32 v46, v46, v54
    v_add_f32 v47, v47, v55
    s_waitcnt vmcnt(0)
    v_readfirstlane_b32 s79, v35
    s_mul_i32 s79, s79, 0x9E3779B1
    s_add_u32 s79, s79, 0x7F4A7C15
    s_cmp_lt_u32 s2, 64
    s_cbranch_scc0 F_MOD1
    s_mov_b32 exec_lo, 65280
    s_mov_b32 exec_hi, 0
    v_mov_b32 v40, v42
    v_mov_b32 v41, v43
    s_mov_b32 exec_lo, 16711680
    s_mov_b32 exec_hi, 0
    v_mov_b32 v40, v44
    v_mov_b32 v41, v45
    s_mov_b32 exec_lo, 4278190080
    s_mov_b32 exec_hi, 0
    v_mov_b32 v40, v46
    v_mov_b32 v41, v47
    s_mov_b64 exec, -1
    v_mov_b32 v42, v41
    v_mov_b32 v41, s79
    v_mov_b32 v43, s79
    v_lshlrev_b32 v39, 1, v39
    v_lshrrev_b32 v6, 3, v1
    v_lshl_add_u32 v39, v6, 4, v39
    s_lshr_b32 s88, s2, 4
    s_lshl_b32 s88, s88, 13
    s_and_b32 s89, s2, 15
    s_lshl_b32 s89, s89, 9
    s_add_u32 s88, s88, s89
    s_add_u32 s88, s88, 196608
    s_mov_b32 exec_hi, 0
    buffer_store_dwordx4 v[40:43], v39, s[44:47], s88 offen sc1
    s_mov_b64 exec, -1
    s_branch F_MOD2
F_MOD1:
    s_cmp_lt_u32 s2, 192
    s_cbranch_scc0 F_MOD2
    s_mov_b64 exec, 0xff00
    v_mov_b32 v40, v44
    v_mov_b32 v41, v45
    v_mov_b32 v42, v46
    v_mov_b32 v43, v47
    v_add_u32 v39, 16, v39
    s_mov_b64 exec, 0xffff
    buffer_store_dwordx4 v[40:43], v39, s[44:47], s3 offen sc1
    v_mov_b32 v5, 0
    v_mov_b32 v6, s79
    s_lshl_b32 s88, s2, 2
    s_add_u32 s88, s88, 28416
    s_waitcnt vmcnt(0)
    s_mov_b64 exec, 1
    buffer_store_dword v6, v5, s[44:47], s88 offen sc1
    s_mov_b64 exec, -1
F_MOD2:
    v_add_u32 v5, 0, v4
    v_xor_b32 v5, v5, v3
    v_lshlrev_b32 v5, 4, v5
    v_lshl_add_u32 v8, v3, 8, v5
    v_add_u32 v5, 4, v4
    v_xor_b32 v5, v5, v3
    v_lshlrev_b32 v5, 4, v5
    v_lshl_add_u32 v9, v3, 8, v5
    v_add_u32 v5, 8, v4
    v_xor_b32 v5, v5, v3
    v_lshlrev_b32 v5, 4, v5
    v_lshl_add_u32 v10, v3, 8, v5
    v_add_u32 v5, 12, v4
    v_xor_b32 v5, v5, v3
    v_lshlrev_b32 v5, 4, v5
    v_lshl_add_u32 v11, v3, 8, v5
    v_lshrrev_b32 v6, 2, v3
    v_lshl_add_u32 v7, v4, 2, v6
    v_and_b32 v36, 7, v7
    v_lshlrev_b32 v36, 1, v36
    v_bfe_u32 v37, v3, 1, 1
    v_and_b32 v38, 1, v3
    v_lshlrev_b32 v38, 3, v38
    v_lshl_add_u32 v38, v7, 8, v38
    v_add_u32 v38, 65536, v38
    v_add_u32 v5, 0, v37
    v_xor_b32 v5, v5, v36
    v_lshl_add_u32 v12, v5, 4, v38
    v_add_u32 v5, 2, v37
    v_xor_b32 v5, v5, v36
    v_lshl_add_u32 v13, v5, 4, v38
    v_add_u32 v5, 4, v37
    v_xor_b32 v5, v5, v36
    v_lshl_add_u32 v14, v5, 4, v38
    v_add_u32 v5, 6, v37
    v_xor_b32 v5, v5, v36
    v_lshl_add_u32 v15, v5, 4, v38
    v_add_u32 v5, 8, v37
    v_xor_b32 v5, v5, v36
    v_lshl_add_u32 v16, v5, 4, v38
    v_add_u32 v5, 10, v37
    v_xor_b32 v5, v5, v36
    v_lshl_add_u32 v17, v5, 4, v38
    v_add_u32 v5, 12, v37
    v_xor_b32 v5, v5, v36
    v_lshl_add_u32 v18, v5, 4, v38
    v_add_u32 v5, 14, v37
    v_xor_b32 v5, v5, v36
    v_lshl_add_u32 v19, v5, 4, v38
    v_lshl_add_u32 v7, v2, 3, v4
    v_add_u32 v5, 0, v7
    v_and_b32 v5, 15, v5
    v_xor_b32 v5, v5, v3
    v_lshlrev_b32 v5, 4, v5
    v_lshl_add_u32 v20, v7, 8, v5
    v_add_u32 v5, 0, v4
    v_lshlrev_b32 v5, 1, v5
    v_xor_b32 v5, v5, v3
    v_lshlrev_b32 v5, 4, v5
    v_lshl_add_u32 v22, v7, 8, v5
    v_add_u32 v5, 4, v7
    v_and_b32 v5, 15, v5
    v_xor_b32 v5, v5, v3
    v_lshlrev_b32 v5, 4, v5
    v_lshl_add_u32 v21, v7, 8, v5
    v_add_u32 v5, 4, v4
    v_lshlrev_b32 v5, 1, v5
    v_xor_b32 v5, v5, v3
    v_lshlrev_b32 v5, 4, v5
    v_lshl_add_u32 v23, v7, 8, v5
    v_lshl_add_u32 v7, v4, 3, v6
    v_and_b32 v36, 3, v3
    v_xor_b32 v5, 0, v6
    v_lshl_add_u32 v5, v5, 2, v36
    v_lshlrev_b32 v5, 4, v5
    v_lshl_add_u32 v24, v7, 8, v5
    v_add_u32 v28, 0x10000, v24
    v_xor_b32 v5, 1, v6
    v_lshl_add_u32 v5, v5, 2, v36
    v_lshlrev_b32 v5, 4, v5
    v_lshl_add_u32 v25, v7, 8, v5
    v_add_u32 v29, 0x10000, v25
    v_xor_b32 v5, 2, v6
    v_lshl_add_u32 v5, v5, 2, v36
    v_lshlrev_b32 v5, 4, v5
    v_lshl_add_u32 v26, v7, 8, v5
    v_add_u32 v30, 0x10000, v26
    v_xor_b32 v5, 3, v6
    v_lshl_add_u32 v5, v5, 2, v36
    v_lshlrev_b32 v5, 4, v5
    v_lshl_add_u32 v27, v7, 8, v5
    v_add_u32 v31, 0x10000, v27
    v_lshlrev_b32 v34, 6, v4
    v_add_u32 v34, 131072, v34
    v_lshlrev_b32 v5, 2, v4
    v_xor_b32 v5, v3, v5
    v_lshlrev_b32 v5, 4, v5
    v_lshl_add_u32 v32, v4, 13, v5
    v_mov_b32 v5, 0x3f803f80
    v_accvgpr_write_b32 a252, v5
    v_accvgpr_write_b32 a253, v5
    v_accvgpr_write_b32 a254, v5
    v_accvgpr_write_b32 a255, v5
    s_branch F_SYNC
F_WQ:
    s_getpc_b64 s[56:57]
F_PC:
    s_sub_u32 s56, s56, F_PC-adaLN_cond__mha_block_cached__moe_arch_mod__prompt_kernel
    s_subb_u32 s57, s57, 0
    s_mov_b32 s58, F_CODE_END-adaLN_cond__mha_block_cached__moe_arch_mod__prompt_kernel
    s_mov_b32 s59, 0x20000
    s_lshr_b32 s89, s2, 3
    s_mul_i32 s89, s89, 3072
    buffer_load_dwordx4 v[108:111], v33, s[56:59], s89 offen offset:0
    buffer_load_dwordx4 v[112:115], v33, s[56:59], s89 offen offset:1024
    buffer_load_dwordx4 v[116:119], v33, s[56:59], s89 offen offset:2048
    v_lshlrev_b32 v5, 2, v4
    v_xor_b32 v5, v3, v5
    v_lshlrev_b32 v5, 4, v5
    v_lshl_add_u32 v32, v4, 13, v5
    s_lshl_b32 s88, s77, 8
    s_waitcnt lgkmcnt(0)
    s_mov_b32 s44, s30
    s_mov_b32 s45, s31
    s_mov_b32 s46, 33554432
    s_mov_b32 s47, 0x20000
    buffer_load_dword v35, off, s[44:47], 0 offset:0 sc1
    s_mov_b32 s40, s10
    s_mov_b32 s41, s11
    s_mov_b32 s42, 4194304
    s_mov_b32 s43, 0x20000
    s_lshl_b32 s89, s78, 19
    s_add_u32 s89, s89, s88
    buffer_load_dwordx4 v[40:43], v32, s[40:43], s89 offen
    s_add_u32 s89, s89, 32768
    buffer_load_dwordx4 v[44:47], v32, s[40:43], s89 offen
    s_add_u32 s89, s89, 32768
    buffer_load_dwordx4 v[48:51], v32, s[40:43], s89 offen
    s_add_u32 s89, s89, 32768
    buffer_load_dwordx4 v[52:55], v32, s[40:43], s89 offen
    s_add_u32 s89, s89, 32768
    buffer_load_dwordx4 v[56:59], v32, s[40:43], s89 offen
    s_add_u32 s89, s89, 32768
    buffer_load_dwordx4 v[60:63], v32, s[40:43], s89 offen
    s_add_u32 s89, s89, 32768
    buffer_load_dwordx4 v[64:67], v32, s[40:43], s89 offen
    s_add_u32 s89, s89, 32768
    buffer_load_dwordx4 v[68:71], v32, s[40:43], s89 offen
    s_add_u32 s89, s89, 32768
    buffer_load_dwordx4 v[72:75], v32, s[40:43], s89 offen
    s_add_u32 s89, s89, 32768
    buffer_load_dwordx4 v[76:79], v32, s[40:43], s89 offen
    s_add_u32 s89, s89, 32768
    buffer_load_dwordx4 v[80:83], v32, s[40:43], s89 offen
    s_add_u32 s89, s89, 32768
    buffer_load_dwordx4 v[84:87], v32, s[40:43], s89 offen
    s_add_u32 s89, s89, 32768
    buffer_load_dwordx4 v[88:91], v32, s[40:43], s89 offen
    s_add_u32 s89, s89, 32768
    buffer_load_dwordx4 v[92:95], v32, s[40:43], s89 offen
    s_add_u32 s89, s89, 32768
    buffer_load_dwordx4 v[96:99], v32, s[40:43], s89 offen
    s_add_u32 s89, s89, 32768
    buffer_load_dwordx4 v[100:103], v32, s[40:43], s89 offen
    s_mov_b32 s3, s88
    s_mov_b32 s48, s4
    s_mov_b32 s49, s5
    s_mov_b32 s50, 2097152
    s_mov_b32 s51, 0x20000
    s_mov_b32 s40, s10
    s_mov_b32 s41, s11
    s_mov_b32 s42, 4194304
    s_mov_b32 s43, 0x20000
    s_lshl_b32 s88, s77, 19
    s_add_u32 s32, s6, s88
    s_addc_u32 s33, s7, 0
    s_mov_b32 s34, 524288
    s_mov_b32 s35, 0x20000
    s_add_u32 s36, s8, s88
    s_addc_u32 s37, s9, 0
    s_mov_b32 s38, 524288
    s_mov_b32 s39, 0x20000
    s_bfe_u32 s89, s2, 0x20001
    s_lshl_b32 s88, s89, 20
    s_add_u32 s52, s12, s88
    s_addc_u32 s53, s13, 0
    s_mov_b32 s54, 1048576
    s_mov_b32 s55, 0x20000
    s_lshr_b32 s86, s2, 3
    s_lshl_b32 s86, s86, 15
    s_lshl_b32 s88, s76, 13
    s_add_u32 s86, s86, s88
    s_mul_i32 s87, s2, 7168
    s_cmp_eq_u32 s76, 0
    s_cselect_b32 s56, s18, s20
    s_cselect_b32 s57, s19, s21
    s_cmp_eq_u32 s76, 2
    s_cselect_b32 s56, s22, s56
    s_cselect_b32 s57, s23, s57
    s_cmp_eq_u32 s76, 3
    s_cselect_b32 s58, 0, 1835008
    s_mov_b32 s59, 0x20000
    s_cmp_lt_u32 s2, 112
    s_cselect_b32 s88, 1835008, 0
    s_mov_b32 s68, s18
    s_mov_b32 s69, s19
    s_mov_b32 s70, s88
    s_mov_b32 s71, 0x20000
    s_mov_b32 s72, s20
    s_mov_b32 s73, s21
    s_mov_b32 s74, s88
    s_mov_b32 s75, 0x20000
    s_mov_b32 s20, s22
    s_mov_b32 s21, s23
    s_mov_b32 s22, s88
    s_mov_b32 s23, 0x20000
    s_mov_b32 s60, s28
    s_mov_b32 s61, s29
    s_mov_b32 s62, 2097152
    s_mov_b32 s63, 0x20000
    s_mov_b32 s64, s16
    s_mov_b32 s65, s17
    s_mov_b32 s66, 1024
    s_mov_b32 s67, 0x20000
    s_mov_b32 s80, 0
    s_mov_b32 s81, 0
    s_lshl_b32 s82, s76, 11
    s_mov_b32 s4, s89
    s_and_b32 s5, s2, 1
    s_lshl_b32 s5, s5, 3
    s_lshr_b32 s88, s2, 5
    s_add_u32 s5, s5, s88
    s_bfe_u32 s6, s2, 0x20003
    s_lshl_b32 s10, s76, 12
    s_lshl_b32 s85, s6, 8
    s_lshl_b32 s83, s78, 4
    s_lshl_b32 s88, s76, 2
    s_add_u32 s83, s83, s88
    s_lshl_b32 s83, s83, 10
    s_lshl_b32 s11, s77, 19
    s_add_u32 s11, s11, s83
    s_add_u32 s11, s11, 8388608
    s_add_u32 s83, s83, 1048576
    s_lshl_b32 s7, s4, 2
    s_add_u32 s7, s7, s6
    s_lshl_b32 s8, s5, 4
    s_add_u32 s8, s8, s7
    s_lshl_b32 s9, s8, 13
    s_and_b32 s14, s2, 7
    s_mul_i32 s14, s14, 14
    s_lshr_b32 s88, s2, 3
    s_add_u32 s14, s14, s88
    s_lshl_b32 s12, s14, 5
    s_add_u32 s13, s12, 7168
    s_lshl_b32 s15, s14, 14
    s_add_u32 s15, s15, s10
    v_add_u32 v5, 0, v4
    v_xor_b32 v5, v5, v3
    v_lshlrev_b32 v5, 4, v5
    v_lshl_add_u32 v8, v3, 8, v5
    v_add_u32 v5, 4, v4
    v_xor_b32 v5, v5, v3
    v_lshlrev_b32 v5, 4, v5
    v_lshl_add_u32 v9, v3, 8, v5
    v_add_u32 v5, 8, v4
    v_xor_b32 v5, v5, v3
    v_lshlrev_b32 v5, 4, v5
    v_lshl_add_u32 v10, v3, 8, v5
    v_add_u32 v5, 12, v4
    v_xor_b32 v5, v5, v3
    v_lshlrev_b32 v5, 4, v5
    v_lshl_add_u32 v11, v3, 8, v5
    v_lshrrev_b32 v6, 2, v3
    v_lshl_add_u32 v7, v4, 2, v6
    v_and_b32 v36, 7, v7
    v_lshlrev_b32 v36, 1, v36
    v_bfe_u32 v37, v3, 1, 1
    v_and_b32 v38, 1, v3
    v_lshlrev_b32 v38, 3, v38
    v_lshl_add_u32 v38, v7, 8, v38
    v_add_u32 v38, 65536, v38
    v_add_u32 v5, 0, v37
    v_xor_b32 v5, v5, v36
    v_lshl_add_u32 v12, v5, 4, v38
    v_add_u32 v5, 2, v37
    v_xor_b32 v5, v5, v36
    v_lshl_add_u32 v13, v5, 4, v38
    v_add_u32 v5, 4, v37
    v_xor_b32 v5, v5, v36
    v_lshl_add_u32 v14, v5, 4, v38
    v_add_u32 v5, 6, v37
    v_xor_b32 v5, v5, v36
    v_lshl_add_u32 v15, v5, 4, v38
    v_add_u32 v5, 8, v37
    v_xor_b32 v5, v5, v36
    v_lshl_add_u32 v16, v5, 4, v38
    v_add_u32 v5, 10, v37
    v_xor_b32 v5, v5, v36
    v_lshl_add_u32 v17, v5, 4, v38
    v_add_u32 v5, 12, v37
    v_xor_b32 v5, v5, v36
    v_lshl_add_u32 v18, v5, 4, v38
    v_add_u32 v5, 14, v37
    v_xor_b32 v5, v5, v36
    v_lshl_add_u32 v19, v5, 4, v38
    v_lshl_add_u32 v7, v2, 3, v4
    v_add_u32 v5, 0, v7
    v_and_b32 v5, 15, v5
    v_xor_b32 v5, v5, v3
    v_lshlrev_b32 v5, 4, v5
    v_lshl_add_u32 v20, v7, 8, v5
    v_add_u32 v5, 0, v4
    v_lshlrev_b32 v5, 1, v5
    v_xor_b32 v5, v5, v3
    v_lshlrev_b32 v5, 4, v5
    v_lshl_add_u32 v22, v7, 8, v5
    v_add_u32 v5, 4, v7
    v_and_b32 v5, 15, v5
    v_xor_b32 v5, v5, v3
    v_lshlrev_b32 v5, 4, v5
    v_lshl_add_u32 v21, v7, 8, v5
    v_add_u32 v5, 4, v4
    v_lshlrev_b32 v5, 1, v5
    v_xor_b32 v5, v5, v3
    v_lshlrev_b32 v5, 4, v5
    v_lshl_add_u32 v23, v7, 8, v5
    v_lshl_add_u32 v7, v4, 3, v6
    v_and_b32 v36, 3, v3
    v_xor_b32 v5, 0, v6
    v_lshl_add_u32 v5, v5, 2, v36
    v_lshlrev_b32 v5, 4, v5
    v_lshl_add_u32 v24, v7, 8, v5
    v_add_u32 v28, 0x10000, v24
    v_xor_b32 v5, 1, v6
    v_lshl_add_u32 v5, v5, 2, v36
    v_lshlrev_b32 v5, 4, v5
    v_lshl_add_u32 v25, v7, 8, v5
    v_add_u32 v29, 0x10000, v25
    v_xor_b32 v5, 2, v6
    v_lshl_add_u32 v5, v5, 2, v36
    v_lshlrev_b32 v5, 4, v5
    v_lshl_add_u32 v26, v7, 8, v5
    v_add_u32 v30, 0x10000, v26
    v_xor_b32 v5, 3, v6
    v_lshl_add_u32 v5, v5, 2, v36
    v_lshlrev_b32 v5, 4, v5
    v_lshl_add_u32 v27, v7, 8, v5
    v_add_u32 v31, 0x10000, v27
    v_lshlrev_b32 v34, 6, v4
    v_add_u32 v34, 131072, v34
    v_lshlrev_b32 v5, 2, v4
    v_xor_b32 v5, v3, v5
    v_lshlrev_b32 v5, 4, v5
    v_lshl_add_u32 v32, v4, 13, v5
    v_mov_b32 v5, 0x3f803f80
    v_accvgpr_write_b32 a252, v5
    v_accvgpr_write_b32 a253, v5
    v_accvgpr_write_b32 a254, v5
    v_accvgpr_write_b32 a255, v5
    s_waitcnt vmcnt(0)
    v_readfirstlane_b32 s79, v35
    s_mul_i32 s79, s79, 0x9E3779B1
    s_add_u32 s79, s79, 0x7F4A7C15
    s_mov_b32 m0, 0
    s_nop 0
    buffer_load_dwordx4 v32, s[40:43], s3 offen lds
    s_mov_b32 m0, 1024
    s_add_u32 s3, s3, 32768
    buffer_load_dwordx4 v32, s[40:43], s3 offen lds
    s_mov_b32 m0, 2048
    s_add_u32 s3, s3, 32768
    buffer_load_dwordx4 v32, s[40:43], s3 offen lds
    s_mov_b32 m0, 3072
    s_add_u32 s3, s3, 32768
    buffer_load_dwordx4 v32, s[40:43], s3 offen lds
    s_waitcnt vmcnt(24)
    s_mov_b32 m0, 4096
    s_add_u32 s3, s3, 32768
    buffer_load_dwordx4 v32, s[40:43], s3 offen lds
    s_mov_b32 m0, 5120
    s_add_u32 s3, s3, 32768
    buffer_load_dwordx4 v32, s[40:43], s3 offen lds
    s_mov_b32 m0, 6144
    s_add_u32 s3, s3, 32768
    buffer_load_dwordx4 v32, s[40:43], s3 offen lds
    s_mov_b32 m0, 7168
    s_add_u32 s3, s3, 32768
    buffer_load_dwordx4 v32, s[40:43], s3 offen lds
    s_waitcnt vmcnt(24)
    s_mov_b32 m0, 8192
    s_add_u32 s3, s3, 32768
    buffer_load_dwordx4 v32, s[40:43], s3 offen lds
    s_mov_b32 m0, 9216
    s_add_u32 s3, s3, 32768
    buffer_load_dwordx4 v32, s[40:43], s3 offen lds
    s_mov_b32 m0, 10240
    s_add_u32 s3, s3, 32768
    buffer_load_dwordx4 v32, s[40:43], s3 offen lds
    s_mov_b32 m0, 11264
    s_add_u32 s3, s3, 32768
    buffer_load_dwordx4 v32, s[40:43], s3 offen lds
    s_waitcnt vmcnt(24)
    s_mov_b32 m0, 12288
    s_add_u32 s3, s3, 32768
    buffer_load_dwordx4 v32, s[40:43], s3 offen lds
    s_mov_b32 m0, 13312
    s_add_u32 s3, s3, 32768
    buffer_load_dwordx4 v32, s[40:43], s3 offen lds
    s_mov_b32 m0, 14336
    s_add_u32 s3, s3, 32768
    buffer_load_dwordx4 v32, s[40:43], s3 offen lds
    s_mov_b32 m0, 15360
    s_add_u32 s3, s3, 32768
    buffer_load_dwordx4 v32, s[40:43], s3 offen lds
    s_waitcnt vmcnt(24)
    s_mov_b32 m0, 16384
    s_add_u32 s3, s3, 32768
    buffer_load_dwordx4 v32, s[40:43], s3 offen lds
    s_mov_b32 m0, 17408
    s_add_u32 s3, s3, 32768
    buffer_load_dwordx4 v32, s[40:43], s3 offen lds
    s_mov_b32 m0, 18432
    s_add_u32 s3, s3, 32768
    buffer_load_dwordx4 v32, s[40:43], s3 offen lds
    s_mov_b32 m0, 19456
    s_add_u32 s3, s3, 32768
    buffer_load_dwordx4 v32, s[40:43], s3 offen lds
    s_waitcnt vmcnt(24)
    s_mov_b32 m0, 20480
    s_add_u32 s3, s3, 32768
    buffer_load_dwordx4 v32, s[40:43], s3 offen lds
    s_mov_b32 m0, 21504
    s_add_u32 s3, s3, 32768
    buffer_load_dwordx4 v32, s[40:43], s3 offen lds
    s_mov_b32 m0, 22528
    s_add_u32 s3, s3, 32768
    buffer_load_dwordx4 v32, s[40:43], s3 offen lds
    s_mov_b32 m0, 23552
    s_add_u32 s3, s3, 32768
    buffer_load_dwordx4 v32, s[40:43], s3 offen lds
    s_waitcnt vmcnt(24)
    s_mov_b32 m0, 24576
    s_add_u32 s3, s3, 32768
    buffer_load_dwordx4 v32, s[40:43], s3 offen lds
    s_mov_b32 m0, 25600
    s_add_u32 s3, s3, 32768
    buffer_load_dwordx4 v32, s[40:43], s3 offen lds
    s_mov_b32 m0, 26624
    s_add_u32 s3, s3, 32768
    buffer_load_dwordx4 v32, s[40:43], s3 offen lds
    s_mov_b32 m0, 27648
    s_add_u32 s3, s3, 32768
    buffer_load_dwordx4 v32, s[40:43], s3 offen lds
    s_waitcnt vmcnt(24)
    s_mov_b32 m0, 28672
    s_add_u32 s3, s3, 32768
    buffer_load_dwordx4 v32, s[40:43], s3 offen lds
    s_mov_b32 m0, 29696
    s_add_u32 s3, s3, 32768
    buffer_load_dwordx4 v32, s[40:43], s3 offen lds
    s_mov_b32 m0, 30720
    s_add_u32 s3, s3, 32768
    buffer_load_dwordx4 v32, s[40:43], s3 offen lds
    s_mov_b32 m0, 31744
    s_add_u32 s3, s3, 32768
    buffer_load_dwordx4 v32, s[40:43], s3 offen lds
    s_waitcnt vmcnt(24)
    s_mov_b32 m0, 65536
    s_add_u32 s3, s3, 32768
    buffer_load_dwordx4 v32, s[40:43], s3 offen lds
    s_mov_b32 m0, 66560
    s_add_u32 s3, s3, 32768
    buffer_load_dwordx4 v32, s[40:43], s3 offen lds
    s_mov_b32 m0, 67584
    s_add_u32 s3, s3, 32768
    buffer_load_dwordx4 v32, s[40:43], s3 offen lds
    s_mov_b32 m0, 68608
    s_add_u32 s3, s3, 32768
    buffer_load_dwordx4 v32, s[40:43], s3 offen lds
    s_waitcnt vmcnt(24)
    s_mov_b32 m0, 69632
    s_add_u32 s3, s3, 32768
    buffer_load_dwordx4 v32, s[40:43], s3 offen lds
    s_mov_b32 m0, 70656
    s_add_u32 s3, s3, 32768
    buffer_load_dwordx4 v32, s[40:43], s3 offen lds
    s_mov_b32 m0, 71680
    s_add_u32 s3, s3, 32768
    buffer_load_dwordx4 v32, s[40:43], s3 offen lds
    s_mov_b32 m0, 72704
    s_add_u32 s3, s3, 32768
    buffer_load_dwordx4 v32, s[40:43], s3 offen lds
    s_waitcnt vmcnt(24)
    s_mov_b32 m0, 73728
    s_add_u32 s3, s3, 32768
    buffer_load_dwordx4 v32, s[40:43], s3 offen lds
    s_mov_b32 m0, 74752
    s_add_u32 s3, s3, 32768
    buffer_load_dwordx4 v32, s[40:43], s3 offen lds
    s_mov_b32 m0, 75776
    s_add_u32 s3, s3, 32768
    buffer_load_dwordx4 v32, s[40:43], s3 offen lds
    s_mov_b32 m0, 76800
    s_add_u32 s3, s3, 32768
    buffer_load_dwordx4 v32, s[40:43], s3 offen lds
    s_waitcnt vmcnt(24)
    s_mov_b32 m0, 77824
    s_add_u32 s3, s3, 32768
    buffer_load_dwordx4 v32, s[40:43], s3 offen lds
    s_mov_b32 m0, 78848
    s_add_u32 s3, s3, 32768
    buffer_load_dwordx4 v32, s[40:43], s3 offen lds
    s_mov_b32 m0, 79872
    s_add_u32 s3, s3, 32768
    buffer_load_dwordx4 v32, s[40:43], s3 offen lds
    s_mov_b32 m0, 80896
    s_add_u32 s3, s3, 32768
    buffer_load_dwordx4 v32, s[40:43], s3 offen lds
    s_waitcnt vmcnt(24)
    s_mov_b32 m0, 32768
    s_add_u32 s3, s3, 32768
    buffer_load_dwordx4 v32, s[40:43], s3 offen lds
    s_mov_b32 m0, 33792
    s_add_u32 s3, s3, 32768
    buffer_load_dwordx4 v32, s[40:43], s3 offen lds
    s_mov_b32 m0, 34816
    s_add_u32 s3, s3, 32768
    buffer_load_dwordx4 v32, s[40:43], s3 offen lds
    s_mov_b32 m0, 35840
    s_add_u32 s3, s3, 32768
    buffer_load_dwordx4 v32, s[40:43], s3 offen lds
    s_waitcnt vmcnt(24)
    s_mov_b32 m0, 36864
    s_add_u32 s3, s3, 32768
    buffer_load_dwordx4 v32, s[40:43], s3 offen lds
    s_mov_b32 m0, 37888
    s_add_u32 s3, s3, 32768
    buffer_load_dwordx4 v32, s[40:43], s3 offen lds
    s_mov_b32 m0, 38912
    s_add_u32 s3, s3, 32768
    buffer_load_dwordx4 v32, s[40:43], s3 offen lds
    s_mov_b32 m0, 39936
    s_add_u32 s3, s3, 32768
    buffer_load_dwordx4 v32, s[40:43], s3 offen lds
    s_waitcnt vmcnt(24)
    s_mov_b32 m0, 40960
    s_add_u32 s3, s3, 32768
    buffer_load_dwordx4 v32, s[40:43], s3 offen lds
    s_mov_b32 m0, 41984
    s_add_u32 s3, s3, 32768
    buffer_load_dwordx4 v32, s[40:43], s3 offen lds
    s_mov_b32 m0, 43008
    s_add_u32 s3, s3, 32768
    buffer_load_dwordx4 v32, s[40:43], s3 offen lds
    s_mov_b32 m0, 44032
    s_add_u32 s3, s3, 32768
    buffer_load_dwordx4 v32, s[40:43], s3 offen lds
    s_waitcnt vmcnt(24)
    s_mov_b32 m0, 45056
    s_add_u32 s3, s3, 32768
    buffer_load_dwordx4 v32, s[40:43], s3 offen lds
    s_mov_b32 m0, 46080
    s_add_u32 s3, s3, 32768
    buffer_load_dwordx4 v32, s[40:43], s3 offen lds
    s_mov_b32 m0, 47104
    s_add_u32 s3, s3, 32768
    buffer_load_dwordx4 v32, s[40:43], s3 offen lds
    s_mov_b32 m0, 48128
    s_add_u32 s3, s3, 32768
    buffer_load_dwordx4 v32, s[40:43], s3 offen lds
    s_waitcnt vmcnt(24)
    s_mov_b32 m0, 81920
    s_add_u32 s3, s3, 32768
    buffer_load_dwordx4 v32, s[40:43], s3 offen lds
    s_mov_b32 m0, 82944
    s_add_u32 s3, s3, 32768
    buffer_load_dwordx4 v32, s[40:43], s3 offen lds
    s_mov_b32 m0, 83968
    s_add_u32 s3, s3, 32768
    buffer_load_dwordx4 v32, s[40:43], s3 offen lds
    s_mov_b32 m0, 84992
    s_add_u32 s3, s3, 32768
    buffer_load_dwordx4 v32, s[40:43], s3 offen lds
    s_waitcnt vmcnt(24)
    s_mov_b32 m0, 86016
    s_add_u32 s3, s3, 32768
    buffer_load_dwordx4 v32, s[40:43], s3 offen lds
    s_mov_b32 m0, 87040
    s_add_u32 s3, s3, 32768
    buffer_load_dwordx4 v32, s[40:43], s3 offen lds
    s_mov_b32 m0, 88064
    s_add_u32 s3, s3, 32768
    buffer_load_dwordx4 v32, s[40:43], s3 offen lds
    s_mov_b32 m0, 89088
    s_add_u32 s3, s3, 32768
    buffer_load_dwordx4 v32, s[40:43], s3 offen lds
    s_waitcnt vmcnt(24)
    s_mov_b32 m0, 90112
    s_add_u32 s3, s3, 32768
    buffer_load_dwordx4 v32, s[40:43], s3 offen lds
    s_mov_b32 m0, 91136
    s_add_u32 s3, s3, 32768
    buffer_load_dwordx4 v32, s[40:43], s3 offen lds
    s_mov_b32 m0, 92160
    s_add_u32 s3, s3, 32768
    buffer_load_dwordx4 v32, s[40:43], s3 offen lds
    s_mov_b32 m0, 93184
    s_add_u32 s3, s3, 32768
    buffer_load_dwordx4 v32, s[40:43], s3 offen lds
    s_waitcnt vmcnt(24)
    s_mov_b32 m0, 94208
    s_add_u32 s3, s3, 32768
    buffer_load_dwordx4 v32, s[40:43], s3 offen lds
    s_mov_b32 m0, 95232
    s_add_u32 s3, s3, 32768
    buffer_load_dwordx4 v32, s[40:43], s3 offen lds
    s_mov_b32 m0, 96256
    s_add_u32 s3, s3, 32768
    buffer_load_dwordx4 v32, s[40:43], s3 offen lds
    s_mov_b32 m0, 97280
    s_add_u32 s3, s3, 32768
    buffer_load_dwordx4 v32, s[40:43], s3 offen lds
    s_waitcnt vmcnt(24)
    s_mov_b32 m0, 49152
    s_add_u32 s3, s3, 32768
    buffer_load_dwordx4 v32, s[40:43], s3 offen lds
    s_mov_b32 m0, 50176
    s_add_u32 s3, s3, 32768
    buffer_load_dwordx4 v32, s[40:43], s3 offen lds
    s_mov_b32 m0, 51200
    s_add_u32 s3, s3, 32768
    buffer_load_dwordx4 v32, s[40:43], s3 offen lds
    s_mov_b32 m0, 52224
    s_add_u32 s3, s3, 32768
    buffer_load_dwordx4 v32, s[40:43], s3 offen lds
    s_waitcnt vmcnt(24)
    s_mov_b32 m0, 53248
    s_add_u32 s3, s3, 32768
    buffer_load_dwordx4 v32, s[40:43], s3 offen lds
    s_mov_b32 m0, 54272
    s_add_u32 s3, s3, 32768
    buffer_load_dwordx4 v32, s[40:43], s3 offen lds
    s_mov_b32 m0, 55296
    s_add_u32 s3, s3, 32768
    buffer_load_dwordx4 v32, s[40:43], s3 offen lds
    s_mov_b32 m0, 56320
    s_add_u32 s3, s3, 32768
    buffer_load_dwordx4 v32, s[40:43], s3 offen lds
    s_waitcnt vmcnt(24)
    s_mov_b32 m0, 57344
    s_add_u32 s3, s3, 32768
    buffer_load_dwordx4 v32, s[40:43], s3 offen lds
    s_mov_b32 m0, 58368
    s_add_u32 s3, s3, 32768
    buffer_load_dwordx4 v32, s[40:43], s3 offen lds
    s_mov_b32 m0, 59392
    s_add_u32 s3, s3, 32768
    buffer_load_dwordx4 v32, s[40:43], s3 offen lds
    s_mov_b32 m0, 60416
    s_add_u32 s3, s3, 32768
    buffer_load_dwordx4 v32, s[40:43], s3 offen lds
    s_waitcnt vmcnt(24)
    s_mov_b32 m0, 61440
    s_add_u32 s3, s3, 32768
    buffer_load_dwordx4 v32, s[40:43], s3 offen lds
    s_mov_b32 m0, 62464
    s_add_u32 s3, s3, 32768
    buffer_load_dwordx4 v32, s[40:43], s3 offen lds
    s_mov_b32 m0, 63488
    s_add_u32 s3, s3, 32768
    buffer_load_dwordx4 v32, s[40:43], s3 offen lds
    s_mov_b32 m0, 64512
    s_add_u32 s3, s3, 32768
    buffer_load_dwordx4 v32, s[40:43], s3 offen lds
    s_waitcnt vmcnt(24)
    s_mov_b32 m0, 98304
    s_add_u32 s3, s3, 32768
    buffer_load_dwordx4 v32, s[40:43], s3 offen lds
    s_mov_b32 m0, 99328
    s_add_u32 s3, s3, 32768
    buffer_load_dwordx4 v32, s[40:43], s3 offen lds
    s_mov_b32 m0, 100352
    s_add_u32 s3, s3, 32768
    buffer_load_dwordx4 v32, s[40:43], s3 offen lds
    s_mov_b32 m0, 101376
    s_add_u32 s3, s3, 32768
    buffer_load_dwordx4 v32, s[40:43], s3 offen lds
    s_waitcnt vmcnt(24)
    s_mov_b32 m0, 102400
    s_add_u32 s3, s3, 32768
    buffer_load_dwordx4 v32, s[40:43], s3 offen lds
    s_mov_b32 m0, 103424
    s_add_u32 s3, s3, 32768
    buffer_load_dwordx4 v32, s[40:43], s3 offen lds
    s_mov_b32 m0, 104448
    s_add_u32 s3, s3, 32768
    buffer_load_dwordx4 v32, s[40:43], s3 offen lds
    s_mov_b32 m0, 105472
    s_add_u32 s3, s3, 32768
    buffer_load_dwordx4 v32, s[40:43], s3 offen lds
    s_waitcnt vmcnt(24)
    s_mov_b32 m0, 106496
    s_add_u32 s3, s3, 32768
    buffer_load_dwordx4 v32, s[40:43], s3 offen lds
    s_mov_b32 m0, 107520
    s_add_u32 s3, s3, 32768
    buffer_load_dwordx4 v32, s[40:43], s3 offen lds
    s_mov_b32 m0, 108544
    s_add_u32 s3, s3, 32768
    buffer_load_dwordx4 v32, s[40:43], s3 offen lds
    s_mov_b32 m0, 109568
    s_add_u32 s3, s3, 32768
    buffer_load_dwordx4 v32, s[40:43], s3 offen lds
    s_waitcnt vmcnt(24)
    s_mov_b32 m0, 110592
    s_add_u32 s3, s3, 32768
    buffer_load_dwordx4 v32, s[40:43], s3 offen lds
    s_mov_b32 m0, 111616
    s_add_u32 s3, s3, 32768
    buffer_load_dwordx4 v32, s[40:43], s3 offen lds
    s_mov_b32 m0, 112640
    s_add_u32 s3, s3, 32768
    buffer_load_dwordx4 v32, s[40:43], s3 offen lds
    s_mov_b32 m0, 113664
    s_add_u32 s3, s3, 32768
    buffer_load_dwordx4 v32, s[40:43], s3 offen lds
    s_waitcnt vmcnt(24)
    s_mov_b32 m0, 114688
    s_add_u32 s3, s3, 32768
    buffer_load_dwordx4 v32, s[40:43], s3 offen lds
    s_mov_b32 m0, 115712
    s_add_u32 s3, s3, 32768
    buffer_load_dwordx4 v32, s[40:43], s3 offen lds
    s_mov_b32 m0, 116736
    s_add_u32 s3, s3, 32768
    buffer_load_dwordx4 v32, s[40:43], s3 offen lds
    s_mov_b32 m0, 117760
    s_add_u32 s3, s3, 32768
    buffer_load_dwordx4 v32, s[40:43], s3 offen lds
    s_waitcnt vmcnt(24)
    s_mov_b32 m0, 118784
    s_add_u32 s3, s3, 32768
    buffer_load_dwordx4 v32, s[40:43], s3 offen lds
    s_mov_b32 m0, 119808
    s_add_u32 s3, s3, 32768
    buffer_load_dwordx4 v32, s[40:43], s3 offen lds
    s_mov_b32 m0, 120832
    s_add_u32 s3, s3, 32768
    buffer_load_dwordx4 v32, s[40:43], s3 offen lds
    s_mov_b32 m0, 121856
    s_add_u32 s3, s3, 32768
    buffer_load_dwordx4 v32, s[40:43], s3 offen lds
    s_waitcnt vmcnt(24)
    s_mov_b32 m0, 122880
    s_add_u32 s3, s3, 32768
    buffer_load_dwordx4 v32, s[40:43], s3 offen lds
    s_mov_b32 m0, 123904
    s_add_u32 s3, s3, 32768
    buffer_load_dwordx4 v32, s[40:43], s3 offen lds
    s_mov_b32 m0, 124928
    s_add_u32 s3, s3, 32768
    buffer_load_dwordx4 v32, s[40:43], s3 offen lds
    s_mov_b32 m0, 125952
    s_add_u32 s3, s3, 32768
    buffer_load_dwordx4 v32, s[40:43], s3 offen lds
    s_waitcnt vmcnt(24)
    s_mov_b32 m0, 126976
    s_add_u32 s3, s3, 32768
    buffer_load_dwordx4 v32, s[40:43], s3 offen lds
    s_mov_b32 m0, 128000
    s_add_u32 s3, s3, 32768
    buffer_load_dwordx4 v32, s[40:43], s3 offen lds
    s_mov_b32 m0, 129024
    s_add_u32 s3, s3, 32768
    buffer_load_dwordx4 v32, s[40:43], s3 offen lds
    s_mov_b32 m0, 130048
    s_add_u32 s3, s3, 32768
    buffer_load_dwordx4 v32, s[40:43], s3 offen lds
    s_waitcnt vmcnt(24)
F_SYNC:
    s_barrier
    v_lshlrev_b32 v5, 4, v0
    v_add_u32 v6, 196608, v5
    v_add_u32 v232, 0, v6
    v_add_u32 v233, 4096, v6
    v_add_u32 v234, 8192, v6
    v_add_u32 v235, 12288, v6
    v_add_u32 v244, 16384, v6
    v_add_u32 v245, 20480, v6
    v_add_u32 v246, 24576, v6
    v_add_u32 v247, 28672, v6
    s_cmp_lg_u32 s76, 0
    s_cbranch_scc1 F0_a
    v_lshlrev_b32 v7, 2, v1
    s_lshl_b32 s90, s78, 8
    s_and_b32 s3, s77, 3
    s_lshl_b32 s3, s3, 11
    s_add_u32 s90, s90, s3
    s_add_u32 s90, s90, 4096
    buffer_load_dword v40, v7, s[44:47], s90 offen sc1
F0_a:
    s_mov_b32 s91, 262144
FMP_loop:
    buffer_load_dwordx4 v[168:171], v232, s[44:47], 0 offen sc1
    buffer_load_dwordx4 v[172:175], v233, s[44:47], 0 offen sc1
    buffer_load_dwordx4 v[176:179], v234, s[44:47], 0 offen sc1
    buffer_load_dwordx4 v[180:183], v235, s[44:47], 0 offen sc1
    buffer_load_dwordx4 v[184:187], v244, s[44:47], 0 offen sc1
    buffer_load_dwordx4 v[188:191], v245, s[44:47], 0 offen sc1
    buffer_load_dwordx4 v[192:195], v246, s[44:47], 0 offen sc1
    buffer_load_dwordx4 v[196:199], v247, s[44:47], 0 offen sc1
    s_waitcnt vmcnt(0)
    v_min_u32 v236, v169, v171
    v_min3_u32 v236, v236, v173, v175
    v_min3_u32 v236, v236, v177, v179
    v_min3_u32 v236, v236, v181, v183
    v_min3_u32 v236, v236, v185, v187
    v_min3_u32 v236, v236, v189, v191
    v_min3_u32 v236, v236, v193, v195
    v_min3_u32 v236, v236, v197, v199
    v_max_u32 v237, v169, v171
    v_max3_u32 v237, v237, v173, v175
    v_max3_u32 v237, v237, v177, v179
    v_max3_u32 v237, v237, v181, v183
    v_max3_u32 v237, v237, v185, v187
    v_max3_u32 v237, v237, v189, v191
    v_max3_u32 v237, v237, v193, v195
    v_max3_u32 v237, v237, v197, v199
    v_cmp_ne_u32 vcc, s79, v236
    s_mov_b64 s[88:89], vcc
    v_cmp_ne_u32 vcc, s79, v237
    s_or_b64 vcc, vcc, s[88:89]
    s_sub_u32 s91, s91, 1
    s_cbranch_scc1 FMP_out
    s_cbranch_vccz FMP_out
    s_sleep 1
    s_branch FMP_loop
FMP_out:
    v_lshrrev_b32 v5, 2, v0
    v_lshlrev_b32 v5, 6, v5
    v_and_b32 v6, 3, v0
    v_lshl_add_u32 v5, v6, 3, v5
    v_add_u32 v5, 131072, v5
    v_add_f32 v168, v168, v176
    v_add_f32 v184, v184, v192
    v_add_f32 v170, v170, v178
    v_add_f32 v186, v186, v194
    v_add_f32 v172, v172, v180
    v_add_f32 v188, v188, v196
    v_add_f32 v174, v174, v182
    v_add_f32 v190, v190, v198
    v_add_f32 v200, v168, v184
    v_add_f32 v201, v170, v186
    v_add_f32 v208, v172, v188
    v_add_f32 v209, v174, v190
    v_cvt_pk_bf16_f32 v200, v200, v201
    v_cvt_pk_bf16_f32 v208, v208, v209
    v_and_b32 v201, 0xffff0000, v200
    v_lshlrev_b32 v200, 16, v200
    v_and_b32 v209, 0xffff0000, v208
    v_lshlrev_b32 v208, 16, v208
    v_add_f32 v208, 1.0, v208
    v_add_f32 v209, 1.0, v209
    v_cvt_pk_bf16_f32 v208, v208, v209
    v_and_b32 v209, 0xffff0000, v208
    v_lshlrev_b32 v208, 16, v208
    v_mul_f32 v200, 0x3e0293ee, v200
    v_mul_f32 v201, 0x3e0293ee, v201
    v_mul_f32 v208, 0x3e0293ee, v208
    v_mul_f32 v209, 0x3e0293ee, v209
    ds_write_b64 v5, v[208:209]
    ds_write_b64 v5, v[200:201] offset:32
    v_lshrrev_b32 v5, 2, v3
    v_and_b32 v6, 3, v3
    v_lshlrev_b32 v39, 8, v5
    v_lshl_add_u32 v39, v4, 6, v39
    v_lshl_add_u32 v39, v6, 4, v39
    s_cmp_lg_u32 s76, 0
    s_cbranch_scc1 F0_b
    s_mov_b32 s91, 262144
    s_branch F0_chk
F0_loop:
    buffer_load_dword v40, v7, s[44:47], s90 offen sc1
F0_chk:
    s_waitcnt vmcnt(0)
    v_cmp_ne_u32 vcc, s79, v40
    s_sub_u32 s91, s91, 1
    s_cbranch_scc1 F0_out
    s_cbranch_vccz F0_out
    s_sleep 1
    s_branch F0_loop
F0_out:
F0_b:
    s_lshl_b32 s3, s77, 8
    s_lshl_b32 s88, s76, 17
    s_add_u32 s3, s3, s88
    v_lshlrev_b32 v35, 3, v1
    s_mov_b32 s90, 28672
    s_waitcnt lgkmcnt(0)
    s_barrier
    buffer_load_dwordx4 v[40:43], v39, s[44:47], s83 offen offset:0 sc1
    buffer_load_dwordx4 v[44:47], v39, s[44:47], s83 offen offset:1024 sc1
    buffer_load_dwordx4 v[48:51], v39, s[44:47], s83 offen offset:2048 sc1
    buffer_load_dwordx4 v[52:55], v39, s[44:47], s83 offen offset:3072 sc1
    s_add_u32 s83, s83, 131072
    buffer_load_dwordx2 v[252:253], v35, s[44:47], s90 offen sc1
    buffer_load_dwordx4 v[56:59], v39, s[44:47], s83 offen offset:0 sc1
    buffer_load_dwordx4 v[60:63], v39, s[44:47], s83 offen offset:1024 sc1
    buffer_load_dwordx4 v[64:67], v39, s[44:47], s83 offen offset:2048 sc1
    buffer_load_dwordx4 v[68:71], v39, s[44:47], s83 offen offset:3072 sc1
    s_add_u32 s83, s83, 131072
    buffer_load_dwordx4 v[72:75], v39, s[44:47], s83 offen offset:0 sc1
    buffer_load_dwordx4 v[76:79], v39, s[44:47], s83 offen offset:1024 sc1
    buffer_load_dwordx4 v[80:83], v39, s[44:47], s83 offen offset:2048 sc1
    buffer_load_dwordx4 v[84:87], v39, s[44:47], s83 offen offset:3072 sc1
    s_add_u32 s83, s83, 131072
    buffer_load_dwordx4 v[88:91], v39, s[44:47], s83 offen offset:0 sc1
    buffer_load_dwordx4 v[92:95], v39, s[44:47], s83 offen offset:1024 sc1
    buffer_load_dwordx4 v[96:99], v39, s[44:47], s83 offen offset:2048 sc1
    buffer_load_dwordx4 v[100:103], v39, s[44:47], s83 offen offset:3072 sc1
    s_add_u32 s83, s83, 131072
    ds_read_b128 v[200:203], v34 offset:0
    ds_read_b128 v[204:207], v34 offset:16
    ds_read_b128 v[208:211], v34 offset:32
    ds_read_b128 v[212:215], v34 offset:48
    ds_read_b128 v[216:219], v34 offset:256
    ds_read_b128 v[220:223], v34 offset:272
    ds_read_b128 v[224:227], v34 offset:288
    ds_read_b128 v[228:231], v34 offset:304
    ds_read_b64_tr_b16 a[128:129], v24 offset:0
    ds_read_b64_tr_b16 a[130:131], v24 offset:1024
    ds_read_b64_tr_b16 a[132:133], v24 offset:8
    ds_read_b64_tr_b16 a[134:135], v24 offset:1032
    ds_read_b64_tr_b16 a[136:137], v25 offset:0
    ds_read_b64_tr_b16 a[138:139], v25 offset:1024
    ds_read_b64_tr_b16 a[140:141], v25 offset:8
    ds_read_b64_tr_b16 a[142:143], v25 offset:1032
    ds_read_b64_tr_b16 a[144:145], v26 offset:0
    ds_read_b64_tr_b16 a[146:147], v26 offset:1024
    ds_read_b64_tr_b16 a[148:149], v26 offset:8
    ds_read_b64_tr_b16 a[150:151], v26 offset:1032
    ds_read_b64_tr_b16 a[152:153], v27 offset:0
    ds_read_b64_tr_b16 a[154:155], v27 offset:1024
    ds_read_b64_tr_b16 a[156:157], v27 offset:8
    ds_read_b64_tr_b16 a[158:159], v27 offset:1032
    s_waitcnt vmcnt(13)
    s_waitcnt lgkmcnt(15)
    v_fma_mix_f32 v236, v40, v200, v208 op_sel_hi:[1,0,0]
    v_fma_mix_f32 v237, v40, v201, v209 op_sel:[1,0,0] op_sel_hi:[1,0,0]
    v_cvt_pk_bf16_f32 v168, v236, v237
    v_fma_mix_f32 v238, v41, v202, v210 op_sel_hi:[1,0,0]
    v_fma_mix_f32 v239, v41, v203, v211 op_sel:[1,0,0] op_sel_hi:[1,0,0]
    v_cvt_pk_bf16_f32 v169, v238, v239
    v_fma_mix_f32 v240, v42, v204, v212 op_sel_hi:[1,0,0]
    v_fma_mix_f32 v241, v42, v205, v213 op_sel:[1,0,0] op_sel_hi:[1,0,0]
    v_cvt_pk_bf16_f32 v170, v240, v241
    v_fma_mix_f32 v242, v43, v206, v214 op_sel_hi:[1,0,0]
    v_fma_mix_f32 v243, v43, v207, v215 op_sel:[1,0,0] op_sel_hi:[1,0,0]
    v_cvt_pk_bf16_f32 v171, v242, v243
    v_fma_mix_f32 v236, v44, v200, v208 op_sel_hi:[1,0,0]
    v_fma_mix_f32 v237, v44, v201, v209 op_sel:[1,0,0] op_sel_hi:[1,0,0]
    v_cvt_pk_bf16_f32 v172, v236, v237
    v_fma_mix_f32 v238, v45, v202, v210 op_sel_hi:[1,0,0]
    v_fma_mix_f32 v239, v45, v203, v211 op_sel:[1,0,0] op_sel_hi:[1,0,0]
    v_cvt_pk_bf16_f32 v173, v238, v239
    v_fma_mix_f32 v240, v46, v204, v212 op_sel_hi:[1,0,0]
    v_fma_mix_f32 v241, v46, v205, v213 op_sel:[1,0,0] op_sel_hi:[1,0,0]
    v_cvt_pk_bf16_f32 v174, v240, v241
    v_fma_mix_f32 v242, v47, v206, v214 op_sel_hi:[1,0,0]
    v_fma_mix_f32 v243, v47, v207, v215 op_sel:[1,0,0] op_sel_hi:[1,0,0]
    v_cvt_pk_bf16_f32 v175, v242, v243
    v_fma_mix_f32 v236, v48, v200, v208 op_sel_hi:[1,0,0]
    v_fma_mix_f32 v237, v48, v201, v209 op_sel:[1,0,0] op_sel_hi:[1,0,0]
    v_cvt_pk_bf16_f32 v176, v236, v237
    v_fma_mix_f32 v238, v49, v202, v210 op_sel_hi:[1,0,0]
    v_fma_mix_f32 v239, v49, v203, v211 op_sel:[1,0,0] op_sel_hi:[1,0,0]
    v_cvt_pk_bf16_f32 v177, v238, v239
    v_fma_mix_f32 v240, v50, v204, v212 op_sel_hi:[1,0,0]
    v_fma_mix_f32 v241, v50, v205, v213 op_sel:[1,0,0] op_sel_hi:[1,0,0]
    v_cvt_pk_bf16_f32 v178, v240, v241
    v_fma_mix_f32 v242, v51, v206, v214 op_sel_hi:[1,0,0]
    v_fma_mix_f32 v243, v51, v207, v215 op_sel:[1,0,0] op_sel_hi:[1,0,0]
    v_cvt_pk_bf16_f32 v179, v242, v243
    v_fma_mix_f32 v236, v52, v200, v208 op_sel_hi:[1,0,0]
    v_fma_mix_f32 v237, v52, v201, v209 op_sel:[1,0,0] op_sel_hi:[1,0,0]
    v_cvt_pk_bf16_f32 v180, v236, v237
    v_fma_mix_f32 v238, v53, v202, v210 op_sel_hi:[1,0,0]
    v_fma_mix_f32 v239, v53, v203, v211 op_sel:[1,0,0] op_sel_hi:[1,0,0]
    v_cvt_pk_bf16_f32 v181, v238, v239
    v_fma_mix_f32 v240, v54, v204, v212 op_sel_hi:[1,0,0]
    v_fma_mix_f32 v241, v54, v205, v213 op_sel:[1,0,0] op_sel_hi:[1,0,0]
    v_cvt_pk_bf16_f32 v182, v240, v241
    v_fma_mix_f32 v242, v55, v206, v214 op_sel_hi:[1,0,0]
    v_fma_mix_f32 v243, v55, v207, v215 op_sel:[1,0,0] op_sel_hi:[1,0,0]
    v_cvt_pk_bf16_f32 v183, v242, v243
    s_waitcnt vmcnt(8)
    s_waitcnt lgkmcnt(15)
    s_waitcnt lgkmcnt(8)
    v_mfma_f32_16x16x32_bf16 a[0:3], a[128:131], v[168:171], 0
    ds_read_b64_tr_b16 a[160:161], v24 offset:8192
    ds_read_b64_tr_b16 a[162:163], v24 offset:9216
    v_fma_mix_f32 v236, v56, v216, v224 op_sel_hi:[1,0,0]
    v_mfma_f32_16x16x32_bf16 a[4:7], a[128:131], v[172:175], 0
    buffer_load_dwordx4 v[116:119], v39, s[44:47], s83 offen offset:3072 sc1
    v_fma_mix_f32 v237, v56, v217, v225 op_sel:[1,0,0] op_sel_hi:[1,0,0]
    v_mfma_f32_16x16x32_bf16 a[8:11], a[128:131], v[176:179], 0
    v_cvt_pk_bf16_f32 v184, v236, v237
    v_fma_mix_f32 v238, v57, v218, v226 op_sel_hi:[1,0,0]
    v_mfma_f32_16x16x32_bf16 a[12:15], a[128:131], v[180:183], 0
    ds_read_b128 v[200:203], v34 offset:512
    v_fma_mix_f32 v239, v57, v219, v227 op_sel:[1,0,0] op_sel_hi:[1,0,0]
    v_mfma_f32_16x16x32_bf16 a[16:19], a[132:135], v[168:171], 0
    ds_read_b64_tr_b16 a[164:165], v24 offset:8200
    ds_read_b64_tr_b16 a[166:167], v24 offset:9224
    v_cvt_pk_bf16_f32 v185, v238, v239
    v_mfma_f32_16x16x32_bf16 a[20:23], a[132:135], v[172:175], 0
    v_fma_mix_f32 v240, v58, v220, v228 op_sel_hi:[1,0,0]
    v_fma_mix_f32 v241, v58, v221, v229 op_sel:[1,0,0] op_sel_hi:[1,0,0]
    v_mfma_f32_16x16x32_bf16 a[24:27], a[132:135], v[176:179], 0
    v_cvt_pk_bf16_f32 v186, v240, v241
    v_fma_mix_f32 v242, v59, v222, v230 op_sel_hi:[1,0,0]
    v_mfma_f32_16x16x32_bf16 a[28:31], a[132:135], v[180:183], 0
    ds_read_b128 v[204:207], v34 offset:528
    v_fma_mix_f32 v243, v59, v223, v231 op_sel:[1,0,0] op_sel_hi:[1,0,0]
    v_cvt_pk_bf16_f32 v187, v242, v243
    v_mfma_f32_16x16x32_bf16 a[32:35], a[136:139], v[168:171], 0
    ds_read_b64_tr_b16 a[168:169], v25 offset:8192
    ds_read_b64_tr_b16 a[170:171], v25 offset:9216
    v_fma_mix_f32 v236, v60, v216, v224 op_sel_hi:[1,0,0]
    v_mfma_f32_16x16x32_bf16 a[36:39], a[136:139], v[172:175], 0
    v_fma_mix_f32 v237, v60, v217, v225 op_sel:[1,0,0] op_sel_hi:[1,0,0]
    v_cvt_pk_bf16_f32 v188, v236, v237
    v_mfma_f32_16x16x32_bf16 a[40:43], a[136:139], v[176:179], 0
    v_fma_mix_f32 v238, v61, v218, v226 op_sel_hi:[1,0,0]
    v_fma_mix_f32 v239, v61, v219, v227 op_sel:[1,0,0] op_sel_hi:[1,0,0]
    v_mfma_f32_16x16x32_bf16 a[44:47], a[136:139], v[180:183], 0
    ds_read_b128 v[208:211], v34 offset:544
    v_cvt_pk_bf16_f32 v189, v238, v239
    v_mfma_f32_16x16x32_bf16 a[48:51], a[140:143], v[168:171], 0
    ds_read_b64_tr_b16 a[172:173], v25 offset:8200
    ds_read_b64_tr_b16 a[174:175], v25 offset:9224
    v_fma_mix_f32 v240, v62, v220, v228 op_sel_hi:[1,0,0]
    v_mfma_f32_16x16x32_bf16 a[52:55], a[140:143], v[172:175], 0
    v_fma_mix_f32 v241, v62, v221, v229 op_sel:[1,0,0] op_sel_hi:[1,0,0]
    v_cvt_pk_bf16_f32 v190, v240, v241
    v_mfma_f32_16x16x32_bf16 a[56:59], a[140:143], v[176:179], 0
    v_fma_mix_f32 v242, v63, v222, v230 op_sel_hi:[1,0,0]
    v_fma_mix_f32 v243, v63, v223, v231 op_sel:[1,0,0] op_sel_hi:[1,0,0]
    v_mfma_f32_16x16x32_bf16 a[60:63], a[140:143], v[180:183], 0
    s_waitcnt lgkmcnt(11)
    v_cvt_pk_bf16_f32 v191, v242, v243
    v_fma_mix_f32 v236, v64, v216, v224 op_sel_hi:[1,0,0]
    v_mfma_f32_16x16x32_bf16 a[64:67], a[144:147], v[168:171], 0
    ds_read_b64_tr_b16 a[176:177], v26 offset:8192
    ds_read_b64_tr_b16 a[178:179], v26 offset:9216
    v_fma_mix_f32 v237, v64, v217, v225 op_sel:[1,0,0] op_sel_hi:[1,0,0]
    v_mfma_f32_16x16x32_bf16 a[68:71], a[144:147], v[172:175], 0
    v_cvt_pk_bf16_f32 v192, v236, v237
    v_fma_mix_f32 v238, v65, v218, v226 op_sel_hi:[1,0,0]
    v_mfma_f32_16x16x32_bf16 a[72:75], a[144:147], v[176:179], 0
    v_fma_mix_f32 v239, v65, v219, v227 op_sel:[1,0,0] op_sel_hi:[1,0,0]
    v_cvt_pk_bf16_f32 v193, v238, v239
    v_mfma_f32_16x16x32_bf16 a[76:79], a[144:147], v[180:183], 0
    ds_read_b128 v[212:215], v34 offset:560
    v_fma_mix_f32 v240, v66, v220, v228 op_sel_hi:[1,0,0]
    v_fma_mix_f32 v241, v66, v221, v229 op_sel:[1,0,0] op_sel_hi:[1,0,0]
    v_mfma_f32_16x16x32_bf16 a[80:83], a[148:151], v[168:171], 0
    ds_read_b64_tr_b16 a[180:181], v26 offset:8200
    ds_read_b64_tr_b16 a[182:183], v26 offset:9224
    v_mfma_f32_16x16x32_bf16 a[84:87], a[148:151], v[172:175], 0
    v_cvt_pk_bf16_f32 v194, v240, v241
    v_fma_mix_f32 v242, v67, v222, v230 op_sel_hi:[1,0,0]
    v_mfma_f32_16x16x32_bf16 a[88:91], a[148:151], v[176:179], 0
    v_fma_mix_f32 v243, v67, v223, v231 op_sel:[1,0,0] op_sel_hi:[1,0,0]
    v_cvt_pk_bf16_f32 v195, v242, v243
    v_fma_mix_f32 v236, v68, v216, v224 op_sel_hi:[1,0,0]
    v_mfma_f32_16x16x32_bf16 a[92:95], a[148:151], v[180:183], 0
    buffer_load_dwordx4 v[104:107], v39, s[44:47], s83 offen offset:0 sc1
    v_mfma_f32_16x16x32_bf16 a[96:99], a[152:155], v[168:171], 0
    ds_read_b64_tr_b16 a[184:185], v27 offset:8192
    ds_read_b64_tr_b16 a[186:187], v27 offset:9216
    v_fma_mix_f32 v237, v68, v217, v225 op_sel:[1,0,0] op_sel_hi:[1,0,0]
    v_mfma_f32_16x16x32_bf16 a[100:103], a[152:155], v[172:175], 0
    v_cvt_pk_bf16_f32 v196, v236, v237
    v_fma_mix_f32 v238, v69, v218, v226 op_sel_hi:[1,0,0]
    v_mfma_f32_16x16x32_bf16 a[104:107], a[152:155], v[176:179], 0
    v_fma_mix_f32 v239, v69, v219, v227 op_sel:[1,0,0] op_sel_hi:[1,0,0]
    v_cvt_pk_bf16_f32 v197, v238, v239
    v_mfma_f32_16x16x32_bf16 a[108:111], a[152:155], v[180:183], 0
    buffer_load_dwordx4 v[108:111], v39, s[44:47], s83 offen offset:1024 sc1
    v_fma_mix_f32 v240, v70, v220, v228 op_sel_hi:[1,0,0]
    v_mfma_f32_16x16x32_bf16 a[112:115], a[156:159], v[168:171], 0
    ds_read_b64_tr_b16 a[188:189], v27 offset:8200
    ds_read_b64_tr_b16 a[190:191], v27 offset:9224
    v_fma_mix_f32 v241, v70, v221, v229 op_sel:[1,0,0] op_sel_hi:[1,0,0]
    v_mfma_f32_16x16x32_bf16 a[116:119], a[156:159], v[172:175], 0
    v_cvt_pk_bf16_f32 v198, v240, v241
    v_fma_mix_f32 v242, v71, v222, v230 op_sel_hi:[1,0,0]
    v_mfma_f32_16x16x32_bf16 a[120:123], a[156:159], v[176:179], 0
    v_fma_mix_f32 v243, v71, v223, v231 op_sel:[1,0,0] op_sel_hi:[1,0,0]
    v_cvt_pk_bf16_f32 v199, v242, v243
    v_mfma_f32_16x16x32_bf16 a[124:127], a[156:159], v[180:183], 0
    buffer_load_dwordx4 v[112:115], v39, s[44:47], s83 offen offset:2048 sc1
    s_add_u32 s83, s83, 131072
    s_waitcnt vmcnt(8)
    s_waitcnt lgkmcnt(6)
    v_mfma_f32_16x16x32_bf16 a[0:3], a[160:163], v[184:187], a[0:3]
    ds_read_b64_tr_b16 a[128:129], v24 offset:16384
    ds_read_b64_tr_b16 a[130:131], v24 offset:17408
    v_fma_mix_f32 v236, v72, v200, v208 op_sel_hi:[1,0,0]
    v_mfma_f32_16x16x32_bf16 a[4:7], a[160:163], v[188:191], a[4:7]
    buffer_load_dwordx4 v[132:135], v39, s[44:47], s83 offen offset:3072 sc1
    v_fma_mix_f32 v237, v72, v201, v209 op_sel:[1,0,0] op_sel_hi:[1,0,0]
    v_mfma_f32_16x16x32_bf16 a[8:11], a[160:163], v[192:195], a[8:11]
    v_cvt_pk_bf16_f32 v168, v236, v237
    v_fma_mix_f32 v238, v73, v202, v210 op_sel_hi:[1,0,0]
    v_mfma_f32_16x16x32_bf16 a[12:15], a[160:163], v[196:199], a[12:15]
    ds_read_b128 v[216:219], v34 offset:768
    v_fma_mix_f32 v239, v73, v203, v211 op_sel:[1,0,0] op_sel_hi:[1,0,0]
    v_mfma_f32_16x16x32_bf16 a[16:19], a[164:167], v[184:187], a[16:19]
    ds_read_b64_tr_b16 a[132:133], v24 offset:16392
    ds_read_b64_tr_b16 a[134:135], v24 offset:17416
    v_cvt_pk_bf16_f32 v169, v238, v239
    v_mfma_f32_16x16x32_bf16 a[20:23], a[164:167], v[188:191], a[20:23]
    v_fma_mix_f32 v240, v74, v204, v212 op_sel_hi:[1,0,0]
    v_fma_mix_f32 v241, v74, v205, v213 op_sel:[1,0,0] op_sel_hi:[1,0,0]
    v_mfma_f32_16x16x32_bf16 a[24:27], a[164:167], v[192:195], a[24:27]
    v_cvt_pk_bf16_f32 v170, v240, v241
    v_fma_mix_f32 v242, v75, v206, v214 op_sel_hi:[1,0,0]
    v_mfma_f32_16x16x32_bf16 a[28:31], a[164:167], v[196:199], a[28:31]
    ds_read_b128 v[220:223], v34 offset:784
    v_fma_mix_f32 v243, v75, v207, v215 op_sel:[1,0,0] op_sel_hi:[1,0,0]
    v_cvt_pk_bf16_f32 v171, v242, v243
    v_mfma_f32_16x16x32_bf16 a[32:35], a[168:171], v[184:187], a[32:35]
    ds_read_b64_tr_b16 a[136:137], v25 offset:16384
    ds_read_b64_tr_b16 a[138:139], v25 offset:17408
    v_fma_mix_f32 v236, v76, v200, v208 op_sel_hi:[1,0,0]
    v_mfma_f32_16x16x32_bf16 a[36:39], a[168:171], v[188:191], a[36:39]
    v_fma_mix_f32 v237, v76, v201, v209 op_sel:[1,0,0] op_sel_hi:[1,0,0]
    v_cvt_pk_bf16_f32 v172, v236, v237
    v_mfma_f32_16x16x32_bf16 a[40:43], a[168:171], v[192:195], a[40:43]
    v_fma_mix_f32 v238, v77, v202, v210 op_sel_hi:[1,0,0]
    v_fma_mix_f32 v239, v77, v203, v211 op_sel:[1,0,0] op_sel_hi:[1,0,0]
    v_mfma_f32_16x16x32_bf16 a[44:47], a[168:171], v[196:199], a[44:47]
    ds_read_b128 v[224:227], v34 offset:800
    v_cvt_pk_bf16_f32 v173, v238, v239
    v_mfma_f32_16x16x32_bf16 a[48:51], a[172:175], v[184:187], a[48:51]
    ds_read_b64_tr_b16 a[140:141], v25 offset:16392
    ds_read_b64_tr_b16 a[142:143], v25 offset:17416
    v_fma_mix_f32 v240, v78, v204, v212 op_sel_hi:[1,0,0]
    v_mfma_f32_16x16x32_bf16 a[52:55], a[172:175], v[188:191], a[52:55]
    v_fma_mix_f32 v241, v78, v205, v213 op_sel:[1,0,0] op_sel_hi:[1,0,0]
    v_cvt_pk_bf16_f32 v174, v240, v241
    v_mfma_f32_16x16x32_bf16 a[56:59], a[172:175], v[192:195], a[56:59]
    v_fma_mix_f32 v242, v79, v206, v214 op_sel_hi:[1,0,0]
    v_fma_mix_f32 v243, v79, v207, v215 op_sel:[1,0,0] op_sel_hi:[1,0,0]
    v_mfma_f32_16x16x32_bf16 a[60:63], a[172:175], v[196:199], a[60:63]
    s_waitcnt lgkmcnt(11)
    v_cvt_pk_bf16_f32 v175, v242, v243
    v_fma_mix_f32 v236, v80, v200, v208 op_sel_hi:[1,0,0]
    v_mfma_f32_16x16x32_bf16 a[64:67], a[176:179], v[184:187], a[64:67]
    ds_read_b64_tr_b16 a[144:145], v26 offset:16384
    ds_read_b64_tr_b16 a[146:147], v26 offset:17408
    v_fma_mix_f32 v237, v80, v201, v209 op_sel:[1,0,0] op_sel_hi:[1,0,0]
    v_mfma_f32_16x16x32_bf16 a[68:71], a[176:179], v[188:191], a[68:71]
    v_cvt_pk_bf16_f32 v176, v236, v237
    v_fma_mix_f32 v238, v81, v202, v210 op_sel_hi:[1,0,0]
    v_mfma_f32_16x16x32_bf16 a[72:75], a[176:179], v[192:195], a[72:75]
    v_fma_mix_f32 v239, v81, v203, v211 op_sel:[1,0,0] op_sel_hi:[1,0,0]
    v_cvt_pk_bf16_f32 v177, v238, v239
    v_mfma_f32_16x16x32_bf16 a[76:79], a[176:179], v[196:199], a[76:79]
    ds_read_b128 v[228:231], v34 offset:816
    v_fma_mix_f32 v240, v82, v204, v212 op_sel_hi:[1,0,0]
    v_fma_mix_f32 v241, v82, v205, v213 op_sel:[1,0,0] op_sel_hi:[1,0,0]
    v_mfma_f32_16x16x32_bf16 a[80:83], a[180:183], v[184:187], a[80:83]
    ds_read_b64_tr_b16 a[148:149], v26 offset:16392
    ds_read_b64_tr_b16 a[150:151], v26 offset:17416
    v_mfma_f32_16x16x32_bf16 a[84:87], a[180:183], v[188:191], a[84:87]
    v_cvt_pk_bf16_f32 v178, v240, v241
    v_fma_mix_f32 v242, v83, v206, v214 op_sel_hi:[1,0,0]
    v_mfma_f32_16x16x32_bf16 a[88:91], a[180:183], v[192:195], a[88:91]
    v_fma_mix_f32 v243, v83, v207, v215 op_sel:[1,0,0] op_sel_hi:[1,0,0]
    v_cvt_pk_bf16_f32 v179, v242, v243
    v_fma_mix_f32 v236, v84, v200, v208 op_sel_hi:[1,0,0]
    v_mfma_f32_16x16x32_bf16 a[92:95], a[180:183], v[196:199], a[92:95]
    buffer_load_dwordx4 v[120:123], v39, s[44:47], s83 offen offset:0 sc1
    v_mfma_f32_16x16x32_bf16 a[96:99], a[184:187], v[184:187], a[96:99]
    ds_read_b64_tr_b16 a[152:153], v27 offset:16384
    ds_read_b64_tr_b16 a[154:155], v27 offset:17408
    v_fma_mix_f32 v237, v84, v201, v209 op_sel:[1,0,0] op_sel_hi:[1,0,0]
    v_mfma_f32_16x16x32_bf16 a[100:103], a[184:187], v[188:191], a[100:103]
    v_cvt_pk_bf16_f32 v180, v236, v237
    v_fma_mix_f32 v238, v85, v202, v210 op_sel_hi:[1,0,0]
    v_mfma_f32_16x16x32_bf16 a[104:107], a[184:187], v[192:195], a[104:107]
    v_fma_mix_f32 v239, v85, v203, v211 op_sel:[1,0,0] op_sel_hi:[1,0,0]
    v_cvt_pk_bf16_f32 v181, v238, v239
    v_mfma_f32_16x16x32_bf16 a[108:111], a[184:187], v[196:199], a[108:111]
    buffer_load_dwordx4 v[124:127], v39, s[44:47], s83 offen offset:1024 sc1
    v_fma_mix_f32 v240, v86, v204, v212 op_sel_hi:[1,0,0]
    v_mfma_f32_16x16x32_bf16 a[112:115], a[188:191], v[184:187], a[112:115]
    ds_read_b64_tr_b16 a[156:157], v27 offset:16392
    ds_read_b64_tr_b16 a[158:159], v27 offset:17416
    v_fma_mix_f32 v241, v86, v205, v213 op_sel:[1,0,0] op_sel_hi:[1,0,0]
    v_mfma_f32_16x16x32_bf16 a[116:119], a[188:191], v[188:191], a[116:119]
    v_cvt_pk_bf16_f32 v182, v240, v241
    v_fma_mix_f32 v242, v87, v206, v214 op_sel_hi:[1,0,0]
    v_mfma_f32_16x16x32_bf16 a[120:123], a[188:191], v[192:195], a[120:123]
    v_fma_mix_f32 v243, v87, v207, v215 op_sel:[1,0,0] op_sel_hi:[1,0,0]
    v_cvt_pk_bf16_f32 v183, v242, v243
    v_mfma_f32_16x16x32_bf16 a[124:127], a[188:191], v[196:199], a[124:127]
    buffer_load_dwordx4 v[128:131], v39, s[44:47], s83 offen offset:2048 sc1
    s_add_u32 s83, s83, 131072
    s_waitcnt vmcnt(8)
    s_waitcnt lgkmcnt(6)
    v_mfma_f32_16x16x32_bf16 a[0:3], a[128:131], v[168:171], a[0:3]
    ds_read_b64_tr_b16 a[160:161], v24 offset:24576
    ds_read_b64_tr_b16 a[162:163], v24 offset:25600
    v_fma_mix_f32 v236, v88, v216, v224 op_sel_hi:[1,0,0]
    v_mfma_f32_16x16x32_bf16 a[4:7], a[128:131], v[172:175], a[4:7]
    buffer_load_dwordx4 v[148:151], v39, s[44:47], s83 offen offset:3072 sc1
    v_fma_mix_f32 v237, v88, v217, v225 op_sel:[1,0,0] op_sel_hi:[1,0,0]
    v_mfma_f32_16x16x32_bf16 a[8:11], a[128:131], v[176:179], a[8:11]
    v_cvt_pk_bf16_f32 v184, v236, v237
    v_fma_mix_f32 v238, v89, v218, v226 op_sel_hi:[1,0,0]
    v_mfma_f32_16x16x32_bf16 a[12:15], a[128:131], v[180:183], a[12:15]
    ds_read_b128 v[200:203], v34 offset:1024
    v_fma_mix_f32 v239, v89, v219, v227 op_sel:[1,0,0] op_sel_hi:[1,0,0]
    v_mfma_f32_16x16x32_bf16 a[16:19], a[132:135], v[168:171], a[16:19]
    ds_read_b64_tr_b16 a[164:165], v24 offset:24584
    ds_read_b64_tr_b16 a[166:167], v24 offset:25608
    v_cvt_pk_bf16_f32 v185, v238, v239
    v_mfma_f32_16x16x32_bf16 a[20:23], a[132:135], v[172:175], a[20:23]
    v_fma_mix_f32 v240, v90, v220, v228 op_sel_hi:[1,0,0]
    v_fma_mix_f32 v241, v90, v221, v229 op_sel:[1,0,0] op_sel_hi:[1,0,0]
    v_mfma_f32_16x16x32_bf16 a[24:27], a[132:135], v[176:179], a[24:27]
    v_cvt_pk_bf16_f32 v186, v240, v241
    v_fma_mix_f32 v242, v91, v222, v230 op_sel_hi:[1,0,0]
    v_mfma_f32_16x16x32_bf16 a[28:31], a[132:135], v[180:183], a[28:31]
    ds_read_b128 v[204:207], v34 offset:1040
    v_fma_mix_f32 v243, v91, v223, v231 op_sel:[1,0,0] op_sel_hi:[1,0,0]
    v_cvt_pk_bf16_f32 v187, v242, v243
    v_mfma_f32_16x16x32_bf16 a[32:35], a[136:139], v[168:171], a[32:35]
    ds_read_b64_tr_b16 a[168:169], v25 offset:24576
    ds_read_b64_tr_b16 a[170:171], v25 offset:25600
    v_fma_mix_f32 v236, v92, v216, v224 op_sel_hi:[1,0,0]
    v_mfma_f32_16x16x32_bf16 a[36:39], a[136:139], v[172:175], a[36:39]
    v_fma_mix_f32 v237, v92, v217, v225 op_sel:[1,0,0] op_sel_hi:[1,0,0]
    v_cvt_pk_bf16_f32 v188, v236, v237
    v_mfma_f32_16x16x32_bf16 a[40:43], a[136:139], v[176:179], a[40:43]
    v_fma_mix_f32 v238, v93, v218, v226 op_sel_hi:[1,0,0]
    v_fma_mix_f32 v239, v93, v219, v227 op_sel:[1,0,0] op_sel_hi:[1,0,0]
    v_mfma_f32_16x16x32_bf16 a[44:47], a[136:139], v[180:183], a[44:47]
    ds_read_b128 v[208:211], v34 offset:1056
    v_cvt_pk_bf16_f32 v189, v238, v239
    v_mfma_f32_16x16x32_bf16 a[48:51], a[140:143], v[168:171], a[48:51]
    ds_read_b64_tr_b16 a[172:173], v25 offset:24584
    ds_read_b64_tr_b16 a[174:175], v25 offset:25608
    v_fma_mix_f32 v240, v94, v220, v228 op_sel_hi:[1,0,0]
    v_mfma_f32_16x16x32_bf16 a[52:55], a[140:143], v[172:175], a[52:55]
    v_fma_mix_f32 v241, v94, v221, v229 op_sel:[1,0,0] op_sel_hi:[1,0,0]
    v_cvt_pk_bf16_f32 v190, v240, v241
    v_mfma_f32_16x16x32_bf16 a[56:59], a[140:143], v[176:179], a[56:59]
    v_fma_mix_f32 v242, v95, v222, v230 op_sel_hi:[1,0,0]
    v_fma_mix_f32 v243, v95, v223, v231 op_sel:[1,0,0] op_sel_hi:[1,0,0]
    v_mfma_f32_16x16x32_bf16 a[60:63], a[140:143], v[180:183], a[60:63]
    s_waitcnt lgkmcnt(11)
    v_cvt_pk_bf16_f32 v191, v242, v243
    v_fma_mix_f32 v236, v96, v216, v224 op_sel_hi:[1,0,0]
    v_mfma_f32_16x16x32_bf16 a[64:67], a[144:147], v[168:171], a[64:67]
    ds_read_b64_tr_b16 a[176:177], v26 offset:24576
    ds_read_b64_tr_b16 a[178:179], v26 offset:25600
    v_fma_mix_f32 v237, v96, v217, v225 op_sel:[1,0,0] op_sel_hi:[1,0,0]
    v_mfma_f32_16x16x32_bf16 a[68:71], a[144:147], v[172:175], a[68:71]
    v_cvt_pk_bf16_f32 v192, v236, v237
    v_fma_mix_f32 v238, v97, v218, v226 op_sel_hi:[1,0,0]
    v_mfma_f32_16x16x32_bf16 a[72:75], a[144:147], v[176:179], a[72:75]
    v_fma_mix_f32 v239, v97, v219, v227 op_sel:[1,0,0] op_sel_hi:[1,0,0]
    v_cvt_pk_bf16_f32 v193, v238, v239
    v_mfma_f32_16x16x32_bf16 a[76:79], a[144:147], v[180:183], a[76:79]
    ds_read_b128 v[212:215], v34 offset:1072
    v_fma_mix_f32 v240, v98, v220, v228 op_sel_hi:[1,0,0]
    v_fma_mix_f32 v241, v98, v221, v229 op_sel:[1,0,0] op_sel_hi:[1,0,0]
    v_mfma_f32_16x16x32_bf16 a[80:83], a[148:151], v[168:171], a[80:83]
    ds_read_b64_tr_b16 a[180:181], v26 offset:24584
    ds_read_b64_tr_b16 a[182:183], v26 offset:25608
    v_mfma_f32_16x16x32_bf16 a[84:87], a[148:151], v[172:175], a[84:87]
    v_cvt_pk_bf16_f32 v194, v240, v241
    v_fma_mix_f32 v242, v99, v222, v230 op_sel_hi:[1,0,0]
    v_mfma_f32_16x16x32_bf16 a[88:91], a[148:151], v[176:179], a[88:91]
    v_fma_mix_f32 v243, v99, v223, v231 op_sel:[1,0,0] op_sel_hi:[1,0,0]
    v_cvt_pk_bf16_f32 v195, v242, v243
    v_fma_mix_f32 v236, v100, v216, v224 op_sel_hi:[1,0,0]
    v_mfma_f32_16x16x32_bf16 a[92:95], a[148:151], v[180:183], a[92:95]
    buffer_load_dwordx4 v[136:139], v39, s[44:47], s83 offen offset:0 sc1
    v_mfma_f32_16x16x32_bf16 a[96:99], a[152:155], v[168:171], a[96:99]
    ds_read_b64_tr_b16 a[184:185], v27 offset:24576
    ds_read_b64_tr_b16 a[186:187], v27 offset:25600
    v_fma_mix_f32 v237, v100, v217, v225 op_sel:[1,0,0] op_sel_hi:[1,0,0]
    v_mfma_f32_16x16x32_bf16 a[100:103], a[152:155], v[172:175], a[100:103]
    v_cvt_pk_bf16_f32 v196, v236, v237
    v_fma_mix_f32 v238, v101, v218, v226 op_sel_hi:[1,0,0]
    v_mfma_f32_16x16x32_bf16 a[104:107], a[152:155], v[176:179], a[104:107]
    v_fma_mix_f32 v239, v101, v219, v227 op_sel:[1,0,0] op_sel_hi:[1,0,0]
    v_cvt_pk_bf16_f32 v197, v238, v239
    v_mfma_f32_16x16x32_bf16 a[108:111], a[152:155], v[180:183], a[108:111]
    buffer_load_dwordx4 v[140:143], v39, s[44:47], s83 offen offset:1024 sc1
    v_fma_mix_f32 v240, v102, v220, v228 op_sel_hi:[1,0,0]
    v_mfma_f32_16x16x32_bf16 a[112:115], a[156:159], v[168:171], a[112:115]
    ds_read_b64_tr_b16 a[188:189], v27 offset:24584
    ds_read_b64_tr_b16 a[190:191], v27 offset:25608
    v_fma_mix_f32 v241, v102, v221, v229 op_sel:[1,0,0] op_sel_hi:[1,0,0]
    v_mfma_f32_16x16x32_bf16 a[116:119], a[156:159], v[172:175], a[116:119]
    v_cvt_pk_bf16_f32 v198, v240, v241
    v_fma_mix_f32 v242, v103, v222, v230 op_sel_hi:[1,0,0]
    v_mfma_f32_16x16x32_bf16 a[120:123], a[156:159], v[176:179], a[120:123]
    v_fma_mix_f32 v243, v103, v223, v231 op_sel:[1,0,0] op_sel_hi:[1,0,0]
    v_cvt_pk_bf16_f32 v199, v242, v243
    v_mfma_f32_16x16x32_bf16 a[124:127], a[156:159], v[180:183], a[124:127]
    buffer_load_dwordx4 v[144:147], v39, s[44:47], s83 offen offset:2048 sc1
    s_add_u32 s83, s83, 131072
    s_waitcnt vmcnt(8)
    s_waitcnt lgkmcnt(6)
    s_barrier
    v_mfma_f32_16x16x32_bf16 a[0:3], a[160:163], v[184:187], a[0:3]
    ds_read_b64_tr_b16 a[128:129], v28 offset:0
    ds_read_b64_tr_b16 a[130:131], v28 offset:1024
    v_fma_mix_f32 v236, v104, v200, v208 op_sel_hi:[1,0,0]
    v_mfma_f32_16x16x32_bf16 a[4:7], a[160:163], v[188:191], a[4:7]
    buffer_load_dwordx4 v[156:159], v39, s[44:47], s83 offen offset:1024 sc1
    v_fma_mix_f32 v237, v104, v201, v209 op_sel:[1,0,0] op_sel_hi:[1,0,0]
    v_mfma_f32_16x16x32_bf16 a[8:11], a[160:163], v[192:195], a[8:11]
    v_cvt_pk_bf16_f32 v168, v236, v237
    v_fma_mix_f32 v238, v105, v202, v210 op_sel_hi:[1,0,0]
    v_fma_mix_f32 v239, v105, v203, v211 op_sel:[1,0,0] op_sel_hi:[1,0,0]
    v_mfma_f32_16x16x32_bf16 a[12:15], a[160:163], v[196:199], a[12:15]
    ds_read_b128 v[216:219], v34 offset:1280
    v_cvt_pk_bf16_f32 v169, v238, v239
    v_mfma_f32_16x16x32_bf16 a[16:19], a[164:167], v[184:187], a[16:19]
    ds_read_b64_tr_b16 a[132:133], v28 offset:8
    ds_read_b64_tr_b16 a[134:135], v28 offset:1032
    v_fma_mix_f32 v240, v106, v204, v212 op_sel_hi:[1,0,0]
    v_mfma_f32_16x16x32_bf16 a[20:23], a[164:167], v[188:191], a[20:23]
    s_add_u32 m0, s82, 0
    v_fma_mix_f32 v241, v106, v205, v213 op_sel:[1,0,0] op_sel_hi:[1,0,0]
    v_cvt_pk_bf16_f32 v170, v240, v241
    v_mfma_f32_16x16x32_bf16 a[24:27], a[164:167], v[192:195], a[24:27]
    buffer_load_dwordx4 v20, s[32:35], s80 offen lds
    v_fma_mix_f32 v242, v107, v206, v214 op_sel_hi:[1,0,0]
    v_mfma_f32_16x16x32_bf16 a[28:31], a[164:167], v[196:199], a[28:31]
    ds_read_b128 v[220:223], v34 offset:1296
    v_fma_mix_f32 v243, v107, v207, v215 op_sel:[1,0,0] op_sel_hi:[1,0,0]
    v_cvt_pk_bf16_f32 v171, v242, v243
    v_mfma_f32_16x16x32_bf16 a[32:35], a[168:171], v[184:187], a[32:35]
    ds_read_b64_tr_b16 a[136:137], v29 offset:0
    ds_read_b64_tr_b16 a[138:139], v29 offset:1024
    v_fma_mix_f32 v236, v108, v200, v208 op_sel_hi:[1,0,0]
    v_mfma_f32_16x16x32_bf16 a[36:39], a[168:171], v[188:191], a[36:39]
    buffer_load_dwordx4 v[160:163], v39, s[44:47], s83 offen offset:2048 sc1
    v_mfma_f32_16x16x32_bf16 a[40:43], a[168:171], v[192:195], a[40:43]
    buffer_load_dwordx4 v21, s[32:35], s80 offen offset:1024 lds
    v_fma_mix_f32 v237, v108, v201, v209 op_sel:[1,0,0] op_sel_hi:[1,0,0]
    v_mfma_f32_16x16x32_bf16 a[44:47], a[168:171], v[196:199], a[44:47]
    s_add_u32 s80, s80, 8192
    v_cvt_pk_bf16_f32 v172, v236, v237
    v_fma_mix_f32 v238, v109, v202, v210 op_sel_hi:[1,0,0]
    v_fma_mix_f32 v239, v109, v203, v211 op_sel:[1,0,0] op_sel_hi:[1,0,0]
    v_mfma_f32_16x16x32_bf16 a[48:51], a[172:175], v[184:187], a[48:51]
    ds_read_b64_tr_b16 a[140:141], v29 offset:8
    ds_read_b64_tr_b16 a[142:143], v29 offset:1032
    v_mfma_f32_16x16x32_bf16 a[52:55], a[172:175], v[188:191], a[52:55]
    buffer_load_dwordx4 v[164:167], v39, s[44:47], s83 offen offset:3072 sc1
    v_cvt_pk_bf16_f32 v173, v238, v239
    v_mfma_f32_16x16x32_bf16 a[56:59], a[172:175], v[192:195], a[56:59]
    v_fma_mix_f32 v240, v110, v204, v212 op_sel_hi:[1,0,0]
    v_fma_mix_f32 v241, v110, v205, v213 op_sel:[1,0,0] op_sel_hi:[1,0,0]
    v_cvt_pk_bf16_f32 v174, v240, v241
    v_mfma_f32_16x16x32_bf16 a[60:63], a[172:175], v[196:199], a[60:63]
    s_waitcnt lgkmcnt(10)
    v_fma_mix_f32 v242, v111, v206, v214 op_sel_hi:[1,0,0]
    v_fma_mix_f32 v243, v111, v207, v215 op_sel:[1,0,0] op_sel_hi:[1,0,0]
    v_mfma_f32_16x16x32_bf16 a[64:67], a[176:179], v[184:187], a[64:67]
    ds_read_b64_tr_b16 a[144:145], v30 offset:0
    ds_read_b64_tr_b16 a[146:147], v30 offset:1024
    v_cvt_pk_bf16_f32 v175, v242, v243
    v_mfma_f32_16x16x32_bf16 a[68:71], a[176:179], v[188:191], a[68:71]
    v_fma_mix_f32 v236, v112, v200, v208 op_sel_hi:[1,0,0]
    v_fma_mix_f32 v237, v112, v201, v209 op_sel:[1,0,0] op_sel_hi:[1,0,0]
    v_mfma_f32_16x16x32_bf16 a[72:75], a[176:179], v[192:195], a[72:75]
    v_cvt_pk_bf16_f32 v176, v236, v237
    v_fma_mix_f32 v238, v113, v202, v210 op_sel_hi:[1,0,0]
    v_fma_mix_f32 v239, v113, v203, v211 op_sel:[1,0,0] op_sel_hi:[1,0,0]
    v_mfma_f32_16x16x32_bf16 a[76:79], a[176:179], v[196:199], a[76:79]
    ds_read_b128 v[224:227], v34 offset:1312
    v_cvt_pk_bf16_f32 v177, v238, v239
    v_mfma_f32_16x16x32_bf16 a[80:83], a[180:183], v[184:187], a[80:83]
    ds_read_b64_tr_b16 a[148:149], v30 offset:8
    ds_read_b64_tr_b16 a[150:151], v30 offset:1032
    v_fma_mix_f32 v240, v114, v204, v212 op_sel_hi:[1,0,0]
    v_mfma_f32_16x16x32_bf16 a[84:87], a[180:183], v[188:191], a[84:87]
    s_add_u32 m0, s82, 8192
    v_fma_mix_f32 v241, v114, v205, v213 op_sel:[1,0,0] op_sel_hi:[1,0,0]
    v_cvt_pk_bf16_f32 v178, v240, v241
    v_mfma_f32_16x16x32_bf16 a[88:91], a[180:183], v[192:195], a[88:91]
    buffer_load_dwordx4 v20, s[32:35], s80 offen lds
    v_fma_mix_f32 v242, v115, v206, v214 op_sel_hi:[1,0,0]
    v_mfma_f32_16x16x32_bf16 a[92:95], a[180:183], v[196:199], a[92:95]
    ds_read_b128 v[228:231], v34 offset:1328
    v_fma_mix_f32 v243, v115, v207, v215 op_sel:[1,0,0] op_sel_hi:[1,0,0]
    v_cvt_pk_bf16_f32 v179, v242, v243
    v_mfma_f32_16x16x32_bf16 a[96:99], a[184:187], v[184:187], a[96:99]
    ds_read_b64_tr_b16 a[152:153], v31 offset:0
    ds_read_b64_tr_b16 a[154:155], v31 offset:1024
    v_fma_mix_f32 v236, v116, v200, v208 op_sel_hi:[1,0,0]
    v_mfma_f32_16x16x32_bf16 a[100:103], a[184:187], v[188:191], a[100:103]
    v_fma_mix_f32 v237, v116, v201, v209 op_sel:[1,0,0] op_sel_hi:[1,0,0]
    v_cvt_pk_bf16_f32 v180, v236, v237
    v_mfma_f32_16x16x32_bf16 a[104:107], a[184:187], v[192:195], a[104:107]
    buffer_load_dwordx4 v21, s[32:35], s80 offen offset:1024 lds
    v_fma_mix_f32 v238, v117, v202, v210 op_sel_hi:[1,0,0]
    v_mfma_f32_16x16x32_bf16 a[108:111], a[184:187], v[196:199], a[108:111]
    s_add_u32 s80, s80, 8192
    v_fma_mix_f32 v239, v117, v203, v211 op_sel:[1,0,0] op_sel_hi:[1,0,0]
    v_cvt_pk_bf16_f32 v181, v238, v239
    v_mfma_f32_16x16x32_bf16 a[112:115], a[188:191], v[184:187], a[112:115]
    ds_read_b64_tr_b16 a[156:157], v31 offset:8
    ds_read_b64_tr_b16 a[158:159], v31 offset:1032
    v_fma_mix_f32 v240, v118, v204, v212 op_sel_hi:[1,0,0]
    v_mfma_f32_16x16x32_bf16 a[116:119], a[188:191], v[188:191], a[116:119]
    v_fma_mix_f32 v241, v118, v205, v213 op_sel:[1,0,0] op_sel_hi:[1,0,0]
    v_cvt_pk_bf16_f32 v182, v240, v241
    v_mfma_f32_16x16x32_bf16 a[120:123], a[188:191], v[192:195], a[120:123]
    v_fma_mix_f32 v242, v119, v206, v214 op_sel_hi:[1,0,0]
    v_fma_mix_f32 v243, v119, v207, v215 op_sel:[1,0,0] op_sel_hi:[1,0,0]
    v_cvt_pk_bf16_f32 v183, v242, v243
    v_mfma_f32_16x16x32_bf16 a[124:127], a[188:191], v[196:199], a[124:127]
    buffer_load_dwordx4 v[152:155], v39, s[44:47], s83 offen offset:0 sc1
    s_add_u32 s83, s83, 131072
    s_waitcnt vmcnt(12)
    s_waitcnt lgkmcnt(4)
    v_mfma_f32_16x16x32_bf16 a[0:3], a[128:131], v[168:171], a[0:3]
    ds_read_b64_tr_b16 a[160:161], v28 offset:8192
    ds_read_b64_tr_b16 a[162:163], v28 offset:9216
    v_fma_mix_f32 v236, v120, v216, v224 op_sel_hi:[1,0,0]
    v_mfma_f32_16x16x32_bf16 a[4:7], a[128:131], v[172:175], a[4:7]
    buffer_load_dwordx4 v[52:55], v39, s[44:47], s83 offen offset:3072 sc1
    v_fma_mix_f32 v237, v120, v217, v225 op_sel:[1,0,0] op_sel_hi:[1,0,0]
    v_mfma_f32_16x16x32_bf16 a[8:11], a[128:131], v[176:179], a[8:11]
    v_cvt_pk_bf16_f32 v184, v236, v237
    v_fma_mix_f32 v238, v121, v218, v226 op_sel_hi:[1,0,0]
    v_mfma_f32_16x16x32_bf16 a[12:15], a[128:131], v[180:183], a[12:15]
    ds_read_b128 v[200:203], v34 offset:1536
    v_fma_mix_f32 v239, v121, v219, v227 op_sel:[1,0,0] op_sel_hi:[1,0,0]
    v_mfma_f32_16x16x32_bf16 a[16:19], a[132:135], v[168:171], a[16:19]
    ds_read_b64_tr_b16 a[164:165], v28 offset:8200
    ds_read_b64_tr_b16 a[166:167], v28 offset:9224
    v_cvt_pk_bf16_f32 v185, v238, v239
    v_mfma_f32_16x16x32_bf16 a[20:23], a[132:135], v[172:175], a[20:23]
    v_fma_mix_f32 v240, v122, v220, v228 op_sel_hi:[1,0,0]
    v_fma_mix_f32 v241, v122, v221, v229 op_sel:[1,0,0] op_sel_hi:[1,0,0]
    v_mfma_f32_16x16x32_bf16 a[24:27], a[132:135], v[176:179], a[24:27]
    v_cvt_pk_bf16_f32 v186, v240, v241
    v_fma_mix_f32 v242, v123, v222, v230 op_sel_hi:[1,0,0]
    v_mfma_f32_16x16x32_bf16 a[28:31], a[132:135], v[180:183], a[28:31]
    ds_read_b128 v[204:207], v34 offset:1552
    v_fma_mix_f32 v243, v123, v223, v231 op_sel:[1,0,0] op_sel_hi:[1,0,0]
    v_cvt_pk_bf16_f32 v187, v242, v243
    v_mfma_f32_16x16x32_bf16 a[32:35], a[136:139], v[168:171], a[32:35]
    ds_read_b64_tr_b16 a[168:169], v29 offset:8192
    ds_read_b64_tr_b16 a[170:171], v29 offset:9216
    v_fma_mix_f32 v236, v124, v216, v224 op_sel_hi:[1,0,0]
    v_mfma_f32_16x16x32_bf16 a[36:39], a[136:139], v[172:175], a[36:39]
    v_fma_mix_f32 v237, v124, v217, v225 op_sel:[1,0,0] op_sel_hi:[1,0,0]
    v_cvt_pk_bf16_f32 v188, v236, v237
    v_mfma_f32_16x16x32_bf16 a[40:43], a[136:139], v[176:179], a[40:43]
    v_fma_mix_f32 v238, v125, v218, v226 op_sel_hi:[1,0,0]
    v_fma_mix_f32 v239, v125, v219, v227 op_sel:[1,0,0] op_sel_hi:[1,0,0]
    v_mfma_f32_16x16x32_bf16 a[44:47], a[136:139], v[180:183], a[44:47]
    ds_read_b128 v[208:211], v34 offset:1568
    v_cvt_pk_bf16_f32 v189, v238, v239
    v_mfma_f32_16x16x32_bf16 a[48:51], a[140:143], v[168:171], a[48:51]
    ds_read_b64_tr_b16 a[172:173], v29 offset:8200
    ds_read_b64_tr_b16 a[174:175], v29 offset:9224
    v_fma_mix_f32 v240, v126, v220, v228 op_sel_hi:[1,0,0]
    v_mfma_f32_16x16x32_bf16 a[52:55], a[140:143], v[172:175], a[52:55]
    v_fma_mix_f32 v241, v126, v221, v229 op_sel:[1,0,0] op_sel_hi:[1,0,0]
    v_cvt_pk_bf16_f32 v190, v240, v241
    v_mfma_f32_16x16x32_bf16 a[56:59], a[140:143], v[176:179], a[56:59]
    v_fma_mix_f32 v242, v127, v222, v230 op_sel_hi:[1,0,0]
    v_fma_mix_f32 v243, v127, v223, v231 op_sel:[1,0,0] op_sel_hi:[1,0,0]
    v_mfma_f32_16x16x32_bf16 a[60:63], a[140:143], v[180:183], a[60:63]
    s_waitcnt lgkmcnt(11)
    v_cvt_pk_bf16_f32 v191, v242, v243
    v_fma_mix_f32 v236, v128, v216, v224 op_sel_hi:[1,0,0]
    v_mfma_f32_16x16x32_bf16 a[64:67], a[144:147], v[168:171], a[64:67]
    ds_read_b64_tr_b16 a[176:177], v30 offset:8192
    ds_read_b64_tr_b16 a[178:179], v30 offset:9216
    v_fma_mix_f32 v237, v128, v217, v225 op_sel:[1,0,0] op_sel_hi:[1,0,0]
    v_mfma_f32_16x16x32_bf16 a[68:71], a[144:147], v[172:175], a[68:71]
    v_cvt_pk_bf16_f32 v192, v236, v237
    v_fma_mix_f32 v238, v129, v218, v226 op_sel_hi:[1,0,0]
    v_mfma_f32_16x16x32_bf16 a[72:75], a[144:147], v[176:179], a[72:75]
    v_fma_mix_f32 v239, v129, v219, v227 op_sel:[1,0,0] op_sel_hi:[1,0,0]
    v_cvt_pk_bf16_f32 v193, v238, v239
    v_mfma_f32_16x16x32_bf16 a[76:79], a[144:147], v[180:183], a[76:79]
    ds_read_b128 v[212:215], v34 offset:1584
    v_fma_mix_f32 v240, v130, v220, v228 op_sel_hi:[1,0,0]
    v_fma_mix_f32 v241, v130, v221, v229 op_sel:[1,0,0] op_sel_hi:[1,0,0]
    v_mfma_f32_16x16x32_bf16 a[80:83], a[148:151], v[168:171], a[80:83]
    ds_read_b64_tr_b16 a[180:181], v30 offset:8200
    ds_read_b64_tr_b16 a[182:183], v30 offset:9224
    v_mfma_f32_16x16x32_bf16 a[84:87], a[148:151], v[172:175], a[84:87]
    v_cvt_pk_bf16_f32 v194, v240, v241
    v_fma_mix_f32 v242, v131, v222, v230 op_sel_hi:[1,0,0]
    v_mfma_f32_16x16x32_bf16 a[88:91], a[148:151], v[176:179], a[88:91]
    v_fma_mix_f32 v243, v131, v223, v231 op_sel:[1,0,0] op_sel_hi:[1,0,0]
    v_cvt_pk_bf16_f32 v195, v242, v243
    v_fma_mix_f32 v236, v132, v216, v224 op_sel_hi:[1,0,0]
    v_mfma_f32_16x16x32_bf16 a[92:95], a[148:151], v[180:183], a[92:95]
    buffer_load_dwordx4 v[40:43], v39, s[44:47], s83 offen offset:0 sc1
    v_mfma_f32_16x16x32_bf16 a[96:99], a[152:155], v[168:171], a[96:99]
    ds_read_b64_tr_b16 a[184:185], v31 offset:8192
    ds_read_b64_tr_b16 a[186:187], v31 offset:9216
    v_fma_mix_f32 v237, v132, v217, v225 op_sel:[1,0,0] op_sel_hi:[1,0,0]
    v_mfma_f32_16x16x32_bf16 a[100:103], a[152:155], v[172:175], a[100:103]
    v_cvt_pk_bf16_f32 v196, v236, v237
    v_fma_mix_f32 v238, v133, v218, v226 op_sel_hi:[1,0,0]
    v_mfma_f32_16x16x32_bf16 a[104:107], a[152:155], v[176:179], a[104:107]
    v_fma_mix_f32 v239, v133, v219, v227 op_sel:[1,0,0] op_sel_hi:[1,0,0]
    v_cvt_pk_bf16_f32 v197, v238, v239
    v_mfma_f32_16x16x32_bf16 a[108:111], a[152:155], v[180:183], a[108:111]
    buffer_load_dwordx4 v[44:47], v39, s[44:47], s83 offen offset:1024 sc1
    v_fma_mix_f32 v240, v134, v220, v228 op_sel_hi:[1,0,0]
    v_mfma_f32_16x16x32_bf16 a[112:115], a[156:159], v[168:171], a[112:115]
    ds_read_b64_tr_b16 a[188:189], v31 offset:8200
    ds_read_b64_tr_b16 a[190:191], v31 offset:9224
    v_fma_mix_f32 v241, v134, v221, v229 op_sel:[1,0,0] op_sel_hi:[1,0,0]
    v_mfma_f32_16x16x32_bf16 a[116:119], a[156:159], v[172:175], a[116:119]
    v_cvt_pk_bf16_f32 v198, v240, v241
    v_fma_mix_f32 v242, v135, v222, v230 op_sel_hi:[1,0,0]
    v_mfma_f32_16x16x32_bf16 a[120:123], a[156:159], v[176:179], a[120:123]
    v_fma_mix_f32 v243, v135, v223, v231 op_sel:[1,0,0] op_sel_hi:[1,0,0]
    v_cvt_pk_bf16_f32 v199, v242, v243
    v_mfma_f32_16x16x32_bf16 a[124:127], a[156:159], v[180:183], a[124:127]
    buffer_load_dwordx4 v[48:51], v39, s[44:47], s83 offen offset:2048 sc1
    s_add_u32 s83, s83, 131072
    s_waitcnt vmcnt(12)
    s_waitcnt lgkmcnt(6)
    s_barrier
    v_mfma_f32_16x16x32_bf16 a[0:3], a[160:163], v[184:187], a[0:3]
    ds_read_b64_tr_b16 a[128:129], v24 offset:32768
    ds_read_b64_tr_b16 a[130:131], v24 offset:33792
    v_fma_mix_f32 v236, v136, v200, v208 op_sel_hi:[1,0,0]
    v_mfma_f32_16x16x32_bf16 a[4:7], a[160:163], v[188:191], a[4:7]
    buffer_load_dwordx4 v[60:63], v39, s[44:47], s83 offen offset:1024 sc1
    v_fma_mix_f32 v237, v136, v201, v209 op_sel:[1,0,0] op_sel_hi:[1,0,0]
    v_mfma_f32_16x16x32_bf16 a[8:11], a[160:163], v[192:195], a[8:11]
    v_cvt_pk_bf16_f32 v168, v236, v237
    v_fma_mix_f32 v238, v137, v202, v210 op_sel_hi:[1,0,0]
    v_fma_mix_f32 v239, v137, v203, v211 op_sel:[1,0,0] op_sel_hi:[1,0,0]
    v_mfma_f32_16x16x32_bf16 a[12:15], a[160:163], v[196:199], a[12:15]
    ds_read_b128 v[216:219], v34 offset:1792
    v_cvt_pk_bf16_f32 v169, v238, v239
    v_mfma_f32_16x16x32_bf16 a[16:19], a[164:167], v[184:187], a[16:19]
    ds_read_b64_tr_b16 a[132:133], v24 offset:32776
    ds_read_b64_tr_b16 a[134:135], v24 offset:33800
    v_fma_mix_f32 v240, v138, v204, v212 op_sel_hi:[1,0,0]
    v_mfma_f32_16x16x32_bf16 a[20:23], a[164:167], v[188:191], a[20:23]
    s_add_u32 m0, s82, 16384
    v_fma_mix_f32 v241, v138, v205, v213 op_sel:[1,0,0] op_sel_hi:[1,0,0]
    v_cvt_pk_bf16_f32 v170, v240, v241
    v_mfma_f32_16x16x32_bf16 a[24:27], a[164:167], v[192:195], a[24:27]
    buffer_load_dwordx4 v20, s[32:35], s80 offen lds
    v_fma_mix_f32 v242, v139, v206, v214 op_sel_hi:[1,0,0]
    v_mfma_f32_16x16x32_bf16 a[28:31], a[164:167], v[196:199], a[28:31]
    ds_read_b128 v[220:223], v34 offset:1808
    v_fma_mix_f32 v243, v139, v207, v215 op_sel:[1,0,0] op_sel_hi:[1,0,0]
    v_cvt_pk_bf16_f32 v171, v242, v243
    v_mfma_f32_16x16x32_bf16 a[32:35], a[168:171], v[184:187], a[32:35]
    ds_read_b64_tr_b16 a[136:137], v25 offset:32768
    ds_read_b64_tr_b16 a[138:139], v25 offset:33792
    v_fma_mix_f32 v236, v140, v200, v208 op_sel_hi:[1,0,0]
    v_mfma_f32_16x16x32_bf16 a[36:39], a[168:171], v[188:191], a[36:39]
    buffer_load_dwordx4 v[64:67], v39, s[44:47], s83 offen offset:2048 sc1
    v_mfma_f32_16x16x32_bf16 a[40:43], a[168:171], v[192:195], a[40:43]
    buffer_load_dwordx4 v21, s[32:35], s80 offen offset:1024 lds
    v_fma_mix_f32 v237, v140, v201, v209 op_sel:[1,0,0] op_sel_hi:[1,0,0]
    v_mfma_f32_16x16x32_bf16 a[44:47], a[168:171], v[196:199], a[44:47]
    s_add_u32 s80, s80, 8192
    v_cvt_pk_bf16_f32 v172, v236, v237
    v_fma_mix_f32 v238, v141, v202, v210 op_sel_hi:[1,0,0]
    v_fma_mix_f32 v239, v141, v203, v211 op_sel:[1,0,0] op_sel_hi:[1,0,0]
    v_mfma_f32_16x16x32_bf16 a[48:51], a[172:175], v[184:187], a[48:51]
    ds_read_b64_tr_b16 a[140:141], v25 offset:32776
    ds_read_b64_tr_b16 a[142:143], v25 offset:33800
    v_mfma_f32_16x16x32_bf16 a[52:55], a[172:175], v[188:191], a[52:55]
    buffer_load_dwordx4 v[68:71], v39, s[44:47], s83 offen offset:3072 sc1
    v_cvt_pk_bf16_f32 v173, v238, v239
    v_mfma_f32_16x16x32_bf16 a[56:59], a[172:175], v[192:195], a[56:59]
    v_fma_mix_f32 v240, v142, v204, v212 op_sel_hi:[1,0,0]
    v_fma_mix_f32 v241, v142, v205, v213 op_sel:[1,0,0] op_sel_hi:[1,0,0]
    v_cvt_pk_bf16_f32 v174, v240, v241
    v_mfma_f32_16x16x32_bf16 a[60:63], a[172:175], v[196:199], a[60:63]
    s_waitcnt lgkmcnt(10)
    v_fma_mix_f32 v242, v143, v206, v214 op_sel_hi:[1,0,0]
    v_fma_mix_f32 v243, v143, v207, v215 op_sel:[1,0,0] op_sel_hi:[1,0,0]
    v_mfma_f32_16x16x32_bf16 a[64:67], a[176:179], v[184:187], a[64:67]
    ds_read_b64_tr_b16 a[144:145], v26 offset:32768
    ds_read_b64_tr_b16 a[146:147], v26 offset:33792
    v_cvt_pk_bf16_f32 v175, v242, v243
    v_mfma_f32_16x16x32_bf16 a[68:71], a[176:179], v[188:191], a[68:71]
    v_fma_mix_f32 v236, v144, v200, v208 op_sel_hi:[1,0,0]
    v_fma_mix_f32 v237, v144, v201, v209 op_sel:[1,0,0] op_sel_hi:[1,0,0]
    v_mfma_f32_16x16x32_bf16 a[72:75], a[176:179], v[192:195], a[72:75]
    v_cvt_pk_bf16_f32 v176, v236, v237
    v_fma_mix_f32 v238, v145, v202, v210 op_sel_hi:[1,0,0]
    v_fma_mix_f32 v239, v145, v203, v211 op_sel:[1,0,0] op_sel_hi:[1,0,0]
    v_mfma_f32_16x16x32_bf16 a[76:79], a[176:179], v[196:199], a[76:79]
    ds_read_b128 v[224:227], v34 offset:1824
    v_cvt_pk_bf16_f32 v177, v238, v239
    v_mfma_f32_16x16x32_bf16 a[80:83], a[180:183], v[184:187], a[80:83]
    ds_read_b64_tr_b16 a[148:149], v26 offset:32776
    ds_read_b64_tr_b16 a[150:151], v26 offset:33800
    v_fma_mix_f32 v240, v146, v204, v212 op_sel_hi:[1,0,0]
    v_mfma_f32_16x16x32_bf16 a[84:87], a[180:183], v[188:191], a[84:87]
    s_add_u32 m0, s82, 24576
    v_fma_mix_f32 v241, v146, v205, v213 op_sel:[1,0,0] op_sel_hi:[1,0,0]
    v_cvt_pk_bf16_f32 v178, v240, v241
    v_mfma_f32_16x16x32_bf16 a[88:91], a[180:183], v[192:195], a[88:91]
    buffer_load_dwordx4 v20, s[32:35], s80 offen lds
    v_fma_mix_f32 v242, v147, v206, v214 op_sel_hi:[1,0,0]
    v_mfma_f32_16x16x32_bf16 a[92:95], a[180:183], v[196:199], a[92:95]
    ds_read_b128 v[228:231], v34 offset:1840
    v_fma_mix_f32 v243, v147, v207, v215 op_sel:[1,0,0] op_sel_hi:[1,0,0]
    v_cvt_pk_bf16_f32 v179, v242, v243
    v_mfma_f32_16x16x32_bf16 a[96:99], a[184:187], v[184:187], a[96:99]
    ds_read_b64_tr_b16 a[152:153], v27 offset:32768
    ds_read_b64_tr_b16 a[154:155], v27 offset:33792
    v_fma_mix_f32 v236, v148, v200, v208 op_sel_hi:[1,0,0]
    v_mfma_f32_16x16x32_bf16 a[100:103], a[184:187], v[188:191], a[100:103]
    v_fma_mix_f32 v237, v148, v201, v209 op_sel:[1,0,0] op_sel_hi:[1,0,0]
    v_cvt_pk_bf16_f32 v180, v236, v237
    v_mfma_f32_16x16x32_bf16 a[104:107], a[184:187], v[192:195], a[104:107]
    buffer_load_dwordx4 v21, s[32:35], s80 offen offset:1024 lds
    v_fma_mix_f32 v238, v149, v202, v210 op_sel_hi:[1,0,0]
    v_mfma_f32_16x16x32_bf16 a[108:111], a[184:187], v[196:199], a[108:111]
    s_add_u32 s80, s80, 8192
    v_fma_mix_f32 v239, v149, v203, v211 op_sel:[1,0,0] op_sel_hi:[1,0,0]
    v_cvt_pk_bf16_f32 v181, v238, v239
    v_mfma_f32_16x16x32_bf16 a[112:115], a[188:191], v[184:187], a[112:115]
    ds_read_b64_tr_b16 a[156:157], v27 offset:32776
    ds_read_b64_tr_b16 a[158:159], v27 offset:33800
    v_fma_mix_f32 v240, v150, v204, v212 op_sel_hi:[1,0,0]
    v_mfma_f32_16x16x32_bf16 a[116:119], a[188:191], v[188:191], a[116:119]
    v_fma_mix_f32 v241, v150, v205, v213 op_sel:[1,0,0] op_sel_hi:[1,0,0]
    v_cvt_pk_bf16_f32 v182, v240, v241
    v_mfma_f32_16x16x32_bf16 a[120:123], a[188:191], v[192:195], a[120:123]
    v_fma_mix_f32 v242, v151, v206, v214 op_sel_hi:[1,0,0]
    v_fma_mix_f32 v243, v151, v207, v215 op_sel:[1,0,0] op_sel_hi:[1,0,0]
    v_cvt_pk_bf16_f32 v183, v242, v243
    v_mfma_f32_16x16x32_bf16 a[124:127], a[188:191], v[196:199], a[124:127]
    buffer_load_dwordx4 v[56:59], v39, s[44:47], s83 offen offset:0 sc1
    s_add_u32 s83, s83, 131072
    s_waitcnt vmcnt(12)
    s_waitcnt lgkmcnt(4)
    v_mfma_f32_16x16x32_bf16 a[0:3], a[128:131], v[168:171], a[0:3]
    ds_read_b64_tr_b16 a[160:161], v24 offset:40960
    ds_read_b64_tr_b16 a[162:163], v24 offset:41984
    v_fma_mix_f32 v236, v152, v216, v224 op_sel_hi:[1,0,0]
    v_mfma_f32_16x16x32_bf16 a[4:7], a[128:131], v[172:175], a[4:7]
    buffer_load_dwordx4 v[84:87], v39, s[44:47], s83 offen offset:3072 sc1
    v_fma_mix_f32 v237, v152, v217, v225 op_sel:[1,0,0] op_sel_hi:[1,0,0]
    v_mfma_f32_16x16x32_bf16 a[8:11], a[128:131], v[176:179], a[8:11]
    v_cvt_pk_bf16_f32 v184, v236, v237
    v_fma_mix_f32 v238, v153, v218, v226 op_sel_hi:[1,0,0]
    v_mfma_f32_16x16x32_bf16 a[12:15], a[128:131], v[180:183], a[12:15]
    ds_read_b128 v[200:203], v34 offset:2048
    v_fma_mix_f32 v239, v153, v219, v227 op_sel:[1,0,0] op_sel_hi:[1,0,0]
    v_mfma_f32_16x16x32_bf16 a[16:19], a[132:135], v[168:171], a[16:19]
    ds_read_b64_tr_b16 a[164:165], v24 offset:40968
    ds_read_b64_tr_b16 a[166:167], v24 offset:41992
    v_cvt_pk_bf16_f32 v185, v238, v239
    v_mfma_f32_16x16x32_bf16 a[20:23], a[132:135], v[172:175], a[20:23]
    v_fma_mix_f32 v240, v154, v220, v228 op_sel_hi:[1,0,0]
    v_fma_mix_f32 v241, v154, v221, v229 op_sel:[1,0,0] op_sel_hi:[1,0,0]
    v_mfma_f32_16x16x32_bf16 a[24:27], a[132:135], v[176:179], a[24:27]
    v_cvt_pk_bf16_f32 v186, v240, v241
    v_fma_mix_f32 v242, v155, v222, v230 op_sel_hi:[1,0,0]
    v_mfma_f32_16x16x32_bf16 a[28:31], a[132:135], v[180:183], a[28:31]
    ds_read_b128 v[204:207], v34 offset:2064
    v_fma_mix_f32 v243, v155, v223, v231 op_sel:[1,0,0] op_sel_hi:[1,0,0]
    v_cvt_pk_bf16_f32 v187, v242, v243
    v_mfma_f32_16x16x32_bf16 a[32:35], a[136:139], v[168:171], a[32:35]
    ds_read_b64_tr_b16 a[168:169], v25 offset:40960
    ds_read_b64_tr_b16 a[170:171], v25 offset:41984
    v_fma_mix_f32 v236, v156, v216, v224 op_sel_hi:[1,0,0]
    v_mfma_f32_16x16x32_bf16 a[36:39], a[136:139], v[172:175], a[36:39]
    v_fma_mix_f32 v237, v156, v217, v225 op_sel:[1,0,0] op_sel_hi:[1,0,0]
    v_cvt_pk_bf16_f32 v188, v236, v237
    v_mfma_f32_16x16x32_bf16 a[40:43], a[136:139], v[176:179], a[40:43]
    v_fma_mix_f32 v238, v157, v218, v226 op_sel_hi:[1,0,0]
    v_fma_mix_f32 v239, v157, v219, v227 op_sel:[1,0,0] op_sel_hi:[1,0,0]
    v_mfma_f32_16x16x32_bf16 a[44:47], a[136:139], v[180:183], a[44:47]
    ds_read_b128 v[208:211], v34 offset:2080
    v_cvt_pk_bf16_f32 v189, v238, v239
    v_mfma_f32_16x16x32_bf16 a[48:51], a[140:143], v[168:171], a[48:51]
    ds_read_b64_tr_b16 a[172:173], v25 offset:40968
    ds_read_b64_tr_b16 a[174:175], v25 offset:41992
    v_fma_mix_f32 v240, v158, v220, v228 op_sel_hi:[1,0,0]
    v_mfma_f32_16x16x32_bf16 a[52:55], a[140:143], v[172:175], a[52:55]
    v_fma_mix_f32 v241, v158, v221, v229 op_sel:[1,0,0] op_sel_hi:[1,0,0]
    v_cvt_pk_bf16_f32 v190, v240, v241
    v_mfma_f32_16x16x32_bf16 a[56:59], a[140:143], v[176:179], a[56:59]
    v_fma_mix_f32 v242, v159, v222, v230 op_sel_hi:[1,0,0]
    v_fma_mix_f32 v243, v159, v223, v231 op_sel:[1,0,0] op_sel_hi:[1,0,0]
    v_mfma_f32_16x16x32_bf16 a[60:63], a[140:143], v[180:183], a[60:63]
    s_waitcnt lgkmcnt(11)
    v_cvt_pk_bf16_f32 v191, v242, v243
    v_fma_mix_f32 v236, v160, v216, v224 op_sel_hi:[1,0,0]
    v_mfma_f32_16x16x32_bf16 a[64:67], a[144:147], v[168:171], a[64:67]
    ds_read_b64_tr_b16 a[176:177], v26 offset:40960
    ds_read_b64_tr_b16 a[178:179], v26 offset:41984
    v_fma_mix_f32 v237, v160, v217, v225 op_sel:[1,0,0] op_sel_hi:[1,0,0]
    v_mfma_f32_16x16x32_bf16 a[68:71], a[144:147], v[172:175], a[68:71]
    v_cvt_pk_bf16_f32 v192, v236, v237
    v_fma_mix_f32 v238, v161, v218, v226 op_sel_hi:[1,0,0]
    v_mfma_f32_16x16x32_bf16 a[72:75], a[144:147], v[176:179], a[72:75]
    v_fma_mix_f32 v239, v161, v219, v227 op_sel:[1,0,0] op_sel_hi:[1,0,0]
    v_cvt_pk_bf16_f32 v193, v238, v239
    v_mfma_f32_16x16x32_bf16 a[76:79], a[144:147], v[180:183], a[76:79]
    ds_read_b128 v[212:215], v34 offset:2096
    v_fma_mix_f32 v240, v162, v220, v228 op_sel_hi:[1,0,0]
    v_fma_mix_f32 v241, v162, v221, v229 op_sel:[1,0,0] op_sel_hi:[1,0,0]
    v_mfma_f32_16x16x32_bf16 a[80:83], a[148:151], v[168:171], a[80:83]
    ds_read_b64_tr_b16 a[180:181], v26 offset:40968
    ds_read_b64_tr_b16 a[182:183], v26 offset:41992
    v_mfma_f32_16x16x32_bf16 a[84:87], a[148:151], v[172:175], a[84:87]
    v_cvt_pk_bf16_f32 v194, v240, v241
    v_fma_mix_f32 v242, v163, v222, v230 op_sel_hi:[1,0,0]
    v_mfma_f32_16x16x32_bf16 a[88:91], a[148:151], v[176:179], a[88:91]
    v_fma_mix_f32 v243, v163, v223, v231 op_sel:[1,0,0] op_sel_hi:[1,0,0]
    v_cvt_pk_bf16_f32 v195, v242, v243
    v_fma_mix_f32 v236, v164, v216, v224 op_sel_hi:[1,0,0]
    v_mfma_f32_16x16x32_bf16 a[92:95], a[148:151], v[180:183], a[92:95]
    buffer_load_dwordx4 v[72:75], v39, s[44:47], s83 offen offset:0 sc1
    v_mfma_f32_16x16x32_bf16 a[96:99], a[152:155], v[168:171], a[96:99]
    ds_read_b64_tr_b16 a[184:185], v27 offset:40960
    ds_read_b64_tr_b16 a[186:187], v27 offset:41984
    v_fma_mix_f32 v237, v164, v217, v225 op_sel:[1,0,0] op_sel_hi:[1,0,0]
    v_mfma_f32_16x16x32_bf16 a[100:103], a[152:155], v[172:175], a[100:103]
    v_cvt_pk_bf16_f32 v196, v236, v237
    v_fma_mix_f32 v238, v165, v218, v226 op_sel_hi:[1,0,0]
    v_mfma_f32_16x16x32_bf16 a[104:107], a[152:155], v[176:179], a[104:107]
    v_fma_mix_f32 v239, v165, v219, v227 op_sel:[1,0,0] op_sel_hi:[1,0,0]
    v_cvt_pk_bf16_f32 v197, v238, v239
    v_mfma_f32_16x16x32_bf16 a[108:111], a[152:155], v[180:183], a[108:111]
    buffer_load_dwordx4 v[76:79], v39, s[44:47], s83 offen offset:1024 sc1
    v_fma_mix_f32 v240, v166, v220, v228 op_sel_hi:[1,0,0]
    v_mfma_f32_16x16x32_bf16 a[112:115], a[156:159], v[168:171], a[112:115]
    ds_read_b64_tr_b16 a[188:189], v27 offset:40968
    ds_read_b64_tr_b16 a[190:191], v27 offset:41992
    v_fma_mix_f32 v241, v166, v221, v229 op_sel:[1,0,0] op_sel_hi:[1,0,0]
    v_mfma_f32_16x16x32_bf16 a[116:119], a[156:159], v[172:175], a[116:119]
    v_cvt_pk_bf16_f32 v198, v240, v241
    v_fma_mix_f32 v242, v167, v222, v230 op_sel_hi:[1,0,0]
    v_mfma_f32_16x16x32_bf16 a[120:123], a[156:159], v[176:179], a[120:123]
    v_fma_mix_f32 v243, v167, v223, v231 op_sel:[1,0,0] op_sel_hi:[1,0,0]
    v_cvt_pk_bf16_f32 v199, v242, v243
    v_mfma_f32_16x16x32_bf16 a[124:127], a[156:159], v[180:183], a[124:127]
    buffer_load_dwordx4 v[80:83], v39, s[44:47], s83 offen offset:2048 sc1
    s_add_u32 s83, s83, 131072
    s_waitcnt vmcnt(12)
    s_waitcnt lgkmcnt(6)
    s_barrier
    v_mfma_f32_16x16x32_bf16 a[0:3], a[160:163], v[184:187], a[0:3]
    ds_read_b64_tr_b16 a[128:129], v28 offset:16384
    ds_read_b64_tr_b16 a[130:131], v28 offset:17408
    v_fma_mix_f32 v236, v40, v200, v208 op_sel_hi:[1,0,0]
    v_mfma_f32_16x16x32_bf16 a[4:7], a[160:163], v[188:191], a[4:7]
    buffer_load_dwordx4 v[92:95], v39, s[44:47], s83 offen offset:1024 sc1
    v_fma_mix_f32 v237, v40, v201, v209 op_sel:[1,0,0] op_sel_hi:[1,0,0]
    v_mfma_f32_16x16x32_bf16 a[8:11], a[160:163], v[192:195], a[8:11]
    v_cvt_pk_bf16_f32 v168, v236, v237
    v_fma_mix_f32 v238, v41, v202, v210 op_sel_hi:[1,0,0]
    v_fma_mix_f32 v239, v41, v203, v211 op_sel:[1,0,0] op_sel_hi:[1,0,0]
    v_mfma_f32_16x16x32_bf16 a[12:15], a[160:163], v[196:199], a[12:15]
    ds_read_b128 v[216:219], v34 offset:2304
    v_cvt_pk_bf16_f32 v169, v238, v239
    v_mfma_f32_16x16x32_bf16 a[16:19], a[164:167], v[184:187], a[16:19]
    ds_read_b64_tr_b16 a[132:133], v28 offset:16392
    ds_read_b64_tr_b16 a[134:135], v28 offset:17416
    v_fma_mix_f32 v240, v42, v204, v212 op_sel_hi:[1,0,0]
    v_mfma_f32_16x16x32_bf16 a[20:23], a[164:167], v[188:191], a[20:23]
    s_add_u32 m0, s82, 65536
    v_fma_mix_f32 v241, v42, v205, v213 op_sel:[1,0,0] op_sel_hi:[1,0,0]
    v_cvt_pk_bf16_f32 v170, v240, v241
    v_mfma_f32_16x16x32_bf16 a[24:27], a[164:167], v[192:195], a[24:27]
    buffer_load_dwordx4 v22, s[36:39], s81 offen lds
    v_fma_mix_f32 v242, v43, v206, v214 op_sel_hi:[1,0,0]
    v_mfma_f32_16x16x32_bf16 a[28:31], a[164:167], v[196:199], a[28:31]
    ds_read_b128 v[220:223], v34 offset:2320
    v_fma_mix_f32 v243, v43, v207, v215 op_sel:[1,0,0] op_sel_hi:[1,0,0]
    v_cvt_pk_bf16_f32 v171, v242, v243
    v_mfma_f32_16x16x32_bf16 a[32:35], a[168:171], v[184:187], a[32:35]
    ds_read_b64_tr_b16 a[136:137], v29 offset:16384
    ds_read_b64_tr_b16 a[138:139], v29 offset:17408
    v_fma_mix_f32 v236, v44, v200, v208 op_sel_hi:[1,0,0]
    v_mfma_f32_16x16x32_bf16 a[36:39], a[168:171], v[188:191], a[36:39]
    buffer_load_dwordx4 v[96:99], v39, s[44:47], s83 offen offset:2048 sc1
    v_mfma_f32_16x16x32_bf16 a[40:43], a[168:171], v[192:195], a[40:43]
    buffer_load_dwordx4 v23, s[36:39], s81 offen offset:1024 lds
    v_fma_mix_f32 v237, v44, v201, v209 op_sel:[1,0,0] op_sel_hi:[1,0,0]
    v_mfma_f32_16x16x32_bf16 a[44:47], a[168:171], v[196:199], a[44:47]
    s_add_u32 s81, s81, 8192
    v_cvt_pk_bf16_f32 v172, v236, v237
    v_fma_mix_f32 v238, v45, v202, v210 op_sel_hi:[1,0,0]
    v_fma_mix_f32 v239, v45, v203, v211 op_sel:[1,0,0] op_sel_hi:[1,0,0]
    v_mfma_f32_16x16x32_bf16 a[48:51], a[172:175], v[184:187], a[48:51]
    ds_read_b64_tr_b16 a[140:141], v29 offset:16392
    ds_read_b64_tr_b16 a[142:143], v29 offset:17416
    v_mfma_f32_16x16x32_bf16 a[52:55], a[172:175], v[188:191], a[52:55]
    buffer_load_dwordx4 v[100:103], v39, s[44:47], s83 offen offset:3072 sc1
    v_cvt_pk_bf16_f32 v173, v238, v239
    v_mfma_f32_16x16x32_bf16 a[56:59], a[172:175], v[192:195], a[56:59]
    v_fma_mix_f32 v240, v46, v204, v212 op_sel_hi:[1,0,0]
    v_fma_mix_f32 v241, v46, v205, v213 op_sel:[1,0,0] op_sel_hi:[1,0,0]
    v_cvt_pk_bf16_f32 v174, v240, v241
    v_mfma_f32_16x16x32_bf16 a[60:63], a[172:175], v[196:199], a[60:63]
    s_waitcnt lgkmcnt(10)
    v_fma_mix_f32 v242, v47, v206, v214 op_sel_hi:[1,0,0]
    v_fma_mix_f32 v243, v47, v207, v215 op_sel:[1,0,0] op_sel_hi:[1,0,0]
    v_mfma_f32_16x16x32_bf16 a[64:67], a[176:179], v[184:187], a[64:67]
    ds_read_b64_tr_b16 a[144:145], v30 offset:16384
    ds_read_b64_tr_b16 a[146:147], v30 offset:17408
    v_cvt_pk_bf16_f32 v175, v242, v243
    v_mfma_f32_16x16x32_bf16 a[68:71], a[176:179], v[188:191], a[68:71]
    v_fma_mix_f32 v236, v48, v200, v208 op_sel_hi:[1,0,0]
    v_fma_mix_f32 v237, v48, v201, v209 op_sel:[1,0,0] op_sel_hi:[1,0,0]
    v_mfma_f32_16x16x32_bf16 a[72:75], a[176:179], v[192:195], a[72:75]
    v_cvt_pk_bf16_f32 v176, v236, v237
    v_fma_mix_f32 v238, v49, v202, v210 op_sel_hi:[1,0,0]
    v_fma_mix_f32 v239, v49, v203, v211 op_sel:[1,0,0] op_sel_hi:[1,0,0]
    v_mfma_f32_16x16x32_bf16 a[76:79], a[176:179], v[196:199], a[76:79]
    ds_read_b128 v[224:227], v34 offset:2336
    v_cvt_pk_bf16_f32 v177, v238, v239
    v_mfma_f32_16x16x32_bf16 a[80:83], a[180:183], v[184:187], a[80:83]
    ds_read_b64_tr_b16 a[148:149], v30 offset:16392
    ds_read_b64_tr_b16 a[150:151], v30 offset:17416
    v_fma_mix_f32 v240, v50, v204, v212 op_sel_hi:[1,0,0]
    v_mfma_f32_16x16x32_bf16 a[84:87], a[180:183], v[188:191], a[84:87]
    s_add_u32 m0, s82, 73728
    v_fma_mix_f32 v241, v50, v205, v213 op_sel:[1,0,0] op_sel_hi:[1,0,0]
    v_cvt_pk_bf16_f32 v178, v240, v241
    v_mfma_f32_16x16x32_bf16 a[88:91], a[180:183], v[192:195], a[88:91]
    buffer_load_dwordx4 v22, s[36:39], s81 offen lds
    v_fma_mix_f32 v242, v51, v206, v214 op_sel_hi:[1,0,0]
    v_mfma_f32_16x16x32_bf16 a[92:95], a[180:183], v[196:199], a[92:95]
    ds_read_b128 v[228:231], v34 offset:2352
    v_fma_mix_f32 v243, v51, v207, v215 op_sel:[1,0,0] op_sel_hi:[1,0,0]
    v_cvt_pk_bf16_f32 v179, v242, v243
    v_mfma_f32_16x16x32_bf16 a[96:99], a[184:187], v[184:187], a[96:99]
    ds_read_b64_tr_b16 a[152:153], v31 offset:16384
    ds_read_b64_tr_b16 a[154:155], v31 offset:17408
    v_fma_mix_f32 v236, v52, v200, v208 op_sel_hi:[1,0,0]
    v_mfma_f32_16x16x32_bf16 a[100:103], a[184:187], v[188:191], a[100:103]
    v_fma_mix_f32 v237, v52, v201, v209 op_sel:[1,0,0] op_sel_hi:[1,0,0]
    v_cvt_pk_bf16_f32 v180, v236, v237
    v_mfma_f32_16x16x32_bf16 a[104:107], a[184:187], v[192:195], a[104:107]
    buffer_load_dwordx4 v23, s[36:39], s81 offen offset:1024 lds
    v_fma_mix_f32 v238, v53, v202, v210 op_sel_hi:[1,0,0]
    v_mfma_f32_16x16x32_bf16 a[108:111], a[184:187], v[196:199], a[108:111]
    s_add_u32 s81, s81, 8192
    v_fma_mix_f32 v239, v53, v203, v211 op_sel:[1,0,0] op_sel_hi:[1,0,0]
    v_cvt_pk_bf16_f32 v181, v238, v239
    v_mfma_f32_16x16x32_bf16 a[112:115], a[188:191], v[184:187], a[112:115]
    ds_read_b64_tr_b16 a[156:157], v31 offset:16392
    ds_read_b64_tr_b16 a[158:159], v31 offset:17416
    v_fma_mix_f32 v240, v54, v204, v212 op_sel_hi:[1,0,0]
    v_mfma_f32_16x16x32_bf16 a[116:119], a[188:191], v[188:191], a[116:119]
    v_fma_mix_f32 v241, v54, v205, v213 op_sel:[1,0,0] op_sel_hi:[1,0,0]
    v_cvt_pk_bf16_f32 v182, v240, v241
    v_mfma_f32_16x16x32_bf16 a[120:123], a[188:191], v[192:195], a[120:123]
    v_fma_mix_f32 v242, v55, v206, v214 op_sel_hi:[1,0,0]
    v_fma_mix_f32 v243, v55, v207, v215 op_sel:[1,0,0] op_sel_hi:[1,0,0]
    v_cvt_pk_bf16_f32 v183, v242, v243
    v_mfma_f32_16x16x32_bf16 a[124:127], a[188:191], v[196:199], a[124:127]
    buffer_load_dwordx4 v[88:91], v39, s[44:47], s83 offen offset:0 sc1
    s_add_u32 s83, s83, 131072
    s_waitcnt vmcnt(12)
    s_waitcnt lgkmcnt(4)
    v_mfma_f32_16x16x32_bf16 a[0:3], a[128:131], v[168:171], a[0:3]
    ds_read_b64_tr_b16 a[160:161], v28 offset:24576
    ds_read_b64_tr_b16 a[162:163], v28 offset:25600
    v_fma_mix_f32 v236, v56, v216, v224 op_sel_hi:[1,0,0]
    v_mfma_f32_16x16x32_bf16 a[4:7], a[128:131], v[172:175], a[4:7]
    buffer_load_dwordx4 v[116:119], v39, s[44:47], s83 offen offset:3072 sc1
    v_fma_mix_f32 v237, v56, v217, v225 op_sel:[1,0,0] op_sel_hi:[1,0,0]
    v_mfma_f32_16x16x32_bf16 a[8:11], a[128:131], v[176:179], a[8:11]
    v_cvt_pk_bf16_f32 v184, v236, v237
    v_fma_mix_f32 v238, v57, v218, v226 op_sel_hi:[1,0,0]
    v_mfma_f32_16x16x32_bf16 a[12:15], a[128:131], v[180:183], a[12:15]
    ds_read_b128 v[200:203], v34 offset:2560
    v_fma_mix_f32 v239, v57, v219, v227 op_sel:[1,0,0] op_sel_hi:[1,0,0]
    v_mfma_f32_16x16x32_bf16 a[16:19], a[132:135], v[168:171], a[16:19]
    ds_read_b64_tr_b16 a[164:165], v28 offset:24584
    ds_read_b64_tr_b16 a[166:167], v28 offset:25608
    v_cvt_pk_bf16_f32 v185, v238, v239
    v_mfma_f32_16x16x32_bf16 a[20:23], a[132:135], v[172:175], a[20:23]
    v_fma_mix_f32 v240, v58, v220, v228 op_sel_hi:[1,0,0]
    v_fma_mix_f32 v241, v58, v221, v229 op_sel:[1,0,0] op_sel_hi:[1,0,0]
    v_mfma_f32_16x16x32_bf16 a[24:27], a[132:135], v[176:179], a[24:27]
    v_cvt_pk_bf16_f32 v186, v240, v241
    v_fma_mix_f32 v242, v59, v222, v230 op_sel_hi:[1,0,0]
    v_mfma_f32_16x16x32_bf16 a[28:31], a[132:135], v[180:183], a[28:31]
    ds_read_b128 v[204:207], v34 offset:2576
    v_fma_mix_f32 v243, v59, v223, v231 op_sel:[1,0,0] op_sel_hi:[1,0,0]
    v_cvt_pk_bf16_f32 v187, v242, v243
    v_mfma_f32_16x16x32_bf16 a[32:35], a[136:139], v[168:171], a[32:35]
    ds_read_b64_tr_b16 a[168:169], v29 offset:24576
    ds_read_b64_tr_b16 a[170:171], v29 offset:25600
    v_fma_mix_f32 v236, v60, v216, v224 op_sel_hi:[1,0,0]
    v_mfma_f32_16x16x32_bf16 a[36:39], a[136:139], v[172:175], a[36:39]
    v_fma_mix_f32 v237, v60, v217, v225 op_sel:[1,0,0] op_sel_hi:[1,0,0]
    v_cvt_pk_bf16_f32 v188, v236, v237
    v_mfma_f32_16x16x32_bf16 a[40:43], a[136:139], v[176:179], a[40:43]
    v_fma_mix_f32 v238, v61, v218, v226 op_sel_hi:[1,0,0]
    v_fma_mix_f32 v239, v61, v219, v227 op_sel:[1,0,0] op_sel_hi:[1,0,0]
    v_mfma_f32_16x16x32_bf16 a[44:47], a[136:139], v[180:183], a[44:47]
    ds_read_b128 v[208:211], v34 offset:2592
    v_cvt_pk_bf16_f32 v189, v238, v239
    v_mfma_f32_16x16x32_bf16 a[48:51], a[140:143], v[168:171], a[48:51]
    ds_read_b64_tr_b16 a[172:173], v29 offset:24584
    ds_read_b64_tr_b16 a[174:175], v29 offset:25608
    v_fma_mix_f32 v240, v62, v220, v228 op_sel_hi:[1,0,0]
    v_mfma_f32_16x16x32_bf16 a[52:55], a[140:143], v[172:175], a[52:55]
    v_fma_mix_f32 v241, v62, v221, v229 op_sel:[1,0,0] op_sel_hi:[1,0,0]
    v_cvt_pk_bf16_f32 v190, v240, v241
    v_mfma_f32_16x16x32_bf16 a[56:59], a[140:143], v[176:179], a[56:59]
    v_fma_mix_f32 v242, v63, v222, v230 op_sel_hi:[1,0,0]
    v_fma_mix_f32 v243, v63, v223, v231 op_sel:[1,0,0] op_sel_hi:[1,0,0]
    v_mfma_f32_16x16x32_bf16 a[60:63], a[140:143], v[180:183], a[60:63]
    s_waitcnt lgkmcnt(11)
    v_cvt_pk_bf16_f32 v191, v242, v243
    v_fma_mix_f32 v236, v64, v216, v224 op_sel_hi:[1,0,0]
    v_mfma_f32_16x16x32_bf16 a[64:67], a[144:147], v[168:171], a[64:67]
    ds_read_b64_tr_b16 a[176:177], v30 offset:24576
    ds_read_b64_tr_b16 a[178:179], v30 offset:25600
    v_fma_mix_f32 v237, v64, v217, v225 op_sel:[1,0,0] op_sel_hi:[1,0,0]
    v_mfma_f32_16x16x32_bf16 a[68:71], a[144:147], v[172:175], a[68:71]
    v_cvt_pk_bf16_f32 v192, v236, v237
    v_fma_mix_f32 v238, v65, v218, v226 op_sel_hi:[1,0,0]
    v_mfma_f32_16x16x32_bf16 a[72:75], a[144:147], v[176:179], a[72:75]
    v_fma_mix_f32 v239, v65, v219, v227 op_sel:[1,0,0] op_sel_hi:[1,0,0]
    v_cvt_pk_bf16_f32 v193, v238, v239
    v_mfma_f32_16x16x32_bf16 a[76:79], a[144:147], v[180:183], a[76:79]
    ds_read_b128 v[212:215], v34 offset:2608
    v_fma_mix_f32 v240, v66, v220, v228 op_sel_hi:[1,0,0]
    v_fma_mix_f32 v241, v66, v221, v229 op_sel:[1,0,0] op_sel_hi:[1,0,0]
    v_mfma_f32_16x16x32_bf16 a[80:83], a[148:151], v[168:171], a[80:83]
    ds_read_b64_tr_b16 a[180:181], v30 offset:24584
    ds_read_b64_tr_b16 a[182:183], v30 offset:25608
    v_mfma_f32_16x16x32_bf16 a[84:87], a[148:151], v[172:175], a[84:87]
    v_cvt_pk_bf16_f32 v194, v240, v241
    v_fma_mix_f32 v242, v67, v222, v230 op_sel_hi:[1,0,0]
    v_mfma_f32_16x16x32_bf16 a[88:91], a[148:151], v[176:179], a[88:91]
    v_fma_mix_f32 v243, v67, v223, v231 op_sel:[1,0,0] op_sel_hi:[1,0,0]
    v_cvt_pk_bf16_f32 v195, v242, v243
    v_fma_mix_f32 v236, v68, v216, v224 op_sel_hi:[1,0,0]
    v_mfma_f32_16x16x32_bf16 a[92:95], a[148:151], v[180:183], a[92:95]
    buffer_load_dwordx4 v[104:107], v39, s[44:47], s83 offen offset:0 sc1
    v_mfma_f32_16x16x32_bf16 a[96:99], a[152:155], v[168:171], a[96:99]
    ds_read_b64_tr_b16 a[184:185], v31 offset:24576
    ds_read_b64_tr_b16 a[186:187], v31 offset:25600
    v_fma_mix_f32 v237, v68, v217, v225 op_sel:[1,0,0] op_sel_hi:[1,0,0]
    v_mfma_f32_16x16x32_bf16 a[100:103], a[152:155], v[172:175], a[100:103]
    v_cvt_pk_bf16_f32 v196, v236, v237
    v_fma_mix_f32 v238, v69, v218, v226 op_sel_hi:[1,0,0]
    v_mfma_f32_16x16x32_bf16 a[104:107], a[152:155], v[176:179], a[104:107]
    v_fma_mix_f32 v239, v69, v219, v227 op_sel:[1,0,0] op_sel_hi:[1,0,0]
    v_cvt_pk_bf16_f32 v197, v238, v239
    v_mfma_f32_16x16x32_bf16 a[108:111], a[152:155], v[180:183], a[108:111]
    buffer_load_dwordx4 v[108:111], v39, s[44:47], s83 offen offset:1024 sc1
    v_fma_mix_f32 v240, v70, v220, v228 op_sel_hi:[1,0,0]
    v_mfma_f32_16x16x32_bf16 a[112:115], a[156:159], v[168:171], a[112:115]
    ds_read_b64_tr_b16 a[188:189], v31 offset:24584
    ds_read_b64_tr_b16 a[190:191], v31 offset:25608
    v_fma_mix_f32 v241, v70, v221, v229 op_sel:[1,0,0] op_sel_hi:[1,0,0]
    v_mfma_f32_16x16x32_bf16 a[116:119], a[156:159], v[172:175], a[116:119]
    v_cvt_pk_bf16_f32 v198, v240, v241
    v_fma_mix_f32 v242, v71, v222, v230 op_sel_hi:[1,0,0]
    v_mfma_f32_16x16x32_bf16 a[120:123], a[156:159], v[176:179], a[120:123]
    v_fma_mix_f32 v243, v71, v223, v231 op_sel:[1,0,0] op_sel_hi:[1,0,0]
    v_cvt_pk_bf16_f32 v199, v242, v243
    v_mfma_f32_16x16x32_bf16 a[124:127], a[156:159], v[180:183], a[124:127]
    buffer_load_dwordx4 v[112:115], v39, s[44:47], s83 offen offset:2048 sc1
    s_add_u32 s83, s83, 131072
    s_waitcnt vmcnt(12)
    s_waitcnt lgkmcnt(6)
    s_barrier
    v_mfma_f32_16x16x32_bf16 a[0:3], a[160:163], v[184:187], a[0:3]
    ds_read_b64_tr_b16 a[128:129], v24 offset:49152
    ds_read_b64_tr_b16 a[130:131], v24 offset:50176
    v_fma_mix_f32 v236, v72, v200, v208 op_sel_hi:[1,0,0]
    v_mfma_f32_16x16x32_bf16 a[4:7], a[160:163], v[188:191], a[4:7]
    buffer_load_dwordx4 v[124:127], v39, s[44:47], s83 offen offset:1024 sc1
    v_fma_mix_f32 v237, v72, v201, v209 op_sel:[1,0,0] op_sel_hi:[1,0,0]
    v_mfma_f32_16x16x32_bf16 a[8:11], a[160:163], v[192:195], a[8:11]
    v_cvt_pk_bf16_f32 v168, v236, v237
    v_fma_mix_f32 v238, v73, v202, v210 op_sel_hi:[1,0,0]
    v_fma_mix_f32 v239, v73, v203, v211 op_sel:[1,0,0] op_sel_hi:[1,0,0]
    v_mfma_f32_16x16x32_bf16 a[12:15], a[160:163], v[196:199], a[12:15]
    ds_read_b128 v[216:219], v34 offset:2816
    v_cvt_pk_bf16_f32 v169, v238, v239
    v_mfma_f32_16x16x32_bf16 a[16:19], a[164:167], v[184:187], a[16:19]
    ds_read_b64_tr_b16 a[132:133], v24 offset:49160
    ds_read_b64_tr_b16 a[134:135], v24 offset:50184
    v_fma_mix_f32 v240, v74, v204, v212 op_sel_hi:[1,0,0]
    v_mfma_f32_16x16x32_bf16 a[20:23], a[164:167], v[188:191], a[20:23]
    s_add_u32 m0, s82, 32768
    v_fma_mix_f32 v241, v74, v205, v213 op_sel:[1,0,0] op_sel_hi:[1,0,0]
    v_cvt_pk_bf16_f32 v170, v240, v241
    v_mfma_f32_16x16x32_bf16 a[24:27], a[164:167], v[192:195], a[24:27]
    buffer_load_dwordx4 v20, s[32:35], s80 offen lds
    v_fma_mix_f32 v242, v75, v206, v214 op_sel_hi:[1,0,0]
    v_mfma_f32_16x16x32_bf16 a[28:31], a[164:167], v[196:199], a[28:31]
    ds_read_b128 v[220:223], v34 offset:2832
    v_fma_mix_f32 v243, v75, v207, v215 op_sel:[1,0,0] op_sel_hi:[1,0,0]
    v_cvt_pk_bf16_f32 v171, v242, v243
    v_mfma_f32_16x16x32_bf16 a[32:35], a[168:171], v[184:187], a[32:35]
    ds_read_b64_tr_b16 a[136:137], v25 offset:49152
    ds_read_b64_tr_b16 a[138:139], v25 offset:50176
    v_fma_mix_f32 v236, v76, v200, v208 op_sel_hi:[1,0,0]
    v_mfma_f32_16x16x32_bf16 a[36:39], a[168:171], v[188:191], a[36:39]
    buffer_load_dwordx4 v[128:131], v39, s[44:47], s83 offen offset:2048 sc1
    v_mfma_f32_16x16x32_bf16 a[40:43], a[168:171], v[192:195], a[40:43]
    buffer_load_dwordx4 v21, s[32:35], s80 offen offset:1024 lds
    v_fma_mix_f32 v237, v76, v201, v209 op_sel:[1,0,0] op_sel_hi:[1,0,0]
    v_mfma_f32_16x16x32_bf16 a[44:47], a[168:171], v[196:199], a[44:47]
    s_add_u32 s80, s80, 8192
    v_cvt_pk_bf16_f32 v172, v236, v237
    v_fma_mix_f32 v238, v77, v202, v210 op_sel_hi:[1,0,0]
    v_fma_mix_f32 v239, v77, v203, v211 op_sel:[1,0,0] op_sel_hi:[1,0,0]
    v_mfma_f32_16x16x32_bf16 a[48:51], a[172:175], v[184:187], a[48:51]
    ds_read_b64_tr_b16 a[140:141], v25 offset:49160
    ds_read_b64_tr_b16 a[142:143], v25 offset:50184
    v_mfma_f32_16x16x32_bf16 a[52:55], a[172:175], v[188:191], a[52:55]
    buffer_load_dwordx4 v[132:135], v39, s[44:47], s83 offen offset:3072 sc1
    v_cvt_pk_bf16_f32 v173, v238, v239
    v_mfma_f32_16x16x32_bf16 a[56:59], a[172:175], v[192:195], a[56:59]
    v_fma_mix_f32 v240, v78, v204, v212 op_sel_hi:[1,0,0]
    v_fma_mix_f32 v241, v78, v205, v213 op_sel:[1,0,0] op_sel_hi:[1,0,0]
    v_cvt_pk_bf16_f32 v174, v240, v241
    v_mfma_f32_16x16x32_bf16 a[60:63], a[172:175], v[196:199], a[60:63]
    s_waitcnt lgkmcnt(10)
    v_fma_mix_f32 v242, v79, v206, v214 op_sel_hi:[1,0,0]
    v_fma_mix_f32 v243, v79, v207, v215 op_sel:[1,0,0] op_sel_hi:[1,0,0]
    v_mfma_f32_16x16x32_bf16 a[64:67], a[176:179], v[184:187], a[64:67]
    ds_read_b64_tr_b16 a[144:145], v26 offset:49152
    ds_read_b64_tr_b16 a[146:147], v26 offset:50176
    v_cvt_pk_bf16_f32 v175, v242, v243
    v_mfma_f32_16x16x32_bf16 a[68:71], a[176:179], v[188:191], a[68:71]
    v_fma_mix_f32 v236, v80, v200, v208 op_sel_hi:[1,0,0]
    v_fma_mix_f32 v237, v80, v201, v209 op_sel:[1,0,0] op_sel_hi:[1,0,0]
    v_mfma_f32_16x16x32_bf16 a[72:75], a[176:179], v[192:195], a[72:75]
    v_cvt_pk_bf16_f32 v176, v236, v237
    v_fma_mix_f32 v238, v81, v202, v210 op_sel_hi:[1,0,0]
    v_fma_mix_f32 v239, v81, v203, v211 op_sel:[1,0,0] op_sel_hi:[1,0,0]
    v_mfma_f32_16x16x32_bf16 a[76:79], a[176:179], v[196:199], a[76:79]
    ds_read_b128 v[224:227], v34 offset:2848
    v_cvt_pk_bf16_f32 v177, v238, v239
    v_mfma_f32_16x16x32_bf16 a[80:83], a[180:183], v[184:187], a[80:83]
    ds_read_b64_tr_b16 a[148:149], v26 offset:49160
    ds_read_b64_tr_b16 a[150:151], v26 offset:50184
    v_fma_mix_f32 v240, v82, v204, v212 op_sel_hi:[1,0,0]
    v_mfma_f32_16x16x32_bf16 a[84:87], a[180:183], v[188:191], a[84:87]
    s_add_u32 m0, s82, 40960
    v_fma_mix_f32 v241, v82, v205, v213 op_sel:[1,0,0] op_sel_hi:[1,0,0]
    v_cvt_pk_bf16_f32 v178, v240, v241
    v_mfma_f32_16x16x32_bf16 a[88:91], a[180:183], v[192:195], a[88:91]
    buffer_load_dwordx4 v20, s[32:35], s80 offen lds
    v_fma_mix_f32 v242, v83, v206, v214 op_sel_hi:[1,0,0]
    v_mfma_f32_16x16x32_bf16 a[92:95], a[180:183], v[196:199], a[92:95]
    ds_read_b128 v[228:231], v34 offset:2864
    v_fma_mix_f32 v243, v83, v207, v215 op_sel:[1,0,0] op_sel_hi:[1,0,0]
    v_cvt_pk_bf16_f32 v179, v242, v243
    v_mfma_f32_16x16x32_bf16 a[96:99], a[184:187], v[184:187], a[96:99]
    ds_read_b64_tr_b16 a[152:153], v27 offset:49152
    ds_read_b64_tr_b16 a[154:155], v27 offset:50176
    v_fma_mix_f32 v236, v84, v200, v208 op_sel_hi:[1,0,0]
    v_mfma_f32_16x16x32_bf16 a[100:103], a[184:187], v[188:191], a[100:103]
    v_fma_mix_f32 v237, v84, v201, v209 op_sel:[1,0,0] op_sel_hi:[1,0,0]
    v_cvt_pk_bf16_f32 v180, v236, v237
    v_mfma_f32_16x16x32_bf16 a[104:107], a[184:187], v[192:195], a[104:107]
    buffer_load_dwordx4 v21, s[32:35], s80 offen offset:1024 lds
    v_fma_mix_f32 v238, v85, v202, v210 op_sel_hi:[1,0,0]
    v_mfma_f32_16x16x32_bf16 a[108:111], a[184:187], v[196:199], a[108:111]
    s_add_u32 s80, s80, 8192
    v_fma_mix_f32 v239, v85, v203, v211 op_sel:[1,0,0] op_sel_hi:[1,0,0]
    v_cvt_pk_bf16_f32 v181, v238, v239
    v_mfma_f32_16x16x32_bf16 a[112:115], a[188:191], v[184:187], a[112:115]
    ds_read_b64_tr_b16 a[156:157], v27 offset:49160
    ds_read_b64_tr_b16 a[158:159], v27 offset:50184
    v_fma_mix_f32 v240, v86, v204, v212 op_sel_hi:[1,0,0]
    v_mfma_f32_16x16x32_bf16 a[116:119], a[188:191], v[188:191], a[116:119]
    v_fma_mix_f32 v241, v86, v205, v213 op_sel:[1,0,0] op_sel_hi:[1,0,0]
    v_cvt_pk_bf16_f32 v182, v240, v241
    v_mfma_f32_16x16x32_bf16 a[120:123], a[188:191], v[192:195], a[120:123]
    v_fma_mix_f32 v242, v87, v206, v214 op_sel_hi:[1,0,0]
    v_fma_mix_f32 v243, v87, v207, v215 op_sel:[1,0,0] op_sel_hi:[1,0,0]
    v_cvt_pk_bf16_f32 v183, v242, v243
    v_mfma_f32_16x16x32_bf16 a[124:127], a[188:191], v[196:199], a[124:127]
    buffer_load_dwordx4 v[120:123], v39, s[44:47], s83 offen offset:0 sc1
    s_add_u32 s83, s83, 131072
    s_waitcnt vmcnt(12)
    s_waitcnt lgkmcnt(4)
    v_mfma_f32_16x16x32_bf16 a[0:3], a[128:131], v[168:171], a[0:3]
    ds_read_b64_tr_b16 a[160:161], v24 offset:57344
    ds_read_b64_tr_b16 a[162:163], v24 offset:58368
    v_fma_mix_f32 v236, v88, v216, v224 op_sel_hi:[1,0,0]
    v_mfma_f32_16x16x32_bf16 a[4:7], a[128:131], v[172:175], a[4:7]
    buffer_load_dwordx4 v[148:151], v39, s[44:47], s83 offen offset:3072 sc1
    v_fma_mix_f32 v237, v88, v217, v225 op_sel:[1,0,0] op_sel_hi:[1,0,0]
    v_mfma_f32_16x16x32_bf16 a[8:11], a[128:131], v[176:179], a[8:11]
    v_cvt_pk_bf16_f32 v184, v236, v237
    v_fma_mix_f32 v238, v89, v218, v226 op_sel_hi:[1,0,0]
    v_mfma_f32_16x16x32_bf16 a[12:15], a[128:131], v[180:183], a[12:15]
    ds_read_b128 v[200:203], v34 offset:3072
    v_fma_mix_f32 v239, v89, v219, v227 op_sel:[1,0,0] op_sel_hi:[1,0,0]
    v_mfma_f32_16x16x32_bf16 a[16:19], a[132:135], v[168:171], a[16:19]
    ds_read_b64_tr_b16 a[164:165], v24 offset:57352
    ds_read_b64_tr_b16 a[166:167], v24 offset:58376
    v_cvt_pk_bf16_f32 v185, v238, v239
    v_mfma_f32_16x16x32_bf16 a[20:23], a[132:135], v[172:175], a[20:23]
    v_fma_mix_f32 v240, v90, v220, v228 op_sel_hi:[1,0,0]
    v_fma_mix_f32 v241, v90, v221, v229 op_sel:[1,0,0] op_sel_hi:[1,0,0]
    v_mfma_f32_16x16x32_bf16 a[24:27], a[132:135], v[176:179], a[24:27]
    v_cvt_pk_bf16_f32 v186, v240, v241
    v_fma_mix_f32 v242, v91, v222, v230 op_sel_hi:[1,0,0]
    v_mfma_f32_16x16x32_bf16 a[28:31], a[132:135], v[180:183], a[28:31]
    ds_read_b128 v[204:207], v34 offset:3088
    v_fma_mix_f32 v243, v91, v223, v231 op_sel:[1,0,0] op_sel_hi:[1,0,0]
    v_cvt_pk_bf16_f32 v187, v242, v243
    v_mfma_f32_16x16x32_bf16 a[32:35], a[136:139], v[168:171], a[32:35]
    ds_read_b64_tr_b16 a[168:169], v25 offset:57344
    ds_read_b64_tr_b16 a[170:171], v25 offset:58368
    v_fma_mix_f32 v236, v92, v216, v224 op_sel_hi:[1,0,0]
    v_mfma_f32_16x16x32_bf16 a[36:39], a[136:139], v[172:175], a[36:39]
    v_fma_mix_f32 v237, v92, v217, v225 op_sel:[1,0,0] op_sel_hi:[1,0,0]
    v_cvt_pk_bf16_f32 v188, v236, v237
    v_mfma_f32_16x16x32_bf16 a[40:43], a[136:139], v[176:179], a[40:43]
    v_fma_mix_f32 v238, v93, v218, v226 op_sel_hi:[1,0,0]
    v_fma_mix_f32 v239, v93, v219, v227 op_sel:[1,0,0] op_sel_hi:[1,0,0]
    v_mfma_f32_16x16x32_bf16 a[44:47], a[136:139], v[180:183], a[44:47]
    ds_read_b128 v[208:211], v34 offset:3104
    v_cvt_pk_bf16_f32 v189, v238, v239
    v_mfma_f32_16x16x32_bf16 a[48:51], a[140:143], v[168:171], a[48:51]
    ds_read_b64_tr_b16 a[172:173], v25 offset:57352
    ds_read_b64_tr_b16 a[174:175], v25 offset:58376
    v_fma_mix_f32 v240, v94, v220, v228 op_sel_hi:[1,0,0]
    v_mfma_f32_16x16x32_bf16 a[52:55], a[140:143], v[172:175], a[52:55]
    v_fma_mix_f32 v241, v94, v221, v229 op_sel:[1,0,0] op_sel_hi:[1,0,0]
    v_cvt_pk_bf16_f32 v190, v240, v241
    v_mfma_f32_16x16x32_bf16 a[56:59], a[140:143], v[176:179], a[56:59]
    v_fma_mix_f32 v242, v95, v222, v230 op_sel_hi:[1,0,0]
    v_fma_mix_f32 v243, v95, v223, v231 op_sel:[1,0,0] op_sel_hi:[1,0,0]
    v_mfma_f32_16x16x32_bf16 a[60:63], a[140:143], v[180:183], a[60:63]
    s_waitcnt lgkmcnt(11)
    v_cvt_pk_bf16_f32 v191, v242, v243
    v_fma_mix_f32 v236, v96, v216, v224 op_sel_hi:[1,0,0]
    v_mfma_f32_16x16x32_bf16 a[64:67], a[144:147], v[168:171], a[64:67]
    ds_read_b64_tr_b16 a[176:177], v26 offset:57344
    ds_read_b64_tr_b16 a[178:179], v26 offset:58368
    v_fma_mix_f32 v237, v96, v217, v225 op_sel:[1,0,0] op_sel_hi:[1,0,0]
    v_mfma_f32_16x16x32_bf16 a[68:71], a[144:147], v[172:175], a[68:71]
    v_cvt_pk_bf16_f32 v192, v236, v237
    v_fma_mix_f32 v238, v97, v218, v226 op_sel_hi:[1,0,0]
    v_mfma_f32_16x16x32_bf16 a[72:75], a[144:147], v[176:179], a[72:75]
    v_fma_mix_f32 v239, v97, v219, v227 op_sel:[1,0,0] op_sel_hi:[1,0,0]
    v_cvt_pk_bf16_f32 v193, v238, v239
    v_mfma_f32_16x16x32_bf16 a[76:79], a[144:147], v[180:183], a[76:79]
    ds_read_b128 v[212:215], v34 offset:3120
    v_fma_mix_f32 v240, v98, v220, v228 op_sel_hi:[1,0,0]
    v_fma_mix_f32 v241, v98, v221, v229 op_sel:[1,0,0] op_sel_hi:[1,0,0]
    v_mfma_f32_16x16x32_bf16 a[80:83], a[148:151], v[168:171], a[80:83]
    ds_read_b64_tr_b16 a[180:181], v26 offset:57352
    ds_read_b64_tr_b16 a[182:183], v26 offset:58376
    v_mfma_f32_16x16x32_bf16 a[84:87], a[148:151], v[172:175], a[84:87]
    v_cvt_pk_bf16_f32 v194, v240, v241
    v_fma_mix_f32 v242, v99, v222, v230 op_sel_hi:[1,0,0]
    v_mfma_f32_16x16x32_bf16 a[88:91], a[148:151], v[176:179], a[88:91]
    v_fma_mix_f32 v243, v99, v223, v231 op_sel:[1,0,0] op_sel_hi:[1,0,0]
    v_cvt_pk_bf16_f32 v195, v242, v243
    v_fma_mix_f32 v236, v100, v216, v224 op_sel_hi:[1,0,0]
    v_mfma_f32_16x16x32_bf16 a[92:95], a[148:151], v[180:183], a[92:95]
    buffer_load_dwordx4 v[136:139], v39, s[44:47], s83 offen offset:0 sc1
    v_mfma_f32_16x16x32_bf16 a[96:99], a[152:155], v[168:171], a[96:99]
    ds_read_b64_tr_b16 a[184:185], v27 offset:57344
    ds_read_b64_tr_b16 a[186:187], v27 offset:58368
    v_fma_mix_f32 v237, v100, v217, v225 op_sel:[1,0,0] op_sel_hi:[1,0,0]
    v_mfma_f32_16x16x32_bf16 a[100:103], a[152:155], v[172:175], a[100:103]
    v_cvt_pk_bf16_f32 v196, v236, v237
    v_fma_mix_f32 v238, v101, v218, v226 op_sel_hi:[1,0,0]
    v_mfma_f32_16x16x32_bf16 a[104:107], a[152:155], v[176:179], a[104:107]
    v_fma_mix_f32 v239, v101, v219, v227 op_sel:[1,0,0] op_sel_hi:[1,0,0]
    v_cvt_pk_bf16_f32 v197, v238, v239
    v_mfma_f32_16x16x32_bf16 a[108:111], a[152:155], v[180:183], a[108:111]
    buffer_load_dwordx4 v[140:143], v39, s[44:47], s83 offen offset:1024 sc1
    v_fma_mix_f32 v240, v102, v220, v228 op_sel_hi:[1,0,0]
    v_mfma_f32_16x16x32_bf16 a[112:115], a[156:159], v[168:171], a[112:115]
    ds_read_b64_tr_b16 a[188:189], v27 offset:57352
    ds_read_b64_tr_b16 a[190:191], v27 offset:58376
    v_fma_mix_f32 v241, v102, v221, v229 op_sel:[1,0,0] op_sel_hi:[1,0,0]
    v_mfma_f32_16x16x32_bf16 a[116:119], a[156:159], v[172:175], a[116:119]
    v_cvt_pk_bf16_f32 v198, v240, v241
    v_fma_mix_f32 v242, v103, v222, v230 op_sel_hi:[1,0,0]
    v_mfma_f32_16x16x32_bf16 a[120:123], a[156:159], v[176:179], a[120:123]
    v_fma_mix_f32 v243, v103, v223, v231 op_sel:[1,0,0] op_sel_hi:[1,0,0]
    v_cvt_pk_bf16_f32 v199, v242, v243
    v_mfma_f32_16x16x32_bf16 a[124:127], a[156:159], v[180:183], a[124:127]
    buffer_load_dwordx4 v[144:147], v39, s[44:47], s83 offen offset:2048 sc1
    s_add_u32 s83, s83, 131072
    s_waitcnt vmcnt(12)
    s_waitcnt lgkmcnt(6)
    s_barrier
    v_mfma_f32_16x16x32_bf16 a[0:3], a[160:163], v[184:187], a[0:3]
    ds_read_b64_tr_b16 a[128:129], v28 offset:32768
    ds_read_b64_tr_b16 a[130:131], v28 offset:33792
    v_fma_mix_f32 v236, v104, v200, v208 op_sel_hi:[1,0,0]
    v_mfma_f32_16x16x32_bf16 a[4:7], a[160:163], v[188:191], a[4:7]
    buffer_load_dwordx4 v[156:159], v39, s[44:47], s83 offen offset:1024 sc1
    v_fma_mix_f32 v237, v104, v201, v209 op_sel:[1,0,0] op_sel_hi:[1,0,0]
    v_mfma_f32_16x16x32_bf16 a[8:11], a[160:163], v[192:195], a[8:11]
    v_cvt_pk_bf16_f32 v168, v236, v237
    v_fma_mix_f32 v238, v105, v202, v210 op_sel_hi:[1,0,0]
    v_fma_mix_f32 v239, v105, v203, v211 op_sel:[1,0,0] op_sel_hi:[1,0,0]
    v_mfma_f32_16x16x32_bf16 a[12:15], a[160:163], v[196:199], a[12:15]
    ds_read_b128 v[216:219], v34 offset:3328
    v_cvt_pk_bf16_f32 v169, v238, v239
    v_mfma_f32_16x16x32_bf16 a[16:19], a[164:167], v[184:187], a[16:19]
    ds_read_b64_tr_b16 a[132:133], v28 offset:32776
    ds_read_b64_tr_b16 a[134:135], v28 offset:33800
    v_fma_mix_f32 v240, v106, v204, v212 op_sel_hi:[1,0,0]
    v_mfma_f32_16x16x32_bf16 a[20:23], a[164:167], v[188:191], a[20:23]
    s_add_u32 m0, s82, 81920
    v_fma_mix_f32 v241, v106, v205, v213 op_sel:[1,0,0] op_sel_hi:[1,0,0]
    v_cvt_pk_bf16_f32 v170, v240, v241
    v_mfma_f32_16x16x32_bf16 a[24:27], a[164:167], v[192:195], a[24:27]
    buffer_load_dwordx4 v22, s[36:39], s81 offen lds
    v_fma_mix_f32 v242, v107, v206, v214 op_sel_hi:[1,0,0]
    v_mfma_f32_16x16x32_bf16 a[28:31], a[164:167], v[196:199], a[28:31]
    ds_read_b128 v[220:223], v34 offset:3344
    v_fma_mix_f32 v243, v107, v207, v215 op_sel:[1,0,0] op_sel_hi:[1,0,0]
    v_cvt_pk_bf16_f32 v171, v242, v243
    v_mfma_f32_16x16x32_bf16 a[32:35], a[168:171], v[184:187], a[32:35]
    ds_read_b64_tr_b16 a[136:137], v29 offset:32768
    ds_read_b64_tr_b16 a[138:139], v29 offset:33792
    v_fma_mix_f32 v236, v108, v200, v208 op_sel_hi:[1,0,0]
    v_mfma_f32_16x16x32_bf16 a[36:39], a[168:171], v[188:191], a[36:39]
    buffer_load_dwordx4 v[160:163], v39, s[44:47], s83 offen offset:2048 sc1
    v_mfma_f32_16x16x32_bf16 a[40:43], a[168:171], v[192:195], a[40:43]
    buffer_load_dwordx4 v23, s[36:39], s81 offen offset:1024 lds
    v_fma_mix_f32 v237, v108, v201, v209 op_sel:[1,0,0] op_sel_hi:[1,0,0]
    v_mfma_f32_16x16x32_bf16 a[44:47], a[168:171], v[196:199], a[44:47]
    s_add_u32 s81, s81, 8192
    v_cvt_pk_bf16_f32 v172, v236, v237
    v_fma_mix_f32 v238, v109, v202, v210 op_sel_hi:[1,0,0]
    v_fma_mix_f32 v239, v109, v203, v211 op_sel:[1,0,0] op_sel_hi:[1,0,0]
    v_mfma_f32_16x16x32_bf16 a[48:51], a[172:175], v[184:187], a[48:51]
    ds_read_b64_tr_b16 a[140:141], v29 offset:32776
    ds_read_b64_tr_b16 a[142:143], v29 offset:33800
    v_mfma_f32_16x16x32_bf16 a[52:55], a[172:175], v[188:191], a[52:55]
    buffer_load_dwordx4 v[164:167], v39, s[44:47], s83 offen offset:3072 sc1
    v_cvt_pk_bf16_f32 v173, v238, v239
    v_mfma_f32_16x16x32_bf16 a[56:59], a[172:175], v[192:195], a[56:59]
    v_fma_mix_f32 v240, v110, v204, v212 op_sel_hi:[1,0,0]
    v_fma_mix_f32 v241, v110, v205, v213 op_sel:[1,0,0] op_sel_hi:[1,0,0]
    v_cvt_pk_bf16_f32 v174, v240, v241
    v_mfma_f32_16x16x32_bf16 a[60:63], a[172:175], v[196:199], a[60:63]
    s_waitcnt lgkmcnt(10)
    v_fma_mix_f32 v242, v111, v206, v214 op_sel_hi:[1,0,0]
    v_fma_mix_f32 v243, v111, v207, v215 op_sel:[1,0,0] op_sel_hi:[1,0,0]
    v_mfma_f32_16x16x32_bf16 a[64:67], a[176:179], v[184:187], a[64:67]
    ds_read_b64_tr_b16 a[144:145], v30 offset:32768
    ds_read_b64_tr_b16 a[146:147], v30 offset:33792
    v_cvt_pk_bf16_f32 v175, v242, v243
    v_mfma_f32_16x16x32_bf16 a[68:71], a[176:179], v[188:191], a[68:71]
    v_fma_mix_f32 v236, v112, v200, v208 op_sel_hi:[1,0,0]
    v_fma_mix_f32 v237, v112, v201, v209 op_sel:[1,0,0] op_sel_hi:[1,0,0]
    v_mfma_f32_16x16x32_bf16 a[72:75], a[176:179], v[192:195], a[72:75]
    v_cvt_pk_bf16_f32 v176, v236, v237
    v_fma_mix_f32 v238, v113, v202, v210 op_sel_hi:[1,0,0]
    v_fma_mix_f32 v239, v113, v203, v211 op_sel:[1,0,0] op_sel_hi:[1,0,0]
    v_mfma_f32_16x16x32_bf16 a[76:79], a[176:179], v[196:199], a[76:79]
    ds_read_b128 v[224:227], v34 offset:3360
    v_cvt_pk_bf16_f32 v177, v238, v239
    v_mfma_f32_16x16x32_bf16 a[80:83], a[180:183], v[184:187], a[80:83]
    ds_read_b64_tr_b16 a[148:149], v30 offset:32776
    ds_read_b64_tr_b16 a[150:151], v30 offset:33800
    v_fma_mix_f32 v240, v114, v204, v212 op_sel_hi:[1,0,0]
    v_mfma_f32_16x16x32_bf16 a[84:87], a[180:183], v[188:191], a[84:87]
    s_add_u32 m0, s82, 90112
    v_fma_mix_f32 v241, v114, v205, v213 op_sel:[1,0,0] op_sel_hi:[1,0,0]
    v_cvt_pk_bf16_f32 v178, v240, v241
    v_mfma_f32_16x16x32_bf16 a[88:91], a[180:183], v[192:195], a[88:91]
    buffer_load_dwordx4 v22, s[36:39], s81 offen lds
    v_fma_mix_f32 v242, v115, v206, v214 op_sel_hi:[1,0,0]
    v_mfma_f32_16x16x32_bf16 a[92:95], a[180:183], v[196:199], a[92:95]
    ds_read_b128 v[228:231], v34 offset:3376
    v_fma_mix_f32 v243, v115, v207, v215 op_sel:[1,0,0] op_sel_hi:[1,0,0]
    v_cvt_pk_bf16_f32 v179, v242, v243
    v_mfma_f32_16x16x32_bf16 a[96:99], a[184:187], v[184:187], a[96:99]
    ds_read_b64_tr_b16 a[152:153], v31 offset:32768
    ds_read_b64_tr_b16 a[154:155], v31 offset:33792
    v_fma_mix_f32 v236, v116, v200, v208 op_sel_hi:[1,0,0]
    v_mfma_f32_16x16x32_bf16 a[100:103], a[184:187], v[188:191], a[100:103]
    v_fma_mix_f32 v237, v116, v201, v209 op_sel:[1,0,0] op_sel_hi:[1,0,0]
    v_cvt_pk_bf16_f32 v180, v236, v237
    v_mfma_f32_16x16x32_bf16 a[104:107], a[184:187], v[192:195], a[104:107]
    buffer_load_dwordx4 v23, s[36:39], s81 offen offset:1024 lds
    v_fma_mix_f32 v238, v117, v202, v210 op_sel_hi:[1,0,0]
    v_mfma_f32_16x16x32_bf16 a[108:111], a[184:187], v[196:199], a[108:111]
    s_add_u32 s81, s81, 8192
    v_fma_mix_f32 v239, v117, v203, v211 op_sel:[1,0,0] op_sel_hi:[1,0,0]
    v_cvt_pk_bf16_f32 v181, v238, v239
    v_mfma_f32_16x16x32_bf16 a[112:115], a[188:191], v[184:187], a[112:115]
    ds_read_b64_tr_b16 a[156:157], v31 offset:32776
    ds_read_b64_tr_b16 a[158:159], v31 offset:33800
    v_fma_mix_f32 v240, v118, v204, v212 op_sel_hi:[1,0,0]
    v_mfma_f32_16x16x32_bf16 a[116:119], a[188:191], v[188:191], a[116:119]
    v_fma_mix_f32 v241, v118, v205, v213 op_sel:[1,0,0] op_sel_hi:[1,0,0]
    v_cvt_pk_bf16_f32 v182, v240, v241
    v_mfma_f32_16x16x32_bf16 a[120:123], a[188:191], v[192:195], a[120:123]
    v_fma_mix_f32 v242, v119, v206, v214 op_sel_hi:[1,0,0]
    v_fma_mix_f32 v243, v119, v207, v215 op_sel:[1,0,0] op_sel_hi:[1,0,0]
    v_cvt_pk_bf16_f32 v183, v242, v243
    v_mfma_f32_16x16x32_bf16 a[124:127], a[188:191], v[196:199], a[124:127]
    buffer_load_dwordx4 v[152:155], v39, s[44:47], s83 offen offset:0 sc1
    s_add_u32 s83, s83, 131072
    s_waitcnt vmcnt(12)
    s_waitcnt lgkmcnt(4)
    v_mfma_f32_16x16x32_bf16 a[0:3], a[128:131], v[168:171], a[0:3]
    ds_read_b64_tr_b16 a[160:161], v28 offset:40960
    ds_read_b64_tr_b16 a[162:163], v28 offset:41984
    v_fma_mix_f32 v236, v120, v216, v224 op_sel_hi:[1,0,0]
    v_mfma_f32_16x16x32_bf16 a[4:7], a[128:131], v[172:175], a[4:7]
    v_fma_mix_f32 v237, v120, v217, v225 op_sel:[1,0,0] op_sel_hi:[1,0,0]
    v_cvt_pk_bf16_f32 v184, v236, v237
    v_mfma_f32_16x16x32_bf16 a[8:11], a[128:131], v[176:179], a[8:11]
    v_fma_mix_f32 v238, v121, v218, v226 op_sel_hi:[1,0,0]
    v_fma_mix_f32 v239, v121, v219, v227 op_sel:[1,0,0] op_sel_hi:[1,0,0]
    v_mfma_f32_16x16x32_bf16 a[12:15], a[128:131], v[180:183], a[12:15]
    ds_read_b128 v[200:203], v34 offset:3584
    v_cvt_pk_bf16_f32 v185, v238, v239
    v_mfma_f32_16x16x32_bf16 a[16:19], a[132:135], v[168:171], a[16:19]
    ds_read_b64_tr_b16 a[164:165], v28 offset:40968
    ds_read_b64_tr_b16 a[166:167], v28 offset:41992
    v_fma_mix_f32 v240, v122, v220, v228 op_sel_hi:[1,0,0]
    v_mfma_f32_16x16x32_bf16 a[20:23], a[132:135], v[172:175], a[20:23]
    v_fma_mix_f32 v241, v122, v221, v229 op_sel:[1,0,0] op_sel_hi:[1,0,0]
    v_cvt_pk_bf16_f32 v186, v240, v241
    v_mfma_f32_16x16x32_bf16 a[24:27], a[132:135], v[176:179], a[24:27]
    v_fma_mix_f32 v242, v123, v222, v230 op_sel_hi:[1,0,0]
    v_fma_mix_f32 v243, v123, v223, v231 op_sel:[1,0,0] op_sel_hi:[1,0,0]
    v_mfma_f32_16x16x32_bf16 a[28:31], a[132:135], v[180:183], a[28:31]
    ds_read_b128 v[204:207], v34 offset:3600
    v_cvt_pk_bf16_f32 v187, v242, v243
    v_mfma_f32_16x16x32_bf16 a[32:35], a[136:139], v[168:171], a[32:35]
    ds_read_b64_tr_b16 a[168:169], v29 offset:40960
    ds_read_b64_tr_b16 a[170:171], v29 offset:41984
    v_mfma_f32_16x16x32_bf16 a[36:39], a[136:139], v[172:175], a[36:39]
    v_fma_mix_f32 v236, v124, v216, v224 op_sel_hi:[1,0,0]
    v_fma_mix_f32 v237, v124, v217, v225 op_sel:[1,0,0] op_sel_hi:[1,0,0]
    v_mfma_f32_16x16x32_bf16 a[40:43], a[136:139], v[176:179], a[40:43]
    v_cvt_pk_bf16_f32 v188, v236, v237
    v_fma_mix_f32 v238, v125, v218, v226 op_sel_hi:[1,0,0]
    v_mfma_f32_16x16x32_bf16 a[44:47], a[136:139], v[180:183], a[44:47]
    ds_read_b128 v[208:211], v34 offset:3616
    v_fma_mix_f32 v239, v125, v219, v227 op_sel:[1,0,0] op_sel_hi:[1,0,0]
    v_cvt_pk_bf16_f32 v189, v238, v239
    v_mfma_f32_16x16x32_bf16 a[48:51], a[140:143], v[168:171], a[48:51]
    ds_read_b64_tr_b16 a[172:173], v29 offset:40968
    ds_read_b64_tr_b16 a[174:175], v29 offset:41992
    v_mfma_f32_16x16x32_bf16 a[52:55], a[140:143], v[172:175], a[52:55]
    v_fma_mix_f32 v240, v126, v220, v228 op_sel_hi:[1,0,0]
    v_fma_mix_f32 v241, v126, v221, v229 op_sel:[1,0,0] op_sel_hi:[1,0,0]
    v_mfma_f32_16x16x32_bf16 a[56:59], a[140:143], v[176:179], a[56:59]
    v_cvt_pk_bf16_f32 v190, v240, v241
    v_fma_mix_f32 v242, v127, v222, v230 op_sel_hi:[1,0,0]
    v_mfma_f32_16x16x32_bf16 a[60:63], a[140:143], v[180:183], a[60:63]
    s_waitcnt lgkmcnt(11)
    v_fma_mix_f32 v243, v127, v223, v231 op_sel:[1,0,0] op_sel_hi:[1,0,0]
    v_cvt_pk_bf16_f32 v191, v242, v243
    v_mfma_f32_16x16x32_bf16 a[64:67], a[144:147], v[168:171], a[64:67]
    ds_read_b64_tr_b16 a[176:177], v30 offset:40960
    ds_read_b64_tr_b16 a[178:179], v30 offset:41984
    v_mfma_f32_16x16x32_bf16 a[68:71], a[144:147], v[172:175], a[68:71]
    v_fma_mix_f32 v236, v128, v216, v224 op_sel_hi:[1,0,0]
    v_fma_mix_f32 v237, v128, v217, v225 op_sel:[1,0,0] op_sel_hi:[1,0,0]
    v_mfma_f32_16x16x32_bf16 a[72:75], a[144:147], v[176:179], a[72:75]
    v_cvt_pk_bf16_f32 v192, v236, v237
    v_fma_mix_f32 v238, v129, v218, v226 op_sel_hi:[1,0,0]
    v_mfma_f32_16x16x32_bf16 a[76:79], a[144:147], v[180:183], a[76:79]
    ds_read_b128 v[212:215], v34 offset:3632
    v_fma_mix_f32 v239, v129, v219, v227 op_sel:[1,0,0] op_sel_hi:[1,0,0]
    v_cvt_pk_bf16_f32 v193, v238, v239
    v_mfma_f32_16x16x32_bf16 a[80:83], a[148:151], v[168:171], a[80:83]
    ds_read_b64_tr_b16 a[180:181], v30 offset:40968
    ds_read_b64_tr_b16 a[182:183], v30 offset:41992
    v_mfma_f32_16x16x32_bf16 a[84:87], a[148:151], v[172:175], a[84:87]
    v_fma_mix_f32 v240, v130, v220, v228 op_sel_hi:[1,0,0]
    v_fma_mix_f32 v241, v130, v221, v229 op_sel:[1,0,0] op_sel_hi:[1,0,0]
    v_mfma_f32_16x16x32_bf16 a[88:91], a[148:151], v[176:179], a[88:91]
    v_cvt_pk_bf16_f32 v194, v240, v241
    v_fma_mix_f32 v242, v131, v222, v230 op_sel_hi:[1,0,0]
    v_mfma_f32_16x16x32_bf16 a[92:95], a[148:151], v[180:183], a[92:95]
    v_fma_mix_f32 v243, v131, v223, v231 op_sel:[1,0,0] op_sel_hi:[1,0,0]
    v_cvt_pk_bf16_f32 v195, v242, v243
    v_mfma_f32_16x16x32_bf16 a[96:99], a[152:155], v[168:171], a[96:99]
    ds_read_b64_tr_b16 a[184:185], v31 offset:40960
    ds_read_b64_tr_b16 a[186:187], v31 offset:41984
    v_mfma_f32_16x16x32_bf16 a[100:103], a[152:155], v[172:175], a[100:103]
    v_fma_mix_f32 v236, v132, v216, v224 op_sel_hi:[1,0,0]
    v_fma_mix_f32 v237, v132, v217, v225 op_sel:[1,0,0] op_sel_hi:[1,0,0]
    v_mfma_f32_16x16x32_bf16 a[104:107], a[152:155], v[176:179], a[104:107]
    v_cvt_pk_bf16_f32 v196, v236, v237
    v_fma_mix_f32 v238, v133, v218, v226 op_sel_hi:[1,0,0]
    v_mfma_f32_16x16x32_bf16 a[108:111], a[152:155], v[180:183], a[108:111]
    v_fma_mix_f32 v239, v133, v219, v227 op_sel:[1,0,0] op_sel_hi:[1,0,0]
    v_cvt_pk_bf16_f32 v197, v238, v239
    v_mfma_f32_16x16x32_bf16 a[112:115], a[156:159], v[168:171], a[112:115]
    ds_read_b64_tr_b16 a[188:189], v31 offset:40968
    ds_read_b64_tr_b16 a[190:191], v31 offset:41992
    v_fma_mix_f32 v240, v134, v220, v228 op_sel_hi:[1,0,0]
    v_mfma_f32_16x16x32_bf16 a[116:119], a[156:159], v[172:175], a[116:119]
    v_fma_mix_f32 v241, v134, v221, v229 op_sel:[1,0,0] op_sel_hi:[1,0,0]
    v_cvt_pk_bf16_f32 v198, v240, v241
    v_mfma_f32_16x16x32_bf16 a[120:123], a[156:159], v[176:179], a[120:123]
    v_fma_mix_f32 v242, v135, v222, v230 op_sel_hi:[1,0,0]
    v_fma_mix_f32 v243, v135, v223, v231 op_sel:[1,0,0] op_sel_hi:[1,0,0]
    v_mfma_f32_16x16x32_bf16 a[124:127], a[156:159], v[180:183], a[124:127]
    v_cvt_pk_bf16_f32 v199, v242, v243
    s_waitcnt vmcnt(8)
    s_waitcnt lgkmcnt(6)
    s_barrier
    v_mfma_f32_16x16x32_bf16 a[0:3], a[160:163], v[184:187], a[0:3]
    ds_read_b64_tr_b16 a[128:129], v28 offset:49152
    ds_read_b64_tr_b16 a[130:131], v28 offset:50176
    v_fma_mix_f32 v236, v136, v200, v208 op_sel_hi:[1,0,0]
    v_mfma_f32_16x16x32_bf16 a[4:7], a[160:163], v[188:191], a[4:7]
    v_fma_mix_f32 v237, v136, v201, v209 op_sel:[1,0,0] op_sel_hi:[1,0,0]
    v_cvt_pk_bf16_f32 v168, v236, v237
    v_mfma_f32_16x16x32_bf16 a[8:11], a[160:163], v[192:195], a[8:11]
    v_fma_mix_f32 v238, v137, v202, v210 op_sel_hi:[1,0,0]
    v_fma_mix_f32 v239, v137, v203, v211 op_sel:[1,0,0] op_sel_hi:[1,0,0]
    v_mfma_f32_16x16x32_bf16 a[12:15], a[160:163], v[196:199], a[12:15]
    ds_read_b128 v[216:219], v34 offset:3840
    v_cvt_pk_bf16_f32 v169, v238, v239
    v_mfma_f32_16x16x32_bf16 a[16:19], a[164:167], v[184:187], a[16:19]
    ds_read_b64_tr_b16 a[132:133], v28 offset:49160
    ds_read_b64_tr_b16 a[134:135], v28 offset:50184
    v_fma_mix_f32 v240, v138, v204, v212 op_sel_hi:[1,0,0]
    v_mfma_f32_16x16x32_bf16 a[20:23], a[164:167], v[188:191], a[20:23]
    s_add_u32 m0, s82, 49152
    v_fma_mix_f32 v241, v138, v205, v213 op_sel:[1,0,0] op_sel_hi:[1,0,0]
    v_cvt_pk_bf16_f32 v170, v240, v241
    v_mfma_f32_16x16x32_bf16 a[24:27], a[164:167], v[192:195], a[24:27]
    buffer_load_dwordx4 v20, s[32:35], s80 offen lds
    v_fma_mix_f32 v242, v139, v206, v214 op_sel_hi:[1,0,0]
    v_mfma_f32_16x16x32_bf16 a[28:31], a[164:167], v[196:199], a[28:31]
    ds_read_b128 v[220:223], v34 offset:3856
    v_fma_mix_f32 v243, v139, v207, v215 op_sel:[1,0,0] op_sel_hi:[1,0,0]
    v_mfma_f32_16x16x32_bf16 a[32:35], a[168:171], v[184:187], a[32:35]
    ds_read_b64_tr_b16 a[136:137], v29 offset:49152
    ds_read_b64_tr_b16 a[138:139], v29 offset:50176
    v_cvt_pk_bf16_f32 v171, v242, v243
    v_mfma_f32_16x16x32_bf16 a[36:39], a[168:171], v[188:191], a[36:39]
    v_fma_mix_f32 v236, v140, v200, v208 op_sel_hi:[1,0,0]
    v_fma_mix_f32 v237, v140, v201, v209 op_sel:[1,0,0] op_sel_hi:[1,0,0]
    v_mfma_f32_16x16x32_bf16 a[40:43], a[168:171], v[192:195], a[40:43]
    buffer_load_dwordx4 v21, s[32:35], s80 offen offset:1024 lds
    v_mfma_f32_16x16x32_bf16 a[44:47], a[168:171], v[196:199], a[44:47]
    s_add_u32 s80, s80, 8192
    v_cvt_pk_bf16_f32 v172, v236, v237
    v_fma_mix_f32 v238, v141, v202, v210 op_sel_hi:[1,0,0]
    v_mfma_f32_16x16x32_bf16 a[48:51], a[172:175], v[184:187], a[48:51]
    ds_read_b64_tr_b16 a[140:141], v29 offset:49160
    ds_read_b64_tr_b16 a[142:143], v29 offset:50184
    v_fma_mix_f32 v239, v141, v203, v211 op_sel:[1,0,0] op_sel_hi:[1,0,0]
    v_mfma_f32_16x16x32_bf16 a[52:55], a[172:175], v[188:191], a[52:55]
    v_cvt_pk_bf16_f32 v173, v238, v239
    v_fma_mix_f32 v240, v142, v204, v212 op_sel_hi:[1,0,0]
    v_mfma_f32_16x16x32_bf16 a[56:59], a[172:175], v[192:195], a[56:59]
    v_fma_mix_f32 v241, v142, v205, v213 op_sel:[1,0,0] op_sel_hi:[1,0,0]
    v_cvt_pk_bf16_f32 v174, v240, v241
    v_mfma_f32_16x16x32_bf16 a[60:63], a[172:175], v[196:199], a[60:63]
    s_waitcnt lgkmcnt(10)
    v_fma_mix_f32 v242, v143, v206, v214 op_sel_hi:[1,0,0]
    v_fma_mix_f32 v243, v143, v207, v215 op_sel:[1,0,0] op_sel_hi:[1,0,0]
    v_mfma_f32_16x16x32_bf16 a[64:67], a[176:179], v[184:187], a[64:67]
    ds_read_b64_tr_b16 a[144:145], v30 offset:49152
    ds_read_b64_tr_b16 a[146:147], v30 offset:50176
    v_cvt_pk_bf16_f32 v175, v242, v243
    v_mfma_f32_16x16x32_bf16 a[68:71], a[176:179], v[188:191], a[68:71]
    v_fma_mix_f32 v236, v144, v200, v208 op_sel_hi:[1,0,0]
    v_fma_mix_f32 v237, v144, v201, v209 op_sel:[1,0,0] op_sel_hi:[1,0,0]
    v_mfma_f32_16x16x32_bf16 a[72:75], a[176:179], v[192:195], a[72:75]
    v_cvt_pk_bf16_f32 v176, v236, v237
    v_fma_mix_f32 v238, v145, v202, v210 op_sel_hi:[1,0,0]
    v_mfma_f32_16x16x32_bf16 a[76:79], a[176:179], v[196:199], a[76:79]
    ds_read_b128 v[224:227], v34 offset:3872
    v_fma_mix_f32 v239, v145, v203, v211 op_sel:[1,0,0] op_sel_hi:[1,0,0]
    v_mfma_f32_16x16x32_bf16 a[80:83], a[180:183], v[184:187], a[80:83]
    ds_read_b64_tr_b16 a[148:149], v30 offset:49160
    ds_read_b64_tr_b16 a[150:151], v30 offset:50184
    v_cvt_pk_bf16_f32 v177, v238, v239
    v_mfma_f32_16x16x32_bf16 a[84:87], a[180:183], v[188:191], a[84:87]
    v_fma_mix_f32 v240, v146, v204, v212 op_sel_hi:[1,0,0]
    v_fma_mix_f32 v241, v146, v205, v213 op_sel:[1,0,0] op_sel_hi:[1,0,0]
    v_mfma_f32_16x16x32_bf16 a[88:91], a[180:183], v[192:195], a[88:91]
    v_cvt_pk_bf16_f32 v178, v240, v241
    v_fma_mix_f32 v242, v147, v206, v214 op_sel_hi:[1,0,0]
    v_mfma_f32_16x16x32_bf16 a[92:95], a[180:183], v[196:199], a[92:95]
    ds_read_b128 v[228:231], v34 offset:3888
    v_fma_mix_f32 v243, v147, v207, v215 op_sel:[1,0,0] op_sel_hi:[1,0,0]
    v_mfma_f32_16x16x32_bf16 a[96:99], a[184:187], v[184:187], a[96:99]
    ds_read_b64_tr_b16 a[152:153], v31 offset:49152
    ds_read_b64_tr_b16 a[154:155], v31 offset:50176
    v_cvt_pk_bf16_f32 v179, v242, v243
    v_mfma_f32_16x16x32_bf16 a[100:103], a[184:187], v[188:191], a[100:103]
    v_fma_mix_f32 v236, v148, v200, v208 op_sel_hi:[1,0,0]
    v_fma_mix_f32 v237, v148, v201, v209 op_sel:[1,0,0] op_sel_hi:[1,0,0]
    v_mfma_f32_16x16x32_bf16 a[104:107], a[184:187], v[192:195], a[104:107]
    v_cvt_pk_bf16_f32 v180, v236, v237
    v_fma_mix_f32 v238, v149, v202, v210 op_sel_hi:[1,0,0]
    v_mfma_f32_16x16x32_bf16 a[108:111], a[184:187], v[196:199], a[108:111]
    v_fma_mix_f32 v239, v149, v203, v211 op_sel:[1,0,0] op_sel_hi:[1,0,0]
    v_cvt_pk_bf16_f32 v181, v238, v239
    v_mfma_f32_16x16x32_bf16 a[112:115], a[188:191], v[184:187], a[112:115]
    ds_read_b64_tr_b16 a[156:157], v31 offset:49160
    ds_read_b64_tr_b16 a[158:159], v31 offset:50184
    v_mfma_f32_16x16x32_bf16 a[116:119], a[188:191], v[188:191], a[116:119]
    v_fma_mix_f32 v240, v150, v204, v212 op_sel_hi:[1,0,0]
    v_fma_mix_f32 v241, v150, v205, v213 op_sel:[1,0,0] op_sel_hi:[1,0,0]
    v_mfma_f32_16x16x32_bf16 a[120:123], a[188:191], v[192:195], a[120:123]
    v_cvt_pk_bf16_f32 v182, v240, v241
    v_fma_mix_f32 v242, v151, v206, v214 op_sel_hi:[1,0,0]
    v_mfma_f32_16x16x32_bf16 a[124:127], a[188:191], v[196:199], a[124:127]
    v_fma_mix_f32 v243, v151, v207, v215 op_sel:[1,0,0] op_sel_hi:[1,0,0]
    v_cvt_pk_bf16_f32 v183, v242, v243
    s_waitcnt vmcnt(2)
    s_waitcnt lgkmcnt(4)
    v_mfma_f32_16x16x32_bf16 a[0:3], a[128:131], v[168:171], a[0:3]
    ds_read_b64_tr_b16 a[160:161], v28 offset:57344
    ds_read_b64_tr_b16 a[162:163], v28 offset:58368
    v_mfma_f32_16x16x32_bf16 a[4:7], a[128:131], v[172:175], a[4:7]
    v_fma_mix_f32 v236, v152, v216, v224 op_sel_hi:[1,0,0]
    v_fma_mix_f32 v237, v152, v217, v225 op_sel:[1,0,0] op_sel_hi:[1,0,0]
    v_mfma_f32_16x16x32_bf16 a[8:11], a[128:131], v[176:179], a[8:11]
    v_cvt_pk_bf16_f32 v184, v236, v237
    v_fma_mix_f32 v238, v153, v218, v226 op_sel_hi:[1,0,0]
    v_mfma_f32_16x16x32_bf16 a[12:15], a[128:131], v[180:183], a[12:15]
    v_fma_mix_f32 v239, v153, v219, v227 op_sel:[1,0,0] op_sel_hi:[1,0,0]
    v_cvt_pk_bf16_f32 v185, v238, v239
    v_mfma_f32_16x16x32_bf16 a[16:19], a[132:135], v[168:171], a[16:19]
    ds_read_b64_tr_b16 a[164:165], v28 offset:57352
    ds_read_b64_tr_b16 a[166:167], v28 offset:58376
    v_mfma_f32_16x16x32_bf16 a[20:23], a[132:135], v[172:175], a[20:23]
    v_fma_mix_f32 v240, v154, v220, v228 op_sel_hi:[1,0,0]
    v_fma_mix_f32 v241, v154, v221, v229 op_sel:[1,0,0] op_sel_hi:[1,0,0]
    v_mfma_f32_16x16x32_bf16 a[24:27], a[132:135], v[176:179], a[24:27]
    v_cvt_pk_bf16_f32 v186, v240, v241
    v_fma_mix_f32 v242, v155, v222, v230 op_sel_hi:[1,0,0]
    v_mfma_f32_16x16x32_bf16 a[28:31], a[132:135], v[180:183], a[28:31]
    v_fma_mix_f32 v243, v155, v223, v231 op_sel:[1,0,0] op_sel_hi:[1,0,0]
    v_cvt_pk_bf16_f32 v187, v242, v243
    v_mfma_f32_16x16x32_bf16 a[32:35], a[136:139], v[168:171], a[32:35]
    ds_read_b64_tr_b16 a[168:169], v29 offset:57344
    ds_read_b64_tr_b16 a[170:171], v29 offset:58368
    v_mfma_f32_16x16x32_bf16 a[36:39], a[136:139], v[172:175], a[36:39]
    v_fma_mix_f32 v236, v156, v216, v224 op_sel_hi:[1,0,0]
    v_fma_mix_f32 v237, v156, v217, v225 op_sel:[1,0,0] op_sel_hi:[1,0,0]
    v_mfma_f32_16x16x32_bf16 a[40:43], a[136:139], v[176:179], a[40:43]
    v_cvt_pk_bf16_f32 v188, v236, v237
    v_fma_mix_f32 v238, v157, v218, v226 op_sel_hi:[1,0,0]
    v_mfma_f32_16x16x32_bf16 a[44:47], a[136:139], v[180:183], a[44:47]
    v_fma_mix_f32 v239, v157, v219, v227 op_sel:[1,0,0] op_sel_hi:[1,0,0]
    v_cvt_pk_bf16_f32 v189, v238, v239
    v_mfma_f32_16x16x32_bf16 a[48:51], a[140:143], v[168:171], a[48:51]
    ds_read_b64_tr_b16 a[172:173], v29 offset:57352
    ds_read_b64_tr_b16 a[174:175], v29 offset:58376
    v_mfma_f32_16x16x32_bf16 a[52:55], a[140:143], v[172:175], a[52:55]
    v_fma_mix_f32 v240, v158, v220, v228 op_sel_hi:[1,0,0]
    v_fma_mix_f32 v241, v158, v221, v229 op_sel:[1,0,0] op_sel_hi:[1,0,0]
    v_mfma_f32_16x16x32_bf16 a[56:59], a[140:143], v[176:179], a[56:59]
    v_cvt_pk_bf16_f32 v190, v240, v241
    v_fma_mix_f32 v242, v159, v222, v230 op_sel_hi:[1,0,0]
    v_mfma_f32_16x16x32_bf16 a[60:63], a[140:143], v[180:183], a[60:63]
    s_waitcnt lgkmcnt(8)
    v_fma_mix_f32 v243, v159, v223, v231 op_sel:[1,0,0] op_sel_hi:[1,0,0]
    v_cvt_pk_bf16_f32 v191, v242, v243
    v_mfma_f32_16x16x32_bf16 a[64:67], a[144:147], v[168:171], a[64:67]
    ds_read_b64_tr_b16 a[176:177], v30 offset:57344
    ds_read_b64_tr_b16 a[178:179], v30 offset:58368
    v_mfma_f32_16x16x32_bf16 a[68:71], a[144:147], v[172:175], a[68:71]
    v_fma_mix_f32 v236, v160, v216, v224 op_sel_hi:[1,0,0]
    v_fma_mix_f32 v237, v160, v217, v225 op_sel:[1,0,0] op_sel_hi:[1,0,0]
    v_mfma_f32_16x16x32_bf16 a[72:75], a[144:147], v[176:179], a[72:75]
    v_cvt_pk_bf16_f32 v192, v236, v237
    v_fma_mix_f32 v238, v161, v218, v226 op_sel_hi:[1,0,0]
    v_mfma_f32_16x16x32_bf16 a[76:79], a[144:147], v[180:183], a[76:79]
    v_fma_mix_f32 v239, v161, v219, v227 op_sel:[1,0,0] op_sel_hi:[1,0,0]
    v_cvt_pk_bf16_f32 v193, v238, v239
    v_mfma_f32_16x16x32_bf16 a[80:83], a[148:151], v[168:171], a[80:83]
    ds_read_b64_tr_b16 a[180:181], v30 offset:57352
    ds_read_b64_tr_b16 a[182:183], v30 offset:58376
    v_mfma_f32_16x16x32_bf16 a[84:87], a[148:151], v[172:175], a[84:87]
    v_fma_mix_f32 v240, v162, v220, v228 op_sel_hi:[1,0,0]
    v_fma_mix_f32 v241, v162, v221, v229 op_sel:[1,0,0] op_sel_hi:[1,0,0]
    v_mfma_f32_16x16x32_bf16 a[88:91], a[148:151], v[176:179], a[88:91]
    v_cvt_pk_bf16_f32 v194, v240, v241
    v_fma_mix_f32 v242, v163, v222, v230 op_sel_hi:[1,0,0]
    v_mfma_f32_16x16x32_bf16 a[92:95], a[148:151], v[180:183], a[92:95]
    v_fma_mix_f32 v243, v163, v223, v231 op_sel:[1,0,0] op_sel_hi:[1,0,0]
    v_cvt_pk_bf16_f32 v195, v242, v243
    v_mfma_f32_16x16x32_bf16 a[96:99], a[152:155], v[168:171], a[96:99]
    ds_read_b64_tr_b16 a[184:185], v31 offset:57344
    ds_read_b64_tr_b16 a[186:187], v31 offset:58368
    v_mfma_f32_16x16x32_bf16 a[100:103], a[152:155], v[172:175], a[100:103]
    v_fma_mix_f32 v236, v164, v216, v224 op_sel_hi:[1,0,0]
    v_fma_mix_f32 v237, v164, v217, v225 op_sel:[1,0,0] op_sel_hi:[1,0,0]
    v_mfma_f32_16x16x32_bf16 a[104:107], a[152:155], v[176:179], a[104:107]
    v_cvt_pk_bf16_f32 v196, v236, v237
    v_fma_mix_f32 v238, v165, v218, v226 op_sel_hi:[1,0,0]
    v_mfma_f32_16x16x32_bf16 a[108:111], a[152:155], v[180:183], a[108:111]
    v_fma_mix_f32 v239, v165, v219, v227 op_sel:[1,0,0] op_sel_hi:[1,0,0]
    v_cvt_pk_bf16_f32 v197, v238, v239
    v_mfma_f32_16x16x32_bf16 a[112:115], a[156:159], v[168:171], a[112:115]
    ds_read_b64_tr_b16 a[188:189], v31 offset:57352
    ds_read_b64_tr_b16 a[190:191], v31 offset:58376
    v_mfma_f32_16x16x32_bf16 a[116:119], a[156:159], v[172:175], a[116:119]
    v_fma_mix_f32 v240, v166, v220, v228 op_sel_hi:[1,0,0]
    v_fma_mix_f32 v241, v166, v221, v229 op_sel:[1,0,0] op_sel_hi:[1,0,0]
    v_mfma_f32_16x16x32_bf16 a[120:123], a[156:159], v[176:179], a[120:123]
    v_cvt_pk_bf16_f32 v198, v240, v241
    v_fma_mix_f32 v242, v167, v222, v230 op_sel_hi:[1,0,0]
    v_mfma_f32_16x16x32_bf16 a[124:127], a[156:159], v[180:183], a[124:127]
    v_fma_mix_f32 v243, v167, v223, v231 op_sel:[1,0,0] op_sel_hi:[1,0,0]
    v_cvt_pk_bf16_f32 v199, v242, v243
    s_waitcnt lgkmcnt(8)
    v_mfma_f32_16x16x32_bf16 a[0:3], a[160:163], v[184:187], a[0:3]
    v_mfma_f32_16x16x32_bf16 a[4:7], a[160:163], v[188:191], a[4:7]
    v_mfma_f32_16x16x32_bf16 a[8:11], a[160:163], v[192:195], a[8:11]
    v_mfma_f32_16x16x32_bf16 a[12:15], a[160:163], v[196:199], a[12:15]
    v_mfma_f32_16x16x32_bf16 a[16:19], a[164:167], v[184:187], a[16:19]
    v_mfma_f32_16x16x32_bf16 a[20:23], a[164:167], v[188:191], a[20:23]
    v_mfma_f32_16x16x32_bf16 a[24:27], a[164:167], v[192:195], a[24:27]
    v_mfma_f32_16x16x32_bf16 a[28:31], a[164:167], v[196:199], a[28:31]
    v_mfma_f32_16x16x32_bf16 a[32:35], a[168:171], v[184:187], a[32:35]
    v_mfma_f32_16x16x32_bf16 a[36:39], a[168:171], v[188:191], a[36:39]
    v_mfma_f32_16x16x32_bf16 a[40:43], a[168:171], v[192:195], a[40:43]
    v_mfma_f32_16x16x32_bf16 a[44:47], a[168:171], v[196:199], a[44:47]
    v_mfma_f32_16x16x32_bf16 a[48:51], a[172:175], v[184:187], a[48:51]
    v_mfma_f32_16x16x32_bf16 a[52:55], a[172:175], v[188:191], a[52:55]
    v_mfma_f32_16x16x32_bf16 a[56:59], a[172:175], v[192:195], a[56:59]
    v_mfma_f32_16x16x32_bf16 a[60:63], a[172:175], v[196:199], a[60:63]
    s_waitcnt lgkmcnt(0)
    v_mfma_f32_16x16x32_bf16 a[64:67], a[176:179], v[184:187], a[64:67]
    v_mfma_f32_16x16x32_bf16 a[68:71], a[176:179], v[188:191], a[68:71]
    v_mfma_f32_16x16x32_bf16 a[72:75], a[176:179], v[192:195], a[72:75]
    v_mfma_f32_16x16x32_bf16 a[76:79], a[176:179], v[196:199], a[76:79]
    v_mfma_f32_16x16x32_bf16 a[80:83], a[180:183], v[184:187], a[80:83]
    v_mfma_f32_16x16x32_bf16 a[84:87], a[180:183], v[188:191], a[84:87]
    v_mfma_f32_16x16x32_bf16 a[88:91], a[180:183], v[192:195], a[88:91]
    v_mfma_f32_16x16x32_bf16 a[92:95], a[180:183], v[196:199], a[92:95]
    v_mfma_f32_16x16x32_bf16 a[96:99], a[184:187], v[184:187], a[96:99]
    v_mfma_f32_16x16x32_bf16 a[100:103], a[184:187], v[188:191], a[100:103]
    v_mfma_f32_16x16x32_bf16 a[104:107], a[184:187], v[192:195], a[104:107]
    v_mfma_f32_16x16x32_bf16 a[108:111], a[184:187], v[196:199], a[108:111]
    v_mfma_f32_16x16x32_bf16 a[112:115], a[188:191], v[184:187], a[112:115]
    v_mfma_f32_16x16x32_bf16 a[116:119], a[188:191], v[188:191], a[116:119]
    v_mfma_f32_16x16x32_bf16 a[120:123], a[188:191], v[192:195], a[120:123]
    v_mfma_f32_16x16x32_bf16 a[124:127], a[188:191], v[196:199], a[124:127]
    s_barrier
    ds_read_b128 a[128:131], v8 offset:0
    ds_read_b128 a[132:135], v9 offset:0
    ds_read_b128 a[136:139], v10 offset:0
    ds_read_b128 a[140:143], v11 offset:0
    ds_read_b128 a[144:147], v8 offset:4096
    ds_read_b128 a[148:151], v9 offset:4096
    ds_read_b128 a[152:155], v10 offset:4096
    ds_read_b128 a[156:159], v11 offset:4096
    v_cmp_ne_u32 vcc, s79, v252
    s_mov_b64 s[88:89], vcc
    v_cmp_ne_u32 vcc, s79, v253
    s_or_b64 vcc, vcc, s[88:89]
    s_cbranch_vccz F0R_done
    s_mov_b32 s91, 262144
F0R_loop:
    buffer_load_dwordx2 v[252:253], v35, s[44:47], s90 offen sc1
    s_waitcnt vmcnt(0)
    v_cmp_ne_u32 vcc, s79, v252
    s_mov_b64 s[88:89], vcc
    v_cmp_ne_u32 vcc, s79, v253
    s_or_b64 vcc, vcc, s[88:89]
    s_sub_u32 s91, s91, 1
    s_cbranch_scc1 F0R_out
    s_cbranch_vccz F0R_out
    s_sleep 1
    s_branch F0R_loop
F0R_out:
F0R_done:
    v_lshl_add_u32 v7, v2, 3, v4
    v_mul_u32_u24 v7, 768, v7
    v_add_u32 v32, v22, v7
    v_add_u32 v34, v23, v7
    v_add_u32 v34, 3072, v34
    v_lshrrev_b32 v5, 1, v0
    v_mul_u32_u24 v5, 14336, v5
    v_and_b32 v6, 1, v0
    v_lshl_add_u32 v35, v6, 4, v5
    s_lshl_b32 s88, s8, 12
    s_lshl_b32 s89, s76, 9
    s_add_u32 s88, s88, s89
    s_add_u32 s88, s88, 3145728
    v_lshlrev_b32 v5, 7, v1
    v_add_u32 v5, s88, v5
    s_lshl_b32 s88, s8, 7
    s_lshl_b32 s89, s76, 15
    s_add_u32 s88, s88, s89
    s_add_u32 s88, s88, 131072
    s_lshl_b32 s89, s2, 7
    s_add_u32 s89, s89, 32768
    s_cmp_eq_u32 s76, 2
    s_cselect_b32 s88, s89, s88
    s_lshl_b32 s89, s8, 2
    s_add_u32 s89, s89, 24576
    s_cmp_eq_u32 s76, 3
    s_cselect_b32 s88, s89, s88
    v_mov_b32 v6, s88
    v_cmp_gt_u32 vcc, 4, v1
    s_nop 1
    v_cndmask_b32 v246, v6, v5, vcc
    s_getpc_b64 s[40:41]
F_PC2:
    s_sub_u32 s40, s40, F_PC2-adaLN_cond__mha_block_cached__moe_arch_mod__prompt_kernel
    s_subb_u32 s41, s41, 0
    s_mov_b32 s42, F_SLOW-adaLN_cond__mha_block_cached__moe_arch_mod__prompt_kernel
    s_mov_b32 s43, 0x20000
    s_lshr_b32 s3, s2, 3
    s_lshl_b32 s3, s3, 2
    s_add_u32 s3, s3, s76
    s_lshl_b32 s3, s3, 10
    v_accvgpr_read_b32 v236, a0
    v_accvgpr_read_b32 v237, a1
    v_accvgpr_read_b32 v238, a2
    v_accvgpr_read_b32 v239, a3
    v_accvgpr_read_b32 v240, a16
    v_accvgpr_read_b32 v241, a17
    v_accvgpr_read_b32 v242, a18
    v_accvgpr_read_b32 v243, a19
    v_cvt_pk_bf16_f32 v40, v236, v237
    v_cvt_pk_bf16_f32 v41, v238, v239
    v_cvt_pk_bf16_f32 v42, v240, v241
    v_cvt_pk_bf16_f32 v43, v242, v243
    v_accvgpr_read_b32 v200, a32
    v_accvgpr_read_b32 v201, a33
    v_accvgpr_read_b32 v202, a34
    v_accvgpr_read_b32 v203, a35
    v_accvgpr_read_b32 v204, a48
    v_accvgpr_read_b32 v205, a49
    v_accvgpr_read_b32 v206, a50
    v_accvgpr_read_b32 v207, a51
    v_cvt_pk_bf16_f32 v44, v200, v201
    v_cvt_pk_bf16_f32 v45, v202, v203
    v_cvt_pk_bf16_f32 v46, v204, v205
    v_cvt_pk_bf16_f32 v47, v206, v207
    v_accvgpr_read_b32 v236, a64
    v_accvgpr_read_b32 v237, a65
    v_accvgpr_read_b32 v238, a66
    v_accvgpr_read_b32 v239, a67
    v_accvgpr_read_b32 v240, a80
    v_accvgpr_read_b32 v241, a81
    v_accvgpr_read_b32 v242, a82
    v_accvgpr_read_b32 v243, a83
    v_cvt_pk_bf16_f32 v48, v236, v237
    v_cvt_pk_bf16_f32 v49, v238, v239
    v_cvt_pk_bf16_f32 v50, v240, v241
    v_cvt_pk_bf16_f32 v51, v242, v243
    v_accvgpr_read_b32 v200, a96
    v_accvgpr_read_b32 v201, a97
    v_accvgpr_read_b32 v202, a98
    v_accvgpr_read_b32 v203, a99
    v_accvgpr_read_b32 v204, a112
    v_accvgpr_read_b32 v205, a113
    v_accvgpr_read_b32 v206, a114
    v_accvgpr_read_b32 v207, a115
    v_cvt_pk_bf16_f32 v52, v200, v201
    v_cvt_pk_bf16_f32 v53, v202, v203
    v_cvt_pk_bf16_f32 v54, v204, v205
    v_cvt_pk_bf16_f32 v55, v206, v207
    s_waitcnt lgkmcnt(0)
    v_mfma_f32_16x16x32_bf16 v[104:107], a[128:131], v[40:43], 0
    v_accvgpr_read_b32 v236, a4
    v_accvgpr_read_b32 v237, a5
    v_accvgpr_read_b32 v238, a6
    v_accvgpr_read_b32 v239, a7
    v_accvgpr_read_b32 v240, a20
    v_accvgpr_read_b32 v241, a21
    v_mfma_f32_16x16x32_bf16 v[104:107], a[132:135], v[44:47], v[104:107]
    v_accvgpr_read_b32 v242, a22
    v_accvgpr_read_b32 v243, a23
    v_cvt_pk_bf16_f32 v56, v236, v237
    v_cvt_pk_bf16_f32 v57, v238, v239
    v_cvt_pk_bf16_f32 v58, v240, v241
    v_cvt_pk_bf16_f32 v59, v242, v243
    v_mfma_f32_16x16x32_bf16 v[104:107], a[136:139], v[48:51], v[104:107]
    v_accvgpr_read_b32 v200, a36
    v_accvgpr_read_b32 v201, a37
    v_accvgpr_read_b32 v202, a38
    v_accvgpr_read_b32 v203, a39
    v_accvgpr_read_b32 v204, a52
    v_accvgpr_read_b32 v205, a53
    v_mfma_f32_16x16x32_bf16 v[104:107], a[140:143], v[52:55], v[104:107]
    v_accvgpr_read_b32 v206, a54
    v_accvgpr_read_b32 v207, a55
    v_cvt_pk_bf16_f32 v60, v200, v201
    v_cvt_pk_bf16_f32 v61, v202, v203
    v_cvt_pk_bf16_f32 v62, v204, v205
    v_cvt_pk_bf16_f32 v63, v206, v207
    v_mfma_f32_16x16x32_bf16 v[108:111], a[144:147], v[40:43], 0
    v_accvgpr_read_b32 v236, a68
    v_accvgpr_read_b32 v237, a69
    v_accvgpr_read_b32 v238, a70
    v_accvgpr_read_b32 v239, a71
    v_accvgpr_read_b32 v240, a84
    v_accvgpr_read_b32 v241, a85
    v_mfma_f32_16x16x32_bf16 v[108:111], a[148:151], v[44:47], v[108:111]
    v_accvgpr_read_b32 v242, a86
    v_accvgpr_read_b32 v243, a87
    v_cvt_pk_bf16_f32 v64, v236, v237
    v_cvt_pk_bf16_f32 v65, v238, v239
    v_cvt_pk_bf16_f32 v66, v240, v241
    v_cvt_pk_bf16_f32 v67, v242, v243
    v_mfma_f32_16x16x32_bf16 v[108:111], a[152:155], v[48:51], v[108:111]
    v_accvgpr_read_b32 v200, a100
    v_accvgpr_read_b32 v201, a101
    v_accvgpr_read_b32 v202, a102
    v_accvgpr_read_b32 v203, a103
    v_accvgpr_read_b32 v204, a116
    v_accvgpr_read_b32 v205, a117
    v_mfma_f32_16x16x32_bf16 v[108:111], a[156:159], v[52:55], v[108:111]
    v_accvgpr_read_b32 v206, a118
    v_accvgpr_read_b32 v207, a119
    v_cvt_pk_bf16_f32 v68, v200, v201
    v_cvt_pk_bf16_f32 v69, v202, v203
    v_cvt_pk_bf16_f32 v70, v204, v205
    v_cvt_pk_bf16_f32 v71, v206, v207
    v_mfma_f32_16x16x32_bf16 v[112:115], a[128:131], v[56:59], 0
    v_accvgpr_read_b32 v236, a8
    v_accvgpr_read_b32 v237, a9
    v_accvgpr_read_b32 v238, a10
    v_accvgpr_read_b32 v239, a11
    v_accvgpr_read_b32 v240, a24
    v_accvgpr_read_b32 v241, a25
    v_mfma_f32_16x16x32_bf16 v[112:115], a[132:135], v[60:63], v[112:115]
    v_accvgpr_read_b32 v242, a26
    v_accvgpr_read_b32 v243, a27
    v_cvt_pk_bf16_f32 v72, v236, v237
    v_cvt_pk_bf16_f32 v73, v238, v239
    v_cvt_pk_bf16_f32 v74, v240, v241
    v_cvt_pk_bf16_f32 v75, v242, v243
    v_mfma_f32_16x16x32_bf16 v[112:115], a[136:139], v[64:67], v[112:115]
    v_accvgpr_read_b32 v200, a40
    v_accvgpr_read_b32 v201, a41
    v_accvgpr_read_b32 v202, a42
    v_accvgpr_read_b32 v203, a43
    v_accvgpr_read_b32 v204, a56
    v_accvgpr_read_b32 v205, a57
    v_mfma_f32_16x16x32_bf16 v[112:115], a[140:143], v[68:71], v[112:115]
    v_accvgpr_read_b32 v206, a58
    v_accvgpr_read_b32 v207, a59
    v_cvt_pk_bf16_f32 v76, v200, v201
    v_cvt_pk_bf16_f32 v77, v202, v203
    v_cvt_pk_bf16_f32 v78, v204, v205
    v_cvt_pk_bf16_f32 v79, v206, v207
    v_mfma_f32_16x16x32_bf16 v[116:119], a[144:147], v[56:59], 0
    v_accvgpr_read_b32 v236, a72
    v_accvgpr_read_b32 v237, a73
    v_accvgpr_read_b32 v238, a74
    v_accvgpr_read_b32 v239, a75
    v_accvgpr_read_b32 v240, a88
    v_accvgpr_read_b32 v241, a89
    v_mfma_f32_16x16x32_bf16 v[116:119], a[148:151], v[60:63], v[116:119]
    v_accvgpr_read_b32 v242, a90
    v_accvgpr_read_b32 v243, a91
    v_cvt_pk_bf16_f32 v80, v236, v237
    v_cvt_pk_bf16_f32 v81, v238, v239
    v_cvt_pk_bf16_f32 v82, v240, v241
    v_cvt_pk_bf16_f32 v83, v242, v243
    v_mfma_f32_16x16x32_bf16 v[116:119], a[152:155], v[64:67], v[116:119]
    v_accvgpr_read_b32 v200, a104
    v_accvgpr_read_b32 v201, a105
    v_accvgpr_read_b32 v202, a106
    v_accvgpr_read_b32 v203, a107
    v_accvgpr_read_b32 v204, a120
    v_accvgpr_read_b32 v205, a121
    v_mfma_f32_16x16x32_bf16 v[116:119], a[156:159], v[68:71], v[116:119]
    v_accvgpr_read_b32 v206, a122
    v_accvgpr_read_b32 v207, a123
    v_cvt_pk_bf16_f32 v84, v200, v201
    v_cvt_pk_bf16_f32 v85, v202, v203
    v_cvt_pk_bf16_f32 v86, v204, v205
    v_cvt_pk_bf16_f32 v87, v206, v207
    v_mfma_f32_16x16x32_bf16 v[120:123], a[128:131], v[72:75], 0
    v_accvgpr_read_b32 v236, a12
    v_accvgpr_read_b32 v237, a13
    v_accvgpr_read_b32 v238, a14
    v_accvgpr_read_b32 v239, a15
    v_accvgpr_read_b32 v240, a28
    v_accvgpr_read_b32 v241, a29
    v_mfma_f32_16x16x32_bf16 v[120:123], a[132:135], v[76:79], v[120:123]
    v_accvgpr_read_b32 v242, a30
    v_accvgpr_read_b32 v243, a31
    v_cvt_pk_bf16_f32 v88, v236, v237
    v_cvt_pk_bf16_f32 v89, v238, v239
    v_cvt_pk_bf16_f32 v90, v240, v241
    v_cvt_pk_bf16_f32 v91, v242, v243
    v_mfma_f32_16x16x32_bf16 v[120:123], a[136:139], v[80:83], v[120:123]
    v_accvgpr_read_b32 v200, a44
    v_accvgpr_read_b32 v201, a45
    v_accvgpr_read_b32 v202, a46
    v_accvgpr_read_b32 v203, a47
    v_accvgpr_read_b32 v204, a60
    v_accvgpr_read_b32 v205, a61
    v_mfma_f32_16x16x32_bf16 v[120:123], a[140:143], v[84:87], v[120:123]
    v_accvgpr_read_b32 v206, a62
    v_accvgpr_read_b32 v207, a63
    v_cvt_pk_bf16_f32 v92, v200, v201
    v_cvt_pk_bf16_f32 v93, v202, v203
    v_cvt_pk_bf16_f32 v94, v204, v205
    v_cvt_pk_bf16_f32 v95, v206, v207
    v_mfma_f32_16x16x32_bf16 v[124:127], a[144:147], v[72:75], 0
    v_accvgpr_read_b32 v236, a76
    v_accvgpr_read_b32 v237, a77
    v_accvgpr_read_b32 v238, a78
    v_accvgpr_read_b32 v239, a79
    v_accvgpr_read_b32 v240, a92
    v_accvgpr_read_b32 v241, a93
    v_mfma_f32_16x16x32_bf16 v[124:127], a[148:151], v[76:79], v[124:127]
    v_accvgpr_read_b32 v242, a94
    v_accvgpr_read_b32 v243, a95
    v_cvt_pk_bf16_f32 v96, v236, v237
    v_cvt_pk_bf16_f32 v97, v238, v239
    v_cvt_pk_bf16_f32 v98, v240, v241
    v_cvt_pk_bf16_f32 v99, v242, v243
    v_mfma_f32_16x16x32_bf16 v[124:127], a[152:155], v[80:83], v[124:127]
    v_accvgpr_read_b32 v200, a108
    v_accvgpr_read_b32 v201, a109
    v_accvgpr_read_b32 v202, a110
    v_accvgpr_read_b32 v203, a111
    v_accvgpr_read_b32 v204, a124
    v_accvgpr_read_b32 v205, a125
    v_mfma_f32_16x16x32_bf16 v[124:127], a[156:159], v[84:87], v[124:127]
    v_accvgpr_read_b32 v206, a126
    v_accvgpr_read_b32 v207, a127
    v_cvt_pk_bf16_f32 v100, v200, v201
    v_cvt_pk_bf16_f32 v101, v202, v203
    v_cvt_pk_bf16_f32 v102, v204, v205
    v_cvt_pk_bf16_f32 v103, v206, v207
    v_mfma_f32_16x16x32_bf16 v[128:131], a[128:131], v[88:91], 0
    ds_read_b128 a[160:163], v8 offset:8192
    v_mfma_f32_16x16x32_bf16 v[128:131], a[132:135], v[92:95], v[128:131]
    ds_read_b128 a[164:167], v9 offset:8192
    v_mfma_f32_16x16x32_bf16 v[128:131], a[136:139], v[96:99], v[128:131]
    ds_read_b128 a[168:171], v10 offset:8192
    v_mfma_f32_16x16x32_bf16 v[128:131], a[140:143], v[100:103], v[128:131]
    ds_read_b128 a[172:175], v11 offset:8192
    v_mfma_f32_16x16x32_bf16 v[132:135], a[144:147], v[88:91], 0
    ds_read_b128 a[176:179], v8 offset:12288
    v_mfma_f32_16x16x32_bf16 v[132:135], a[148:151], v[92:95], v[132:135]
    ds_read_b128 a[180:183], v9 offset:12288
    v_mfma_f32_16x16x32_bf16 v[132:135], a[152:155], v[96:99], v[132:135]
    ds_read_b128 a[184:187], v10 offset:12288
    v_mfma_f32_16x16x32_bf16 v[132:135], a[156:159], v[100:103], v[132:135]
    ds_read_b128 a[188:191], v11 offset:12288
    s_nop 7
    v_max3_f32 v236, v104, v105, v106
    v_max3_f32 v236, v236, v107, v108
    v_max3_f32 v236, v236, v109, v110
    v_max_f32 v236, v236, v111
    v_max3_f32 v237, v112, v113, v114
    v_max3_f32 v237, v237, v115, v116
    v_max3_f32 v237, v237, v117, v118
    v_max_f32 v237, v237, v119
    v_max3_f32 v238, v120, v121, v122
    v_max3_f32 v238, v238, v123, v124
    v_max3_f32 v238, v238, v125, v126
    v_max_f32 v238, v238, v127
    v_max3_f32 v239, v128, v129, v130
    v_max3_f32 v239, v239, v131, v132
    v_max3_f32 v239, v239, v133, v134
    v_max_f32 v239, v239, v135
    s_nop 1
    v_mov_b32 v240, v236
    v_mov_b32 v241, v237
    v_mov_b32 v242, v238
    v_mov_b32 v243, v239
    v_permlane16_swap_b32 v240, v236
    v_permlane16_swap_b32 v241, v237
    v_permlane16_swap_b32 v242, v238
    v_permlane16_swap_b32 v243, v239
    v_max_f32 v236, v236, v240
    v_max_f32 v237, v237, v241
    v_max_f32 v238, v238, v242
    v_max_f32 v239, v239, v243
    v_mov_b32 v240, v236
    v_mov_b32 v241, v237
    v_mov_b32 v242, v238
    v_mov_b32 v243, v239
    v_permlane32_swap_b32 v240, v236
    v_permlane32_swap_b32 v241, v237
    v_permlane32_swap_b32 v242, v238
    v_permlane32_swap_b32 v243, v239
    v_max_f32 v236, v236, v240
    v_max_f32 v237, v237, v241
    v_max_f32 v238, v238, v242
    v_max_f32 v239, v239, v243
    v_sub_f32 v200, 0, v236
    v_sub_f32 v201, 0, v236
    v_sub_f32 v202, 0, v236
    v_sub_f32 v203, 0, v236
    v_sub_f32 v104, v104, v236
    v_sub_f32 v105, v105, v236
    v_sub_f32 v106, v106, v236
    v_sub_f32 v107, v107, v236
    v_sub_f32 v108, v108, v236
    v_sub_f32 v109, v109, v236
    v_sub_f32 v110, v110, v236
    v_sub_f32 v111, v111, v236
    v_sub_f32 v204, 0, v237
    v_sub_f32 v205, 0, v237
    v_sub_f32 v206, 0, v237
    v_sub_f32 v207, 0, v237
    v_sub_f32 v112, v112, v237
    v_sub_f32 v113, v113, v237
    v_sub_f32 v114, v114, v237
    v_sub_f32 v115, v115, v237
    v_sub_f32 v116, v116, v237
    v_sub_f32 v117, v117, v237
    v_sub_f32 v118, v118, v237
    v_sub_f32 v119, v119, v237
    v_sub_f32 v208, 0, v238
    v_sub_f32 v209, 0, v238
    v_sub_f32 v210, 0, v238
    v_sub_f32 v211, 0, v238
    v_sub_f32 v120, v120, v238
    v_sub_f32 v121, v121, v238
    v_sub_f32 v122, v122, v238
    v_sub_f32 v123, v123, v238
    v_sub_f32 v124, v124, v238
    v_sub_f32 v125, v125, v238
    v_sub_f32 v126, v126, v238
    v_sub_f32 v127, v127, v238
    v_sub_f32 v212, 0, v239
    v_sub_f32 v213, 0, v239
    v_sub_f32 v214, 0, v239
    v_sub_f32 v215, 0, v239
    v_sub_f32 v128, v128, v239
    v_sub_f32 v129, v129, v239
    v_sub_f32 v130, v130, v239
    v_sub_f32 v131, v131, v239
    v_sub_f32 v132, v132, v239
    v_sub_f32 v133, v133, v239
    v_sub_f32 v134, v134, v239
    v_sub_f32 v135, v135, v239
    s_nop 1
    s_waitcnt lgkmcnt(4)
    v_mfma_f32_16x16x32_bf16 v[136:139], a[160:163], v[40:43], v[200:203]
    ds_read_b128 a[128:131], v8 offset:16384
    v_exp_f32 v236, v104
    s_nop 0
    v_mov_b32 v224, v236
    v_mfma_f32_16x16x32_bf16 v[136:139], a[164:167], v[44:47], v[136:139]
    v_exp_f32 v237, v105
    v_exp_f32 v238, v106
    v_mfma_f32_16x16x32_bf16 v[136:139], a[168:171], v[48:51], v[136:139]
    v_mov_b32 v225, v237
    v_cvt_pk_bf16_f32 v168, v236, v237
    v_exp_f32 v239, v107
    v_mfma_f32_16x16x32_bf16 v[136:139], a[172:175], v[52:55], v[136:139]
    v_add_f32 v224, v224, v238
    v_exp_f32 v240, v108
    v_add_f32 v225, v225, v239
    v_mfma_f32_16x16x32_bf16 v[144:147], a[160:163], v[56:59], v[204:207]
    ds_read_b128 a[132:135], v9 offset:16384
    v_cvt_pk_bf16_f32 v169, v238, v239
    v_add_f32 v224, v224, v240
    v_mfma_f32_16x16x32_bf16 v[144:147], a[164:167], v[60:63], v[144:147]
    s_add_u32 m0, s82, 57344
    v_exp_f32 v241, v109
    v_exp_f32 v242, v110
    v_mfma_f32_16x16x32_bf16 v[144:147], a[168:171], v[64:67], v[144:147]
    buffer_load_dwordx4 v20, s[32:35], s80 offen lds
    v_add_f32 v225, v225, v241
    v_mfma_f32_16x16x32_bf16 v[144:147], a[172:175], v[68:71], v[144:147]
    v_cvt_pk_bf16_f32 v170, v240, v241
    v_exp_f32 v243, v111
    v_add_f32 v224, v224, v242
    v_mfma_f32_16x16x32_bf16 v[152:155], a[160:163], v[72:75], v[208:211]
    ds_read_b128 a[136:139], v10 offset:16384
    v_exp_f32 v252, v112
    v_add_f32 v225, v225, v243
    v_mfma_f32_16x16x32_bf16 v[152:155], a[164:167], v[76:79], v[152:155]
    v_cvt_pk_bf16_f32 v171, v242, v243
    v_exp_f32 v253, v113
    v_mfma_f32_16x16x32_bf16 v[152:155], a[168:171], v[80:83], v[152:155]
    buffer_load_dwordx4 v21, s[32:35], s80 offen offset:1024 lds
    v_exp_f32 v254, v114
    v_mfma_f32_16x16x32_bf16 v[152:155], a[172:175], v[84:87], v[152:155]
    s_add_u32 s80, s80, 8192
    v_cvt_pk_bf16_f32 v172, v252, v253
    v_exp_f32 v255, v115
    v_mfma_f32_16x16x32_bf16 v[160:163], a[160:163], v[88:91], v[212:215]
    ds_read_b128 a[140:143], v11 offset:16384
    v_exp_f32 v236, v116
    v_cvt_pk_bf16_f32 v173, v254, v255
    v_mfma_f32_16x16x32_bf16 v[160:163], a[164:167], v[92:95], v[160:163]
    buffer_load_dwordx4 a[224:227], v33, s[52:55], s86 offen
    v_exp_f32 v237, v117
    v_mfma_f32_16x16x32_bf16 v[160:163], a[168:171], v[96:99], v[160:163]
    s_add_u32 s86, s86, 1024
    v_exp_f32 v238, v118
    v_cvt_pk_bf16_f32 v174, v236, v237
    v_mfma_f32_16x16x32_bf16 v[160:163], a[172:175], v[100:103], v[160:163]
    s_waitcnt lgkmcnt(4)
    v_exp_f32 v239, v119
    v_exp_f32 v240, v120
    v_mfma_f32_16x16x32_bf16 v[140:143], a[176:179], v[40:43], v[200:203]
    ds_read_b128 a[144:147], v8 offset:20480
    v_cvt_pk_bf16_f32 v175, v238, v239
    v_mov_b32 v226, v240
    v_mfma_f32_16x16x32_bf16 v[140:143], a[180:183], v[44:47], v[140:143]
    v_exp_f32 v241, v121
    v_exp_f32 v242, v122
    v_mfma_f32_16x16x32_bf16 v[140:143], a[184:187], v[48:51], v[140:143]
    v_mov_b32 v227, v241
    v_cvt_pk_bf16_f32 v176, v240, v241
    v_add_f32 v226, v226, v242
    v_mfma_f32_16x16x32_bf16 v[140:143], a[188:191], v[52:55], v[140:143]
    v_exp_f32 v243, v123
    v_exp_f32 v252, v124
    v_mfma_f32_16x16x32_bf16 v[148:151], a[176:179], v[56:59], v[204:207]
    ds_read_b128 a[148:151], v9 offset:20480
    v_add_f32 v227, v227, v243
    v_cvt_pk_bf16_f32 v177, v242, v243
    v_mfma_f32_16x16x32_bf16 v[148:151], a[180:183], v[60:63], v[148:151]
    s_add_u32 m0, s82, 0
    v_exp_f32 v253, v125
    v_add_f32 v226, v226, v252
    v_add_f32 v227, v227, v253
    v_mfma_f32_16x16x32_bf16 v[148:151], a[184:187], v[64:67], v[148:151]
    buffer_load_dwordx4 v20, s[32:35], s80 offen lds
    v_exp_f32 v254, v126
    v_mfma_f32_16x16x32_bf16 v[148:151], a[188:191], v[68:71], v[148:151]
    v_cvt_pk_bf16_f32 v178, v252, v253
    v_exp_f32 v255, v127
    v_mfma_f32_16x16x32_bf16 v[156:159], a[176:179], v[72:75], v[208:211]
    ds_read_b128 a[152:155], v10 offset:20480
    v_add_f32 v226, v226, v254
    v_exp_f32 v236, v128
    v_mfma_f32_16x16x32_bf16 v[156:159], a[180:183], v[76:79], v[156:159]
    v_add_f32 v227, v227, v255
    v_cvt_pk_bf16_f32 v179, v254, v255
    v_mfma_f32_16x16x32_bf16 v[156:159], a[184:187], v[80:83], v[156:159]
    buffer_load_dwordx4 v21, s[32:35], s80 offen offset:1024 lds
    v_exp_f32 v237, v129
    v_mfma_f32_16x16x32_bf16 v[156:159], a[188:191], v[84:87], v[156:159]
    s_add_u32 s80, s80, 8192
    v_exp_f32 v238, v130
    v_cvt_pk_bf16_f32 v180, v236, v237
    v_mfma_f32_16x16x32_bf16 v[164:167], a[176:179], v[88:91], v[212:215]
    ds_read_b128 a[156:159], v11 offset:20480
    v_exp_f32 v239, v131
    s_nop 0
    v_cvt_pk_bf16_f32 v181, v238, v239
    v_mfma_f32_16x16x32_bf16 v[164:167], a[180:183], v[92:95], v[164:167]
    s_waitcnt lgkmcnt(4)
    v_exp_f32 v240, v132
    v_exp_f32 v241, v133
    v_mfma_f32_16x16x32_bf16 v[164:167], a[184:187], v[96:99], v[164:167]
    v_exp_f32 v242, v134
    v_cvt_pk_bf16_f32 v182, v240, v241
    v_mfma_f32_16x16x32_bf16 v[164:167], a[188:191], v[100:103], v[164:167]
    v_exp_f32 v243, v135
    s_nop 0
    v_cvt_pk_bf16_f32 v183, v242, v243
    s_mov_b32 s84, 0
    v_mfma_f32_16x16x32_bf16 v[104:107], a[128:131], v[40:43], v[200:203]
    ds_read_b128 a[160:163], v8 offset:24576
    v_exp_f32 v236, v136
    s_nop 0
    v_add_f32 v224, v224, v236
    v_mfma_f32_16x16x32_bf16 v[104:107], a[132:135], v[44:47], v[104:107]
    v_exp_f32 v237, v137
    v_exp_f32 v238, v138
    v_mfma_f32_16x16x32_bf16 v[104:107], a[136:139], v[48:51], v[104:107]
    v_add_f32 v225, v225, v237
    v_cvt_pk_bf16_f32 v184, v236, v237
    v_exp_f32 v239, v139
    v_mfma_f32_16x16x32_bf16 v[104:107], a[140:143], v[52:55], v[104:107]
    v_add_f32 v224, v224, v238
    v_exp_f32 v240, v140
    v_mfma_f32_16x16x32_bf16 v[112:115], a[128:131], v[56:59], v[204:207]
    ds_read_b128 a[164:167], v9 offset:24576
    v_add_f32 v225, v225, v239
    v_cvt_pk_bf16_f32 v185, v238, v239
    v_add_f32 v224, v224, v240
    v_mfma_f32_16x16x32_bf16 v[112:115], a[132:135], v[60:63], v[112:115]
    s_add_u32 m0, s82, 98304
    v_exp_f32 v241, v141
    s_nop 0
    v_add_f32 v225, v225, v241
    v_mfma_f32_16x16x32_bf16 v[112:115], a[136:139], v[64:67], v[112:115]
    buffer_load_dwordx4 v22, s[36:39], s81 offen lds
    v_exp_f32 v242, v142
    v_mfma_f32_16x16x32_bf16 v[112:115], a[140:143], v[68:71], v[112:115]
    v_cvt_pk_bf16_f32 v186, v240, v241
    v_exp_f32 v243, v143
    v_mfma_f32_16x16x32_bf16 v[120:123], a[128:131], v[72:75], v[208:211]
    ds_read_b128 a[168:171], v10 offset:24576
    v_add_f32 v224, v224, v242
    v_exp_f32 v252, v144
    v_mfma_f32_16x16x32_bf16 v[120:123], a[132:135], v[76:79], v[120:123]
    v_add_f32 v225, v225, v243
    v_cvt_pk_bf16_f32 v187, v242, v243
    v_mfma_f32_16x16x32_bf16 v[120:123], a[136:139], v[80:83], v[120:123]
    buffer_load_dwordx4 v23, s[36:39], s81 offen offset:1024 lds
    v_exp_f32 v253, v145
    v_mfma_f32_16x16x32_bf16 v[120:123], a[140:143], v[84:87], v[120:123]
    s_add_u32 s81, s81, 8192
    v_exp_f32 v254, v146
    v_cvt_pk_bf16_f32 v188, v252, v253
    v_mfma_f32_16x16x32_bf16 v[128:131], a[128:131], v[88:91], v[212:215]
    ds_read_b128 a[172:175], v11 offset:24576
    v_exp_f32 v255, v147
    s_nop 0
    v_cvt_pk_bf16_f32 v189, v254, v255
    v_mfma_f32_16x16x32_bf16 v[128:131], a[132:135], v[92:95], v[128:131]
    v_exp_f32 v236, v148
    v_exp_f32 v237, v149
    v_mfma_f32_16x16x32_bf16 v[128:131], a[136:139], v[96:99], v[128:131]
    v_exp_f32 v238, v150
    v_cvt_pk_bf16_f32 v190, v236, v237
    v_mfma_f32_16x16x32_bf16 v[128:131], a[140:143], v[100:103], v[128:131]
    s_waitcnt lgkmcnt(4)
    v_exp_f32 v239, v151
    v_exp_f32 v240, v152
    v_mfma_f32_16x16x32_bf16 v[108:111], a[144:147], v[40:43], v[200:203]
    ds_read_b128 a[176:179], v8 offset:28672
    v_cvt_pk_bf16_f32 v191, v238, v239
    v_exp_f32 v241, v153
    v_mfma_f32_16x16x32_bf16 v[108:111], a[148:151], v[44:47], v[108:111]
    v_add_f32 v226, v226, v240
    v_exp_f32 v242, v154
    v_mfma_f32_16x16x32_bf16 v[108:111], a[152:155], v[48:51], v[108:111]
    v_add_f32 v227, v227, v241
    v_cvt_pk_bf16_f32 v192, v240, v241
    v_exp_f32 v243, v155
    v_mfma_f32_16x16x32_bf16 v[108:111], a[156:159], v[52:55], v[108:111]
    v_add_f32 v226, v226, v242
    v_exp_f32 v252, v156
    v_mfma_f32_16x16x32_bf16 v[116:119], a[144:147], v[56:59], v[204:207]
    ds_read_b128 a[180:183], v9 offset:28672
    v_add_f32 v227, v227, v243
    v_cvt_pk_bf16_f32 v193, v242, v243
    v_add_f32 v226, v226, v252
    v_mfma_f32_16x16x32_bf16 v[116:119], a[148:151], v[60:63], v[116:119]
    s_add_u32 m0, s82, 106496
    v_exp_f32 v253, v157
    s_nop 0
    v_add_f32 v227, v227, v253
    v_mfma_f32_16x16x32_bf16 v[116:119], a[152:155], v[64:67], v[116:119]
    buffer_load_dwordx4 v22, s[36:39], s81 offen lds
    v_exp_f32 v254, v158
    v_mfma_f32_16x16x32_bf16 v[116:119], a[156:159], v[68:71], v[116:119]
    v_cvt_pk_bf16_f32 v194, v252, v253
    v_exp_f32 v255, v159
    v_mfma_f32_16x16x32_bf16 v[124:127], a[144:147], v[72:75], v[208:211]
    ds_read_b128 a[184:187], v10 offset:28672
    v_add_f32 v226, v226, v254
    v_exp_f32 v236, v160
    v_mfma_f32_16x16x32_bf16 v[124:127], a[148:151], v[76:79], v[124:127]
    v_add_f32 v227, v227, v255
    v_cvt_pk_bf16_f32 v195, v254, v255
    v_mfma_f32_16x16x32_bf16 v[124:127], a[152:155], v[80:83], v[124:127]
    buffer_load_dwordx4 v23, s[36:39], s81 offen offset:1024 lds
    v_exp_f32 v237, v161
    v_mfma_f32_16x16x32_bf16 v[124:127], a[156:159], v[84:87], v[124:127]
    s_add_u32 s81, s81, 8192
    v_exp_f32 v238, v162
    v_cvt_pk_bf16_f32 v196, v236, v237
    v_mfma_f32_16x16x32_bf16 v[132:135], a[144:147], v[88:91], v[212:215]
    ds_read_b128 a[188:191], v11 offset:28672
    v_exp_f32 v239, v163
    s_nop 0
    v_cvt_pk_bf16_f32 v197, v238, v239
    v_mfma_f32_16x16x32_bf16 v[132:135], a[148:151], v[92:95], v[132:135]
    s_waitcnt lgkmcnt(4)
    v_exp_f32 v240, v164
    v_exp_f32 v241, v165
    v_mfma_f32_16x16x32_bf16 v[132:135], a[152:155], v[96:99], v[132:135]
    s_waitcnt vmcnt(12)
    v_exp_f32 v242, v166
    v_cvt_pk_bf16_f32 v198, v240, v241
    v_mfma_f32_16x16x32_bf16 v[132:135], a[156:159], v[100:103], v[132:135]
    s_barrier
    v_exp_f32 v243, v167
    s_nop 0
    v_cvt_pk_bf16_f32 v199, v242, v243
    v_mfma_f32_16x16x32_bf16 v[136:139], a[160:163], v[40:43], v[200:203]
    ds_read_b64_tr_b16 a[128:129], v12 offset:0
    ds_read_b64_tr_b16 a[130:131], v12 offset:4096
    v_mfma_f32_16x16x32_bf16 v[136:139], a[164:167], v[44:47], v[136:139]
    v_exp_f32 v236, v104
    v_mfma_f32_16x16x32_bf16 v[136:139], a[168:171], v[48:51], v[136:139]
    v_exp_f32 v237, v105
    v_mfma_f32_16x16x32_bf16 v[136:139], a[172:175], v[52:55], v[136:139]
    v_add_f32 v224, v224, v236
    v_add_f32 v225, v225, v237
    v_mfma_f32_16x16x32_bf16 v[144:147], a[160:163], v[56:59], v[204:207]
    ds_read_b64_tr_b16 a[132:133], v12 offset:8192
    ds_read_b64_tr_b16 a[134:135], v12 offset:12288
    v_mfma_f32_16x16x32_bf16 v[144:147], a[164:167], v[60:63], v[144:147]
    s_add_u32 m0, s82, 8192
    v_exp_f32 v238, v106
    v_mfma_f32_16x16x32_bf16 v[144:147], a[168:171], v[64:67], v[144:147]
    buffer_load_dwordx4 v20, s[32:35], s80 offen lds
    v_mfma_f32_16x16x32_bf16 v[144:147], a[172:175], v[68:71], v[144:147]
    v_cvt_pk_bf16_f32 v24, v236, v237
    v_add_f32 v224, v224, v238
    v_mfma_f32_16x16x32_bf16 v[152:155], a[160:163], v[72:75], v[208:211]
    ds_read_b64_tr_b16 a[136:137], v13 offset:0
    ds_read_b64_tr_b16 a[138:139], v13 offset:4096
    v_mfma_f32_16x16x32_bf16 v[152:155], a[164:167], v[76:79], v[152:155]
    v_exp_f32 v239, v107
    v_mfma_f32_16x16x32_bf16 v[152:155], a[168:171], v[80:83], v[152:155]
    v_exp_f32 v240, v108
    v_mfma_f32_16x16x32_bf16 v[152:155], a[172:175], v[84:87], v[152:155]
    v_add_f32 v225, v225, v239
    v_cvt_pk_bf16_f32 v25, v238, v239
    v_mfma_f32_16x16x32_bf16 v[160:163], a[160:163], v[88:91], v[212:215]
    ds_read_b64_tr_b16 a[140:141], v13 offset:8192
    ds_read_b64_tr_b16 a[142:143], v13 offset:12288
    v_mfma_f32_16x16x32_bf16 v[160:163], a[164:167], v[92:95], v[160:163]
    v_exp_f32 v241, v109
    v_mfma_f32_16x16x32_bf16 v[160:163], a[168:171], v[96:99], v[160:163]
    v_add_f32 v224, v224, v240
    v_add_f32 v225, v225, v241
    v_mfma_f32_16x16x32_bf16 v[160:163], a[172:175], v[100:103], v[160:163]
    s_waitcnt lgkmcnt(8)
    v_exp_f32 v242, v110
    v_mfma_f32_16x16x32_bf16 v[140:143], a[176:179], v[40:43], v[200:203]
    ds_read_b64_tr_b16 a[144:145], v14 offset:0
    ds_read_b64_tr_b16 a[146:147], v14 offset:4096
    v_mfma_f32_16x16x32_bf16 v[140:143], a[180:183], v[44:47], v[140:143]
    v_cvt_pk_bf16_f32 v26, v240, v241
    v_add_f32 v224, v224, v242
    v_mfma_f32_16x16x32_bf16 v[140:143], a[184:187], v[48:51], v[140:143]
    v_exp_f32 v243, v111
    v_mfma_f32_16x16x32_bf16 v[140:143], a[188:191], v[52:55], v[140:143]
    v_exp_f32 v252, v112
    v_mfma_f32_16x16x32_bf16 v[148:151], a[176:179], v[56:59], v[204:207]
    ds_read_b64_tr_b16 a[148:149], v14 offset:8192
    ds_read_b64_tr_b16 a[150:151], v14 offset:12288
    v_mfma_f32_16x16x32_bf16 v[148:151], a[180:183], v[60:63], v[148:151]
    v_add_f32 v225, v225, v243
    v_cvt_pk_bf16_f32 v27, v242, v243
    v_mfma_f32_16x16x32_bf16 v[148:151], a[184:187], v[64:67], v[148:151]
    buffer_load_dwordx4 v21, s[32:35], s80 offen offset:1024 lds
    v_mfma_f32_16x16x32_bf16 v[148:151], a[188:191], v[68:71], v[148:151]
    s_add_u32 s80, s80, 8192
    v_exp_f32 v253, v113
    v_mfma_f32_16x16x32_bf16 v[156:159], a[176:179], v[72:75], v[208:211]
    ds_read_b64_tr_b16 a[152:153], v15 offset:0
    ds_read_b64_tr_b16 a[154:155], v15 offset:4096
    v_mfma_f32_16x16x32_bf16 v[156:159], a[180:183], v[76:79], v[156:159]
    v_exp_f32 v254, v114
    v_mfma_f32_16x16x32_bf16 v[156:159], a[184:187], v[80:83], v[156:159]
    v_cvt_pk_bf16_f32 v28, v252, v253
    v_mfma_f32_16x16x32_bf16 v[156:159], a[188:191], v[84:87], v[156:159]
    v_exp_f32 v255, v115
    v_mfma_f32_16x16x32_bf16 v[164:167], a[176:179], v[88:91], v[212:215]
    ds_read_b64_tr_b16 a[156:157], v15 offset:8192
    ds_read_b64_tr_b16 a[158:159], v15 offset:12288
    v_mfma_f32_16x16x32_bf16 v[164:167], a[180:183], v[92:95], v[164:167]
    v_exp_f32 v236, v116
    v_mfma_f32_16x16x32_bf16 v[164:167], a[184:187], v[96:99], v[164:167]
    v_cvt_pk_bf16_f32 v29, v254, v255
    v_mfma_f32_16x16x32_bf16 v[164:167], a[188:191], v[100:103], v[164:167]
    s_waitcnt lgkmcnt(8)
    v_exp_f32 v237, v117
    v_mfma_f32_16x16x32_bf16 a[0:3], a[128:131], v[168:171], 0
    ds_read_b128 a[160:163], v8 offset:32768
    v_cvt_pk_bf16_f32 v30, v236, v237
    v_mfma_f32_16x16x32_bf16 a[0:3], a[132:135], v[184:187], a[0:3]
    v_exp_f32 v238, v118
    v_mfma_f32_16x16x32_bf16 a[4:7], a[128:131], v[172:175], 0
    v_exp_f32 v239, v119
    v_mfma_f32_16x16x32_bf16 a[4:7], a[132:135], v[188:191], a[4:7]
    v_exp_f32 v240, v120
    v_mfma_f32_16x16x32_bf16 a[8:11], a[128:131], v[176:179], 0
    ds_read_b128 a[164:167], v9 offset:32768
    v_cvt_pk_bf16_f32 v31, v238, v239
    v_mfma_f32_16x16x32_bf16 a[8:11], a[132:135], v[192:195], a[8:11]
    s_add_u32 m0, s82, 16384
    v_exp_f32 v241, v121
    v_mfma_f32_16x16x32_bf16 a[12:15], a[128:131], v[180:183], 0
    buffer_load_dwordx4 v20, s[32:35], s80 offen lds
    v_mfma_f32_16x16x32_bf16 a[12:15], a[132:135], v[196:199], a[12:15]
    v_add_f32 v226, v226, v240
    v_add_f32 v227, v227, v241
    v_mfma_f32_16x16x32_bf16 a[16:19], a[136:139], v[168:171], 0
    ds_read_b128 a[168:171], v10 offset:32768
    v_cvt_pk_bf16_f32 v36, v240, v241
    v_mfma_f32_16x16x32_bf16 a[16:19], a[140:143], v[184:187], a[16:19]
    v_exp_f32 v242, v122
    v_mfma_f32_16x16x32_bf16 a[20:23], a[136:139], v[172:175], 0
    v_exp_f32 v243, v123
    v_mfma_f32_16x16x32_bf16 a[20:23], a[140:143], v[188:191], a[20:23]
    v_add_f32 v226, v226, v242
    v_add_f32 v227, v227, v243
    v_mfma_f32_16x16x32_bf16 a[24:27], a[136:139], v[176:179], 0
    ds_read_b128 a[172:175], v11 offset:32768
    v_cvt_pk_bf16_f32 v37, v242, v243
    v_mfma_f32_16x16x32_bf16 a[24:27], a[140:143], v[192:195], a[24:27]
    buffer_load_dword a251, v246, s[44:47], 0 offen
    v_mfma_f32_16x16x32_bf16 a[28:31], a[136:139], v[180:183], 0
    v_exp_f32 v252, v124
    v_mfma_f32_16x16x32_bf16 a[28:31], a[140:143], v[196:199], a[28:31]
    s_waitcnt lgkmcnt(4)
    v_exp_f32 v253, v125
    v_mfma_f32_16x16x32_bf16 a[32:35], a[144:147], v[168:171], 0
    ds_read_b128 a[176:179], v8 offset:36864
    v_add_f32 v226, v226, v252
    v_mfma_f32_16x16x32_bf16 a[32:35], a[148:151], v[184:187], a[32:35]
    v_exp_f32 v254, v126
    v_mfma_f32_16x16x32_bf16 a[36:39], a[144:147], v[172:175], 0
    v_add_f32 v227, v227, v253
    v_cvt_pk_bf16_f32 v38, v252, v253
    v_mfma_f32_16x16x32_bf16 a[36:39], a[148:151], v[188:191], a[36:39]
    v_exp_f32 v255, v127
    v_mfma_f32_16x16x32_bf16 a[40:43], a[144:147], v[176:179], 0
    ds_read_b128 a[180:183], v9 offset:36864
    v_add_f32 v226, v226, v254
    v_mfma_f32_16x16x32_bf16 a[40:43], a[148:151], v[192:195], a[40:43]
    v_exp_f32 v236, v128
    v_mfma_f32_16x16x32_bf16 a[44:47], a[144:147], v[180:183], 0
    buffer_load_dwordx4 v21, s[32:35], s80 offen offset:1024 lds
    v_mfma_f32_16x16x32_bf16 a[44:47], a[148:151], v[196:199], a[44:47]
    s_add_u32 s80, s80, 8192
    v_add_f32 v227, v227, v255
    v_cvt_pk_bf16_f32 v39, v254, v255
    v_mfma_f32_16x16x32_bf16 a[48:51], a[152:155], v[168:171], 0
    ds_read_b128 a[184:187], v10 offset:36864
    v_mfma_f32_16x16x32_bf16 a[48:51], a[156:159], v[184:187], a[48:51]
    v_exp_f32 v237, v129
    v_mfma_f32_16x16x32_bf16 a[52:55], a[152:155], v[172:175], 0
    v_exp_f32 v238, v130
    v_mfma_f32_16x16x32_bf16 a[52:55], a[156:159], v[188:191], a[52:55]
    v_cvt_pk_bf16_f32 v4, v236, v237
    v_mfma_f32_16x16x32_bf16 a[56:59], a[152:155], v[176:179], 0
    ds_read_b128 a[188:191], v11 offset:36864
    v_mfma_f32_16x16x32_bf16 a[56:59], a[156:159], v[192:195], a[56:59]
    buffer_load_dword a251, v33, s[64:67], 0 offen
    v_mfma_f32_16x16x32_bf16 a[60:63], a[152:155], v[180:183], 0
    v_exp_f32 v239, v131
    v_mfma_f32_16x16x32_bf16 a[60:63], a[156:159], v[196:199], a[60:63]
    s_waitcnt lgkmcnt(4)
    v_exp_f32 v240, v132
    v_mfma_f32_16x16x32_bf16 v[216:219], a[252:255], v[172:175], 0
    v_cvt_pk_bf16_f32 v5, v238, v239
    v_mfma_f32_16x16x32_bf16 v[216:219], a[252:255], v[188:191], v[216:219]
    v_exp_f32 v241, v133
    v_exp_f32 v242, v134
    v_cvt_pk_bf16_f32 v6, v240, v241
    v_exp_f32 v243, v135
    s_nop 0
    v_cvt_pk_bf16_f32 v7, v242, v243
    v_mfma_f32_16x16x32_bf16 v[104:107], a[160:163], v[40:43], v[200:203]
    ds_read_b64_tr_b16 a[128:129], v16 offset:0
    ds_read_b64_tr_b16 a[130:131], v16 offset:4096
    v_mfma_f32_16x16x32_bf16 v[104:107], a[164:167], v[44:47], v[104:107]
    v_exp_f32 v236, v136
    v_mfma_f32_16x16x32_bf16 v[104:107], a[168:171], v[48:51], v[104:107]
    v_exp_f32 v237, v137
    v_mfma_f32_16x16x32_bf16 v[104:107], a[172:175], v[52:55], v[104:107]
    v_add_f32 v224, v224, v236
    v_add_f32 v225, v225, v237
    v_mfma_f32_16x16x32_bf16 v[112:115], a[160:163], v[56:59], v[204:207]
    ds_read_b64_tr_b16 a[132:133], v16 offset:8192
    ds_read_b64_tr_b16 a[134:135], v16 offset:12288
    v_mfma_f32_16x16x32_bf16 v[112:115], a[164:167], v[60:63], v[112:115]
    s_add_u32 m0, s82, 114688
    v_exp_f32 v238, v138
    v_mfma_f32_16x16x32_bf16 v[112:115], a[168:171], v[64:67], v[112:115]
    buffer_load_dwordx4 v22, s[36:39], s81 offen lds
    v_mfma_f32_16x16x32_bf16 v[112:115], a[172:175], v[68:71], v[112:115]
    v_cvt_pk_bf16_f32 v244, v236, v237
    v_add_f32 v224, v224, v238
    v_mfma_f32_16x16x32_bf16 v[120:123], a[160:163], v[72:75], v[208:211]
    ds_read_b64_tr_b16 a[136:137], v17 offset:0
    ds_read_b64_tr_b16 a[138:139], v17 offset:4096
    v_mfma_f32_16x16x32_bf16 v[120:123], a[164:167], v[76:79], v[120:123]
    v_exp_f32 v239, v139
    v_mfma_f32_16x16x32_bf16 v[120:123], a[168:171], v[80:83], v[120:123]
    v_exp_f32 v240, v140
    v_mfma_f32_16x16x32_bf16 v[120:123], a[172:175], v[84:87], v[120:123]
    v_add_f32 v225, v225, v239
    v_cvt_pk_bf16_f32 v245, v238, v239
    v_mfma_f32_16x16x32_bf16 v[128:131], a[160:163], v[88:91], v[212:215]
    ds_read_b64_tr_b16 a[140:141], v17 offset:8192
    ds_read_b64_tr_b16 a[142:143], v17 offset:12288
    v_mfma_f32_16x16x32_bf16 v[128:131], a[164:167], v[92:95], v[128:131]
    v_exp_f32 v241, v141
    v_mfma_f32_16x16x32_bf16 v[128:131], a[168:171], v[96:99], v[128:131]
    v_add_f32 v224, v224, v240
    v_add_f32 v225, v225, v241
    v_mfma_f32_16x16x32_bf16 v[128:131], a[172:175], v[100:103], v[128:131]
    s_waitcnt lgkmcnt(8)
    v_exp_f32 v242, v142
    v_mfma_f32_16x16x32_bf16 v[108:111], a[176:179], v[40:43], v[200:203]
    ds_read_b64_tr_b16 a[144:145], v18 offset:0
    ds_read_b64_tr_b16 a[146:147], v18 offset:4096
    v_mfma_f32_16x16x32_bf16 v[108:111], a[180:183], v[44:47], v[108:111]
    v_cvt_pk_bf16_f32 v246, v240, v241
    v_add_f32 v224, v224, v242
    v_mfma_f32_16x16x32_bf16 v[108:111], a[184:187], v[48:51], v[108:111]
    v_exp_f32 v243, v143
    v_mfma_f32_16x16x32_bf16 v[108:111], a[188:191], v[52:55], v[108:111]
    v_exp_f32 v252, v144
    v_mfma_f32_16x16x32_bf16 v[116:119], a[176:179], v[56:59], v[204:207]
    ds_read_b64_tr_b16 a[148:149], v18 offset:8192
    ds_read_b64_tr_b16 a[150:151], v18 offset:12288
    v_mfma_f32_16x16x32_bf16 v[116:119], a[180:183], v[60:63], v[116:119]
    v_add_f32 v225, v225, v243
    v_cvt_pk_bf16_f32 v247, v242, v243
    v_mfma_f32_16x16x32_bf16 v[116:119], a[184:187], v[64:67], v[116:119]
    buffer_load_dwordx4 v23, s[36:39], s81 offen offset:1024 lds
    v_mfma_f32_16x16x32_bf16 v[116:119], a[188:191], v[68:71], v[116:119]
    s_add_u32 s81, s81, 8192
    v_exp_f32 v253, v145
    v_mfma_f32_16x16x32_bf16 v[124:127], a[176:179], v[72:75], v[208:211]
    ds_read_b64_tr_b16 a[152:153], v19 offset:0
    ds_read_b64_tr_b16 a[154:155], v19 offset:4096
    v_mfma_f32_16x16x32_bf16 v[124:127], a[180:183], v[76:79], v[124:127]
    v_exp_f32 v254, v146
    v_mfma_f32_16x16x32_bf16 v[124:127], a[184:187], v[80:83], v[124:127]
    v_cvt_pk_bf16_f32 v248, v252, v253
    v_mfma_f32_16x16x32_bf16 v[124:127], a[188:191], v[84:87], v[124:127]
    v_exp_f32 v255, v147
    v_mfma_f32_16x16x32_bf16 v[132:135], a[176:179], v[88:91], v[212:215]
    ds_read_b64_tr_b16 a[156:157], v19 offset:8192
    ds_read_b64_tr_b16 a[158:159], v19 offset:12288
    v_mfma_f32_16x16x32_bf16 v[132:135], a[180:183], v[92:95], v[132:135]
    v_exp_f32 v236, v148
    v_mfma_f32_16x16x32_bf16 v[132:135], a[184:187], v[96:99], v[132:135]
    v_cvt_pk_bf16_f32 v249, v254, v255
    v_mfma_f32_16x16x32_bf16 v[132:135], a[188:191], v[100:103], v[132:135]
    s_waitcnt lgkmcnt(8)
    v_exp_f32 v237, v149
    v_mfma_f32_16x16x32_bf16 a[64:67], a[128:131], v[168:171], 0
    ds_read_b128 a[160:163], v8 offset:40960
    v_cvt_pk_bf16_f32 v250, v236, v237
    v_mfma_f32_16x16x32_bf16 a[64:67], a[132:135], v[184:187], a[64:67]
    v_exp_f32 v238, v150
    v_mfma_f32_16x16x32_bf16 a[68:71], a[128:131], v[172:175], 0
    v_exp_f32 v239, v151
    v_mfma_f32_16x16x32_bf16 a[68:71], a[132:135], v[188:191], a[68:71]
    v_exp_f32 v240, v152
    v_mfma_f32_16x16x32_bf16 a[72:75], a[128:131], v[176:179], 0
    ds_read_b128 a[164:167], v9 offset:40960
    v_cvt_pk_bf16_f32 v251, v238, v239
    v_mfma_f32_16x16x32_bf16 a[72:75], a[132:135], v[192:195], a[72:75]
    s_add_u32 m0, s82, 122880
    v_exp_f32 v241, v153
    v_mfma_f32_16x16x32_bf16 a[76:79], a[128:131], v[180:183], 0
    buffer_load_dwordx4 v22, s[36:39], s81 offen lds
    v_mfma_f32_16x16x32_bf16 a[76:79], a[132:135], v[196:199], a[76:79]
    v_add_f32 v226, v226, v240
    v_add_f32 v227, v227, v241
    v_mfma_f32_16x16x32_bf16 a[80:83], a[136:139], v[168:171], 0
    ds_read_b128 a[168:171], v10 offset:40960
    v_cvt_pk_bf16_f32 v232, v240, v241
    v_mfma_f32_16x16x32_bf16 a[80:83], a[140:143], v[184:187], a[80:83]
    v_exp_f32 v242, v154
    v_mfma_f32_16x16x32_bf16 a[84:87], a[136:139], v[172:175], 0
    v_exp_f32 v243, v155
    v_mfma_f32_16x16x32_bf16 a[84:87], a[140:143], v[188:191], a[84:87]
    v_add_f32 v226, v226, v242
    v_add_f32 v227, v227, v243
    v_mfma_f32_16x16x32_bf16 a[88:91], a[136:139], v[176:179], 0
    ds_read_b128 a[172:175], v11 offset:40960
    v_cvt_pk_bf16_f32 v233, v242, v243
    v_mfma_f32_16x16x32_bf16 a[88:91], a[140:143], v[192:195], a[88:91]
    v_exp_f32 v252, v156
    v_mfma_f32_16x16x32_bf16 a[92:95], a[136:139], v[180:183], 0
    v_exp_f32 v253, v157
    v_mfma_f32_16x16x32_bf16 a[92:95], a[140:143], v[196:199], a[92:95]
    s_waitcnt lgkmcnt(4)
    v_add_f32 v226, v226, v252
    v_add_f32 v227, v227, v253
    v_mfma_f32_16x16x32_bf16 a[96:99], a[144:147], v[168:171], 0
    ds_read_b128 a[176:179], v8 offset:45056
    v_cvt_pk_bf16_f32 v234, v252, v253
    v_mfma_f32_16x16x32_bf16 a[96:99], a[148:151], v[184:187], a[96:99]
    v_exp_f32 v254, v158
    v_mfma_f32_16x16x32_bf16 a[100:103], a[144:147], v[172:175], 0
    v_exp_f32 v255, v159
    v_mfma_f32_16x16x32_bf16 a[100:103], a[148:151], v[188:191], a[100:103]
    v_add_f32 v226, v226, v254
    v_add_f32 v227, v227, v255
    v_mfma_f32_16x16x32_bf16 a[104:107], a[144:147], v[176:179], 0
    ds_read_b128 a[180:183], v9 offset:45056
    v_cvt_pk_bf16_f32 v235, v254, v255
    v_mfma_f32_16x16x32_bf16 a[104:107], a[148:151], v[192:195], a[104:107]
    v_exp_f32 v236, v160
    v_mfma_f32_16x16x32_bf16 a[108:111], a[144:147], v[180:183], 0
    buffer_load_dwordx4 v23, s[36:39], s81 offen offset:1024 lds
    v_mfma_f32_16x16x32_bf16 a[108:111], a[148:151], v[196:199], a[108:111]
    s_add_u32 s81, s81, 8192
    v_exp_f32 v237, v161
    v_mfma_f32_16x16x32_bf16 a[112:115], a[152:155], v[168:171], 0
    ds_read_b128 a[184:187], v10 offset:45056
    v_cvt_pk_bf16_f32 v228, v236, v237
    v_mfma_f32_16x16x32_bf16 a[112:115], a[156:159], v[184:187], a[112:115]
    v_exp_f32 v238, v162
    v_mfma_f32_16x16x32_bf16 a[116:119], a[152:155], v[172:175], 0
    v_exp_f32 v239, v163
    v_mfma_f32_16x16x32_bf16 a[116:119], a[156:159], v[188:191], a[116:119]
    v_exp_f32 v240, v164
    v_mfma_f32_16x16x32_bf16 a[120:123], a[152:155], v[176:179], 0
    ds_read_b128 a[188:191], v11 offset:45056
    v_cvt_pk_bf16_f32 v229, v238, v239
    v_mfma_f32_16x16x32_bf16 a[120:123], a[156:159], v[192:195], a[120:123]
    v_exp_f32 v241, v165
    v_mfma_f32_16x16x32_bf16 a[124:127], a[152:155], v[180:183], 0
    v_exp_f32 v242, v166
    v_mfma_f32_16x16x32_bf16 a[124:127], a[156:159], v[196:199], a[124:127]
    s_waitcnt lgkmcnt(4)
    v_cvt_pk_bf16_f32 v230, v240, v241
    v_mfma_f32_16x16x32_bf16 v[220:223], a[252:255], v[180:183], 0
    s_waitcnt vmcnt(12)
    v_exp_f32 v243, v167
    v_mfma_f32_16x16x32_bf16 v[220:223], a[252:255], v[196:199], v[220:223]
    s_barrier
    v_cvt_pk_bf16_f32 v231, v242, v243
.p2align 6
F_LOOP:
    v_mfma_f32_16x16x32_bf16 v[136:139], a[160:163], v[40:43], v[200:203]
    ds_read_b64_tr_b16 a[128:129], v12 offset:16384
    ds_read_b64_tr_b16 a[130:131], v12 offset:20480
    v_mfma_f32_16x16x32_bf16 v[136:139], a[164:167], v[44:47], v[136:139]
    v_exp_f32 v236, v104
    v_mfma_f32_16x16x32_bf16 v[136:139], a[168:171], v[48:51], v[136:139]
    v_exp_f32 v237, v105
    v_mfma_f32_16x16x32_bf16 v[136:139], a[172:175], v[52:55], v[136:139]
    v_add_f32 v224, v224, v236
    v_add_f32 v225, v225, v237
    v_mfma_f32_16x16x32_bf16 v[144:147], a[160:163], v[56:59], v[204:207]
    ds_read_b64_tr_b16 a[132:133], v12 offset:24576
    ds_read_b64_tr_b16 a[134:135], v12 offset:28672
    v_mfma_f32_16x16x32_bf16 v[144:147], a[164:167], v[60:63], v[144:147]
    s_add_u32 m0, s82, 24576
    v_exp_f32 v238, v106
    v_mfma_f32_16x16x32_bf16 v[144:147], a[168:171], v[64:67], v[144:147]
    buffer_load_dwordx4 v20, s[32:35], s80 offen lds
    v_mfma_f32_16x16x32_bf16 v[144:147], a[172:175], v[68:71], v[144:147]
    v_cvt_pk_bf16_f32 v168, v236, v237
    v_add_f32 v224, v224, v238
    v_mfma_f32_16x16x32_bf16 v[152:155], a[160:163], v[72:75], v[208:211]
    ds_read_b64_tr_b16 a[136:137], v13 offset:16384
    ds_read_b64_tr_b16 a[138:139], v13 offset:20480
    v_mfma_f32_16x16x32_bf16 v[152:155], a[164:167], v[76:79], v[152:155]
    v_exp_f32 v239, v107
    v_mfma_f32_16x16x32_bf16 v[152:155], a[168:171], v[80:83], v[152:155]
    v_exp_f32 v240, v108
    v_mfma_f32_16x16x32_bf16 v[152:155], a[172:175], v[84:87], v[152:155]
    v_add_f32 v225, v225, v239
    v_cvt_pk_bf16_f32 v169, v238, v239
    v_mfma_f32_16x16x32_bf16 v[160:163], a[160:163], v[88:91], v[212:215]
    ds_read_b64_tr_b16 a[140:141], v13 offset:24576
    ds_read_b64_tr_b16 a[142:143], v13 offset:28672
    v_mfma_f32_16x16x32_bf16 v[160:163], a[164:167], v[92:95], v[160:163]
    v_exp_f32 v241, v109
    v_mfma_f32_16x16x32_bf16 v[160:163], a[168:171], v[96:99], v[160:163]
    v_add_f32 v224, v224, v240
    v_add_f32 v225, v225, v241
    v_mfma_f32_16x16x32_bf16 v[160:163], a[172:175], v[100:103], v[160:163]
    s_waitcnt lgkmcnt(8)
    v_exp_f32 v242, v110
    v_mfma_f32_16x16x32_bf16 v[140:143], a[176:179], v[40:43], v[200:203]
    ds_read_b64_tr_b16 a[144:145], v14 offset:16384
    ds_read_b64_tr_b16 a[146:147], v14 offset:20480
    v_mfma_f32_16x16x32_bf16 v[140:143], a[180:183], v[44:47], v[140:143]
    v_cvt_pk_bf16_f32 v170, v240, v241
    v_add_f32 v224, v224, v242
    v_mfma_f32_16x16x32_bf16 v[140:143], a[184:187], v[48:51], v[140:143]
    v_exp_f32 v243, v111
    v_mfma_f32_16x16x32_bf16 v[140:143], a[188:191], v[52:55], v[140:143]
    v_exp_f32 v252, v112
    v_mfma_f32_16x16x32_bf16 v[148:151], a[176:179], v[56:59], v[204:207]
    ds_read_b64_tr_b16 a[148:149], v14 offset:24576
    ds_read_b64_tr_b16 a[150:151], v14 offset:28672
    v_mfma_f32_16x16x32_bf16 v[148:151], a[180:183], v[60:63], v[148:151]
    v_add_f32 v225, v225, v243
    v_cvt_pk_bf16_f32 v171, v242, v243
    v_mfma_f32_16x16x32_bf16 v[148:151], a[184:187], v[64:67], v[148:151]
    buffer_load_dwordx4 v21, s[32:35], s80 offen offset:1024 lds
    v_mfma_f32_16x16x32_bf16 v[148:151], a[188:191], v[68:71], v[148:151]
    s_add_u32 s80, s80, 8192
    v_exp_f32 v253, v113
    v_mfma_f32_16x16x32_bf16 v[156:159], a[176:179], v[72:75], v[208:211]
    ds_read_b64_tr_b16 a[152:153], v15 offset:16384
    ds_read_b64_tr_b16 a[154:155], v15 offset:20480
    v_mfma_f32_16x16x32_bf16 v[156:159], a[180:183], v[76:79], v[156:159]
    v_exp_f32 v254, v114
    v_mfma_f32_16x16x32_bf16 v[156:159], a[184:187], v[80:83], v[156:159]
    v_cvt_pk_bf16_f32 v172, v252, v253
    v_mfma_f32_16x16x32_bf16 v[156:159], a[188:191], v[84:87], v[156:159]
    v_exp_f32 v255, v115
    v_mfma_f32_16x16x32_bf16 v[164:167], a[176:179], v[88:91], v[212:215]
    ds_read_b64_tr_b16 a[156:157], v15 offset:24576
    ds_read_b64_tr_b16 a[158:159], v15 offset:28672
    v_mfma_f32_16x16x32_bf16 v[164:167], a[180:183], v[92:95], v[164:167]
    v_exp_f32 v236, v116
    v_mfma_f32_16x16x32_bf16 v[164:167], a[184:187], v[96:99], v[164:167]
    v_cvt_pk_bf16_f32 v173, v254, v255
    v_mfma_f32_16x16x32_bf16 v[164:167], a[188:191], v[100:103], v[164:167]
    s_waitcnt lgkmcnt(8)
    v_exp_f32 v237, v117
    v_mfma_f32_16x16x32_bf16 a[0:3], a[128:131], v[24:27], a[0:3]
    ds_read_b128 a[160:163], v8 offset:49152
    v_cvt_pk_bf16_f32 v174, v236, v237
    v_mfma_f32_16x16x32_bf16 a[0:3], a[132:135], v[244:247], a[0:3]
    v_exp_f32 v238, v118
    v_mfma_f32_16x16x32_bf16 a[4:7], a[128:131], v[28:31], a[4:7]
    v_exp_f32 v239, v119
    v_mfma_f32_16x16x32_bf16 a[4:7], a[132:135], v[248:251], a[4:7]
    v_exp_f32 v240, v120
    v_mfma_f32_16x16x32_bf16 a[8:11], a[128:131], v[36:39], a[8:11]
    ds_read_b128 a[164:167], v9 offset:49152
    v_cvt_pk_bf16_f32 v175, v238, v239
    v_mfma_f32_16x16x32_bf16 a[8:11], a[132:135], v[232:235], a[8:11]
    s_add_u32 m0, s82, 32768
    v_exp_f32 v241, v121
    v_mfma_f32_16x16x32_bf16 a[12:15], a[128:131], v[4:7], a[12:15]
    buffer_load_dwordx4 v20, s[32:35], s80 offen lds
    v_mfma_f32_16x16x32_bf16 a[12:15], a[132:135], v[228:231], a[12:15]
    v_add_f32 v226, v226, v240
    v_add_f32 v227, v227, v241
    v_mfma_f32_16x16x32_bf16 a[16:19], a[136:139], v[24:27], a[16:19]
    ds_read_b128 a[168:171], v10 offset:49152
    v_cvt_pk_bf16_f32 v176, v240, v241
    v_mfma_f32_16x16x32_bf16 a[16:19], a[140:143], v[244:247], a[16:19]
    v_exp_f32 v242, v122
    v_mfma_f32_16x16x32_bf16 a[20:23], a[136:139], v[28:31], a[20:23]
    v_exp_f32 v243, v123
    v_mfma_f32_16x16x32_bf16 a[20:23], a[140:143], v[248:251], a[20:23]
    v_add_f32 v226, v226, v242
    v_add_f32 v227, v227, v243
    v_mfma_f32_16x16x32_bf16 a[24:27], a[136:139], v[36:39], a[24:27]
    ds_read_b128 a[172:175], v11 offset:49152
    v_cvt_pk_bf16_f32 v177, v242, v243
    v_mfma_f32_16x16x32_bf16 a[24:27], a[140:143], v[232:235], a[24:27]
    buffer_load_dwordx4 a[224:227], v33, s[40:43], s3 offen
    v_mfma_f32_16x16x32_bf16 a[28:31], a[136:139], v[4:7], a[28:31]
    v_exp_f32 v252, v124
    v_mfma_f32_16x16x32_bf16 a[28:31], a[140:143], v[228:231], a[28:31]
    s_waitcnt lgkmcnt(4)
    v_exp_f32 v253, v125
    v_mfma_f32_16x16x32_bf16 a[32:35], a[144:147], v[24:27], a[32:35]
    ds_read_b128 a[176:179], v8 offset:53248
    v_add_f32 v226, v226, v252
    v_mfma_f32_16x16x32_bf16 a[32:35], a[148:151], v[244:247], a[32:35]
    v_exp_f32 v254, v126
    v_mfma_f32_16x16x32_bf16 a[36:39], a[144:147], v[28:31], a[36:39]
    v_add_f32 v227, v227, v253
    v_cvt_pk_bf16_f32 v178, v252, v253
    v_mfma_f32_16x16x32_bf16 a[36:39], a[148:151], v[248:251], a[36:39]
    v_exp_f32 v255, v127
    v_mfma_f32_16x16x32_bf16 a[40:43], a[144:147], v[36:39], a[40:43]
    ds_read_b128 a[180:183], v9 offset:53248
    v_add_f32 v226, v226, v254
    v_mfma_f32_16x16x32_bf16 a[40:43], a[148:151], v[232:235], a[40:43]
    v_exp_f32 v236, v128
    v_mfma_f32_16x16x32_bf16 a[44:47], a[144:147], v[4:7], a[44:47]
    buffer_load_dwordx4 v21, s[32:35], s80 offen offset:1024 lds
    v_mfma_f32_16x16x32_bf16 a[44:47], a[148:151], v[228:231], a[44:47]
    s_add_u32 s80, s80, 8192
    v_add_f32 v227, v227, v255
    v_cvt_pk_bf16_f32 v179, v254, v255
    v_mfma_f32_16x16x32_bf16 a[48:51], a[152:155], v[24:27], a[48:51]
    ds_read_b128 a[184:187], v10 offset:53248
    v_mfma_f32_16x16x32_bf16 a[48:51], a[156:159], v[244:247], a[48:51]
    v_exp_f32 v237, v129
    v_mfma_f32_16x16x32_bf16 a[52:55], a[152:155], v[28:31], a[52:55]
    v_exp_f32 v238, v130
    v_mfma_f32_16x16x32_bf16 a[52:55], a[156:159], v[248:251], a[52:55]
    v_cvt_pk_bf16_f32 v180, v236, v237
    v_mfma_f32_16x16x32_bf16 a[56:59], a[152:155], v[36:39], a[56:59]
    ds_read_b128 a[188:191], v11 offset:53248
    v_mfma_f32_16x16x32_bf16 a[56:59], a[156:159], v[232:235], a[56:59]
    v_exp_f32 v239, v131
    v_mfma_f32_16x16x32_bf16 a[60:63], a[152:155], v[4:7], a[60:63]
    v_exp_f32 v240, v132
    v_mfma_f32_16x16x32_bf16 a[60:63], a[156:159], v[228:231], a[60:63]
    s_waitcnt lgkmcnt(4)
    v_cvt_pk_bf16_f32 v181, v238, v239
    v_mfma_f32_16x16x32_bf16 v[216:219], a[252:255], v[28:31], v[216:219]
    v_exp_f32 v241, v133
    v_mfma_f32_16x16x32_bf16 v[216:219], a[252:255], v[248:251], v[216:219]
    v_exp_f32 v242, v134
    v_cvt_pk_bf16_f32 v182, v240, v241
    v_exp_f32 v243, v135
    s_nop 0
    v_cvt_pk_bf16_f32 v183, v242, v243
    v_mfma_f32_16x16x32_bf16 v[104:107], a[160:163], v[40:43], v[200:203]
    ds_read_b64_tr_b16 a[128:129], v16 offset:16384
    ds_read_b64_tr_b16 a[130:131], v16 offset:20480
    v_mfma_f32_16x16x32_bf16 v[104:107], a[164:167], v[44:47], v[104:107]
    v_exp_f32 v236, v136
    v_mfma_f32_16x16x32_bf16 v[104:107], a[168:171], v[48:51], v[104:107]
    v_exp_f32 v237, v137
    v_mfma_f32_16x16x32_bf16 v[104:107], a[172:175], v[52:55], v[104:107]
    v_add_f32 v224, v224, v236
    v_add_f32 v225, v225, v237
    v_mfma_f32_16x16x32_bf16 v[112:115], a[160:163], v[56:59], v[204:207]
    ds_read_b64_tr_b16 a[132:133], v16 offset:24576
    ds_read_b64_tr_b16 a[134:135], v16 offset:28672
    v_mfma_f32_16x16x32_bf16 v[112:115], a[164:167], v[60:63], v[112:115]
    s_add_u32 m0, s82, 65536
    v_exp_f32 v238, v138
    v_mfma_f32_16x16x32_bf16 v[112:115], a[168:171], v[64:67], v[112:115]
    buffer_load_dwordx4 v22, s[36:39], s81 offen lds
    v_mfma_f32_16x16x32_bf16 v[112:115], a[172:175], v[68:71], v[112:115]
    v_cvt_pk_bf16_f32 v184, v236, v237
    v_add_f32 v224, v224, v238
    v_mfma_f32_16x16x32_bf16 v[120:123], a[160:163], v[72:75], v[208:211]
    ds_read_b64_tr_b16 a[136:137], v17 offset:16384
    ds_read_b64_tr_b16 a[138:139], v17 offset:20480
    v_mfma_f32_16x16x32_bf16 v[120:123], a[164:167], v[76:79], v[120:123]
    v_exp_f32 v239, v139
    v_mfma_f32_16x16x32_bf16 v[120:123], a[168:171], v[80:83], v[120:123]
    v_exp_f32 v240, v140
    v_mfma_f32_16x16x32_bf16 v[120:123], a[172:175], v[84:87], v[120:123]
    v_add_f32 v225, v225, v239
    v_cvt_pk_bf16_f32 v185, v238, v239
    v_mfma_f32_16x16x32_bf16 v[128:131], a[160:163], v[88:91], v[212:215]
    ds_read_b64_tr_b16 a[140:141], v17 offset:24576
    ds_read_b64_tr_b16 a[142:143], v17 offset:28672
    v_mfma_f32_16x16x32_bf16 v[128:131], a[164:167], v[92:95], v[128:131]
    v_exp_f32 v241, v141
    v_mfma_f32_16x16x32_bf16 v[128:131], a[168:171], v[96:99], v[128:131]
    v_add_f32 v224, v224, v240
    v_add_f32 v225, v225, v241
    v_mfma_f32_16x16x32_bf16 v[128:131], a[172:175], v[100:103], v[128:131]
    s_waitcnt lgkmcnt(8)
    v_exp_f32 v242, v142
    v_mfma_f32_16x16x32_bf16 v[108:111], a[176:179], v[40:43], v[200:203]
    ds_read_b64_tr_b16 a[144:145], v18 offset:16384
    ds_read_b64_tr_b16 a[146:147], v18 offset:20480
    v_mfma_f32_16x16x32_bf16 v[108:111], a[180:183], v[44:47], v[108:111]
    v_cvt_pk_bf16_f32 v186, v240, v241
    v_add_f32 v224, v224, v242
    v_mfma_f32_16x16x32_bf16 v[108:111], a[184:187], v[48:51], v[108:111]
    v_exp_f32 v243, v143
    v_mfma_f32_16x16x32_bf16 v[108:111], a[188:191], v[52:55], v[108:111]
    v_exp_f32 v252, v144
    v_mfma_f32_16x16x32_bf16 v[116:119], a[176:179], v[56:59], v[204:207]
    ds_read_b64_tr_b16 a[148:149], v18 offset:24576
    ds_read_b64_tr_b16 a[150:151], v18 offset:28672
    v_mfma_f32_16x16x32_bf16 v[116:119], a[180:183], v[60:63], v[116:119]
    v_add_f32 v225, v225, v243
    v_cvt_pk_bf16_f32 v187, v242, v243
    v_mfma_f32_16x16x32_bf16 v[116:119], a[184:187], v[64:67], v[116:119]
    buffer_load_dwordx4 v23, s[36:39], s81 offen offset:1024 lds
    v_mfma_f32_16x16x32_bf16 v[116:119], a[188:191], v[68:71], v[116:119]
    s_add_u32 s81, s81, 8192
    v_exp_f32 v253, v145
    v_mfma_f32_16x16x32_bf16 v[124:127], a[176:179], v[72:75], v[208:211]
    ds_read_b64_tr_b16 a[152:153], v19 offset:16384
    ds_read_b64_tr_b16 a[154:155], v19 offset:20480
    v_mfma_f32_16x16x32_bf16 v[124:127], a[180:183], v[76:79], v[124:127]
    v_exp_f32 v254, v146
    v_mfma_f32_16x16x32_bf16 v[124:127], a[184:187], v[80:83], v[124:127]
    v_cvt_pk_bf16_f32 v188, v252, v253
    v_mfma_f32_16x16x32_bf16 v[124:127], a[188:191], v[84:87], v[124:127]
    v_exp_f32 v255, v147
    v_mfma_f32_16x16x32_bf16 v[132:135], a[176:179], v[88:91], v[212:215]
    ds_read_b64_tr_b16 a[156:157], v19 offset:24576
    ds_read_b64_tr_b16 a[158:159], v19 offset:28672
    v_mfma_f32_16x16x32_bf16 v[132:135], a[180:183], v[92:95], v[132:135]
    v_exp_f32 v236, v148
    v_mfma_f32_16x16x32_bf16 v[132:135], a[184:187], v[96:99], v[132:135]
    v_cvt_pk_bf16_f32 v189, v254, v255
    v_mfma_f32_16x16x32_bf16 v[132:135], a[188:191], v[100:103], v[132:135]
    s_waitcnt lgkmcnt(8)
    v_exp_f32 v237, v149
    v_mfma_f32_16x16x32_bf16 a[64:67], a[128:131], v[24:27], a[64:67]
    ds_read_b128 a[160:163], v8 offset:57344
    v_cvt_pk_bf16_f32 v190, v236, v237
    v_mfma_f32_16x16x32_bf16 a[64:67], a[132:135], v[244:247], a[64:67]
    v_exp_f32 v238, v150
    v_mfma_f32_16x16x32_bf16 a[68:71], a[128:131], v[28:31], a[68:71]
    v_exp_f32 v239, v151
    v_mfma_f32_16x16x32_bf16 a[68:71], a[132:135], v[248:251], a[68:71]
    v_exp_f32 v240, v152
    v_mfma_f32_16x16x32_bf16 a[72:75], a[128:131], v[36:39], a[72:75]
    ds_read_b128 a[164:167], v9 offset:57344
    v_cvt_pk_bf16_f32 v191, v238, v239
    v_mfma_f32_16x16x32_bf16 a[72:75], a[132:135], v[232:235], a[72:75]
    s_add_u32 m0, s82, 73728
    v_exp_f32 v241, v153
    v_mfma_f32_16x16x32_bf16 a[76:79], a[128:131], v[4:7], a[76:79]
    buffer_load_dwordx4 v22, s[36:39], s81 offen lds
    v_mfma_f32_16x16x32_bf16 a[76:79], a[132:135], v[228:231], a[76:79]
    v_add_f32 v226, v226, v240
    v_add_f32 v227, v227, v241
    v_mfma_f32_16x16x32_bf16 a[80:83], a[136:139], v[24:27], a[80:83]
    ds_read_b128 a[168:171], v10 offset:57344
    v_cvt_pk_bf16_f32 v192, v240, v241
    v_mfma_f32_16x16x32_bf16 a[80:83], a[140:143], v[244:247], a[80:83]
    v_exp_f32 v242, v154
    v_mfma_f32_16x16x32_bf16 a[84:87], a[136:139], v[28:31], a[84:87]
    v_exp_f32 v243, v155
    v_mfma_f32_16x16x32_bf16 a[84:87], a[140:143], v[248:251], a[84:87]
    v_add_f32 v226, v226, v242
    v_add_f32 v227, v227, v243
    v_mfma_f32_16x16x32_bf16 a[88:91], a[136:139], v[36:39], a[88:91]
    ds_read_b128 a[172:175], v11 offset:57344
    v_cvt_pk_bf16_f32 v193, v242, v243
    v_mfma_f32_16x16x32_bf16 a[88:91], a[140:143], v[232:235], a[88:91]
    v_exp_f32 v252, v156
    v_mfma_f32_16x16x32_bf16 a[92:95], a[136:139], v[4:7], a[92:95]
    v_exp_f32 v253, v157
    v_mfma_f32_16x16x32_bf16 a[92:95], a[140:143], v[228:231], a[92:95]
    s_waitcnt lgkmcnt(4)
    v_add_f32 v226, v226, v252
    v_add_f32 v227, v227, v253
    v_mfma_f32_16x16x32_bf16 a[96:99], a[144:147], v[24:27], a[96:99]
    ds_read_b128 a[176:179], v8 offset:61440
    v_cvt_pk_bf16_f32 v194, v252, v253
    v_mfma_f32_16x16x32_bf16 a[96:99], a[148:151], v[244:247], a[96:99]
    v_exp_f32 v254, v158
    v_mfma_f32_16x16x32_bf16 a[100:103], a[144:147], v[28:31], a[100:103]
    v_exp_f32 v255, v159
    v_mfma_f32_16x16x32_bf16 a[100:103], a[148:151], v[248:251], a[100:103]
    v_add_f32 v226, v226, v254
    v_add_f32 v227, v227, v255
    v_mfma_f32_16x16x32_bf16 a[104:107], a[144:147], v[36:39], a[104:107]
    ds_read_b128 a[180:183], v9 offset:61440
    v_cvt_pk_bf16_f32 v195, v254, v255
    v_mfma_f32_16x16x32_bf16 a[104:107], a[148:151], v[232:235], a[104:107]
    v_exp_f32 v236, v160
    v_mfma_f32_16x16x32_bf16 a[108:111], a[144:147], v[4:7], a[108:111]
    buffer_load_dwordx4 v23, s[36:39], s81 offen offset:1024 lds
    v_mfma_f32_16x16x32_bf16 a[108:111], a[148:151], v[228:231], a[108:111]
    s_add_u32 s81, s81, 8192
    v_exp_f32 v237, v161
    v_mfma_f32_16x16x32_bf16 a[112:115], a[152:155], v[24:27], a[112:115]
    ds_read_b128 a[184:187], v10 offset:61440
    v_cvt_pk_bf16_f32 v196, v236, v237
    v_mfma_f32_16x16x32_bf16 a[112:115], a[156:159], v[244:247], a[112:115]
    v_exp_f32 v238, v162
    v_mfma_f32_16x16x32_bf16 a[116:119], a[152:155], v[28:31], a[116:119]
    v_exp_f32 v239, v163
    v_mfma_f32_16x16x32_bf16 a[116:119], a[156:159], v[248:251], a[116:119]
    v_exp_f32 v240, v164
    v_mfma_f32_16x16x32_bf16 a[120:123], a[152:155], v[36:39], a[120:123]
    ds_read_b128 a[188:191], v11 offset:61440
    v_cvt_pk_bf16_f32 v197, v238, v239
    v_mfma_f32_16x16x32_bf16 a[120:123], a[156:159], v[232:235], a[120:123]
    v_exp_f32 v241, v165
    v_mfma_f32_16x16x32_bf16 a[124:127], a[152:155], v[4:7], a[124:127]
    v_exp_f32 v242, v166
    v_mfma_f32_16x16x32_bf16 a[124:127], a[156:159], v[228:231], a[124:127]
    s_waitcnt lgkmcnt(4)
    v_cvt_pk_bf16_f32 v198, v240, v241
    v_mfma_f32_16x16x32_bf16 v[220:223], a[252:255], v[4:7], v[220:223]
    s_waitcnt vmcnt(12)
    v_exp_f32 v243, v167
    v_mfma_f32_16x16x32_bf16 v[220:223], a[252:255], v[228:231], v[220:223]
    s_barrier
    v_cvt_pk_bf16_f32 v199, v242, v243
    v_mfma_f32_16x16x32_bf16 v[136:139], a[160:163], v[40:43], v[200:203]
    ds_read_b64_tr_b16 a[128:129], v12 offset:32768
    ds_read_b64_tr_b16 a[130:131], v12 offset:36864
    v_mfma_f32_16x16x32_bf16 v[136:139], a[164:167], v[44:47], v[136:139]
    v_exp_f32 v236, v104
    v_mfma_f32_16x16x32_bf16 v[136:139], a[168:171], v[48:51], v[136:139]
    v_exp_f32 v237, v105
    v_mfma_f32_16x16x32_bf16 v[136:139], a[172:175], v[52:55], v[136:139]
    v_add_f32 v224, v224, v236
    v_add_f32 v225, v225, v237
    v_mfma_f32_16x16x32_bf16 v[144:147], a[160:163], v[56:59], v[204:207]
    ds_read_b64_tr_b16 a[132:133], v12 offset:40960
    ds_read_b64_tr_b16 a[134:135], v12 offset:45056
    v_mfma_f32_16x16x32_bf16 v[144:147], a[164:167], v[60:63], v[144:147]
    s_add_u32 m0, s82, 40960
    v_exp_f32 v238, v106
    v_mfma_f32_16x16x32_bf16 v[144:147], a[168:171], v[64:67], v[144:147]
    buffer_load_dwordx4 v20, s[32:35], s80 offen lds
    v_mfma_f32_16x16x32_bf16 v[144:147], a[172:175], v[68:71], v[144:147]
    v_cvt_pk_bf16_f32 v24, v236, v237
    v_add_f32 v224, v224, v238
    v_mfma_f32_16x16x32_bf16 v[152:155], a[160:163], v[72:75], v[208:211]
    ds_read_b64_tr_b16 a[136:137], v13 offset:32768
    ds_read_b64_tr_b16 a[138:139], v13 offset:36864
    v_mfma_f32_16x16x32_bf16 v[152:155], a[164:167], v[76:79], v[152:155]
    v_exp_f32 v239, v107
    v_mfma_f32_16x16x32_bf16 v[152:155], a[168:171], v[80:83], v[152:155]
    v_exp_f32 v240, v108
    v_mfma_f32_16x16x32_bf16 v[152:155], a[172:175], v[84:87], v[152:155]
    v_add_f32 v225, v225, v239
    v_cvt_pk_bf16_f32 v25, v238, v239
    v_mfma_f32_16x16x32_bf16 v[160:163], a[160:163], v[88:91], v[212:215]
    ds_read_b64_tr_b16 a[140:141], v13 offset:40960
    ds_read_b64_tr_b16 a[142:143], v13 offset:45056
    v_mfma_f32_16x16x32_bf16 v[160:163], a[164:167], v[92:95], v[160:163]
    v_exp_f32 v241, v109
    v_mfma_f32_16x16x32_bf16 v[160:163], a[168:171], v[96:99], v[160:163]
    v_add_f32 v224, v224, v240
    v_add_f32 v225, v225, v241
    v_mfma_f32_16x16x32_bf16 v[160:163], a[172:175], v[100:103], v[160:163]
    s_waitcnt lgkmcnt(8)
    v_exp_f32 v242, v110
    v_mfma_f32_16x16x32_bf16 v[140:143], a[176:179], v[40:43], v[200:203]
    ds_read_b64_tr_b16 a[144:145], v14 offset:32768
    ds_read_b64_tr_b16 a[146:147], v14 offset:36864
    v_mfma_f32_16x16x32_bf16 v[140:143], a[180:183], v[44:47], v[140:143]
    v_cvt_pk_bf16_f32 v26, v240, v241
    v_add_f32 v224, v224, v242
    v_mfma_f32_16x16x32_bf16 v[140:143], a[184:187], v[48:51], v[140:143]
    v_exp_f32 v243, v111
    v_mfma_f32_16x16x32_bf16 v[140:143], a[188:191], v[52:55], v[140:143]
    v_exp_f32 v252, v112
    v_mfma_f32_16x16x32_bf16 v[148:151], a[176:179], v[56:59], v[204:207]
    ds_read_b64_tr_b16 a[148:149], v14 offset:40960
    ds_read_b64_tr_b16 a[150:151], v14 offset:45056
    v_mfma_f32_16x16x32_bf16 v[148:151], a[180:183], v[60:63], v[148:151]
    v_add_f32 v225, v225, v243
    v_cvt_pk_bf16_f32 v27, v242, v243
    v_mfma_f32_16x16x32_bf16 v[148:151], a[184:187], v[64:67], v[148:151]
    buffer_load_dwordx4 v21, s[32:35], s80 offen offset:1024 lds
    v_mfma_f32_16x16x32_bf16 v[148:151], a[188:191], v[68:71], v[148:151]
    s_add_u32 s80, s80, 8192
    v_exp_f32 v253, v113
    v_mfma_f32_16x16x32_bf16 v[156:159], a[176:179], v[72:75], v[208:211]
    ds_read_b64_tr_b16 a[152:153], v15 offset:32768
    ds_read_b64_tr_b16 a[154:155], v15 offset:36864
    v_mfma_f32_16x16x32_bf16 v[156:159], a[180:183], v[76:79], v[156:159]
    v_exp_f32 v254, v114
    v_mfma_f32_16x16x32_bf16 v[156:159], a[184:187], v[80:83], v[156:159]
    v_cvt_pk_bf16_f32 v28, v252, v253
    v_mfma_f32_16x16x32_bf16 v[156:159], a[188:191], v[84:87], v[156:159]
    v_exp_f32 v255, v115
    v_mfma_f32_16x16x32_bf16 v[164:167], a[176:179], v[88:91], v[212:215]
    ds_read_b64_tr_b16 a[156:157], v15 offset:40960
    ds_read_b64_tr_b16 a[158:159], v15 offset:45056
    v_mfma_f32_16x16x32_bf16 v[164:167], a[180:183], v[92:95], v[164:167]
    v_exp_f32 v236, v116
    v_mfma_f32_16x16x32_bf16 v[164:167], a[184:187], v[96:99], v[164:167]
    v_cvt_pk_bf16_f32 v29, v254, v255
    v_mfma_f32_16x16x32_bf16 v[164:167], a[188:191], v[100:103], v[164:167]
    s_waitcnt lgkmcnt(8)
    v_exp_f32 v237, v117
    v_mfma_f32_16x16x32_bf16 a[0:3], a[128:131], v[168:171], a[0:3]
    ds_read_b128 a[160:163], v8 offset:0
    v_cvt_pk_bf16_f32 v30, v236, v237
    v_mfma_f32_16x16x32_bf16 a[0:3], a[132:135], v[184:187], a[0:3]
    v_exp_f32 v238, v118
    v_mfma_f32_16x16x32_bf16 a[4:7], a[128:131], v[172:175], a[4:7]
    v_exp_f32 v239, v119
    v_mfma_f32_16x16x32_bf16 a[4:7], a[132:135], v[188:191], a[4:7]
    v_exp_f32 v240, v120
    v_mfma_f32_16x16x32_bf16 a[8:11], a[128:131], v[176:179], a[8:11]
    ds_read_b128 a[164:167], v9 offset:0
    v_cvt_pk_bf16_f32 v31, v238, v239
    v_mfma_f32_16x16x32_bf16 a[8:11], a[132:135], v[192:195], a[8:11]
    s_add_u32 m0, s82, 49152
    v_exp_f32 v241, v121
    v_mfma_f32_16x16x32_bf16 a[12:15], a[128:131], v[180:183], a[12:15]
    buffer_load_dwordx4 v20, s[32:35], s80 offen lds
    v_mfma_f32_16x16x32_bf16 a[12:15], a[132:135], v[196:199], a[12:15]
    v_add_f32 v226, v226, v240
    v_add_f32 v227, v227, v241
    v_mfma_f32_16x16x32_bf16 a[16:19], a[136:139], v[168:171], a[16:19]
    ds_read_b128 a[168:171], v10 offset:0
    v_cvt_pk_bf16_f32 v36, v240, v241
    v_mfma_f32_16x16x32_bf16 a[16:19], a[140:143], v[184:187], a[16:19]
    v_exp_f32 v242, v122
    v_mfma_f32_16x16x32_bf16 a[20:23], a[136:139], v[172:175], a[20:23]
    v_exp_f32 v243, v123
    v_mfma_f32_16x16x32_bf16 a[20:23], a[140:143], v[188:191], a[20:23]
    v_add_f32 v226, v226, v242
    v_add_f32 v227, v227, v243
    v_mfma_f32_16x16x32_bf16 a[24:27], a[136:139], v[176:179], a[24:27]
    ds_read_b128 a[172:175], v11 offset:0
    v_cvt_pk_bf16_f32 v37, v242, v243
    v_mfma_f32_16x16x32_bf16 a[24:27], a[140:143], v[192:195], a[24:27]
    buffer_load_dwordx4 a[224:227], v33, s[56:59], s87 offen
    v_mfma_f32_16x16x32_bf16 a[28:31], a[136:139], v[180:183], a[28:31]
    s_add_u32 s87, s87, 1024
    v_exp_f32 v252, v124
    v_mfma_f32_16x16x32_bf16 a[28:31], a[140:143], v[196:199], a[28:31]
    s_waitcnt lgkmcnt(4)
    v_exp_f32 v253, v125
    v_mfma_f32_16x16x32_bf16 a[32:35], a[144:147], v[168:171], a[32:35]
    ds_read_b128 a[176:179], v8 offset:4096
    v_add_f32 v226, v226, v252
    v_mfma_f32_16x16x32_bf16 a[32:35], a[148:151], v[184:187], a[32:35]
    v_exp_f32 v254, v126
    v_mfma_f32_16x16x32_bf16 a[36:39], a[144:147], v[172:175], a[36:39]
    v_add_f32 v227, v227, v253
    v_cvt_pk_bf16_f32 v38, v252, v253
    v_mfma_f32_16x16x32_bf16 a[36:39], a[148:151], v[188:191], a[36:39]
    v_exp_f32 v255, v127
    v_mfma_f32_16x16x32_bf16 a[40:43], a[144:147], v[176:179], a[40:43]
    ds_read_b128 a[180:183], v9 offset:4096
    v_add_f32 v226, v226, v254
    v_mfma_f32_16x16x32_bf16 a[40:43], a[148:151], v[192:195], a[40:43]
    v_exp_f32 v236, v128
    v_mfma_f32_16x16x32_bf16 a[44:47], a[144:147], v[180:183], a[44:47]
    buffer_load_dwordx4 v21, s[32:35], s80 offen offset:1024 lds
    v_mfma_f32_16x16x32_bf16 a[44:47], a[148:151], v[196:199], a[44:47]
    s_add_u32 s80, s80, 8192
    v_add_f32 v227, v227, v255
    v_cvt_pk_bf16_f32 v39, v254, v255
    v_mfma_f32_16x16x32_bf16 a[48:51], a[152:155], v[168:171], a[48:51]
    ds_read_b128 a[184:187], v10 offset:4096
    v_mfma_f32_16x16x32_bf16 a[48:51], a[156:159], v[184:187], a[48:51]
    v_exp_f32 v237, v129
    v_mfma_f32_16x16x32_bf16 a[52:55], a[152:155], v[172:175], a[52:55]
    v_exp_f32 v238, v130
    v_mfma_f32_16x16x32_bf16 a[52:55], a[156:159], v[188:191], a[52:55]
    v_cvt_pk_bf16_f32 v4, v236, v237
    v_mfma_f32_16x16x32_bf16 a[56:59], a[152:155], v[176:179], a[56:59]
    ds_read_b128 a[188:191], v11 offset:4096
    v_mfma_f32_16x16x32_bf16 a[56:59], a[156:159], v[192:195], a[56:59]
    v_exp_f32 v239, v131
    v_mfma_f32_16x16x32_bf16 a[60:63], a[152:155], v[180:183], a[60:63]
    v_exp_f32 v240, v132
    v_mfma_f32_16x16x32_bf16 a[60:63], a[156:159], v[196:199], a[60:63]
    s_waitcnt lgkmcnt(4)
    v_cvt_pk_bf16_f32 v5, v238, v239
    v_mfma_f32_16x16x32_bf16 v[216:219], a[252:255], v[172:175], v[216:219]
    v_exp_f32 v241, v133
    v_mfma_f32_16x16x32_bf16 v[216:219], a[252:255], v[188:191], v[216:219]
    v_exp_f32 v242, v134
    v_cvt_pk_bf16_f32 v6, v240, v241
    v_exp_f32 v243, v135
    s_nop 0
    v_cvt_pk_bf16_f32 v7, v242, v243
    v_mfma_f32_16x16x32_bf16 v[104:107], a[160:163], v[40:43], v[200:203]
    ds_read_b64_tr_b16 a[128:129], v16 offset:32768
    ds_read_b64_tr_b16 a[130:131], v16 offset:36864
    v_mfma_f32_16x16x32_bf16 v[104:107], a[164:167], v[44:47], v[104:107]
    v_exp_f32 v236, v136
    v_mfma_f32_16x16x32_bf16 v[104:107], a[168:171], v[48:51], v[104:107]
    v_exp_f32 v237, v137
    v_mfma_f32_16x16x32_bf16 v[104:107], a[172:175], v[52:55], v[104:107]
    v_add_f32 v224, v224, v236
    v_add_f32 v225, v225, v237
    v_mfma_f32_16x16x32_bf16 v[112:115], a[160:163], v[56:59], v[204:207]
    ds_read_b64_tr_b16 a[132:133], v16 offset:40960
    ds_read_b64_tr_b16 a[134:135], v16 offset:45056
    v_mfma_f32_16x16x32_bf16 v[112:115], a[164:167], v[60:63], v[112:115]
    s_add_u32 m0, s82, 81920
    v_exp_f32 v238, v138
    v_mfma_f32_16x16x32_bf16 v[112:115], a[168:171], v[64:67], v[112:115]
    buffer_load_dwordx4 v22, s[36:39], s81 offen lds
    v_mfma_f32_16x16x32_bf16 v[112:115], a[172:175], v[68:71], v[112:115]
    v_cvt_pk_bf16_f32 v244, v236, v237
    v_add_f32 v224, v224, v238
    v_mfma_f32_16x16x32_bf16 v[120:123], a[160:163], v[72:75], v[208:211]
    ds_read_b64_tr_b16 a[136:137], v17 offset:32768
    ds_read_b64_tr_b16 a[138:139], v17 offset:36864
    v_mfma_f32_16x16x32_bf16 v[120:123], a[164:167], v[76:79], v[120:123]
    v_exp_f32 v239, v139
    v_mfma_f32_16x16x32_bf16 v[120:123], a[168:171], v[80:83], v[120:123]
    v_exp_f32 v240, v140
    v_mfma_f32_16x16x32_bf16 v[120:123], a[172:175], v[84:87], v[120:123]
    v_add_f32 v225, v225, v239
    v_cvt_pk_bf16_f32 v245, v238, v239
    v_mfma_f32_16x16x32_bf16 v[128:131], a[160:163], v[88:91], v[212:215]
    ds_read_b64_tr_b16 a[140:141], v17 offset:40960
    ds_read_b64_tr_b16 a[142:143], v17 offset:45056
    v_mfma_f32_16x16x32_bf16 v[128:131], a[164:167], v[92:95], v[128:131]
    v_exp_f32 v241, v141
    v_mfma_f32_16x16x32_bf16 v[128:131], a[168:171], v[96:99], v[128:131]
    v_add_f32 v224, v224, v240
    v_add_f32 v225, v225, v241
    v_mfma_f32_16x16x32_bf16 v[128:131], a[172:175], v[100:103], v[128:131]
    s_waitcnt lgkmcnt(8)
    v_exp_f32 v242, v142
    v_mfma_f32_16x16x32_bf16 v[108:111], a[176:179], v[40:43], v[200:203]
    ds_read_b64_tr_b16 a[144:145], v18 offset:32768
    ds_read_b64_tr_b16 a[146:147], v18 offset:36864
    v_mfma_f32_16x16x32_bf16 v[108:111], a[180:183], v[44:47], v[108:111]
    v_cvt_pk_bf16_f32 v246, v240, v241
    v_add_f32 v224, v224, v242
    v_mfma_f32_16x16x32_bf16 v[108:111], a[184:187], v[48:51], v[108:111]
    v_exp_f32 v243, v143
    v_mfma_f32_16x16x32_bf16 v[108:111], a[188:191], v[52:55], v[108:111]
    v_exp_f32 v252, v144
    v_mfma_f32_16x16x32_bf16 v[116:119], a[176:179], v[56:59], v[204:207]
    ds_read_b64_tr_b16 a[148:149], v18 offset:40960
    ds_read_b64_tr_b16 a[150:151], v18 offset:45056
    v_mfma_f32_16x16x32_bf16 v[116:119], a[180:183], v[60:63], v[116:119]
    v_add_f32 v225, v225, v243
    v_cvt_pk_bf16_f32 v247, v242, v243
    v_mfma_f32_16x16x32_bf16 v[116:119], a[184:187], v[64:67], v[116:119]
    buffer_load_dwordx4 v23, s[36:39], s81 offen offset:1024 lds
    v_mfma_f32_16x16x32_bf16 v[116:119], a[188:191], v[68:71], v[116:119]
    s_add_u32 s81, s81, 8192
    v_exp_f32 v253, v145
    v_mfma_f32_16x16x32_bf16 v[124:127], a[176:179], v[72:75], v[208:211]
    ds_read_b64_tr_b16 a[152:153], v19 offset:32768
    ds_read_b64_tr_b16 a[154:155], v19 offset:36864
    v_mfma_f32_16x16x32_bf16 v[124:127], a[180:183], v[76:79], v[124:127]
    v_exp_f32 v254, v146
    v_mfma_f32_16x16x32_bf16 v[124:127], a[184:187], v[80:83], v[124:127]
    v_cvt_pk_bf16_f32 v248, v252, v253
    v_mfma_f32_16x16x32_bf16 v[124:127], a[188:191], v[84:87], v[124:127]
    v_exp_f32 v255, v147
    v_mfma_f32_16x16x32_bf16 v[132:135], a[176:179], v[88:91], v[212:215]
    ds_read_b64_tr_b16 a[156:157], v19 offset:40960
    ds_read_b64_tr_b16 a[158:159], v19 offset:45056
    v_mfma_f32_16x16x32_bf16 v[132:135], a[180:183], v[92:95], v[132:135]
    v_exp_f32 v236, v148
    v_mfma_f32_16x16x32_bf16 v[132:135], a[184:187], v[96:99], v[132:135]
    v_cvt_pk_bf16_f32 v249, v254, v255
    v_mfma_f32_16x16x32_bf16 v[132:135], a[188:191], v[100:103], v[132:135]
    s_waitcnt lgkmcnt(8)
    v_exp_f32 v237, v149
    v_mfma_f32_16x16x32_bf16 a[64:67], a[128:131], v[168:171], a[64:67]
    ds_read_b128 a[160:163], v8 offset:8192
    v_cvt_pk_bf16_f32 v250, v236, v237
    v_mfma_f32_16x16x32_bf16 a[64:67], a[132:135], v[184:187], a[64:67]
    v_exp_f32 v238, v150
    v_mfma_f32_16x16x32_bf16 a[68:71], a[128:131], v[172:175], a[68:71]
    v_exp_f32 v239, v151
    v_mfma_f32_16x16x32_bf16 a[68:71], a[132:135], v[188:191], a[68:71]
    v_exp_f32 v240, v152
    v_mfma_f32_16x16x32_bf16 a[72:75], a[128:131], v[176:179], a[72:75]
    ds_read_b128 a[164:167], v9 offset:8192
    v_cvt_pk_bf16_f32 v251, v238, v239
    v_mfma_f32_16x16x32_bf16 a[72:75], a[132:135], v[192:195], a[72:75]
    s_add_u32 m0, s82, 90112
    v_exp_f32 v241, v153
    v_mfma_f32_16x16x32_bf16 a[76:79], a[128:131], v[180:183], a[76:79]
    buffer_load_dwordx4 v22, s[36:39], s81 offen lds
    v_mfma_f32_16x16x32_bf16 a[76:79], a[132:135], v[196:199], a[76:79]
    v_add_f32 v226, v226, v240
    v_add_f32 v227, v227, v241
    v_mfma_f32_16x16x32_bf16 a[80:83], a[136:139], v[168:171], a[80:83]
    ds_read_b128 a[168:171], v10 offset:8192
    v_cvt_pk_bf16_f32 v232, v240, v241
    v_mfma_f32_16x16x32_bf16 a[80:83], a[140:143], v[184:187], a[80:83]
    v_exp_f32 v242, v154
    v_mfma_f32_16x16x32_bf16 a[84:87], a[136:139], v[172:175], a[84:87]
    v_exp_f32 v243, v155
    v_mfma_f32_16x16x32_bf16 a[84:87], a[140:143], v[188:191], a[84:87]
    v_add_f32 v226, v226, v242
    v_add_f32 v227, v227, v243
    v_mfma_f32_16x16x32_bf16 a[88:91], a[136:139], v[176:179], a[88:91]
    ds_read_b128 a[172:175], v11 offset:8192
    v_cvt_pk_bf16_f32 v233, v242, v243
    v_mfma_f32_16x16x32_bf16 a[88:91], a[140:143], v[192:195], a[88:91]
    v_exp_f32 v252, v156
    v_mfma_f32_16x16x32_bf16 a[92:95], a[136:139], v[180:183], a[92:95]
    v_exp_f32 v253, v157
    v_mfma_f32_16x16x32_bf16 a[92:95], a[140:143], v[196:199], a[92:95]
    s_waitcnt lgkmcnt(4)
    v_add_f32 v226, v226, v252
    v_add_f32 v227, v227, v253
    v_mfma_f32_16x16x32_bf16 a[96:99], a[144:147], v[168:171], a[96:99]
    ds_read_b128 a[176:179], v8 offset:12288
    v_cvt_pk_bf16_f32 v234, v252, v253
    v_mfma_f32_16x16x32_bf16 a[96:99], a[148:151], v[184:187], a[96:99]
    v_exp_f32 v254, v158
    v_mfma_f32_16x16x32_bf16 a[100:103], a[144:147], v[172:175], a[100:103]
    v_exp_f32 v255, v159
    v_mfma_f32_16x16x32_bf16 a[100:103], a[148:151], v[188:191], a[100:103]
    v_add_f32 v226, v226, v254
    v_add_f32 v227, v227, v255
    v_mfma_f32_16x16x32_bf16 a[104:107], a[144:147], v[176:179], a[104:107]
    ds_read_b128 a[180:183], v9 offset:12288
    v_cvt_pk_bf16_f32 v235, v254, v255
    v_mfma_f32_16x16x32_bf16 a[104:107], a[148:151], v[192:195], a[104:107]
    v_exp_f32 v236, v160
    v_mfma_f32_16x16x32_bf16 a[108:111], a[144:147], v[180:183], a[108:111]
    buffer_load_dwordx4 v23, s[36:39], s81 offen offset:1024 lds
    v_mfma_f32_16x16x32_bf16 a[108:111], a[148:151], v[196:199], a[108:111]
    s_add_u32 s81, s81, 8192
    v_exp_f32 v237, v161
    v_mfma_f32_16x16x32_bf16 a[112:115], a[152:155], v[168:171], a[112:115]
    ds_read_b128 a[184:187], v10 offset:12288
    v_cvt_pk_bf16_f32 v228, v236, v237
    v_mfma_f32_16x16x32_bf16 a[112:115], a[156:159], v[184:187], a[112:115]
    v_exp_f32 v238, v162
    v_mfma_f32_16x16x32_bf16 a[116:119], a[152:155], v[172:175], a[116:119]
    v_exp_f32 v239, v163
    v_mfma_f32_16x16x32_bf16 a[116:119], a[156:159], v[188:191], a[116:119]
    v_exp_f32 v240, v164
    v_mfma_f32_16x16x32_bf16 a[120:123], a[152:155], v[176:179], a[120:123]
    ds_read_b128 a[188:191], v11 offset:12288
    v_cvt_pk_bf16_f32 v229, v238, v239
    v_mfma_f32_16x16x32_bf16 a[120:123], a[156:159], v[192:195], a[120:123]
    v_exp_f32 v241, v165
    v_mfma_f32_16x16x32_bf16 a[124:127], a[152:155], v[180:183], a[124:127]
    v_exp_f32 v242, v166
    v_mfma_f32_16x16x32_bf16 a[124:127], a[156:159], v[196:199], a[124:127]
    s_waitcnt lgkmcnt(4)
    v_cvt_pk_bf16_f32 v230, v240, v241
    v_mfma_f32_16x16x32_bf16 v[220:223], a[252:255], v[180:183], v[220:223]
    s_waitcnt vmcnt(12)
    v_exp_f32 v243, v167
    v_mfma_f32_16x16x32_bf16 v[220:223], a[252:255], v[196:199], v[220:223]
    s_barrier
    v_cvt_pk_bf16_f32 v231, v242, v243
    v_mfma_f32_16x16x32_bf16 v[136:139], a[160:163], v[40:43], v[200:203]
    ds_read_b64_tr_b16 a[128:129], v12 offset:49152
    ds_read_b64_tr_b16 a[130:131], v12 offset:53248
    v_mfma_f32_16x16x32_bf16 v[136:139], a[164:167], v[44:47], v[136:139]
    v_exp_f32 v236, v104
    v_mfma_f32_16x16x32_bf16 v[136:139], a[168:171], v[48:51], v[136:139]
    v_exp_f32 v237, v105
    v_mfma_f32_16x16x32_bf16 v[136:139], a[172:175], v[52:55], v[136:139]
    v_add_f32 v224, v224, v236
    v_add_f32 v225, v225, v237
    v_mfma_f32_16x16x32_bf16 v[144:147], a[160:163], v[56:59], v[204:207]
    ds_read_b64_tr_b16 a[132:133], v12 offset:57344
    ds_read_b64_tr_b16 a[134:135], v12 offset:61440
    v_mfma_f32_16x16x32_bf16 v[144:147], a[164:167], v[60:63], v[144:147]
    s_add_u32 m0, s82, 57344
    v_exp_f32 v238, v106
    v_mfma_f32_16x16x32_bf16 v[144:147], a[168:171], v[64:67], v[144:147]
    buffer_load_dwordx4 v20, s[32:35], s80 offen lds
    v_mfma_f32_16x16x32_bf16 v[144:147], a[172:175], v[68:71], v[144:147]
    v_cvt_pk_bf16_f32 v168, v236, v237
    v_add_f32 v224, v224, v238
    v_mfma_f32_16x16x32_bf16 v[152:155], a[160:163], v[72:75], v[208:211]
    ds_read_b64_tr_b16 a[136:137], v13 offset:49152
    ds_read_b64_tr_b16 a[138:139], v13 offset:53248
    v_mfma_f32_16x16x32_bf16 v[152:155], a[164:167], v[76:79], v[152:155]
    v_exp_f32 v239, v107
    v_mfma_f32_16x16x32_bf16 v[152:155], a[168:171], v[80:83], v[152:155]
    v_exp_f32 v240, v108
    v_mfma_f32_16x16x32_bf16 v[152:155], a[172:175], v[84:87], v[152:155]
    v_add_f32 v225, v225, v239
    v_cvt_pk_bf16_f32 v169, v238, v239
    v_mfma_f32_16x16x32_bf16 v[160:163], a[160:163], v[88:91], v[212:215]
    ds_read_b64_tr_b16 a[140:141], v13 offset:57344
    ds_read_b64_tr_b16 a[142:143], v13 offset:61440
    v_mfma_f32_16x16x32_bf16 v[160:163], a[164:167], v[92:95], v[160:163]
    v_exp_f32 v241, v109
    v_mfma_f32_16x16x32_bf16 v[160:163], a[168:171], v[96:99], v[160:163]
    v_add_f32 v224, v224, v240
    v_add_f32 v225, v225, v241
    v_mfma_f32_16x16x32_bf16 v[160:163], a[172:175], v[100:103], v[160:163]
    s_waitcnt lgkmcnt(8)
    v_exp_f32 v242, v110
    v_mfma_f32_16x16x32_bf16 v[140:143], a[176:179], v[40:43], v[200:203]
    ds_read_b64_tr_b16 a[144:145], v14 offset:49152
    ds_read_b64_tr_b16 a[146:147], v14 offset:53248
    v_mfma_f32_16x16x32_bf16 v[140:143], a[180:183], v[44:47], v[140:143]
    v_cvt_pk_bf16_f32 v170, v240, v241
    v_add_f32 v224, v224, v242
    v_mfma_f32_16x16x32_bf16 v[140:143], a[184:187], v[48:51], v[140:143]
    v_exp_f32 v243, v111
    v_mfma_f32_16x16x32_bf16 v[140:143], a[188:191], v[52:55], v[140:143]
    v_exp_f32 v252, v112
    v_mfma_f32_16x16x32_bf16 v[148:151], a[176:179], v[56:59], v[204:207]
    ds_read_b64_tr_b16 a[148:149], v14 offset:57344
    ds_read_b64_tr_b16 a[150:151], v14 offset:61440
    v_mfma_f32_16x16x32_bf16 v[148:151], a[180:183], v[60:63], v[148:151]
    v_add_f32 v225, v225, v243
    v_cvt_pk_bf16_f32 v171, v242, v243
    v_mfma_f32_16x16x32_bf16 v[148:151], a[184:187], v[64:67], v[148:151]
    buffer_load_dwordx4 v21, s[32:35], s80 offen offset:1024 lds
    v_mfma_f32_16x16x32_bf16 v[148:151], a[188:191], v[68:71], v[148:151]
    s_add_u32 s80, s80, 8192
    v_exp_f32 v253, v113
    v_mfma_f32_16x16x32_bf16 v[156:159], a[176:179], v[72:75], v[208:211]
    ds_read_b64_tr_b16 a[152:153], v15 offset:49152
    ds_read_b64_tr_b16 a[154:155], v15 offset:53248
    v_mfma_f32_16x16x32_bf16 v[156:159], a[180:183], v[76:79], v[156:159]
    v_exp_f32 v254, v114
    v_mfma_f32_16x16x32_bf16 v[156:159], a[184:187], v[80:83], v[156:159]
    v_cvt_pk_bf16_f32 v172, v252, v253
    v_mfma_f32_16x16x32_bf16 v[156:159], a[188:191], v[84:87], v[156:159]
    v_exp_f32 v255, v115
    v_mfma_f32_16x16x32_bf16 v[164:167], a[176:179], v[88:91], v[212:215]
    ds_read_b64_tr_b16 a[156:157], v15 offset:57344
    ds_read_b64_tr_b16 a[158:159], v15 offset:61440
    v_mfma_f32_16x16x32_bf16 v[164:167], a[180:183], v[92:95], v[164:167]
    v_exp_f32 v236, v116
    v_mfma_f32_16x16x32_bf16 v[164:167], a[184:187], v[96:99], v[164:167]
    v_cvt_pk_bf16_f32 v173, v254, v255
    v_mfma_f32_16x16x32_bf16 v[164:167], a[188:191], v[100:103], v[164:167]
    s_waitcnt lgkmcnt(8)
    v_exp_f32 v237, v117
    v_mfma_f32_16x16x32_bf16 a[0:3], a[128:131], v[24:27], a[0:3]
    ds_read_b128 a[160:163], v8 offset:16384
    v_cvt_pk_bf16_f32 v174, v236, v237
    v_mfma_f32_16x16x32_bf16 a[0:3], a[132:135], v[244:247], a[0:3]
    v_exp_f32 v238, v118
    v_mfma_f32_16x16x32_bf16 a[4:7], a[128:131], v[28:31], a[4:7]
    v_exp_f32 v239, v119
    v_mfma_f32_16x16x32_bf16 a[4:7], a[132:135], v[248:251], a[4:7]
    v_exp_f32 v240, v120
    v_mfma_f32_16x16x32_bf16 a[8:11], a[128:131], v[36:39], a[8:11]
    ds_read_b128 a[164:167], v9 offset:16384
    v_cvt_pk_bf16_f32 v175, v238, v239
    v_mfma_f32_16x16x32_bf16 a[8:11], a[132:135], v[232:235], a[8:11]
    s_add_u32 m0, s82, 0
    v_exp_f32 v241, v121
    v_mfma_f32_16x16x32_bf16 a[12:15], a[128:131], v[4:7], a[12:15]
    buffer_load_dwordx4 v20, s[32:35], s80 offen lds
    v_mfma_f32_16x16x32_bf16 a[12:15], a[132:135], v[228:231], a[12:15]
    v_add_f32 v226, v226, v240
    v_add_f32 v227, v227, v241
    v_mfma_f32_16x16x32_bf16 a[16:19], a[136:139], v[24:27], a[16:19]
    ds_read_b128 a[168:171], v10 offset:16384
    v_cvt_pk_bf16_f32 v176, v240, v241
    v_mfma_f32_16x16x32_bf16 a[16:19], a[140:143], v[244:247], a[16:19]
    v_exp_f32 v242, v122
    v_mfma_f32_16x16x32_bf16 a[20:23], a[136:139], v[28:31], a[20:23]
    v_exp_f32 v243, v123
    v_mfma_f32_16x16x32_bf16 a[20:23], a[140:143], v[248:251], a[20:23]
    v_add_f32 v226, v226, v242
    v_add_f32 v227, v227, v243
    v_mfma_f32_16x16x32_bf16 a[24:27], a[136:139], v[36:39], a[24:27]
    ds_read_b128 a[172:175], v11 offset:16384
    v_cvt_pk_bf16_f32 v177, v242, v243
    v_mfma_f32_16x16x32_bf16 a[24:27], a[140:143], v[232:235], a[24:27]
    buffer_load_dwordx4 a[224:227], v33, s[52:55], s86 offen
    v_mfma_f32_16x16x32_bf16 a[28:31], a[136:139], v[4:7], a[28:31]
    s_add_u32 s86, s86, 1024
    v_exp_f32 v252, v124
    v_mfma_f32_16x16x32_bf16 a[28:31], a[140:143], v[228:231], a[28:31]
    s_waitcnt lgkmcnt(4)
    v_exp_f32 v253, v125
    v_mfma_f32_16x16x32_bf16 a[32:35], a[144:147], v[24:27], a[32:35]
    ds_read_b128 a[176:179], v8 offset:20480
    v_add_f32 v226, v226, v252
    v_mfma_f32_16x16x32_bf16 a[32:35], a[148:151], v[244:247], a[32:35]
    v_exp_f32 v254, v126
    v_mfma_f32_16x16x32_bf16 a[36:39], a[144:147], v[28:31], a[36:39]
    v_add_f32 v227, v227, v253
    v_cvt_pk_bf16_f32 v178, v252, v253
    v_mfma_f32_16x16x32_bf16 a[36:39], a[148:151], v[248:251], a[36:39]
    v_exp_f32 v255, v127
    v_mfma_f32_16x16x32_bf16 a[40:43], a[144:147], v[36:39], a[40:43]
    ds_read_b128 a[180:183], v9 offset:20480
    v_add_f32 v226, v226, v254
    v_mfma_f32_16x16x32_bf16 a[40:43], a[148:151], v[232:235], a[40:43]
    v_exp_f32 v236, v128
    v_mfma_f32_16x16x32_bf16 a[44:47], a[144:147], v[4:7], a[44:47]
    buffer_load_dwordx4 v21, s[32:35], s80 offen offset:1024 lds
    v_mfma_f32_16x16x32_bf16 a[44:47], a[148:151], v[228:231], a[44:47]
    s_add_u32 s80, s80, 8192
    v_add_f32 v227, v227, v255
    v_cvt_pk_bf16_f32 v179, v254, v255
    v_mfma_f32_16x16x32_bf16 a[48:51], a[152:155], v[24:27], a[48:51]
    ds_read_b128 a[184:187], v10 offset:20480
    v_mfma_f32_16x16x32_bf16 a[48:51], a[156:159], v[244:247], a[48:51]
    v_exp_f32 v237, v129
    v_mfma_f32_16x16x32_bf16 a[52:55], a[152:155], v[28:31], a[52:55]
    v_exp_f32 v238, v130
    v_mfma_f32_16x16x32_bf16 a[52:55], a[156:159], v[248:251], a[52:55]
    v_cvt_pk_bf16_f32 v180, v236, v237
    v_mfma_f32_16x16x32_bf16 a[56:59], a[152:155], v[36:39], a[56:59]
    ds_read_b128 a[188:191], v11 offset:20480
    v_mfma_f32_16x16x32_bf16 a[56:59], a[156:159], v[232:235], a[56:59]
    v_exp_f32 v239, v131
    v_mfma_f32_16x16x32_bf16 a[60:63], a[152:155], v[4:7], a[60:63]
    v_exp_f32 v240, v132
    v_mfma_f32_16x16x32_bf16 a[60:63], a[156:159], v[228:231], a[60:63]
    s_waitcnt lgkmcnt(4)
    v_cvt_pk_bf16_f32 v181, v238, v239
    v_mfma_f32_16x16x32_bf16 v[216:219], a[252:255], v[28:31], v[216:219]
    v_exp_f32 v241, v133
    v_mfma_f32_16x16x32_bf16 v[216:219], a[252:255], v[248:251], v[216:219]
    v_exp_f32 v242, v134
    v_cvt_pk_bf16_f32 v182, v240, v241
    v_exp_f32 v243, v135
    s_nop 0
    v_cvt_pk_bf16_f32 v183, v242, v243
    v_mfma_f32_16x16x32_bf16 v[104:107], a[160:163], v[40:43], v[200:203]
    ds_read_b64_tr_b16 a[128:129], v16 offset:49152
    ds_read_b64_tr_b16 a[130:131], v16 offset:53248
    v_mfma_f32_16x16x32_bf16 v[104:107], a[164:167], v[44:47], v[104:107]
    v_exp_f32 v236, v136
    v_mfma_f32_16x16x32_bf16 v[104:107], a[168:171], v[48:51], v[104:107]
    v_exp_f32 v237, v137
    v_mfma_f32_16x16x32_bf16 v[104:107], a[172:175], v[52:55], v[104:107]
    v_add_f32 v224, v224, v236
    v_add_f32 v225, v225, v237
    v_mfma_f32_16x16x32_bf16 v[112:115], a[160:163], v[56:59], v[204:207]
    ds_read_b64_tr_b16 a[132:133], v16 offset:57344
    ds_read_b64_tr_b16 a[134:135], v16 offset:61440
    v_mfma_f32_16x16x32_bf16 v[112:115], a[164:167], v[60:63], v[112:115]
    s_add_u32 m0, s82, 98304
    v_exp_f32 v238, v138
    v_mfma_f32_16x16x32_bf16 v[112:115], a[168:171], v[64:67], v[112:115]
    buffer_load_dwordx4 v22, s[36:39], s81 offen lds
    v_mfma_f32_16x16x32_bf16 v[112:115], a[172:175], v[68:71], v[112:115]
    v_cvt_pk_bf16_f32 v184, v236, v237
    v_add_f32 v224, v224, v238
    v_mfma_f32_16x16x32_bf16 v[120:123], a[160:163], v[72:75], v[208:211]
    ds_read_b64_tr_b16 a[136:137], v17 offset:49152
    ds_read_b64_tr_b16 a[138:139], v17 offset:53248
    v_mfma_f32_16x16x32_bf16 v[120:123], a[164:167], v[76:79], v[120:123]
    v_exp_f32 v239, v139
    v_mfma_f32_16x16x32_bf16 v[120:123], a[168:171], v[80:83], v[120:123]
    v_exp_f32 v240, v140
    v_mfma_f32_16x16x32_bf16 v[120:123], a[172:175], v[84:87], v[120:123]
    v_add_f32 v225, v225, v239
    v_cvt_pk_bf16_f32 v185, v238, v239
    v_mfma_f32_16x16x32_bf16 v[128:131], a[160:163], v[88:91], v[212:215]
    ds_read_b64_tr_b16 a[140:141], v17 offset:57344
    ds_read_b64_tr_b16 a[142:143], v17 offset:61440
    v_mfma_f32_16x16x32_bf16 v[128:131], a[164:167], v[92:95], v[128:131]
    v_exp_f32 v241, v141
    v_mfma_f32_16x16x32_bf16 v[128:131], a[168:171], v[96:99], v[128:131]
    v_add_f32 v224, v224, v240
    v_add_f32 v225, v225, v241
    v_mfma_f32_16x16x32_bf16 v[128:131], a[172:175], v[100:103], v[128:131]
    s_waitcnt lgkmcnt(8)
    v_exp_f32 v242, v142
    v_mfma_f32_16x16x32_bf16 v[108:111], a[176:179], v[40:43], v[200:203]
    ds_read_b64_tr_b16 a[144:145], v18 offset:49152
    ds_read_b64_tr_b16 a[146:147], v18 offset:53248
    v_mfma_f32_16x16x32_bf16 v[108:111], a[180:183], v[44:47], v[108:111]
    v_cvt_pk_bf16_f32 v186, v240, v241
    v_add_f32 v224, v224, v242
    v_mfma_f32_16x16x32_bf16 v[108:111], a[184:187], v[48:51], v[108:111]
    v_exp_f32 v243, v143
    v_mfma_f32_16x16x32_bf16 v[108:111], a[188:191], v[52:55], v[108:111]
    v_exp_f32 v252, v144
    v_mfma_f32_16x16x32_bf16 v[116:119], a[176:179], v[56:59], v[204:207]
    ds_read_b64_tr_b16 a[148:149], v18 offset:57344
    ds_read_b64_tr_b16 a[150:151], v18 offset:61440
    v_mfma_f32_16x16x32_bf16 v[116:119], a[180:183], v[60:63], v[116:119]
    v_add_f32 v225, v225, v243
    v_cvt_pk_bf16_f32 v187, v242, v243
    v_mfma_f32_16x16x32_bf16 v[116:119], a[184:187], v[64:67], v[116:119]
    buffer_load_dwordx4 v23, s[36:39], s81 offen offset:1024 lds
    v_mfma_f32_16x16x32_bf16 v[116:119], a[188:191], v[68:71], v[116:119]
    s_add_u32 s81, s81, 8192
    v_exp_f32 v253, v145
    v_mfma_f32_16x16x32_bf16 v[124:127], a[176:179], v[72:75], v[208:211]
    ds_read_b64_tr_b16 a[152:153], v19 offset:49152
    ds_read_b64_tr_b16 a[154:155], v19 offset:53248
    v_mfma_f32_16x16x32_bf16 v[124:127], a[180:183], v[76:79], v[124:127]
    v_exp_f32 v254, v146
    v_mfma_f32_16x16x32_bf16 v[124:127], a[184:187], v[80:83], v[124:127]
    v_cvt_pk_bf16_f32 v188, v252, v253
    v_mfma_f32_16x16x32_bf16 v[124:127], a[188:191], v[84:87], v[124:127]
    v_exp_f32 v255, v147
    v_mfma_f32_16x16x32_bf16 v[132:135], a[176:179], v[88:91], v[212:215]
    ds_read_b64_tr_b16 a[156:157], v19 offset:57344
    ds_read_b64_tr_b16 a[158:159], v19 offset:61440
    v_mfma_f32_16x16x32_bf16 v[132:135], a[180:183], v[92:95], v[132:135]
    v_exp_f32 v236, v148
    v_mfma_f32_16x16x32_bf16 v[132:135], a[184:187], v[96:99], v[132:135]
    v_cvt_pk_bf16_f32 v189, v254, v255
    v_mfma_f32_16x16x32_bf16 v[132:135], a[188:191], v[100:103], v[132:135]
    s_waitcnt lgkmcnt(8)
    v_exp_f32 v237, v149
    v_mfma_f32_16x16x32_bf16 a[64:67], a[128:131], v[24:27], a[64:67]
    ds_read_b128 a[160:163], v8 offset:24576
    v_cvt_pk_bf16_f32 v190, v236, v237
    v_mfma_f32_16x16x32_bf16 a[64:67], a[132:135], v[244:247], a[64:67]
    v_exp_f32 v238, v150
    v_mfma_f32_16x16x32_bf16 a[68:71], a[128:131], v[28:31], a[68:71]
    v_exp_f32 v239, v151
    v_mfma_f32_16x16x32_bf16 a[68:71], a[132:135], v[248:251], a[68:71]
    v_exp_f32 v240, v152
    v_mfma_f32_16x16x32_bf16 a[72:75], a[128:131], v[36:39], a[72:75]
    ds_read_b128 a[164:167], v9 offset:24576
    v_cvt_pk_bf16_f32 v191, v238, v239
    v_mfma_f32_16x16x32_bf16 a[72:75], a[132:135], v[232:235], a[72:75]
    s_add_u32 m0, s82, 106496
    v_exp_f32 v241, v153
    v_mfma_f32_16x16x32_bf16 a[76:79], a[128:131], v[4:7], a[76:79]
    buffer_load_dwordx4 v22, s[36:39], s81 offen lds
    v_mfma_f32_16x16x32_bf16 a[76:79], a[132:135], v[228:231], a[76:79]
    v_add_f32 v226, v226, v240
    v_add_f32 v227, v227, v241
    v_mfma_f32_16x16x32_bf16 a[80:83], a[136:139], v[24:27], a[80:83]
    ds_read_b128 a[168:171], v10 offset:24576
    v_cvt_pk_bf16_f32 v192, v240, v241
    v_mfma_f32_16x16x32_bf16 a[80:83], a[140:143], v[244:247], a[80:83]
    v_exp_f32 v242, v154
    v_mfma_f32_16x16x32_bf16 a[84:87], a[136:139], v[28:31], a[84:87]
    v_exp_f32 v243, v155
    v_mfma_f32_16x16x32_bf16 a[84:87], a[140:143], v[248:251], a[84:87]
    v_add_f32 v226, v226, v242
    v_add_f32 v227, v227, v243
    v_mfma_f32_16x16x32_bf16 a[88:91], a[136:139], v[36:39], a[88:91]
    ds_read_b128 a[172:175], v11 offset:24576
    v_cvt_pk_bf16_f32 v193, v242, v243
    v_mfma_f32_16x16x32_bf16 a[88:91], a[140:143], v[232:235], a[88:91]
    v_exp_f32 v252, v156
    v_mfma_f32_16x16x32_bf16 a[92:95], a[136:139], v[4:7], a[92:95]
    v_exp_f32 v253, v157
    v_mfma_f32_16x16x32_bf16 a[92:95], a[140:143], v[228:231], a[92:95]
    s_waitcnt lgkmcnt(4)
    v_add_f32 v226, v226, v252
    v_add_f32 v227, v227, v253
    v_mfma_f32_16x16x32_bf16 a[96:99], a[144:147], v[24:27], a[96:99]
    ds_read_b128 a[176:179], v8 offset:28672
    v_cvt_pk_bf16_f32 v194, v252, v253
    v_mfma_f32_16x16x32_bf16 a[96:99], a[148:151], v[244:247], a[96:99]
    v_exp_f32 v254, v158
    v_mfma_f32_16x16x32_bf16 a[100:103], a[144:147], v[28:31], a[100:103]
    v_exp_f32 v255, v159
    v_mfma_f32_16x16x32_bf16 a[100:103], a[148:151], v[248:251], a[100:103]
    v_add_f32 v226, v226, v254
    v_add_f32 v227, v227, v255
    v_mfma_f32_16x16x32_bf16 a[104:107], a[144:147], v[36:39], a[104:107]
    ds_read_b128 a[180:183], v9 offset:28672
    v_cvt_pk_bf16_f32 v195, v254, v255
    v_mfma_f32_16x16x32_bf16 a[104:107], a[148:151], v[232:235], a[104:107]
    v_exp_f32 v236, v160
    v_mfma_f32_16x16x32_bf16 a[108:111], a[144:147], v[4:7], a[108:111]
    buffer_load_dwordx4 v23, s[36:39], s81 offen offset:1024 lds
    v_mfma_f32_16x16x32_bf16 a[108:111], a[148:151], v[228:231], a[108:111]
    s_add_u32 s81, s81, 8192
    v_exp_f32 v237, v161
    v_mfma_f32_16x16x32_bf16 a[112:115], a[152:155], v[24:27], a[112:115]
    ds_read_b128 a[184:187], v10 offset:28672
    v_cvt_pk_bf16_f32 v196, v236, v237
    v_mfma_f32_16x16x32_bf16 a[112:115], a[156:159], v[244:247], a[112:115]
    v_exp_f32 v238, v162
    v_mfma_f32_16x16x32_bf16 a[116:119], a[152:155], v[28:31], a[116:119]
    v_exp_f32 v239, v163
    v_mfma_f32_16x16x32_bf16 a[116:119], a[156:159], v[248:251], a[116:119]
    v_exp_f32 v240, v164
    v_mfma_f32_16x16x32_bf16 a[120:123], a[152:155], v[36:39], a[120:123]
    ds_read_b128 a[188:191], v11 offset:28672
    v_cvt_pk_bf16_f32 v197, v238, v239
    v_mfma_f32_16x16x32_bf16 a[120:123], a[156:159], v[232:235], a[120:123]
    v_exp_f32 v241, v165
    v_mfma_f32_16x16x32_bf16 a[124:127], a[152:155], v[4:7], a[124:127]
    v_exp_f32 v242, v166
    v_mfma_f32_16x16x32_bf16 a[124:127], a[156:159], v[228:231], a[124:127]
    s_waitcnt lgkmcnt(4)
    v_cvt_pk_bf16_f32 v198, v240, v241
    v_mfma_f32_16x16x32_bf16 v[220:223], a[252:255], v[4:7], v[220:223]
    s_waitcnt vmcnt(12)
    v_exp_f32 v243, v167
    v_mfma_f32_16x16x32_bf16 v[220:223], a[252:255], v[228:231], v[220:223]
    s_barrier
    v_cvt_pk_bf16_f32 v199, v242, v243
    v_mfma_f32_16x16x32_bf16 v[136:139], a[160:163], v[40:43], v[200:203]
    ds_read_b64_tr_b16 a[128:129], v12 offset:0
    ds_read_b64_tr_b16 a[130:131], v12 offset:4096
    v_mfma_f32_16x16x32_bf16 v[136:139], a[164:167], v[44:47], v[136:139]
    v_exp_f32 v236, v104
    v_mfma_f32_16x16x32_bf16 v[136:139], a[168:171], v[48:51], v[136:139]
    v_exp_f32 v237, v105
    v_mfma_f32_16x16x32_bf16 v[136:139], a[172:175], v[52:55], v[136:139]
    v_add_f32 v224, v224, v236
    v_add_f32 v225, v225, v237
    v_mfma_f32_16x16x32_bf16 v[144:147], a[160:163], v[56:59], v[204:207]
    ds_read_b64_tr_b16 a[132:133], v12 offset:8192
    ds_read_b64_tr_b16 a[134:135], v12 offset:12288
    v_mfma_f32_16x16x32_bf16 v[144:147], a[164:167], v[60:63], v[144:147]
    s_add_u32 m0, s82, 8192
    v_exp_f32 v238, v106
    v_mfma_f32_16x16x32_bf16 v[144:147], a[168:171], v[64:67], v[144:147]
    buffer_load_dwordx4 v20, s[32:35], s80 offen lds
    v_mfma_f32_16x16x32_bf16 v[144:147], a[172:175], v[68:71], v[144:147]
    v_cvt_pk_bf16_f32 v24, v236, v237
    v_add_f32 v224, v224, v238
    v_mfma_f32_16x16x32_bf16 v[152:155], a[160:163], v[72:75], v[208:211]
    ds_read_b64_tr_b16 a[136:137], v13 offset:0
    ds_read_b64_tr_b16 a[138:139], v13 offset:4096
    v_mfma_f32_16x16x32_bf16 v[152:155], a[164:167], v[76:79], v[152:155]
    v_exp_f32 v239, v107
    v_mfma_f32_16x16x32_bf16 v[152:155], a[168:171], v[80:83], v[152:155]
    v_exp_f32 v240, v108
    v_mfma_f32_16x16x32_bf16 v[152:155], a[172:175], v[84:87], v[152:155]
    v_add_f32 v225, v225, v239
    v_cvt_pk_bf16_f32 v25, v238, v239
    v_mfma_f32_16x16x32_bf16 v[160:163], a[160:163], v[88:91], v[212:215]
    ds_read_b64_tr_b16 a[140:141], v13 offset:8192
    ds_read_b64_tr_b16 a[142:143], v13 offset:12288
    v_mfma_f32_16x16x32_bf16 v[160:163], a[164:167], v[92:95], v[160:163]
    v_exp_f32 v241, v109
    v_mfma_f32_16x16x32_bf16 v[160:163], a[168:171], v[96:99], v[160:163]
    v_add_f32 v224, v224, v240
    v_add_f32 v225, v225, v241
    v_mfma_f32_16x16x32_bf16 v[160:163], a[172:175], v[100:103], v[160:163]
    s_waitcnt lgkmcnt(8)
    v_exp_f32 v242, v110
    v_mfma_f32_16x16x32_bf16 v[140:143], a[176:179], v[40:43], v[200:203]
    ds_read_b64_tr_b16 a[144:145], v14 offset:0
    ds_read_b64_tr_b16 a[146:147], v14 offset:4096
    v_mfma_f32_16x16x32_bf16 v[140:143], a[180:183], v[44:47], v[140:143]
    v_cvt_pk_bf16_f32 v26, v240, v241
    v_add_f32 v224, v224, v242
    v_mfma_f32_16x16x32_bf16 v[140:143], a[184:187], v[48:51], v[140:143]
    v_exp_f32 v243, v111
    v_mfma_f32_16x16x32_bf16 v[140:143], a[188:191], v[52:55], v[140:143]
    v_exp_f32 v252, v112
    v_mfma_f32_16x16x32_bf16 v[148:151], a[176:179], v[56:59], v[204:207]
    ds_read_b64_tr_b16 a[148:149], v14 offset:8192
    ds_read_b64_tr_b16 a[150:151], v14 offset:12288
    v_mfma_f32_16x16x32_bf16 v[148:151], a[180:183], v[60:63], v[148:151]
    v_add_f32 v225, v225, v243
    v_cvt_pk_bf16_f32 v27, v242, v243
    v_mfma_f32_16x16x32_bf16 v[148:151], a[184:187], v[64:67], v[148:151]
    buffer_load_dwordx4 v21, s[32:35], s80 offen offset:1024 lds
    v_mfma_f32_16x16x32_bf16 v[148:151], a[188:191], v[68:71], v[148:151]
    s_add_u32 s80, s80, 8192
    v_exp_f32 v253, v113
    v_mfma_f32_16x16x32_bf16 v[156:159], a[176:179], v[72:75], v[208:211]
    ds_read_b64_tr_b16 a[152:153], v15 offset:0
    ds_read_b64_tr_b16 a[154:155], v15 offset:4096
    v_mfma_f32_16x16x32_bf16 v[156:159], a[180:183], v[76:79], v[156:159]
    v_exp_f32 v254, v114
    v_mfma_f32_16x16x32_bf16 v[156:159], a[184:187], v[80:83], v[156:159]
    v_cvt_pk_bf16_f32 v28, v252, v253
    v_mfma_f32_16x16x32_bf16 v[156:159], a[188:191], v[84:87], v[156:159]
    v_exp_f32 v255, v115
    v_mfma_f32_16x16x32_bf16 v[164:167], a[176:179], v[88:91], v[212:215]
    ds_read_b64_tr_b16 a[156:157], v15 offset:8192
    ds_read_b64_tr_b16 a[158:159], v15 offset:12288
    v_mfma_f32_16x16x32_bf16 v[164:167], a[180:183], v[92:95], v[164:167]
    v_exp_f32 v236, v116
    v_mfma_f32_16x16x32_bf16 v[164:167], a[184:187], v[96:99], v[164:167]
    v_cvt_pk_bf16_f32 v29, v254, v255
    v_mfma_f32_16x16x32_bf16 v[164:167], a[188:191], v[100:103], v[164:167]
    s_waitcnt lgkmcnt(8)
    v_exp_f32 v237, v117
    v_mfma_f32_16x16x32_bf16 a[0:3], a[128:131], v[168:171], a[0:3]
    ds_read_b128 a[160:163], v8 offset:32768
    v_cvt_pk_bf16_f32 v30, v236, v237
    v_mfma_f32_16x16x32_bf16 a[0:3], a[132:135], v[184:187], a[0:3]
    v_exp_f32 v238, v118
    v_mfma_f32_16x16x32_bf16 a[4:7], a[128:131], v[172:175], a[4:7]
    v_exp_f32 v239, v119
    v_mfma_f32_16x16x32_bf16 a[4:7], a[132:135], v[188:191], a[4:7]
    v_exp_f32 v240, v120
    v_mfma_f32_16x16x32_bf16 a[8:11], a[128:131], v[176:179], a[8:11]
    ds_read_b128 a[164:167], v9 offset:32768
    v_cvt_pk_bf16_f32 v31, v238, v239
    v_mfma_f32_16x16x32_bf16 a[8:11], a[132:135], v[192:195], a[8:11]
    s_add_u32 m0, s82, 16384
    v_exp_f32 v241, v121
    v_mfma_f32_16x16x32_bf16 a[12:15], a[128:131], v[180:183], a[12:15]
    buffer_load_dwordx4 v20, s[32:35], s80 offen lds
    v_mfma_f32_16x16x32_bf16 a[12:15], a[132:135], v[196:199], a[12:15]
    v_add_f32 v226, v226, v240
    v_add_f32 v227, v227, v241
    v_mfma_f32_16x16x32_bf16 a[16:19], a[136:139], v[168:171], a[16:19]
    ds_read_b128 a[168:171], v10 offset:32768
    v_cvt_pk_bf16_f32 v36, v240, v241
    v_mfma_f32_16x16x32_bf16 a[16:19], a[140:143], v[184:187], a[16:19]
    v_exp_f32 v242, v122
    v_mfma_f32_16x16x32_bf16 a[20:23], a[136:139], v[172:175], a[20:23]
    v_exp_f32 v243, v123
    v_mfma_f32_16x16x32_bf16 a[20:23], a[140:143], v[188:191], a[20:23]
    v_add_f32 v226, v226, v242
    v_add_f32 v227, v227, v243
    v_mfma_f32_16x16x32_bf16 a[24:27], a[136:139], v[176:179], a[24:27]
    ds_read_b128 a[172:175], v11 offset:32768
    v_cvt_pk_bf16_f32 v37, v242, v243
    v_mfma_f32_16x16x32_bf16 a[24:27], a[140:143], v[192:195], a[24:27]
    v_exp_f32 v252, v124
    v_mfma_f32_16x16x32_bf16 a[28:31], a[136:139], v[180:183], a[28:31]
    v_exp_f32 v253, v125
    v_mfma_f32_16x16x32_bf16 a[28:31], a[140:143], v[196:199], a[28:31]
    s_waitcnt lgkmcnt(4)
    v_add_f32 v226, v226, v252
    v_add_f32 v227, v227, v253
    v_mfma_f32_16x16x32_bf16 a[32:35], a[144:147], v[168:171], a[32:35]
    ds_read_b128 a[176:179], v8 offset:36864
    v_cvt_pk_bf16_f32 v38, v252, v253
    v_mfma_f32_16x16x32_bf16 a[32:35], a[148:151], v[184:187], a[32:35]
    v_exp_f32 v254, v126
    v_mfma_f32_16x16x32_bf16 a[36:39], a[144:147], v[172:175], a[36:39]
    v_exp_f32 v255, v127
    v_mfma_f32_16x16x32_bf16 a[36:39], a[148:151], v[188:191], a[36:39]
    v_add_f32 v226, v226, v254
    v_add_f32 v227, v227, v255
    v_mfma_f32_16x16x32_bf16 a[40:43], a[144:147], v[176:179], a[40:43]
    ds_read_b128 a[180:183], v9 offset:36864
    v_cvt_pk_bf16_f32 v39, v254, v255
    v_mfma_f32_16x16x32_bf16 a[40:43], a[148:151], v[192:195], a[40:43]
    v_exp_f32 v236, v128
    v_mfma_f32_16x16x32_bf16 a[44:47], a[144:147], v[180:183], a[44:47]
    buffer_load_dwordx4 v21, s[32:35], s80 offen offset:1024 lds
    v_mfma_f32_16x16x32_bf16 a[44:47], a[148:151], v[196:199], a[44:47]
    s_add_u32 s80, s80, 8192
    v_exp_f32 v237, v129
    v_mfma_f32_16x16x32_bf16 a[48:51], a[152:155], v[168:171], a[48:51]
    ds_read_b128 a[184:187], v10 offset:36864
    v_cvt_pk_bf16_f32 v4, v236, v237
    v_mfma_f32_16x16x32_bf16 a[48:51], a[156:159], v[184:187], a[48:51]
    v_exp_f32 v238, v130
    v_mfma_f32_16x16x32_bf16 a[52:55], a[152:155], v[172:175], a[52:55]
    v_exp_f32 v239, v131
    v_mfma_f32_16x16x32_bf16 a[52:55], a[156:159], v[188:191], a[52:55]
    v_exp_f32 v240, v132
    v_mfma_f32_16x16x32_bf16 a[56:59], a[152:155], v[176:179], a[56:59]
    ds_read_b128 a[188:191], v11 offset:36864
    v_cvt_pk_bf16_f32 v5, v238, v239
    v_mfma_f32_16x16x32_bf16 a[56:59], a[156:159], v[192:195], a[56:59]
    v_exp_f32 v241, v133
    v_mfma_f32_16x16x32_bf16 a[60:63], a[152:155], v[180:183], a[60:63]
    v_exp_f32 v242, v134
    v_mfma_f32_16x16x32_bf16 a[60:63], a[156:159], v[196:199], a[60:63]
    s_waitcnt lgkmcnt(4)
    v_cvt_pk_bf16_f32 v6, v240, v241
    v_mfma_f32_16x16x32_bf16 v[216:219], a[252:255], v[172:175], v[216:219]
    v_exp_f32 v243, v135
    v_mfma_f32_16x16x32_bf16 v[216:219], a[252:255], v[188:191], v[216:219]
    v_cvt_pk_bf16_f32 v7, v242, v243
    v_mfma_f32_16x16x32_bf16 v[104:107], a[160:163], v[40:43], v[200:203]
    ds_read_b64_tr_b16 a[128:129], v16 offset:0
    ds_read_b64_tr_b16 a[130:131], v16 offset:4096
    v_mfma_f32_16x16x32_bf16 v[104:107], a[164:167], v[44:47], v[104:107]
    v_exp_f32 v236, v136
    v_mfma_f32_16x16x32_bf16 v[104:107], a[168:171], v[48:51], v[104:107]
    v_exp_f32 v237, v137
    v_mfma_f32_16x16x32_bf16 v[104:107], a[172:175], v[52:55], v[104:107]
    v_add_f32 v224, v224, v236
    v_add_f32 v225, v225, v237
    v_mfma_f32_16x16x32_bf16 v[112:115], a[160:163], v[56:59], v[204:207]
    ds_read_b64_tr_b16 a[132:133], v16 offset:8192
    ds_read_b64_tr_b16 a[134:135], v16 offset:12288
    v_mfma_f32_16x16x32_bf16 v[112:115], a[164:167], v[60:63], v[112:115]
    s_add_u32 m0, s82, 114688
    v_exp_f32 v238, v138
    v_mfma_f32_16x16x32_bf16 v[112:115], a[168:171], v[64:67], v[112:115]
    buffer_load_dwordx4 v22, s[36:39], s81 offen lds
    v_mfma_f32_16x16x32_bf16 v[112:115], a[172:175], v[68:71], v[112:115]
    v_cvt_pk_bf16_f32 v244, v236, v237
    v_add_f32 v224, v224, v238
    v_mfma_f32_16x16x32_bf16 v[120:123], a[160:163], v[72:75], v[208:211]
    ds_read_b64_tr_b16 a[136:137], v17 offset:0
    ds_read_b64_tr_b16 a[138:139], v17 offset:4096
    v_mfma_f32_16x16x32_bf16 v[120:123], a[164:167], v[76:79], v[120:123]
    v_exp_f32 v239, v139
    v_mfma_f32_16x16x32_bf16 v[120:123], a[168:171], v[80:83], v[120:123]
    v_exp_f32 v240, v140
    v_mfma_f32_16x16x32_bf16 v[120:123], a[172:175], v[84:87], v[120:123]
    v_add_f32 v225, v225, v239
    v_cvt_pk_bf16_f32 v245, v238, v239
    v_mfma_f32_16x16x32_bf16 v[128:131], a[160:163], v[88:91], v[212:215]
    ds_read_b64_tr_b16 a[140:141], v17 offset:8192
    ds_read_b64_tr_b16 a[142:143], v17 offset:12288
    v_mfma_f32_16x16x32_bf16 v[128:131], a[164:167], v[92:95], v[128:131]
    v_exp_f32 v241, v141
    v_mfma_f32_16x16x32_bf16 v[128:131], a[168:171], v[96:99], v[128:131]
    v_add_f32 v224, v224, v240
    v_add_f32 v225, v225, v241
    v_mfma_f32_16x16x32_bf16 v[128:131], a[172:175], v[100:103], v[128:131]
    s_waitcnt lgkmcnt(8)
    v_exp_f32 v242, v142
    v_mfma_f32_16x16x32_bf16 v[108:111], a[176:179], v[40:43], v[200:203]
    ds_read_b64_tr_b16 a[144:145], v18 offset:0
    ds_read_b64_tr_b16 a[146:147], v18 offset:4096
    v_mfma_f32_16x16x32_bf16 v[108:111], a[180:183], v[44:47], v[108:111]
    v_cvt_pk_bf16_f32 v246, v240, v241
    v_add_f32 v224, v224, v242
    v_mfma_f32_16x16x32_bf16 v[108:111], a[184:187], v[48:51], v[108:111]
    v_exp_f32 v243, v143
    v_mfma_f32_16x16x32_bf16 v[108:111], a[188:191], v[52:55], v[108:111]
    v_exp_f32 v252, v144
    v_mfma_f32_16x16x32_bf16 v[116:119], a[176:179], v[56:59], v[204:207]
    ds_read_b64_tr_b16 a[148:149], v18 offset:8192
    ds_read_b64_tr_b16 a[150:151], v18 offset:12288
    v_mfma_f32_16x16x32_bf16 v[116:119], a[180:183], v[60:63], v[116:119]
    v_add_f32 v225, v225, v243
    v_cvt_pk_bf16_f32 v247, v242, v243
    v_mfma_f32_16x16x32_bf16 v[116:119], a[184:187], v[64:67], v[116:119]
    buffer_load_dwordx4 v23, s[36:39], s81 offen offset:1024 lds
    v_mfma_f32_16x16x32_bf16 v[116:119], a[188:191], v[68:71], v[116:119]
    s_add_u32 s81, s81, 8192
    v_exp_f32 v253, v145
    v_mfma_f32_16x16x32_bf16 v[124:127], a[176:179], v[72:75], v[208:211]
    ds_read_b64_tr_b16 a[152:153], v19 offset:0
    ds_read_b64_tr_b16 a[154:155], v19 offset:4096
    v_mfma_f32_16x16x32_bf16 v[124:127], a[180:183], v[76:79], v[124:127]
    v_exp_f32 v254, v146
    v_mfma_f32_16x16x32_bf16 v[124:127], a[184:187], v[80:83], v[124:127]
    v_cvt_pk_bf16_f32 v248, v252, v253
    v_mfma_f32_16x16x32_bf16 v[124:127], a[188:191], v[84:87], v[124:127]
    v_exp_f32 v255, v147
    v_mfma_f32_16x16x32_bf16 v[132:135], a[176:179], v[88:91], v[212:215]
    ds_read_b64_tr_b16 a[156:157], v19 offset:8192
    ds_read_b64_tr_b16 a[158:159], v19 offset:12288
    v_mfma_f32_16x16x32_bf16 v[132:135], a[180:183], v[92:95], v[132:135]
    v_exp_f32 v236, v148
    v_mfma_f32_16x16x32_bf16 v[132:135], a[184:187], v[96:99], v[132:135]
    v_cvt_pk_bf16_f32 v249, v254, v255
    v_mfma_f32_16x16x32_bf16 v[132:135], a[188:191], v[100:103], v[132:135]
    s_waitcnt lgkmcnt(8)
    v_exp_f32 v237, v149
    v_mfma_f32_16x16x32_bf16 a[64:67], a[128:131], v[168:171], a[64:67]
    ds_read_b128 a[160:163], v8 offset:40960
    v_cvt_pk_bf16_f32 v250, v236, v237
    v_mfma_f32_16x16x32_bf16 a[64:67], a[132:135], v[184:187], a[64:67]
    v_exp_f32 v238, v150
    v_mfma_f32_16x16x32_bf16 a[68:71], a[128:131], v[172:175], a[68:71]
    v_exp_f32 v239, v151
    v_mfma_f32_16x16x32_bf16 a[68:71], a[132:135], v[188:191], a[68:71]
    v_exp_f32 v240, v152
    v_mfma_f32_16x16x32_bf16 a[72:75], a[128:131], v[176:179], a[72:75]
    ds_read_b128 a[164:167], v9 offset:40960
    v_cvt_pk_bf16_f32 v251, v238, v239
    v_mfma_f32_16x16x32_bf16 a[72:75], a[132:135], v[192:195], a[72:75]
    s_add_u32 m0, s82, 122880
    v_exp_f32 v241, v153
    v_mfma_f32_16x16x32_bf16 a[76:79], a[128:131], v[180:183], a[76:79]
    buffer_load_dwordx4 v22, s[36:39], s81 offen lds
    v_mfma_f32_16x16x32_bf16 a[76:79], a[132:135], v[196:199], a[76:79]
    v_add_f32 v226, v226, v240
    v_add_f32 v227, v227, v241
    v_mfma_f32_16x16x32_bf16 a[80:83], a[136:139], v[168:171], a[80:83]
    ds_read_b128 a[168:171], v10 offset:40960
    v_cvt_pk_bf16_f32 v232, v240, v241
    v_mfma_f32_16x16x32_bf16 a[80:83], a[140:143], v[184:187], a[80:83]
    v_exp_f32 v242, v154
    v_mfma_f32_16x16x32_bf16 a[84:87], a[136:139], v[172:175], a[84:87]
    v_exp_f32 v243, v155
    v_mfma_f32_16x16x32_bf16 a[84:87], a[140:143], v[188:191], a[84:87]
    v_add_f32 v226, v226, v242
    v_add_f32 v227, v227, v243
    v_mfma_f32_16x16x32_bf16 a[88:91], a[136:139], v[176:179], a[88:91]
    ds_read_b128 a[172:175], v11 offset:40960
    v_cvt_pk_bf16_f32 v233, v242, v243
    v_mfma_f32_16x16x32_bf16 a[88:91], a[140:143], v[192:195], a[88:91]
    v_exp_f32 v252, v156
    v_mfma_f32_16x16x32_bf16 a[92:95], a[136:139], v[180:183], a[92:95]
    v_exp_f32 v253, v157
    v_mfma_f32_16x16x32_bf16 a[92:95], a[140:143], v[196:199], a[92:95]
    s_waitcnt lgkmcnt(4)
    v_add_f32 v226, v226, v252
    v_add_f32 v227, v227, v253
    v_mfma_f32_16x16x32_bf16 a[96:99], a[144:147], v[168:171], a[96:99]
    ds_read_b128 a[176:179], v8 offset:45056
    v_cvt_pk_bf16_f32 v234, v252, v253
    v_mfma_f32_16x16x32_bf16 a[96:99], a[148:151], v[184:187], a[96:99]
    v_exp_f32 v254, v158
    v_mfma_f32_16x16x32_bf16 a[100:103], a[144:147], v[172:175], a[100:103]
    v_exp_f32 v255, v159
    v_mfma_f32_16x16x32_bf16 a[100:103], a[148:151], v[188:191], a[100:103]
    v_add_f32 v226, v226, v254
    v_add_f32 v227, v227, v255
    v_mfma_f32_16x16x32_bf16 a[104:107], a[144:147], v[176:179], a[104:107]
    ds_read_b128 a[180:183], v9 offset:45056
    v_cvt_pk_bf16_f32 v235, v254, v255
    v_mfma_f32_16x16x32_bf16 a[104:107], a[148:151], v[192:195], a[104:107]
    v_exp_f32 v236, v160
    v_mfma_f32_16x16x32_bf16 a[108:111], a[144:147], v[180:183], a[108:111]
    buffer_load_dwordx4 v23, s[36:39], s81 offen offset:1024 lds
    v_mfma_f32_16x16x32_bf16 a[108:111], a[148:151], v[196:199], a[108:111]
    s_add_u32 s81, s81, 8192
    v_exp_f32 v237, v161
    v_mfma_f32_16x16x32_bf16 a[112:115], a[152:155], v[168:171], a[112:115]
    ds_read_b128 a[184:187], v10 offset:45056
    v_cvt_pk_bf16_f32 v228, v236, v237
    v_mfma_f32_16x16x32_bf16 a[112:115], a[156:159], v[184:187], a[112:115]
    v_exp_f32 v238, v162
    v_mfma_f32_16x16x32_bf16 a[116:119], a[152:155], v[172:175], a[116:119]
    v_exp_f32 v239, v163
    v_mfma_f32_16x16x32_bf16 a[116:119], a[156:159], v[188:191], a[116:119]
    v_exp_f32 v240, v164
    v_mfma_f32_16x16x32_bf16 a[120:123], a[152:155], v[176:179], a[120:123]
    ds_read_b128 a[188:191], v11 offset:45056
    v_cvt_pk_bf16_f32 v229, v238, v239
    v_mfma_f32_16x16x32_bf16 a[120:123], a[156:159], v[192:195], a[120:123]
    s_add_u32 s84, s84, 1
    v_exp_f32 v241, v165
    v_mfma_f32_16x16x32_bf16 a[124:127], a[152:155], v[180:183], a[124:127]
    s_cmp_lt_u32 s84, 7
    v_exp_f32 v242, v166
    v_mfma_f32_16x16x32_bf16 a[124:127], a[156:159], v[196:199], a[124:127]
    s_waitcnt lgkmcnt(4)
    v_cvt_pk_bf16_f32 v230, v240, v241
    v_mfma_f32_16x16x32_bf16 v[220:223], a[252:255], v[180:183], v[220:223]
    s_waitcnt vmcnt(12)
    v_exp_f32 v243, v167
    v_mfma_f32_16x16x32_bf16 v[220:223], a[252:255], v[196:199], v[220:223]
    s_barrier
    v_cvt_pk_bf16_f32 v231, v242, v243
    s_cbranch_scc1 F_LOOP
    v_mfma_f32_16x16x32_bf16 v[136:139], a[160:163], v[40:43], v[200:203]
    s_lshr_b32 s86, s2, 3
    ds_read_b64_tr_b16 a[128:129], v12 offset:16384
    ds_read_b64_tr_b16 a[130:131], v12 offset:20480
    v_mfma_f32_16x16x32_bf16 v[136:139], a[164:167], v[44:47], v[136:139]
    s_mul_i32 s86, s86, 24576
    v_exp_f32 v236, v104
    s_nop 0
    v_add_f32 v224, v224, v236
    v_mfma_f32_16x16x32_bf16 v[136:139], a[168:171], v[48:51], v[136:139]
    s_mul_i32 s3, s76, 6144
    v_exp_f32 v237, v105
    s_nop 0
    v_add_f32 v225, v225, v237
    v_mfma_f32_16x16x32_bf16 v[136:139], a[172:175], v[52:55], v[136:139]
    s_add_u32 s86, s86, s3
    v_exp_f32 v238, v106
    v_mfma_f32_16x16x32_bf16 v[144:147], a[160:163], v[56:59], v[204:207]
    s_add_u32 s86, s86, 327680
    ds_read_b64_tr_b16 a[132:133], v12 offset:24576
    ds_read_b64_tr_b16 a[134:135], v12 offset:28672
    v_mfma_f32_16x16x32_bf16 v[144:147], a[164:167], v[60:63], v[144:147]
    s_add_u32 m0, s82, 24576
    v_cvt_pk_bf16_f32 v168, v236, v237
    v_add_f32 v224, v224, v238
    v_mfma_f32_16x16x32_bf16 v[144:147], a[168:171], v[64:67], v[144:147]
    buffer_load_dwordx4 v32, s[52:55], s85 offen lds
    v_mfma_f32_16x16x32_bf16 v[144:147], a[172:175], v[68:71], v[144:147]
    v_exp_f32 v239, v107
    v_mfma_f32_16x16x32_bf16 v[152:155], a[160:163], v[72:75], v[208:211]
    ds_read_b64_tr_b16 a[136:137], v13 offset:16384
    ds_read_b64_tr_b16 a[138:139], v13 offset:20480
    v_add_f32 v225, v225, v239
    v_mfma_f32_16x16x32_bf16 v[152:155], a[164:167], v[76:79], v[152:155]
    v_exp_f32 v240, v108
    v_mfma_f32_16x16x32_bf16 v[152:155], a[168:171], v[80:83], v[152:155]
    v_cvt_pk_bf16_f32 v169, v238, v239
    v_add_f32 v224, v224, v240
    v_mfma_f32_16x16x32_bf16 v[152:155], a[172:175], v[84:87], v[152:155]
    v_exp_f32 v241, v109
    v_mfma_f32_16x16x32_bf16 v[160:163], a[160:163], v[88:91], v[212:215]
    ds_read_b64_tr_b16 a[140:141], v13 offset:24576
    ds_read_b64_tr_b16 a[142:143], v13 offset:28672
    v_mfma_f32_16x16x32_bf16 v[160:163], a[164:167], v[92:95], v[160:163]
    v_exp_f32 v242, v110
    v_mfma_f32_16x16x32_bf16 v[160:163], a[168:171], v[96:99], v[160:163]
    v_add_f32 v225, v225, v241
    v_cvt_pk_bf16_f32 v170, v240, v241
    v_mfma_f32_16x16x32_bf16 v[160:163], a[172:175], v[100:103], v[160:163]
    s_waitcnt lgkmcnt(8)
    v_exp_f32 v243, v111
    v_mfma_f32_16x16x32_bf16 v[140:143], a[176:179], v[40:43], v[200:203]
    ds_read_b64_tr_b16 a[144:145], v14 offset:16384
    ds_read_b64_tr_b16 a[146:147], v14 offset:20480
    v_mfma_f32_16x16x32_bf16 v[140:143], a[180:183], v[44:47], v[140:143]
    v_add_f32 v224, v224, v242
    v_add_f32 v225, v225, v243
    v_mfma_f32_16x16x32_bf16 v[140:143], a[184:187], v[48:51], v[140:143]
    v_exp_f32 v252, v112
    v_mfma_f32_16x16x32_bf16 v[140:143], a[188:191], v[52:55], v[140:143]
    v_cvt_pk_bf16_f32 v171, v242, v243
    v_mfma_f32_16x16x32_bf16 v[148:151], a[176:179], v[56:59], v[204:207]
    ds_read_b64_tr_b16 a[148:149], v14 offset:24576
    ds_read_b64_tr_b16 a[150:151], v14 offset:28672
    v_mfma_f32_16x16x32_bf16 v[148:151], a[180:183], v[60:63], v[148:151]
    v_exp_f32 v253, v113
    s_nop 0
    v_cvt_pk_bf16_f32 v172, v252, v253
    v_mfma_f32_16x16x32_bf16 v[148:151], a[184:187], v[64:67], v[148:151]
    buffer_load_dwordx4 v34, s[52:55], s85 offen offset:1024 lds
    v_mfma_f32_16x16x32_bf16 v[148:151], a[188:191], v[68:71], v[148:151]
    s_add_u32 s85, s85, 32768
    v_exp_f32 v254, v114
    v_mfma_f32_16x16x32_bf16 v[156:159], a[176:179], v[72:75], v[208:211]
    ds_read_b64_tr_b16 a[152:153], v15 offset:16384
    ds_read_b64_tr_b16 a[154:155], v15 offset:20480
    v_mfma_f32_16x16x32_bf16 v[156:159], a[180:183], v[76:79], v[156:159]
    v_exp_f32 v255, v115
    s_nop 0
    v_cvt_pk_bf16_f32 v173, v254, v255
    v_mfma_f32_16x16x32_bf16 v[156:159], a[184:187], v[80:83], v[156:159]
    v_exp_f32 v236, v116
    v_mfma_f32_16x16x32_bf16 v[156:159], a[188:191], v[84:87], v[156:159]
    v_exp_f32 v237, v117
    v_mfma_f32_16x16x32_bf16 v[164:167], a[176:179], v[88:91], v[212:215]
    ds_read_b64_tr_b16 a[156:157], v15 offset:24576
    ds_read_b64_tr_b16 a[158:159], v15 offset:28672
    v_mfma_f32_16x16x32_bf16 v[164:167], a[180:183], v[92:95], v[164:167]
    v_exp_f32 v238, v118
    v_mfma_f32_16x16x32_bf16 v[164:167], a[184:187], v[96:99], v[164:167]
    v_cvt_pk_bf16_f32 v174, v236, v237
    v_mfma_f32_16x16x32_bf16 v[164:167], a[188:191], v[100:103], v[164:167]
    s_waitcnt lgkmcnt(8)
    v_exp_f32 v239, v119
    s_nop 0
    v_cvt_pk_bf16_f32 v175, v238, v239
    v_mfma_f32_16x16x32_bf16 a[0:3], a[128:131], v[24:27], a[0:3]
    ds_read_b128 a[160:163], v8 offset:49152
    v_mfma_f32_16x16x32_bf16 a[0:3], a[132:135], v[244:247], a[0:3]
    v_exp_f32 v240, v120
    s_nop 0
    v_add_f32 v226, v226, v240
    v_mfma_f32_16x16x32_bf16 a[4:7], a[128:131], v[28:31], a[4:7]
    v_exp_f32 v241, v121
    v_mfma_f32_16x16x32_bf16 a[4:7], a[132:135], v[248:251], a[4:7]
    v_add_f32 v227, v227, v241
    v_mfma_f32_16x16x32_bf16 a[8:11], a[128:131], v[36:39], a[8:11]
    ds_read_b128 a[164:167], v9 offset:49152
    v_exp_f32 v242, v122
    v_mfma_f32_16x16x32_bf16 a[8:11], a[132:135], v[232:235], a[8:11]
    s_add_u32 m0, s82, 32768
    v_cvt_pk_bf16_f32 v176, v240, v241
    v_mfma_f32_16x16x32_bf16 a[12:15], a[128:131], v[4:7], a[12:15]
    buffer_load_dwordx4 v32, s[52:55], s85 offen lds
    v_add_f32 v226, v226, v242
    v_mfma_f32_16x16x32_bf16 a[12:15], a[132:135], v[228:231], a[12:15]
    v_exp_f32 v243, v123
    v_mfma_f32_16x16x32_bf16 a[16:19], a[136:139], v[24:27], a[16:19]
    ds_read_b128 a[168:171], v10 offset:49152
    v_add_f32 v227, v227, v243
    v_mfma_f32_16x16x32_bf16 a[16:19], a[140:143], v[244:247], a[16:19]
    buffer_load_dword a251, v33, s[52:55], s86 offen
    v_cvt_pk_bf16_f32 v177, v242, v243
    v_mfma_f32_16x16x32_bf16 a[20:23], a[136:139], v[28:31], a[20:23]
    s_add_u32 s86, s86, 1024
    v_mfma_f32_16x16x32_bf16 a[20:23], a[140:143], v[248:251], a[20:23]
    v_exp_f32 v252, v124
    s_nop 0
    v_add_f32 v226, v226, v252
    v_mfma_f32_16x16x32_bf16 a[24:27], a[136:139], v[36:39], a[24:27]
    ds_read_b128 a[172:175], v11 offset:49152
    v_exp_f32 v253, v125
    v_mfma_f32_16x16x32_bf16 a[24:27], a[140:143], v[232:235], a[24:27]
    buffer_load_dwordx4 a[192:195], v35, s[68:71], s12 offen offset:0
    v_mfma_f32_16x16x32_bf16 a[28:31], a[136:139], v[4:7], a[28:31]
    v_exp_f32 v254, v126
    v_mfma_f32_16x16x32_bf16 a[28:31], a[140:143], v[228:231], a[28:31]
    s_waitcnt lgkmcnt(4)
    v_add_f32 v227, v227, v253
    v_cvt_pk_bf16_f32 v178, v252, v253
    v_mfma_f32_16x16x32_bf16 a[32:35], a[144:147], v[24:27], a[32:35]
    ds_read_b128 a[176:179], v8 offset:53248
    v_add_f32 v226, v226, v254
    v_mfma_f32_16x16x32_bf16 a[32:35], a[148:151], v[244:247], a[32:35]
    v_exp_f32 v255, v127
    v_mfma_f32_16x16x32_bf16 a[36:39], a[144:147], v[28:31], a[36:39]
    v_exp_f32 v236, v128
    v_mfma_f32_16x16x32_bf16 a[36:39], a[148:151], v[248:251], a[36:39]
    v_add_f32 v227, v227, v255
    v_mfma_f32_16x16x32_bf16 a[40:43], a[144:147], v[36:39], a[40:43]
    ds_read_b128 a[180:183], v9 offset:53248
    v_cvt_pk_bf16_f32 v179, v254, v255
    v_mfma_f32_16x16x32_bf16 a[40:43], a[148:151], v[232:235], a[40:43]
    v_exp_f32 v237, v129
    v_mfma_f32_16x16x32_bf16 a[44:47], a[144:147], v[4:7], a[44:47]
    buffer_load_dwordx4 v34, s[52:55], s85 offen offset:1024 lds
    v_cvt_pk_bf16_f32 v180, v236, v237
    v_mfma_f32_16x16x32_bf16 a[44:47], a[148:151], v[228:231], a[44:47]
    s_add_u32 s85, s85, 32768
    v_exp_f32 v238, v130
    v_mfma_f32_16x16x32_bf16 a[48:51], a[152:155], v[24:27], a[48:51]
    ds_read_b128 a[184:187], v10 offset:53248
    v_mfma_f32_16x16x32_bf16 a[48:51], a[156:159], v[244:247], a[48:51]
    buffer_load_dword a251, v33, s[52:55], s86 offen
    v_mfma_f32_16x16x32_bf16 a[52:55], a[152:155], v[28:31], a[52:55]
    s_add_u32 s86, s86, 1024
    v_exp_f32 v239, v131
    s_nop 0
    v_cvt_pk_bf16_f32 v181, v238, v239
    v_mfma_f32_16x16x32_bf16 a[52:55], a[156:159], v[248:251], a[52:55]
    v_exp_f32 v240, v132
    v_mfma_f32_16x16x32_bf16 a[56:59], a[152:155], v[36:39], a[56:59]
    ds_read_b128 a[188:191], v11 offset:53248
    v_exp_f32 v241, v133
    v_mfma_f32_16x16x32_bf16 a[56:59], a[156:159], v[232:235], a[56:59]
    buffer_load_dwordx4 a[196:199], v35, s[68:71], s12 offen offset:3584
    v_mfma_f32_16x16x32_bf16 a[60:63], a[152:155], v[4:7], a[60:63]
    v_exp_f32 v242, v134
    v_mfma_f32_16x16x32_bf16 a[60:63], a[156:159], v[228:231], a[60:63]
    s_waitcnt lgkmcnt(4)
    v_cvt_pk_bf16_f32 v182, v240, v241
    v_mfma_f32_16x16x32_bf16 v[216:219], a[252:255], v[28:31], v[216:219]
    v_exp_f32 v243, v135
    s_nop 0
    v_cvt_pk_bf16_f32 v183, v242, v243
    v_mfma_f32_16x16x32_bf16 v[216:219], a[252:255], v[248:251], v[216:219]
    v_mfma_f32_16x16x32_bf16 v[104:107], a[160:163], v[40:43], v[200:203]
    ds_read_b64_tr_b16 a[128:129], v16 offset:16384
    ds_read_b64_tr_b16 a[130:131], v16 offset:20480
    v_mfma_f32_16x16x32_bf16 v[104:107], a[164:167], v[44:47], v[104:107]
    v_exp_f32 v236, v136
    s_nop 0
    v_add_f32 v224, v224, v236
    v_mfma_f32_16x16x32_bf16 v[104:107], a[168:171], v[48:51], v[104:107]
    v_exp_f32 v237, v137
    s_nop 0
    v_add_f32 v225, v225, v237
    v_mfma_f32_16x16x32_bf16 v[104:107], a[172:175], v[52:55], v[104:107]
    v_exp_f32 v238, v138
    v_mfma_f32_16x16x32_bf16 v[112:115], a[160:163], v[56:59], v[204:207]
    ds_read_b64_tr_b16 a[132:133], v16 offset:24576
    ds_read_b64_tr_b16 a[134:135], v16 offset:28672
    v_mfma_f32_16x16x32_bf16 v[112:115], a[164:167], v[60:63], v[112:115]
    s_add_u32 m0, s82, 65536
    v_cvt_pk_bf16_f32 v184, v236, v237
    v_add_f32 v224, v224, v238
    v_mfma_f32_16x16x32_bf16 v[112:115], a[168:171], v[64:67], v[112:115]
    buffer_load_dwordx4 v32, s[52:55], s85 offen lds
    v_mfma_f32_16x16x32_bf16 v[112:115], a[172:175], v[68:71], v[112:115]
    v_exp_f32 v239, v139
    v_mfma_f32_16x16x32_bf16 v[120:123], a[160:163], v[72:75], v[208:211]
    ds_read_b64_tr_b16 a[136:137], v17 offset:16384
    ds_read_b64_tr_b16 a[138:139], v17 offset:20480
    v_add_f32 v225, v225, v239
    v_mfma_f32_16x16x32_bf16 v[120:123], a[164:167], v[76:79], v[120:123]
    v_exp_f32 v240, v140
    v_mfma_f32_16x16x32_bf16 v[120:123], a[168:171], v[80:83], v[120:123]
    v_cvt_pk_bf16_f32 v185, v238, v239
    v_add_f32 v224, v224, v240
    v_mfma_f32_16x16x32_bf16 v[120:123], a[172:175], v[84:87], v[120:123]
    v_exp_f32 v241, v141
    v_mfma_f32_16x16x32_bf16 v[128:131], a[160:163], v[88:91], v[212:215]
    ds_read_b64_tr_b16 a[140:141], v17 offset:24576
    ds_read_b64_tr_b16 a[142:143], v17 offset:28672
    v_mfma_f32_16x16x32_bf16 v[128:131], a[164:167], v[92:95], v[128:131]
    v_exp_f32 v242, v142
    v_mfma_f32_16x16x32_bf16 v[128:131], a[168:171], v[96:99], v[128:131]
    v_add_f32 v225, v225, v241
    v_cvt_pk_bf16_f32 v186, v240, v241
    v_mfma_f32_16x16x32_bf16 v[128:131], a[172:175], v[100:103], v[128:131]
    s_waitcnt lgkmcnt(8)
    v_exp_f32 v243, v143
    v_mfma_f32_16x16x32_bf16 v[108:111], a[176:179], v[40:43], v[200:203]
    ds_read_b64_tr_b16 a[144:145], v18 offset:16384
    ds_read_b64_tr_b16 a[146:147], v18 offset:20480
    v_mfma_f32_16x16x32_bf16 v[108:111], a[180:183], v[44:47], v[108:111]
    v_add_f32 v224, v224, v242
    v_add_f32 v225, v225, v243
    v_mfma_f32_16x16x32_bf16 v[108:111], a[184:187], v[48:51], v[108:111]
    v_exp_f32 v252, v144
    v_mfma_f32_16x16x32_bf16 v[108:111], a[188:191], v[52:55], v[108:111]
    v_cvt_pk_bf16_f32 v187, v242, v243
    v_mfma_f32_16x16x32_bf16 v[116:119], a[176:179], v[56:59], v[204:207]
    ds_read_b64_tr_b16 a[148:149], v18 offset:24576
    ds_read_b64_tr_b16 a[150:151], v18 offset:28672
    v_mfma_f32_16x16x32_bf16 v[116:119], a[180:183], v[60:63], v[116:119]
    v_exp_f32 v253, v145
    s_nop 0
    v_cvt_pk_bf16_f32 v188, v252, v253
    v_mfma_f32_16x16x32_bf16 v[116:119], a[184:187], v[64:67], v[116:119]
    buffer_load_dwordx4 v34, s[52:55], s85 offen offset:1024 lds
    v_mfma_f32_16x16x32_bf16 v[116:119], a[188:191], v[68:71], v[116:119]
    s_add_u32 s85, s85, 32768
    v_exp_f32 v254, v146
    v_mfma_f32_16x16x32_bf16 v[124:127], a[176:179], v[72:75], v[208:211]
    ds_read_b64_tr_b16 a[152:153], v19 offset:16384
    ds_read_b64_tr_b16 a[154:155], v19 offset:20480
    v_mfma_f32_16x16x32_bf16 v[124:127], a[180:183], v[76:79], v[124:127]
    v_exp_f32 v255, v147
    s_nop 0
    v_cvt_pk_bf16_f32 v189, v254, v255
    v_mfma_f32_16x16x32_bf16 v[124:127], a[184:187], v[80:83], v[124:127]
    v_exp_f32 v236, v148
    v_mfma_f32_16x16x32_bf16 v[124:127], a[188:191], v[84:87], v[124:127]
    v_exp_f32 v237, v149
    v_mfma_f32_16x16x32_bf16 v[132:135], a[176:179], v[88:91], v[212:215]
    ds_read_b64_tr_b16 a[156:157], v19 offset:24576
    ds_read_b64_tr_b16 a[158:159], v19 offset:28672
    v_mfma_f32_16x16x32_bf16 v[132:135], a[180:183], v[92:95], v[132:135]
    v_exp_f32 v238, v150
    v_mfma_f32_16x16x32_bf16 v[132:135], a[184:187], v[96:99], v[132:135]
    v_cvt_pk_bf16_f32 v190, v236, v237
    v_mfma_f32_16x16x32_bf16 v[132:135], a[188:191], v[100:103], v[132:135]
    s_waitcnt lgkmcnt(8)
    v_exp_f32 v239, v151
    s_nop 0
    v_cvt_pk_bf16_f32 v191, v238, v239
    v_mfma_f32_16x16x32_bf16 a[64:67], a[128:131], v[24:27], a[64:67]
    ds_read_b128 a[160:163], v8 offset:57344
    v_mfma_f32_16x16x32_bf16 a[64:67], a[132:135], v[244:247], a[64:67]
    v_exp_f32 v240, v152
    s_nop 0
    v_add_f32 v226, v226, v240
    v_mfma_f32_16x16x32_bf16 a[68:71], a[128:131], v[28:31], a[68:71]
    v_exp_f32 v241, v153
    v_mfma_f32_16x16x32_bf16 a[68:71], a[132:135], v[248:251], a[68:71]
    v_add_f32 v227, v227, v241
    v_mfma_f32_16x16x32_bf16 a[72:75], a[128:131], v[36:39], a[72:75]
    ds_read_b128 a[164:167], v9 offset:57344
    v_exp_f32 v242, v154
    v_mfma_f32_16x16x32_bf16 a[72:75], a[132:135], v[232:235], a[72:75]
    s_add_u32 m0, s82, 73728
    v_cvt_pk_bf16_f32 v192, v240, v241
    v_mfma_f32_16x16x32_bf16 a[76:79], a[128:131], v[4:7], a[76:79]
    buffer_load_dwordx4 v32, s[52:55], s85 offen lds
    v_add_f32 v226, v226, v242
    v_mfma_f32_16x16x32_bf16 a[76:79], a[132:135], v[228:231], a[76:79]
    v_exp_f32 v243, v155
    v_mfma_f32_16x16x32_bf16 a[80:83], a[136:139], v[24:27], a[80:83]
    ds_read_b128 a[168:171], v10 offset:57344
    v_add_f32 v227, v227, v243
    v_mfma_f32_16x16x32_bf16 a[80:83], a[140:143], v[244:247], a[80:83]
    buffer_load_dword a251, v33, s[52:55], s86 offen
    v_cvt_pk_bf16_f32 v193, v242, v243
    v_mfma_f32_16x16x32_bf16 a[84:87], a[136:139], v[28:31], a[84:87]
    s_add_u32 s86, s86, 1024
    v_mfma_f32_16x16x32_bf16 a[84:87], a[140:143], v[248:251], a[84:87]
    v_exp_f32 v252, v156
    s_nop 0
    v_add_f32 v226, v226, v252
    v_mfma_f32_16x16x32_bf16 a[88:91], a[136:139], v[36:39], a[88:91]
    ds_read_b128 a[172:175], v11 offset:57344
    v_exp_f32 v253, v157
    v_mfma_f32_16x16x32_bf16 a[88:91], a[140:143], v[232:235], a[88:91]
    buffer_load_dwordx4 a[200:203], v35, s[68:71], s13 offen offset:0
    v_mfma_f32_16x16x32_bf16 a[92:95], a[136:139], v[4:7], a[92:95]
    v_exp_f32 v254, v158
    v_mfma_f32_16x16x32_bf16 a[92:95], a[140:143], v[228:231], a[92:95]
    s_waitcnt lgkmcnt(4)
    v_add_f32 v227, v227, v253
    v_cvt_pk_bf16_f32 v194, v252, v253
    v_mfma_f32_16x16x32_bf16 a[96:99], a[144:147], v[24:27], a[96:99]
    ds_read_b128 a[176:179], v8 offset:61440
    v_add_f32 v226, v226, v254
    v_mfma_f32_16x16x32_bf16 a[96:99], a[148:151], v[244:247], a[96:99]
    v_exp_f32 v255, v159
    v_mfma_f32_16x16x32_bf16 a[100:103], a[144:147], v[28:31], a[100:103]
    v_exp_f32 v236, v160
    v_mfma_f32_16x16x32_bf16 a[100:103], a[148:151], v[248:251], a[100:103]
    v_add_f32 v227, v227, v255
    v_mfma_f32_16x16x32_bf16 a[104:107], a[144:147], v[36:39], a[104:107]
    ds_read_b128 a[180:183], v9 offset:61440
    v_cvt_pk_bf16_f32 v195, v254, v255
    v_mfma_f32_16x16x32_bf16 a[104:107], a[148:151], v[232:235], a[104:107]
    v_exp_f32 v237, v161
    v_mfma_f32_16x16x32_bf16 a[108:111], a[144:147], v[4:7], a[108:111]
    buffer_load_dwordx4 v34, s[52:55], s85 offen offset:1024 lds
    v_cvt_pk_bf16_f32 v196, v236, v237
    v_mfma_f32_16x16x32_bf16 a[108:111], a[148:151], v[228:231], a[108:111]
    s_add_u32 s85, s85, 32768
    v_exp_f32 v238, v162
    v_mfma_f32_16x16x32_bf16 a[112:115], a[152:155], v[24:27], a[112:115]
    ds_read_b128 a[184:187], v10 offset:61440
    v_mfma_f32_16x16x32_bf16 a[112:115], a[156:159], v[244:247], a[112:115]
    buffer_load_dword a251, v33, s[52:55], s86 offen
    v_mfma_f32_16x16x32_bf16 a[116:119], a[152:155], v[28:31], a[116:119]
    s_add_u32 s86, s86, 1024
    v_exp_f32 v239, v163
    s_nop 0
    v_cvt_pk_bf16_f32 v197, v238, v239
    v_mfma_f32_16x16x32_bf16 a[116:119], a[156:159], v[248:251], a[116:119]
    v_exp_f32 v240, v164
    v_mfma_f32_16x16x32_bf16 a[120:123], a[152:155], v[36:39], a[120:123]
    ds_read_b128 a[188:191], v11 offset:61440
    v_exp_f32 v241, v165
    v_mfma_f32_16x16x32_bf16 a[120:123], a[156:159], v[232:235], a[120:123]
    buffer_load_dwordx4 a[204:207], v35, s[68:71], s13 offen offset:3584
    v_mfma_f32_16x16x32_bf16 a[124:127], a[152:155], v[4:7], a[124:127]
    v_exp_f32 v242, v166
    v_mfma_f32_16x16x32_bf16 a[124:127], a[156:159], v[228:231], a[124:127]
    s_waitcnt lgkmcnt(4)
    v_cvt_pk_bf16_f32 v198, v240, v241
    v_mfma_f32_16x16x32_bf16 v[220:223], a[252:255], v[4:7], v[220:223]
    s_waitcnt vmcnt(16)
    v_exp_f32 v243, v167
    s_nop 0
    v_cvt_pk_bf16_f32 v199, v242, v243
    v_mfma_f32_16x16x32_bf16 v[220:223], a[252:255], v[228:231], v[220:223]
    s_barrier
    v_mfma_f32_16x16x32_bf16 v[136:139], a[160:163], v[40:43], v[200:203]
    ds_read_b64_tr_b16 a[128:129], v12 offset:32768
    ds_read_b64_tr_b16 a[130:131], v12 offset:36864
    v_mfma_f32_16x16x32_bf16 v[136:139], a[164:167], v[44:47], v[136:139]
    v_exp_f32 v236, v104
    s_nop 0
    v_add_f32 v224, v224, v236
    v_mfma_f32_16x16x32_bf16 v[136:139], a[168:171], v[48:51], v[136:139]
    v_exp_f32 v237, v105
    s_nop 0
    v_add_f32 v225, v225, v237
    v_mfma_f32_16x16x32_bf16 v[136:139], a[172:175], v[52:55], v[136:139]
    v_exp_f32 v238, v106
    v_mfma_f32_16x16x32_bf16 v[144:147], a[160:163], v[56:59], v[204:207]
    ds_read_b64_tr_b16 a[132:133], v12 offset:40960
    ds_read_b64_tr_b16 a[134:135], v12 offset:45056
    v_cvt_pk_bf16_f32 v24, v236, v237
    v_mfma_f32_16x16x32_bf16 v[144:147], a[164:167], v[60:63], v[144:147]
    s_add_u32 m0, s82, 0
    v_add_f32 v224, v224, v238
    v_mfma_f32_16x16x32_bf16 v[144:147], a[168:171], v[64:67], v[144:147]
    buffer_load_dwordx4 v32, s[52:55], s85 offen lds
    v_mfma_f32_16x16x32_bf16 v[144:147], a[172:175], v[68:71], v[144:147]
    v_exp_f32 v239, v107
    s_nop 0
    v_add_f32 v225, v225, v239
    v_mfma_f32_16x16x32_bf16 v[152:155], a[160:163], v[72:75], v[208:211]
    ds_read_b64_tr_b16 a[136:137], v13 offset:32768
    ds_read_b64_tr_b16 a[138:139], v13 offset:36864
    v_cvt_pk_bf16_f32 v25, v238, v239
    v_mfma_f32_16x16x32_bf16 v[152:155], a[164:167], v[76:79], v[152:155]
    v_exp_f32 v240, v108
    v_mfma_f32_16x16x32_bf16 v[152:155], a[168:171], v[80:83], v[152:155]
    v_exp_f32 v241, v109
    v_mfma_f32_16x16x32_bf16 v[152:155], a[172:175], v[84:87], v[152:155]
    v_add_f32 v224, v224, v240
    v_mfma_f32_16x16x32_bf16 v[160:163], a[160:163], v[88:91], v[212:215]
    ds_read_b64_tr_b16 a[140:141], v13 offset:40960
    ds_read_b64_tr_b16 a[142:143], v13 offset:45056
    v_add_f32 v225, v225, v241
    v_mfma_f32_16x16x32_bf16 v[160:163], a[164:167], v[92:95], v[160:163]
    v_exp_f32 v242, v110
    v_mfma_f32_16x16x32_bf16 v[160:163], a[168:171], v[96:99], v[160:163]
    v_cvt_pk_bf16_f32 v26, v240, v241
    v_add_f32 v224, v224, v242
    v_mfma_f32_16x16x32_bf16 v[160:163], a[172:175], v[100:103], v[160:163]
    s_waitcnt lgkmcnt(8)
    v_exp_f32 v243, v111
    v_mfma_f32_16x16x32_bf16 v[140:143], a[176:179], v[40:43], v[200:203]
    ds_read_b64_tr_b16 a[144:145], v14 offset:32768
    ds_read_b64_tr_b16 a[146:147], v14 offset:36864
    v_mfma_f32_16x16x32_bf16 v[140:143], a[180:183], v[44:47], v[140:143]
    v_exp_f32 v252, v112
    v_mfma_f32_16x16x32_bf16 v[140:143], a[184:187], v[48:51], v[140:143]
    v_add_f32 v225, v225, v243
    v_cvt_pk_bf16_f32 v27, v242, v243
    v_mfma_f32_16x16x32_bf16 v[140:143], a[188:191], v[52:55], v[140:143]
    v_exp_f32 v253, v113
    v_mfma_f32_16x16x32_bf16 v[148:151], a[176:179], v[56:59], v[204:207]
    ds_read_b64_tr_b16 a[148:149], v14 offset:40960
    ds_read_b64_tr_b16 a[150:151], v14 offset:45056
    v_cvt_pk_bf16_f32 v28, v252, v253
    v_mfma_f32_16x16x32_bf16 v[148:151], a[180:183], v[60:63], v[148:151]
    v_exp_f32 v254, v114
    v_mfma_f32_16x16x32_bf16 v[148:151], a[184:187], v[64:67], v[148:151]
    buffer_load_dwordx4 v34, s[52:55], s85 offen offset:1024 lds
    v_mfma_f32_16x16x32_bf16 v[148:151], a[188:191], v[68:71], v[148:151]
    s_add_u32 s85, s85, 32768
    v_exp_f32 v255, v115
    v_mfma_f32_16x16x32_bf16 v[156:159], a[176:179], v[72:75], v[208:211]
    ds_read_b64_tr_b16 a[152:153], v15 offset:32768
    ds_read_b64_tr_b16 a[154:155], v15 offset:36864
    v_cvt_pk_bf16_f32 v29, v254, v255
    v_mfma_f32_16x16x32_bf16 v[156:159], a[180:183], v[76:79], v[156:159]
    v_exp_f32 v236, v116
    v_mfma_f32_16x16x32_bf16 v[156:159], a[184:187], v[80:83], v[156:159]
    v_exp_f32 v237, v117
    v_mfma_f32_16x16x32_bf16 v[156:159], a[188:191], v[84:87], v[156:159]
    v_exp_f32 v238, v118
    v_mfma_f32_16x16x32_bf16 v[164:167], a[176:179], v[88:91], v[212:215]
    ds_read_b64_tr_b16 a[156:157], v15 offset:40960
    ds_read_b64_tr_b16 a[158:159], v15 offset:45056
    v_mfma_f32_16x16x32_bf16 v[164:167], a[180:183], v[92:95], v[164:167]
    v_cvt_pk_bf16_f32 v30, v236, v237
    v_mfma_f32_16x16x32_bf16 v[164:167], a[184:187], v[96:99], v[164:167]
    v_exp_f32 v239, v119
    s_nop 0
    v_cvt_pk_bf16_f32 v31, v238, v239
    v_mfma_f32_16x16x32_bf16 v[164:167], a[188:191], v[100:103], v[164:167]
    s_waitcnt lgkmcnt(8)
    v_exp_f32 v240, v120
    v_mfma_f32_16x16x32_bf16 a[0:3], a[128:131], v[168:171], a[0:3]
    ds_read_b64_tr_b16 a[160:161], v16 offset:32768
    ds_read_b64_tr_b16 a[162:163], v16 offset:36864
    v_add_f32 v226, v226, v240
    v_mfma_f32_16x16x32_bf16 a[0:3], a[132:135], v[184:187], a[0:3]
    v_exp_f32 v241, v121
    v_mfma_f32_16x16x32_bf16 a[4:7], a[128:131], v[172:175], a[4:7]
    v_exp_f32 v242, v122
    v_mfma_f32_16x16x32_bf16 a[4:7], a[132:135], v[188:191], a[4:7]
    v_add_f32 v227, v227, v241
    v_cvt_pk_bf16_f32 v36, v240, v241
    v_mfma_f32_16x16x32_bf16 a[8:11], a[128:131], v[176:179], a[8:11]
    ds_read_b64_tr_b16 a[164:165], v16 offset:40960
    ds_read_b64_tr_b16 a[166:167], v16 offset:45056
    v_mfma_f32_16x16x32_bf16 a[8:11], a[132:135], v[192:195], a[8:11]
    s_add_u32 m0, s82, 8192
    v_exp_f32 v243, v123
    v_mfma_f32_16x16x32_bf16 a[12:15], a[128:131], v[180:183], a[12:15]
    buffer_load_dwordx4 v32, s[52:55], s85 offen lds
    v_add_f32 v226, v226, v242
    v_mfma_f32_16x16x32_bf16 a[12:15], a[132:135], v[196:199], a[12:15]
    v_exp_f32 v252, v124
    v_mfma_f32_16x16x32_bf16 a[16:19], a[136:139], v[168:171], a[16:19]
    ds_read_b64_tr_b16 a[168:169], v17 offset:32768
    ds_read_b64_tr_b16 a[170:171], v17 offset:36864
    v_mfma_f32_16x16x32_bf16 a[16:19], a[140:143], v[184:187], a[16:19]
    buffer_load_dword a251, v33, s[52:55], s86 offen
    v_add_f32 v227, v227, v243
    v_mfma_f32_16x16x32_bf16 a[20:23], a[136:139], v[172:175], a[20:23]
    s_add_u32 s86, s86, 1024
    v_cvt_pk_bf16_f32 v37, v242, v243
    v_add_f32 v226, v226, v252
    v_mfma_f32_16x16x32_bf16 a[20:23], a[140:143], v[188:191], a[20:23]
    v_exp_f32 v253, v125
    v_mfma_f32_16x16x32_bf16 a[24:27], a[136:139], v[176:179], a[24:27]
    ds_read_b64_tr_b16 a[172:173], v17 offset:40960
    ds_read_b64_tr_b16 a[174:175], v17 offset:45056
    v_mfma_f32_16x16x32_bf16 a[24:27], a[140:143], v[192:195], a[24:27]
    buffer_load_dwordx4 a[208:211], v35, s[72:75], s12 offen offset:0
    v_add_f32 v227, v227, v253
    v_mfma_f32_16x16x32_bf16 a[28:31], a[136:139], v[180:183], a[28:31]
    v_exp_f32 v254, v126
    v_mfma_f32_16x16x32_bf16 a[28:31], a[140:143], v[196:199], a[28:31]
    s_waitcnt lgkmcnt(8)
    v_cvt_pk_bf16_f32 v38, v252, v253
    v_add_f32 v226, v226, v254
    v_mfma_f32_16x16x32_bf16 a[32:35], a[144:147], v[168:171], a[32:35]
    ds_read_b64_tr_b16 a[176:177], v18 offset:32768
    ds_read_b64_tr_b16 a[178:179], v18 offset:36864
    v_mfma_f32_16x16x32_bf16 a[32:35], a[148:151], v[184:187], a[32:35]
    v_exp_f32 v255, v127
    v_mfma_f32_16x16x32_bf16 a[36:39], a[144:147], v[172:175], a[36:39]
    v_exp_f32 v236, v128
    v_mfma_f32_16x16x32_bf16 a[36:39], a[148:151], v[188:191], a[36:39]
    v_add_f32 v227, v227, v255
    v_cvt_pk_bf16_f32 v39, v254, v255
    v_mfma_f32_16x16x32_bf16 a[40:43], a[144:147], v[176:179], a[40:43]
    ds_read_b64_tr_b16 a[180:181], v18 offset:40960
    ds_read_b64_tr_b16 a[182:183], v18 offset:45056
    v_mfma_f32_16x16x32_bf16 a[40:43], a[148:151], v[192:195], a[40:43]
    v_exp_f32 v237, v129
    s_nop 0
    v_cvt_pk_bf16_f32 v4, v236, v237
    v_mfma_f32_16x16x32_bf16 a[44:47], a[144:147], v[180:183], a[44:47]
    buffer_load_dwordx4 v34, s[52:55], s85 offen offset:1024 lds
    v_mfma_f32_16x16x32_bf16 a[44:47], a[148:151], v[196:199], a[44:47]
    s_add_u32 s85, s85, 32768
    v_exp_f32 v238, v130
    v_mfma_f32_16x16x32_bf16 a[48:51], a[152:155], v[168:171], a[48:51]
    ds_read_b64_tr_b16 a[184:185], v19 offset:32768
    ds_read_b64_tr_b16 a[186:187], v19 offset:36864
    v_mfma_f32_16x16x32_bf16 a[48:51], a[156:159], v[184:187], a[48:51]
    buffer_load_dword a251, v33, s[52:55], s86 offen
    v_mfma_f32_16x16x32_bf16 a[52:55], a[152:155], v[172:175], a[52:55]
    s_add_u32 s86, s86, 1024
    v_exp_f32 v239, v131
    s_nop 0
    v_cvt_pk_bf16_f32 v5, v238, v239
    v_mfma_f32_16x16x32_bf16 a[52:55], a[156:159], v[188:191], a[52:55]
    v_exp_f32 v240, v132
    v_mfma_f32_16x16x32_bf16 a[56:59], a[152:155], v[176:179], a[56:59]
    ds_read_b64_tr_b16 a[188:189], v19 offset:40960
    ds_read_b64_tr_b16 a[190:191], v19 offset:45056
    v_mfma_f32_16x16x32_bf16 a[56:59], a[156:159], v[192:195], a[56:59]
    buffer_load_dwordx4 a[212:215], v35, s[72:75], s12 offen offset:3584
    v_mfma_f32_16x16x32_bf16 a[60:63], a[152:155], v[180:183], a[60:63]
    v_exp_f32 v241, v133
    s_nop 0
    v_cvt_pk_bf16_f32 v6, v240, v241
    v_mfma_f32_16x16x32_bf16 a[60:63], a[156:159], v[196:199], a[60:63]
    s_waitcnt lgkmcnt(8)
    v_exp_f32 v242, v134
    v_mfma_f32_16x16x32_bf16 v[216:219], a[252:255], v[172:175], v[216:219]
    v_exp_f32 v243, v135
    s_nop 0
    v_cvt_pk_bf16_f32 v7, v242, v243
    v_mfma_f32_16x16x32_bf16 v[216:219], a[252:255], v[188:191], v[216:219]
    v_mfma_f32_16x16x32_bf16 a[64:67], a[160:163], v[168:171], a[64:67]
    ds_read_b64_tr_b16 a[128:129], v12 offset:49152
    ds_read_b64_tr_b16 a[130:131], v12 offset:53248
    v_exp_f32 v236, v136
    v_mfma_f32_16x16x32_bf16 a[64:67], a[164:167], v[184:187], a[64:67]
    v_exp_f32 v237, v137
    v_add_f32 v224, v224, v236
    v_add_f32 v225, v225, v237
    v_mfma_f32_16x16x32_bf16 a[68:71], a[160:163], v[172:175], a[68:71]
    v_exp_f32 v238, v138
    v_cvt_pk_bf16_f32 v244, v236, v237
    v_add_f32 v224, v224, v238
    v_mfma_f32_16x16x32_bf16 a[68:71], a[164:167], v[188:191], a[68:71]
    v_exp_f32 v239, v139
    v_exp_f32 v240, v140
    v_mfma_f32_16x16x32_bf16 a[72:75], a[160:163], v[176:179], a[72:75]
    ds_read_b64_tr_b16 a[132:133], v12 offset:57344
    ds_read_b64_tr_b16 a[134:135], v12 offset:61440
    v_add_f32 v225, v225, v239
    v_cvt_pk_bf16_f32 v245, v238, v239
    v_mfma_f32_16x16x32_bf16 a[72:75], a[164:167], v[192:195], a[72:75]
    s_add_u32 m0, s82, 16384
    v_exp_f32 v241, v141
    v_add_f32 v224, v224, v240
    v_mfma_f32_16x16x32_bf16 a[76:79], a[160:163], v[180:183], a[76:79]
    buffer_load_dwordx4 v32, s[52:55], s85 offen lds
    v_exp_f32 v242, v142
    v_mfma_f32_16x16x32_bf16 a[76:79], a[164:167], v[196:199], a[76:79]
    v_add_f32 v225, v225, v241
    v_cvt_pk_bf16_f32 v246, v240, v241
    v_exp_f32 v243, v143
    v_mfma_f32_16x16x32_bf16 a[80:83], a[168:171], v[168:171], a[80:83]
    ds_read_b64_tr_b16 a[136:137], v13 offset:49152
    ds_read_b64_tr_b16 a[138:139], v13 offset:53248
    v_add_f32 v224, v224, v242
    v_mfma_f32_16x16x32_bf16 a[80:83], a[172:175], v[184:187], a[80:83]
    v_exp_f32 v252, v144
    v_add_f32 v225, v225, v243
    v_cvt_pk_bf16_f32 v247, v242, v243
    v_mfma_f32_16x16x32_bf16 a[84:87], a[168:171], v[172:175], a[84:87]
    buffer_load_dwordx4 v34, s[52:55], s85 offen offset:1024 lds
    v_exp_f32 v253, v145
    v_mfma_f32_16x16x32_bf16 a[84:87], a[172:175], v[188:191], a[84:87]
    s_add_u32 s85, s85, 32768
    v_exp_f32 v254, v146
    v_cvt_pk_bf16_f32 v248, v252, v253
    v_mfma_f32_16x16x32_bf16 a[88:91], a[168:171], v[176:179], a[88:91]
    ds_read_b64_tr_b16 a[140:141], v13 offset:57344
    ds_read_b64_tr_b16 a[142:143], v13 offset:61440
    v_exp_f32 v255, v147
    v_mfma_f32_16x16x32_bf16 a[88:91], a[172:175], v[192:195], a[88:91]
    buffer_load_dwordx4 a[216:219], v35, s[72:75], s13 offen offset:0
    v_exp_f32 v236, v148
    v_mfma_f32_16x16x32_bf16 a[92:95], a[168:171], v[180:183], a[92:95]
    v_cvt_pk_bf16_f32 v249, v254, v255
    v_exp_f32 v237, v149
    v_mfma_f32_16x16x32_bf16 a[92:95], a[172:175], v[196:199], a[92:95]
    s_waitcnt lgkmcnt(8)
    v_exp_f32 v238, v150
    v_cvt_pk_bf16_f32 v250, v236, v237
    v_mfma_f32_16x16x32_bf16 a[96:99], a[176:179], v[168:171], a[96:99]
    ds_read_b64_tr_b16 a[144:145], v14 offset:49152
    ds_read_b64_tr_b16 a[146:147], v14 offset:53248
    v_exp_f32 v239, v151
    v_mfma_f32_16x16x32_bf16 a[96:99], a[180:183], v[184:187], a[96:99]
    v_exp_f32 v240, v152
    v_cvt_pk_bf16_f32 v251, v238, v239
    v_add_f32 v226, v226, v240
    v_mfma_f32_16x16x32_bf16 a[100:103], a[176:179], v[172:175], a[100:103]
    v_exp_f32 v241, v153
    v_exp_f32 v242, v154
    v_mfma_f32_16x16x32_bf16 a[100:103], a[180:183], v[188:191], a[100:103]
    v_add_f32 v227, v227, v241
    v_cvt_pk_bf16_f32 v232, v240, v241
    v_add_f32 v226, v226, v242
    v_mfma_f32_16x16x32_bf16 a[104:107], a[176:179], v[176:179], a[104:107]
    ds_read_b64_tr_b16 a[148:149], v14 offset:57344
    ds_read_b64_tr_b16 a[150:151], v14 offset:61440
    v_exp_f32 v243, v155
    v_mfma_f32_16x16x32_bf16 a[104:107], a[180:183], v[192:195], a[104:107]
    s_add_u32 m0, s82, 40960
    v_exp_f32 v252, v156
    v_add_f32 v227, v227, v243
    v_cvt_pk_bf16_f32 v233, v242, v243
    v_mfma_f32_16x16x32_bf16 a[108:111], a[176:179], v[180:183], a[108:111]
    buffer_load_dwordx4 v32, s[52:55], s85 offen lds
    v_add_f32 v226, v226, v252
    v_mfma_f32_16x16x32_bf16 a[108:111], a[180:183], v[196:199], a[108:111]
    v_exp_f32 v253, v157
    v_exp_f32 v254, v158
    v_mfma_f32_16x16x32_bf16 a[112:115], a[184:187], v[168:171], a[112:115]
    ds_read_b64_tr_b16 a[152:153], v15 offset:49152
    ds_read_b64_tr_b16 a[154:155], v15 offset:53248
    v_add_f32 v227, v227, v253
    v_cvt_pk_bf16_f32 v234, v252, v253
    v_mfma_f32_16x16x32_bf16 a[112:115], a[188:191], v[184:187], a[112:115]
    v_exp_f32 v255, v159
    v_add_f32 v226, v226, v254
    v_mfma_f32_16x16x32_bf16 a[116:119], a[184:187], v[172:175], a[116:119]
    buffer_load_dwordx4 v34, s[52:55], s85 offen offset:1024 lds
    v_exp_f32 v236, v160
    v_mfma_f32_16x16x32_bf16 a[116:119], a[188:191], v[188:191], a[116:119]
    s_add_u32 s85, s85, 32768
    v_add_f32 v227, v227, v255
    v_cvt_pk_bf16_f32 v235, v254, v255
    v_exp_f32 v237, v161
    v_mfma_f32_16x16x32_bf16 a[120:123], a[184:187], v[176:179], a[120:123]
    ds_read_b64_tr_b16 a[156:157], v15 offset:57344
    ds_read_b64_tr_b16 a[158:159], v15 offset:61440
    v_cvt_pk_bf16_f32 v228, v236, v237
    v_mfma_f32_16x16x32_bf16 a[120:123], a[188:191], v[192:195], a[120:123]
    buffer_load_dwordx4 a[220:223], v35, s[72:75], s13 offen offset:3584
    v_exp_f32 v238, v162
    v_mfma_f32_16x16x32_bf16 a[124:127], a[184:187], v[180:183], a[124:127]
    v_exp_f32 v239, v163
    v_exp_f32 v240, v164
    v_mfma_f32_16x16x32_bf16 a[124:127], a[188:191], v[196:199], a[124:127]
    s_waitcnt lgkmcnt(8)
    v_cvt_pk_bf16_f32 v229, v238, v239
    v_exp_f32 v241, v165
    v_mfma_f32_16x16x32_bf16 v[220:223], a[252:255], v[180:183], v[220:223]
    v_exp_f32 v242, v166
    v_cvt_pk_bf16_f32 v230, v240, v241
    v_mfma_f32_16x16x32_bf16 v[220:223], a[252:255], v[196:199], v[220:223]
    v_exp_f32 v243, v167
    s_nop 0
    v_cvt_pk_bf16_f32 v231, v242, v243
    s_lshl_b32 s90, s8, 7
    s_add_u32 s87, s90, 131072
    v_and_b32 v35, 7, v1
    v_lshlrev_b32 v35, 2, v35
    v_mfma_f32_16x16x32_bf16 v[216:219], a[252:255], v[28:31], v[216:219]
    v_mfma_f32_16x16x32_bf16 v[216:219], a[252:255], v[248:251], v[216:219]
    v_mfma_f32_16x16x32_bf16 v[220:223], a[252:255], v[4:7], v[220:223]
    v_mfma_f32_16x16x32_bf16 v[220:223], a[252:255], v[228:231], v[220:223]
    v_add_f32 v224, v224, v225
    v_add_f32 v226, v226, v227
    s_nop 1
    v_mov_b32 v225, v224
    v_mov_b32 v227, v226
    s_nop 0
    v_permlane16_swap_b32 v225, v224
    v_permlane16_swap_b32 v227, v226
    v_add_f32 v224, v224, v225
    v_add_f32 v226, v226, v227
    s_nop 0
    v_mov_b32 v225, v224
    v_mov_b32 v227, v226
    s_nop 0
    v_permlane32_swap_b32 v225, v224
    v_permlane32_swap_b32 v227, v226
    v_add_f32 v224, v224, v225
    v_add_f32 v226, v226, v227
    s_nop 0
    v_mfma_f32_16x16x32_bf16 a[0:3], a[128:131], v[24:27], a[0:3]
    ds_read_b64_tr_b16 a[160:161], v16 offset:49152
    ds_read_b64_tr_b16 a[162:163], v16 offset:53248
    v_mfma_f32_16x16x32_bf16 a[0:3], a[132:135], v[244:247], a[0:3]
    s_add_u32 m0, s82, 49152
    s_nop 0
    buffer_load_dwordx4 v32, s[52:55], s85 offen lds
    v_mfma_f32_16x16x32_bf16 a[4:7], a[128:131], v[28:31], a[4:7]
    v_mfma_f32_16x16x32_bf16 a[4:7], a[132:135], v[248:251], a[4:7]
    v_mfma_f32_16x16x32_bf16 a[8:11], a[128:131], v[36:39], a[8:11]
    ds_read_b64_tr_b16 a[164:165], v16 offset:57344
    ds_read_b64_tr_b16 a[166:167], v16 offset:61440
    v_mfma_f32_16x16x32_bf16 a[8:11], a[132:135], v[232:235], a[8:11]
    buffer_load_dwordx4 v34, s[52:55], s85 offen offset:1024 lds
    s_add_u32 s85, s85, 32768
    v_mfma_f32_16x16x32_bf16 a[12:15], a[128:131], v[4:7], a[12:15]
    v_mfma_f32_16x16x32_bf16 a[12:15], a[132:135], v[228:231], a[12:15]
    v_mfma_f32_16x16x32_bf16 a[16:19], a[136:139], v[24:27], a[16:19]
    ds_read_b64_tr_b16 a[168:169], v17 offset:49152
    ds_read_b64_tr_b16 a[170:171], v17 offset:53248
    v_mfma_f32_16x16x32_bf16 a[16:19], a[140:143], v[244:247], a[16:19]
    s_add_u32 m0, s82, 81920
    s_nop 0
    buffer_load_dwordx4 v32, s[52:55], s85 offen lds
    v_mfma_f32_16x16x32_bf16 a[20:23], a[136:139], v[28:31], a[20:23]
    v_mov_b32 v236, 0x53800000
    s_mov_b64 s[88:89], 0
    v_rcp_f32 v200, v224
    v_cmp_nle_f32 vcc, v224, v236
    s_or_b64 s[88:89], s[88:89], vcc
    v_rcp_f32 v201, v216
    v_cmp_nle_f32 vcc, v216, v236
    s_or_b64 s[88:89], s[88:89], vcc
    v_rcp_f32 v202, v226
    v_cmp_nle_f32 vcc, v226, v236
    s_or_b64 s[88:89], s[88:89], vcc
    v_rcp_f32 v203, v220
    v_cmp_nle_f32 vcc, v220, v236
    s_or_b64 s[88:89], s[88:89], vcc
    v_mfma_f32_16x16x32_bf16 a[20:23], a[140:143], v[248:251], a[20:23]
    v_mfma_f32_16x16x32_bf16 a[24:27], a[136:139], v[36:39], a[24:27]
    ds_read_b64_tr_b16 a[172:173], v17 offset:57344
    ds_read_b64_tr_b16 a[174:175], v17 offset:61440
    v_mfma_f32_16x16x32_bf16 a[24:27], a[140:143], v[232:235], a[24:27]
    buffer_load_dwordx4 v34, s[52:55], s85 offen offset:1024 lds
    s_add_u32 s85, s85, 32768
    v_mfma_f32_16x16x32_bf16 a[28:31], a[136:139], v[4:7], a[28:31]
    v_mfma_f32_16x16x32_bf16 a[28:31], a[140:143], v[228:231], a[28:31]
    s_waitcnt lgkmcnt(8)
    v_mfma_f32_16x16x32_bf16 a[32:35], a[144:147], v[24:27], a[32:35]
    ds_read_b64_tr_b16 a[176:177], v18 offset:49152
    ds_read_b64_tr_b16 a[178:179], v18 offset:53248
    v_mfma_f32_16x16x32_bf16 a[32:35], a[148:151], v[244:247], a[32:35]
    v_mfma_f32_16x16x32_bf16 a[36:39], a[144:147], v[28:31], a[36:39]
    v_mfma_f32_16x16x32_bf16 a[36:39], a[148:151], v[248:251], a[36:39]
    v_mfma_f32_16x16x32_bf16 a[40:43], a[144:147], v[36:39], a[40:43]
    ds_read_b64_tr_b16 a[180:181], v18 offset:57344
    ds_read_b64_tr_b16 a[182:183], v18 offset:61440
    v_mfma_f32_16x16x32_bf16 a[40:43], a[148:151], v[232:235], a[40:43]
    v_mfma_f32_16x16x32_bf16 a[44:47], a[144:147], v[4:7], a[44:47]
    v_mfma_f32_16x16x32_bf16 a[44:47], a[148:151], v[228:231], a[44:47]
    v_accvgpr_read_b32 v104, a0
    v_accvgpr_read_b32 v105, a1
    v_accvgpr_read_b32 v106, a2
    v_mfma_f32_16x16x32_bf16 a[48:51], a[152:155], v[24:27], a[48:51]
    ds_read_b64_tr_b16 a[184:185], v19 offset:49152
    ds_read_b64_tr_b16 a[186:187], v19 offset:53248
    v_accvgpr_read_b32 v107, a3
    v_accvgpr_read_b32 v108, a16
    v_accvgpr_read_b32 v109, a17
    v_mfma_f32_16x16x32_bf16 a[48:51], a[156:159], v[244:247], a[48:51]
    v_accvgpr_read_b32 v110, a18
    v_accvgpr_read_b32 v111, a19
    v_mul_f32 v104, v104, v200
    v_mfma_f32_16x16x32_bf16 a[52:55], a[152:155], v[28:31], a[52:55]
    v_mul_f32 v105, v105, v200
    v_mul_f32 v106, v106, v200
    v_mul_f32 v107, v107, v200
    v_mfma_f32_16x16x32_bf16 a[52:55], a[156:159], v[248:251], a[52:55]
    v_mul_f32 v108, v108, v200
    v_mul_f32 v109, v109, v200
    v_mul_f32 v110, v110, v200
    v_mfma_f32_16x16x32_bf16 a[56:59], a[152:155], v[36:39], a[56:59]
    ds_read_b64_tr_b16 a[188:189], v19 offset:57344
    ds_read_b64_tr_b16 a[190:191], v19 offset:61440
    v_mul_f32 v111, v111, v200
    v_cvt_pk_bf16_f32 v112, v104, v105
    v_cvt_pk_bf16_f32 v113, v106, v107
    v_mfma_f32_16x16x32_bf16 a[56:59], a[156:159], v[232:235], a[56:59]
    v_cvt_pk_bf16_f32 v114, v108, v109
    v_cvt_pk_bf16_f32 v115, v110, v111
    buffer_store_dwordx4 v[112:115], v33, s[44:47], s11 offen offset:0 sc1
    v_mfma_f32_16x16x32_bf16 a[60:63], a[152:155], v[4:7], a[60:63]
    v_accvgpr_read_b32 v116, a4
    v_accvgpr_read_b32 v117, a5
    v_accvgpr_read_b32 v118, a6
    v_mfma_f32_16x16x32_bf16 a[60:63], a[156:159], v[228:231], a[60:63]
    s_waitcnt lgkmcnt(8)
    v_accvgpr_read_b32 v119, a7
    v_accvgpr_read_b32 v120, a20
    v_accvgpr_read_b32 v121, a21
    v_mfma_f32_16x16x32_bf16 a[64:67], a[160:163], v[24:27], a[64:67]
    v_accvgpr_read_b32 v122, a22
    v_accvgpr_read_b32 v123, a23
    v_mul_f32 v116, v116, v201
    v_mfma_f32_16x16x32_bf16 a[64:67], a[164:167], v[244:247], a[64:67]
    v_mul_f32 v117, v117, v201
    v_mul_f32 v118, v118, v201
    v_mul_f32 v119, v119, v201
    v_mfma_f32_16x16x32_bf16 a[68:71], a[160:163], v[28:31], a[68:71]
    v_mul_f32 v120, v120, v201
    v_mul_f32 v121, v121, v201
    v_mul_f32 v122, v122, v201
    v_mfma_f32_16x16x32_bf16 a[68:71], a[164:167], v[248:251], a[68:71]
    v_mul_f32 v123, v123, v201
    v_cvt_pk_bf16_f32 v124, v116, v117
    v_cvt_pk_bf16_f32 v125, v118, v119
    v_mfma_f32_16x16x32_bf16 a[72:75], a[160:163], v[36:39], a[72:75]
    v_cvt_pk_bf16_f32 v126, v120, v121
    v_cvt_pk_bf16_f32 v127, v122, v123
    buffer_store_dwordx4 v[124:127], v33, s[44:47], s11 offen offset:1024 sc1
    v_mfma_f32_16x16x32_bf16 a[72:75], a[164:167], v[232:235], a[72:75]
    v_accvgpr_read_b32 v128, a8
    v_accvgpr_read_b32 v129, a9
    v_accvgpr_read_b32 v130, a10
    v_mfma_f32_16x16x32_bf16 a[76:79], a[160:163], v[4:7], a[76:79]
    v_accvgpr_read_b32 v131, a11
    v_accvgpr_read_b32 v132, a24
    v_accvgpr_read_b32 v133, a25
    v_mfma_f32_16x16x32_bf16 a[76:79], a[164:167], v[228:231], a[76:79]
    v_accvgpr_read_b32 v134, a26
    v_accvgpr_read_b32 v135, a27
    v_mul_f32 v128, v128, v202
    v_mfma_f32_16x16x32_bf16 a[80:83], a[168:171], v[24:27], a[80:83]
    v_mul_f32 v129, v129, v202
    v_mul_f32 v130, v130, v202
    v_mul_f32 v131, v131, v202
    v_mfma_f32_16x16x32_bf16 a[80:83], a[172:175], v[244:247], a[80:83]
    v_mul_f32 v132, v132, v202
    v_mul_f32 v133, v133, v202
    v_mul_f32 v134, v134, v202
    v_mfma_f32_16x16x32_bf16 a[84:87], a[168:171], v[28:31], a[84:87]
    v_mul_f32 v135, v135, v202
    v_cvt_pk_bf16_f32 v136, v128, v129
    v_cvt_pk_bf16_f32 v137, v130, v131
    v_mfma_f32_16x16x32_bf16 a[84:87], a[172:175], v[248:251], a[84:87]
    v_cvt_pk_bf16_f32 v138, v132, v133
    v_cvt_pk_bf16_f32 v139, v134, v135
    buffer_store_dwordx4 v[136:139], v33, s[44:47], s11 offen offset:2048 sc1
    v_mfma_f32_16x16x32_bf16 a[88:91], a[168:171], v[36:39], a[88:91]
    v_accvgpr_read_b32 v140, a12
    v_accvgpr_read_b32 v141, a13
    v_accvgpr_read_b32 v142, a14
    v_mfma_f32_16x16x32_bf16 a[88:91], a[172:175], v[232:235], a[88:91]
    v_accvgpr_read_b32 v143, a15
    v_accvgpr_read_b32 v144, a28
    v_accvgpr_read_b32 v145, a29
    v_mfma_f32_16x16x32_bf16 a[92:95], a[168:171], v[4:7], a[92:95]
    v_accvgpr_read_b32 v146, a30
    v_accvgpr_read_b32 v147, a31
    v_mul_f32 v140, v140, v203
    v_mfma_f32_16x16x32_bf16 a[92:95], a[172:175], v[228:231], a[92:95]
    s_waitcnt lgkmcnt(0)
    v_mul_f32 v141, v141, v203
    v_mul_f32 v142, v142, v203
    v_mul_f32 v143, v143, v203
    v_mfma_f32_16x16x32_bf16 a[96:99], a[176:179], v[24:27], a[96:99]
    v_mul_f32 v144, v144, v203
    v_mul_f32 v145, v145, v203
    v_mul_f32 v146, v146, v203
    v_mfma_f32_16x16x32_bf16 a[96:99], a[180:183], v[244:247], a[96:99]
    v_mul_f32 v147, v147, v203
    v_cvt_pk_bf16_f32 v148, v140, v141
    v_cvt_pk_bf16_f32 v149, v142, v143
    v_mfma_f32_16x16x32_bf16 a[100:103], a[176:179], v[28:31], a[100:103]
    v_cvt_pk_bf16_f32 v150, v144, v145
    v_cvt_pk_bf16_f32 v151, v146, v147
    buffer_store_dwordx4 v[148:151], v33, s[44:47], s11 offen offset:3072 sc1
    v_mfma_f32_16x16x32_bf16 a[100:103], a[180:183], v[248:251], a[100:103]
    s_add_u32 s11, s11, 131072
    v_accvgpr_read_b32 v104, a32
    v_accvgpr_read_b32 v105, a33
    v_mfma_f32_16x16x32_bf16 a[104:107], a[176:179], v[36:39], a[104:107]
    v_accvgpr_read_b32 v106, a34
    v_accvgpr_read_b32 v107, a35
    v_accvgpr_read_b32 v108, a48
    v_mfma_f32_16x16x32_bf16 a[104:107], a[180:183], v[232:235], a[104:107]
    v_accvgpr_read_b32 v109, a49
    v_accvgpr_read_b32 v110, a50
    v_accvgpr_read_b32 v111, a51
    v_mfma_f32_16x16x32_bf16 a[108:111], a[176:179], v[4:7], a[108:111]
    v_mul_f32 v104, v104, v200
    v_mul_f32 v105, v105, v200
    v_mul_f32 v106, v106, v200
    v_mfma_f32_16x16x32_bf16 a[108:111], a[180:183], v[228:231], a[108:111]
    v_mul_f32 v107, v107, v200
    v_mul_f32 v108, v108, v200
    v_mul_f32 v109, v109, v200
    v_mfma_f32_16x16x32_bf16 a[112:115], a[184:187], v[24:27], a[112:115]
    buffer_load_dword v252, v35, s[44:47], s87 offen sc1
    v_mul_f32 v110, v110, v200
    v_mul_f32 v111, v111, v200
    v_cvt_pk_bf16_f32 v112, v104, v105
    v_mfma_f32_16x16x32_bf16 a[112:115], a[188:191], v[244:247], a[112:115]
    v_cvt_pk_bf16_f32 v113, v106, v107
    v_cvt_pk_bf16_f32 v114, v108, v109
    v_cvt_pk_bf16_f32 v115, v110, v111
    v_mfma_f32_16x16x32_bf16 a[116:119], a[184:187], v[28:31], a[116:119]
    buffer_store_dwordx4 v[112:115], v33, s[44:47], s11 offen offset:0 sc1
    v_accvgpr_read_b32 v116, a36
    v_accvgpr_read_b32 v117, a37
    v_mfma_f32_16x16x32_bf16 a[116:119], a[188:191], v[248:251], a[116:119]
    v_accvgpr_read_b32 v118, a38
    v_accvgpr_read_b32 v119, a39
    v_accvgpr_read_b32 v120, a52
    v_mfma_f32_16x16x32_bf16 a[120:123], a[184:187], v[36:39], a[120:123]
    v_accvgpr_read_b32 v121, a53
    v_accvgpr_read_b32 v122, a54
    v_accvgpr_read_b32 v123, a55
    v_mfma_f32_16x16x32_bf16 a[120:123], a[188:191], v[232:235], a[120:123]
    v_mul_f32 v116, v116, v201
    v_mul_f32 v117, v117, v201
    v_mul_f32 v118, v118, v201
    v_mfma_f32_16x16x32_bf16 a[124:127], a[184:187], v[4:7], a[124:127]
    v_mul_f32 v119, v119, v201
    v_mul_f32 v120, v120, v201
    v_mul_f32 v121, v121, v201
    v_mfma_f32_16x16x32_bf16 a[124:127], a[188:191], v[228:231], a[124:127]
    v_mul_f32 v122, v122, v201
    v_mul_f32 v123, v123, v201
    v_cvt_pk_bf16_f32 v124, v116, v117
    v_cvt_pk_bf16_f32 v125, v118, v119
    v_cvt_pk_bf16_f32 v126, v120, v121
    v_cvt_pk_bf16_f32 v127, v122, v123
    buffer_store_dwordx4 v[124:127], v33, s[44:47], s11 offen offset:1024 sc1
    v_accvgpr_read_b32 v128, a40
    v_accvgpr_read_b32 v129, a41
    v_accvgpr_read_b32 v130, a42
    v_accvgpr_read_b32 v131, a43
    v_accvgpr_read_b32 v132, a56
    v_accvgpr_read_b32 v133, a57
    v_accvgpr_read_b32 v134, a58
    v_accvgpr_read_b32 v135, a59
    v_mul_f32 v128, v128, v202
    v_mul_f32 v129, v129, v202
    v_mul_f32 v130, v130, v202
    v_mul_f32 v131, v131, v202
    v_mul_f32 v132, v132, v202
    v_mul_f32 v133, v133, v202
    v_mul_f32 v134, v134, v202
    v_mul_f32 v135, v135, v202
    v_cvt_pk_bf16_f32 v136, v128, v129
    v_cvt_pk_bf16_f32 v137, v130, v131
    v_cvt_pk_bf16_f32 v138, v132, v133
    v_cvt_pk_bf16_f32 v139, v134, v135
    buffer_store_dwordx4 v[136:139], v33, s[44:47], s11 offen offset:2048 sc1
    v_accvgpr_read_b32 v140, a44
    v_accvgpr_read_b32 v141, a45
    v_accvgpr_read_b32 v142, a46
    v_accvgpr_read_b32 v143, a47
    v_accvgpr_read_b32 v144, a60
    v_accvgpr_read_b32 v145, a61
    v_accvgpr_read_b32 v146, a62
    v_accvgpr_read_b32 v147, a63
    v_mul_f32 v140, v140, v203
    v_mul_f32 v141, v141, v203
    v_mul_f32 v142, v142, v203
    v_mul_f32 v143, v143, v203
    v_mul_f32 v144, v144, v203
    v_mul_f32 v145, v145, v203
    v_mul_f32 v146, v146, v203
    v_mul_f32 v147, v147, v203
    v_cvt_pk_bf16_f32 v148, v140, v141
    v_cvt_pk_bf16_f32 v149, v142, v143
    v_cvt_pk_bf16_f32 v150, v144, v145
    v_cvt_pk_bf16_f32 v151, v146, v147
    buffer_store_dwordx4 v[148:151], v33, s[44:47], s11 offen offset:3072 sc1
    s_add_u32 s11, s11, 131072
    v_accvgpr_read_b32 v104, a64
    v_accvgpr_read_b32 v105, a65
    v_accvgpr_read_b32 v106, a66
    v_accvgpr_read_b32 v107, a67
    v_accvgpr_read_b32 v108, a80
    v_accvgpr_read_b32 v109, a81
    v_accvgpr_read_b32 v110, a82
    v_accvgpr_read_b32 v111, a83
    v_mul_f32 v104, v104, v200
    v_mul_f32 v105, v105, v200
    v_mul_f32 v106, v106, v200
    v_mul_f32 v107, v107, v200
    v_mul_f32 v108, v108, v200
    v_mul_f32 v109, v109, v200
    v_mul_f32 v110, v110, v200
    v_mul_f32 v111, v111, v200
    v_cvt_pk_bf16_f32 v112, v104, v105
    v_cvt_pk_bf16_f32 v113, v106, v107
    v_cvt_pk_bf16_f32 v114, v108, v109
    v_cvt_pk_bf16_f32 v115, v110, v111
    buffer_store_dwordx4 v[112:115], v33, s[44:47], s11 offen offset:0 sc1
    v_accvgpr_read_b32 v116, a68
    v_accvgpr_read_b32 v117, a69
    v_accvgpr_read_b32 v118, a70
    v_accvgpr_read_b32 v119, a71
    v_accvgpr_read_b32 v120, a84
    v_accvgpr_read_b32 v121, a85
    v_accvgpr_read_b32 v122, a86
    v_accvgpr_read_b32 v123, a87
    v_mul_f32 v116, v116, v201
    v_mul_f32 v117, v117, v201
    v_mul_f32 v118, v118, v201
    v_mul_f32 v119, v119, v201
    v_mul_f32 v120, v120, v201
    v_mul_f32 v121, v121, v201
    v_mul_f32 v122, v122, v201
    v_mul_f32 v123, v123, v201
    v_cvt_pk_bf16_f32 v124, v116, v117
    v_cvt_pk_bf16_f32 v125, v118, v119
    v_cvt_pk_bf16_f32 v126, v120, v121
    v_cvt_pk_bf16_f32 v127, v122, v123
    buffer_store_dwordx4 v[124:127], v33, s[44:47], s11 offen offset:1024 sc1
    v_accvgpr_read_b32 v128, a72
    v_accvgpr_read_b32 v129, a73
    v_accvgpr_read_b32 v130, a74
    v_accvgpr_read_b32 v131, a75
    v_accvgpr_read_b32 v132, a88
    v_accvgpr_read_b32 v133, a89
    v_accvgpr_read_b32 v134, a90
    v_accvgpr_read_b32 v135, a91
    v_mul_f32 v128, v128, v202
    v_mul_f32 v129, v129, v202
    v_mul_f32 v130, v130, v202
    v_mul_f32 v131, v131, v202
    v_mul_f32 v132, v132, v202
    v_mul_f32 v133, v133, v202
    v_mul_f32 v134, v134, v202
    v_mul_f32 v135, v135, v202
    v_cvt_pk_bf16_f32 v136, v128, v129
    v_cvt_pk_bf16_f32 v137, v130, v131
    v_cvt_pk_bf16_f32 v138, v132, v133
    v_cvt_pk_bf16_f32 v139, v134, v135
    buffer_store_dwordx4 v[136:139], v33, s[44:47], s11 offen offset:2048 sc1
    v_accvgpr_read_b32 v140, a76
    v_accvgpr_read_b32 v141, a77
    v_accvgpr_read_b32 v142, a78
    v_accvgpr_read_b32 v143, a79
    v_accvgpr_read_b32 v144, a92
    v_accvgpr_read_b32 v145, a93
    v_accvgpr_read_b32 v146, a94
    v_accvgpr_read_b32 v147, a95
    v_mul_f32 v140, v140, v203
    v_mul_f32 v141, v141, v203
    v_mul_f32 v142, v142, v203
    v_mul_f32 v143, v143, v203
    v_mul_f32 v144, v144, v203
    v_mul_f32 v145, v145, v203
    v_mul_f32 v146, v146, v203
    v_mul_f32 v147, v147, v203
    v_cvt_pk_bf16_f32 v148, v140, v141
    v_cvt_pk_bf16_f32 v149, v142, v143
    v_cvt_pk_bf16_f32 v150, v144, v145
    v_cvt_pk_bf16_f32 v151, v146, v147
    buffer_store_dwordx4 v[148:151], v33, s[44:47], s11 offen offset:3072 sc1
    s_add_u32 s11, s11, 131072
    s_nop 7
    v_accvgpr_read_b32 v104, a96
    v_accvgpr_read_b32 v105, a97
    v_accvgpr_read_b32 v106, a98
    v_accvgpr_read_b32 v107, a99
    v_accvgpr_read_b32 v108, a112
    v_accvgpr_read_b32 v109, a113
    v_accvgpr_read_b32 v110, a114
    v_accvgpr_read_b32 v111, a115
    v_mul_f32 v104, v104, v200
    v_mul_f32 v105, v105, v200
    v_mul_f32 v106, v106, v200
    v_mul_f32 v107, v107, v200
    v_mul_f32 v108, v108, v200
    v_mul_f32 v109, v109, v200
    v_mul_f32 v110, v110, v200
    v_mul_f32 v111, v111, v200
    v_cvt_pk_bf16_f32 v112, v104, v105
    v_cvt_pk_bf16_f32 v113, v106, v107
    v_cvt_pk_bf16_f32 v114, v108, v109
    v_cvt_pk_bf16_f32 v115, v110, v111
    buffer_store_dwordx4 v[112:115], v33, s[44:47], s11 offen offset:0 sc1
    v_accvgpr_read_b32 v116, a100
    v_accvgpr_read_b32 v117, a101
    v_accvgpr_read_b32 v118, a102
    v_accvgpr_read_b32 v119, a103
    v_accvgpr_read_b32 v120, a116
    v_accvgpr_read_b32 v121, a117
    v_accvgpr_read_b32 v122, a118
    v_accvgpr_read_b32 v123, a119
    v_mul_f32 v116, v116, v201
    v_mul_f32 v117, v117, v201
    v_mul_f32 v118, v118, v201
    v_mul_f32 v119, v119, v201
    v_mul_f32 v120, v120, v201
    v_mul_f32 v121, v121, v201
    v_mul_f32 v122, v122, v201
    v_mul_f32 v123, v123, v201
    v_cvt_pk_bf16_f32 v124, v116, v117
    v_cvt_pk_bf16_f32 v125, v118, v119
    v_cvt_pk_bf16_f32 v126, v120, v121
    v_cvt_pk_bf16_f32 v127, v122, v123
    buffer_store_dwordx4 v[124:127], v33, s[44:47], s11 offen offset:1024 sc1
    v_accvgpr_read_b32 v128, a104
    v_accvgpr_read_b32 v129, a105
    v_accvgpr_read_b32 v130, a106
    v_accvgpr_read_b32 v131, a107
    v_accvgpr_read_b32 v132, a120
    v_accvgpr_read_b32 v133, a121
    v_accvgpr_read_b32 v134, a122
    v_accvgpr_read_b32 v135, a123
    v_mul_f32 v128, v128, v202
    v_mul_f32 v129, v129, v202
    v_mul_f32 v130, v130, v202
    v_mul_f32 v131, v131, v202
    v_mul_f32 v132, v132, v202
    v_mul_f32 v133, v133, v202
    v_mul_f32 v134, v134, v202
    v_mul_f32 v135, v135, v202
    v_cvt_pk_bf16_f32 v136, v128, v129
    v_cvt_pk_bf16_f32 v137, v130, v131
    v_cvt_pk_bf16_f32 v138, v132, v133
    v_cvt_pk_bf16_f32 v139, v134, v135
    buffer_store_dwordx4 v[136:139], v33, s[44:47], s11 offen offset:2048 sc1
    v_accvgpr_read_b32 v140, a108
    v_accvgpr_read_b32 v141, a109
    v_accvgpr_read_b32 v142, a110
    v_accvgpr_read_b32 v143, a111
    v_accvgpr_read_b32 v144, a124
    v_accvgpr_read_b32 v145, a125
    v_accvgpr_read_b32 v146, a126
    v_accvgpr_read_b32 v147, a127
    v_mul_f32 v140, v140, v203
    v_mul_f32 v141, v141, v203
    v_mul_f32 v142, v142, v203
    v_mul_f32 v143, v143, v203
    v_mul_f32 v144, v144, v203
    v_mul_f32 v145, v145, v203
    v_mul_f32 v146, v146, v203
    v_mul_f32 v147, v147, v203
    v_cvt_pk_bf16_f32 v148, v140, v141
    v_cvt_pk_bf16_f32 v149, v142, v143
    v_cvt_pk_bf16_f32 v150, v144, v145
    v_cvt_pk_bf16_f32 v151, v146, v147
    buffer_store_dwordx4 v[148:151], v33, s[44:47], s11 offen offset:3072 sc1
F_PUB:
    s_cmp_lg_u64 s[88:89], 0
    s_cselect_b32 s90, 1, 0
    s_waitcnt vmcnt(12)
    v_cmp_ne_u32 vcc, s79, v252
    s_cmp_lg_u64 vcc, 0
    s_cselect_b32 s91, 2, 0
    s_or_b32 s90, s90, s91
    v_mov_b32 v237, s90
    v_lshlrev_b32 v238, 2, v2
    v_add_u32 v238, 135168, v238
    ds_write_b32 v238, v237
    v_mov_b32 v238, 135168
    s_lshl_b32 s88, s78, 12
    s_lshr_b32 s89, s77, 3
    s_lshl_b32 s89, s89, 9
    s_add_u32 s88, s88, s89
    s_and_b32 s89, s77, 7
    s_lshl_b32 s89, s89, 2
    s_add_u32 s88, s88, s89
    s_add_u32 s88, s88, 131072
    v_lshrrev_b32 v5, 2, v1
    v_lshlrev_b32 v5, 11, v5
    v_and_b32 v6, 3, v1
    v_lshl_add_u32 v5, v6, 7, v5
    v_mov_b32 v6, s79
    v_subrev_u32 v184, 0x10000, v12
    v_subrev_u32 v185, 0x10000, v13
    v_subrev_u32 v186, 0x10000, v14
    v_subrev_u32 v187, 0x10000, v15
    v_subrev_u32 v188, 0x10000, v16
    v_subrev_u32 v189, 0x10000, v17
    v_subrev_u32 v190, 0x10000, v18
    v_subrev_u32 v191, 0x10000, v19
    s_lshl_b32 s86, s4, 22
    s_lshl_b32 s89, s5, 13
    s_add_u32 s86, s86, s89
    s_add_u32 s86, s86, s82
    s_add_u32 s86, s86, 8388608
    s_waitcnt vmcnt(0) lgkmcnt(0)
    s_barrier
    ds_read_b128 v[240:243], v238
    s_waitcnt lgkmcnt(0)
    v_or_b32 v240, v240, v241
    v_or3_b32 v240, v240, v242, v243
    s_nop 0
    v_readfirstlane_b32 s90, v240
    s_bitcmp1_b32 s90, 0
    s_cbranch_scc1 F_SLOW
    s_cmp_lg_u32 s76, 0
    s_cbranch_scc1 FO_sig
    s_mov_b64 exec, 0xff
    buffer_store_dword v6, v5, s[44:47], s88 offen sc1
    s_mov_b64 exec, -1
FO_sig:
    s_bitcmp1_b32 s90, 1
    s_cbranch_scc0 FO_go
    s_cmp_lg_u32 s76, 0
    s_cbranch_scc1 FO_done
    s_mov_b32 s91, 262144
FOW_loop:
    buffer_load_dword v252, v35, s[44:47], s87 offen sc1
    s_waitcnt vmcnt(0)
    v_cmp_ne_u32 vcc, s79, v252
    s_cbranch_vccz FOW_out
    s_sleep 2
    s_sub_u32 s91, s91, 1
    s_cbranch_scc0 FOW_loop
FOW_out:
FO_done:
    s_barrier
FO_go:
    buffer_load_dwordx4 a[0:3], v33, s[44:47], s86 offen offset:0 sc1
    buffer_load_dwordx4 a[4:7], v33, s[44:47], s86 offen offset:1024 sc1
    s_add_u32 s86, s86, 131072
    buffer_load_dwordx4 a[8:11], v33, s[44:47], s86 offen offset:0 sc1
    buffer_load_dwordx4 a[12:15], v33, s[44:47], s86 offen offset:1024 sc1
    s_add_u32 s86, s86, 131072
    ds_read_b64_tr_b16 a[128:129], v184 offset:24576
    ds_read_b64_tr_b16 a[130:131], v184 offset:28672
    ds_read_b64_tr_b16 a[132:133], v184 offset:32768
    ds_read_b64_tr_b16 a[134:135], v184 offset:36864
    ds_read_b64_tr_b16 a[136:137], v185 offset:24576
    ds_read_b64_tr_b16 a[138:139], v185 offset:28672
    ds_read_b64_tr_b16 a[140:141], v185 offset:32768
    ds_read_b64_tr_b16 a[142:143], v185 offset:36864
    ds_read_b64_tr_b16 a[144:145], v186 offset:24576
    ds_read_b64_tr_b16 a[146:147], v186 offset:28672
    ds_read_b64_tr_b16 a[148:149], v186 offset:32768
    ds_read_b64_tr_b16 a[150:151], v186 offset:36864
    ds_read_b64_tr_b16 a[152:153], v187 offset:24576
    ds_read_b64_tr_b16 a[154:155], v187 offset:28672
    ds_read_b64_tr_b16 a[156:157], v187 offset:32768
    ds_read_b64_tr_b16 a[158:159], v187 offset:36864
    buffer_load_dwordx4 a[16:19], v33, s[44:47], s86 offen offset:0 sc1
    buffer_load_dwordx4 a[20:23], v33, s[44:47], s86 offen offset:1024 sc1
    s_add_u32 s86, s86, 131072
    buffer_load_dwordx4 a[24:27], v33, s[44:47], s86 offen offset:0 sc1
    buffer_load_dwordx4 a[28:31], v33, s[44:47], s86 offen offset:1024 sc1
    s_add_u32 s86, s86, 131072
    buffer_load_dwordx4 a[32:35], v33, s[44:47], s86 offen offset:0 sc1
    buffer_load_dwordx4 a[36:39], v33, s[44:47], s86 offen offset:1024 sc1
    s_add_u32 s86, s86, 131072
    buffer_load_dwordx4 a[40:43], v33, s[44:47], s86 offen offset:0 sc1
    buffer_load_dwordx4 a[44:47], v33, s[44:47], s86 offen offset:1024 sc1
    s_add_u32 s86, s86, 131072
    buffer_load_dwordx4 a[48:51], v33, s[44:47], s86 offen offset:0 sc1
    buffer_load_dwordx4 a[52:55], v33, s[44:47], s86 offen offset:1024 sc1
    s_add_u32 s86, s86, 131072
    buffer_load_dwordx4 a[56:59], v33, s[44:47], s86 offen offset:0 sc1
    buffer_load_dwordx4 a[60:63], v33, s[44:47], s86 offen offset:1024 sc1
    s_add_u32 s86, s86, 131072
    buffer_load_dwordx4 a[64:67], v33, s[44:47], s86 offen offset:0 sc1
    buffer_load_dwordx4 a[68:71], v33, s[44:47], s86 offen offset:1024 sc1
    s_add_u32 s86, s86, 131072
    buffer_load_dwordx4 a[72:75], v33, s[44:47], s86 offen offset:0 sc1
    buffer_load_dwordx4 a[76:79], v33, s[44:47], s86 offen offset:1024 sc1
    s_add_u32 s86, s86, 131072
    v_lshrrev_b32 v5, 5, v1
    v_bfe_u32 v6, v1, 3, 2
    v_and_b32 v7, 7, v1
    v_lshlrev_b32 v196, 10, v5
    v_lshl_add_u32 v196, v6, 8, v196
    v_lshl_add_u32 v196, v7, 4, v196
    v_lshl_add_u32 v5, v5, 3, v6
    v_lshlrev_b32 v198, 4, v5
    v_lshl_add_u32 v198, v2, 9, v198
    v_lshrrev_b32 v5, 1, v198
    v_lshl_add_u32 v197, v7, 10, v5
    v_lshrrev_b32 v31, 1, v198
    s_lshl_b32 s88, s8, 15
    s_lshl_b32 s89, s76, 13
    s_add_u32 s88, s88, s89
    s_add_u32 s88, s88, 25165824
    s_add_u32 s89, s88, 4096
    s_lshl_b32 s16, s5, 19
    s_lshr_b32 s17, s7, 1
    s_lshl_b32 s17, s17, 12
    s_add_u32 s16, s16, s17
    s_and_b32 s17, s7, 1
    s_lshl_b32 s17, s17, 7
    s_add_u32 s16, s16, s17
    s_lshl_b32 s17, s76, 15
    s_add_u32 s16, s16, s17
    s_add_u32 s16, s16, 25165824
    s_add_u32 s17, s16, 131072
    s_add_u32 s18, s16, 262144
    s_add_u32 s19, s16, 393216
    s_lshl_b32 s90, s8, 7
    s_add_u32 s90, s90, 163840
    s_lshl_b32 s13, s5, 11
    s_lshl_b32 s91, s76, 9
    s_add_u32 s13, s13, s91
    s_lshl_b32 s91, s7, 2
    s_add_u32 s13, s13, s91
    s_add_u32 s13, s13, 163840
    v_lshlrev_b32 v5, 7, v1
    v_mov_b32 v6, s79
    v_lshlrev_b32 v35, 2, v3
    v_add_u32 v7, 155648, v198
    s_waitcnt vmcnt(16)
    s_waitcnt lgkmcnt(8)
    v_mfma_f32_16x16x32_bf16 v[40:43], a[128:131], a[0:3], 0
    ds_read_b64_tr_b16 a[160:161], v188 offset:24576
    ds_read_b64_tr_b16 a[162:163], v188 offset:28672
    v_mfma_f32_16x16x32_bf16 v[40:43], a[132:135], a[8:11], v[40:43]
    s_add_u32 m0, s82, 90112
    v_mfma_f32_16x16x32_bf16 v[72:75], a[128:131], a[4:7], 0
    ds_read_b64_tr_b16 a[164:165], v188 offset:32768
    ds_read_b64_tr_b16 a[166:167], v188 offset:36864
    v_mfma_f32_16x16x32_bf16 v[72:75], a[132:135], a[12:15], v[72:75]
    buffer_load_dwordx4 v32, s[52:55], s85 offen lds
    v_mfma_f32_16x16x32_bf16 v[44:47], a[136:139], a[0:3], 0
    ds_read_b64_tr_b16 a[168:169], v189 offset:24576
    ds_read_b64_tr_b16 a[170:171], v189 offset:28672
    v_mfma_f32_16x16x32_bf16 v[44:47], a[140:143], a[8:11], v[44:47]
    buffer_load_dwordx4 v34, s[52:55], s85 offen offset:1024 lds
    v_mfma_f32_16x16x32_bf16 v[76:79], a[136:139], a[4:7], 0
    ds_read_b64_tr_b16 a[172:173], v189 offset:32768
    ds_read_b64_tr_b16 a[174:175], v189 offset:36864
    v_mfma_f32_16x16x32_bf16 v[76:79], a[140:143], a[12:15], v[76:79]
    s_waitcnt lgkmcnt(8)
    v_mfma_f32_16x16x32_bf16 v[48:51], a[144:147], a[0:3], 0
    ds_read_b64_tr_b16 a[176:177], v190 offset:24576
    ds_read_b64_tr_b16 a[178:179], v190 offset:28672
    v_mfma_f32_16x16x32_bf16 v[48:51], a[148:151], a[8:11], v[48:51]
    s_add_u32 s85, s85, 32768
    buffer_load_dwordx4 a[80:83], v33, s[44:47], s86 offen offset:0 sc1
    v_mfma_f32_16x16x32_bf16 v[80:83], a[144:147], a[4:7], 0
    ds_read_b64_tr_b16 a[180:181], v190 offset:32768
    ds_read_b64_tr_b16 a[182:183], v190 offset:36864
    v_mfma_f32_16x16x32_bf16 v[80:83], a[148:151], a[12:15], v[80:83]
    buffer_load_dwordx4 a[84:87], v33, s[44:47], s86 offen offset:1024 sc1
    v_mfma_f32_16x16x32_bf16 v[52:55], a[152:155], a[0:3], 0
    ds_read_b64_tr_b16 a[184:185], v191 offset:24576
    ds_read_b64_tr_b16 a[186:187], v191 offset:28672
    v_mfma_f32_16x16x32_bf16 v[52:55], a[156:159], a[8:11], v[52:55]
    s_add_u32 s86, s86, 131072
    v_mfma_f32_16x16x32_bf16 v[84:87], a[152:155], a[4:7], 0
    ds_read_b64_tr_b16 a[188:189], v191 offset:32768
    ds_read_b64_tr_b16 a[190:191], v191 offset:36864
    v_mfma_f32_16x16x32_bf16 v[84:87], a[156:159], a[12:15], v[84:87]
    s_waitcnt lgkmcnt(8)
    v_mfma_f32_16x16x32_bf16 v[56:59], a[160:163], a[0:3], 0
    ds_read_b64_tr_b16 a[128:129], v12 offset:0
    ds_read_b64_tr_b16 a[130:131], v12 offset:4096
    v_mfma_f32_16x16x32_bf16 v[56:59], a[164:167], a[8:11], v[56:59]
    s_add_u32 m0, s82, 57344
    v_mfma_f32_16x16x32_bf16 v[88:91], a[160:163], a[4:7], 0
    ds_read_b64_tr_b16 a[132:133], v12 offset:8192
    ds_read_b64_tr_b16 a[134:135], v12 offset:12288
    v_mfma_f32_16x16x32_bf16 v[88:91], a[164:167], a[12:15], v[88:91]
    buffer_load_dwordx4 v32, s[52:55], s85 offen lds
    v_mfma_f32_16x16x32_bf16 v[60:63], a[168:171], a[0:3], 0
    ds_read_b64_tr_b16 a[136:137], v13 offset:0
    ds_read_b64_tr_b16 a[138:139], v13 offset:4096
    v_mfma_f32_16x16x32_bf16 v[60:63], a[172:175], a[8:11], v[60:63]
    buffer_load_dwordx4 v34, s[52:55], s85 offen offset:1024 lds
    v_mfma_f32_16x16x32_bf16 v[92:95], a[168:171], a[4:7], 0
    ds_read_b64_tr_b16 a[140:141], v13 offset:8192
    ds_read_b64_tr_b16 a[142:143], v13 offset:12288
    v_mfma_f32_16x16x32_bf16 v[92:95], a[172:175], a[12:15], v[92:95]
    s_waitcnt lgkmcnt(8)
    v_mfma_f32_16x16x32_bf16 v[64:67], a[176:179], a[0:3], 0
    ds_read_b64_tr_b16 a[144:145], v14 offset:0
    ds_read_b64_tr_b16 a[146:147], v14 offset:4096
    v_mfma_f32_16x16x32_bf16 v[64:67], a[180:183], a[8:11], v[64:67]
    s_add_u32 s85, s85, 32768
    buffer_load_dwordx4 a[88:91], v33, s[44:47], s86 offen offset:0 sc1
    v_mfma_f32_16x16x32_bf16 v[96:99], a[176:179], a[4:7], 0
    ds_read_b64_tr_b16 a[148:149], v14 offset:8192
    ds_read_b64_tr_b16 a[150:151], v14 offset:12288
    v_mfma_f32_16x16x32_bf16 v[96:99], a[180:183], a[12:15], v[96:99]
    buffer_load_dwordx4 a[92:95], v33, s[44:47], s86 offen offset:1024 sc1
    v_mfma_f32_16x16x32_bf16 v[68:71], a[184:187], a[0:3], 0
    ds_read_b64_tr_b16 a[152:153], v15 offset:0
    ds_read_b64_tr_b16 a[154:155], v15 offset:4096
    v_mfma_f32_16x16x32_bf16 v[68:71], a[188:191], a[8:11], v[68:71]
    s_add_u32 s86, s86, 131072
    v_mfma_f32_16x16x32_bf16 v[100:103], a[184:187], a[4:7], 0
    ds_read_b64_tr_b16 a[156:157], v15 offset:8192
    ds_read_b64_tr_b16 a[158:159], v15 offset:12288
    v_mfma_f32_16x16x32_bf16 v[100:103], a[188:191], a[12:15], v[100:103]
    s_waitcnt vmcnt(20)
    s_waitcnt lgkmcnt(8)
    v_mfma_f32_16x16x32_bf16 v[40:43], a[128:131], a[16:19], v[40:43]
    ds_read_b64_tr_b16 a[160:161], v16 offset:0
    ds_read_b64_tr_b16 a[162:163], v16 offset:4096
    v_mfma_f32_16x16x32_bf16 v[40:43], a[132:135], a[24:27], v[40:43]
    s_add_u32 m0, s82, 98304
    v_mfma_f32_16x16x32_bf16 v[72:75], a[128:131], a[20:23], v[72:75]
    ds_read_b64_tr_b16 a[164:165], v16 offset:8192
    ds_read_b64_tr_b16 a[166:167], v16 offset:12288
    v_mfma_f32_16x16x32_bf16 v[72:75], a[132:135], a[28:31], v[72:75]
    buffer_load_dwordx4 v32, s[52:55], s85 offen lds
    v_mfma_f32_16x16x32_bf16 v[44:47], a[136:139], a[16:19], v[44:47]
    ds_read_b64_tr_b16 a[168:169], v17 offset:0
    ds_read_b64_tr_b16 a[170:171], v17 offset:4096
    v_mfma_f32_16x16x32_bf16 v[44:47], a[140:143], a[24:27], v[44:47]
    buffer_load_dwordx4 v34, s[52:55], s85 offen offset:1024 lds
    v_mfma_f32_16x16x32_bf16 v[76:79], a[136:139], a[20:23], v[76:79]
    ds_read_b64_tr_b16 a[172:173], v17 offset:8192
    ds_read_b64_tr_b16 a[174:175], v17 offset:12288
    v_mfma_f32_16x16x32_bf16 v[76:79], a[140:143], a[28:31], v[76:79]
    s_waitcnt lgkmcnt(8)
    v_mfma_f32_16x16x32_bf16 v[48:51], a[144:147], a[16:19], v[48:51]
    ds_read_b64_tr_b16 a[176:177], v18 offset:0
    ds_read_b64_tr_b16 a[178:179], v18 offset:4096
    v_mfma_f32_16x16x32_bf16 v[48:51], a[148:151], a[24:27], v[48:51]
    s_add_u32 s85, s85, 32768
    buffer_load_dwordx4 a[0:3], v33, s[44:47], s86 offen offset:0 sc1
    v_mfma_f32_16x16x32_bf16 v[80:83], a[144:147], a[20:23], v[80:83]
    ds_read_b64_tr_b16 a[180:181], v18 offset:8192
    ds_read_b64_tr_b16 a[182:183], v18 offset:12288
    v_mfma_f32_16x16x32_bf16 v[80:83], a[148:151], a[28:31], v[80:83]
    buffer_load_dwordx4 a[4:7], v33, s[44:47], s86 offen offset:1024 sc1
    v_mfma_f32_16x16x32_bf16 v[52:55], a[152:155], a[16:19], v[52:55]
    ds_read_b64_tr_b16 a[184:185], v19 offset:0
    ds_read_b64_tr_b16 a[186:187], v19 offset:4096
    v_mfma_f32_16x16x32_bf16 v[52:55], a[156:159], a[24:27], v[52:55]
    s_add_u32 s86, s86, 131072
    v_mfma_f32_16x16x32_bf16 v[84:87], a[152:155], a[20:23], v[84:87]
    ds_read_b64_tr_b16 a[188:189], v19 offset:8192
    ds_read_b64_tr_b16 a[190:191], v19 offset:12288
    v_mfma_f32_16x16x32_bf16 v[84:87], a[156:159], a[28:31], v[84:87]
    s_barrier
    s_waitcnt lgkmcnt(8)
    v_mfma_f32_16x16x32_bf16 v[56:59], a[160:163], a[16:19], v[56:59]
    ds_read_b64_tr_b16 a[128:129], v184 offset:0
    ds_read_b64_tr_b16 a[130:131], v184 offset:4096
    v_mfma_f32_16x16x32_bf16 v[56:59], a[164:167], a[24:27], v[56:59]
    s_add_u32 m0, s82, 106496
    v_mfma_f32_16x16x32_bf16 v[88:91], a[160:163], a[20:23], v[88:91]
    ds_read_b64_tr_b16 a[132:133], v184 offset:8192
    ds_read_b64_tr_b16 a[134:135], v184 offset:12288
    v_mfma_f32_16x16x32_bf16 v[88:91], a[164:167], a[28:31], v[88:91]
    buffer_load_dwordx4 v32, s[52:55], s85 offen lds
    v_mfma_f32_16x16x32_bf16 v[60:63], a[168:171], a[16:19], v[60:63]
    ds_read_b64_tr_b16 a[136:137], v185 offset:0
    ds_read_b64_tr_b16 a[138:139], v185 offset:4096
    v_mfma_f32_16x16x32_bf16 v[60:63], a[172:175], a[24:27], v[60:63]
    buffer_load_dwordx4 v34, s[52:55], s85 offen offset:1024 lds
    v_mfma_f32_16x16x32_bf16 v[92:95], a[168:171], a[20:23], v[92:95]
    ds_read_b64_tr_b16 a[140:141], v185 offset:8192
    ds_read_b64_tr_b16 a[142:143], v185 offset:12288
    v_mfma_f32_16x16x32_bf16 v[92:95], a[172:175], a[28:31], v[92:95]
    s_waitcnt lgkmcnt(8)
    v_mfma_f32_16x16x32_bf16 v[64:67], a[176:179], a[16:19], v[64:67]
    ds_read_b64_tr_b16 a[144:145], v186 offset:0
    ds_read_b64_tr_b16 a[146:147], v186 offset:4096
    v_mfma_f32_16x16x32_bf16 v[64:67], a[180:183], a[24:27], v[64:67]
    s_add_u32 s85, s85, 32768
    buffer_load_dwordx4 a[8:11], v33, s[44:47], s86 offen offset:0 sc1
    v_mfma_f32_16x16x32_bf16 v[96:99], a[176:179], a[20:23], v[96:99]
    ds_read_b64_tr_b16 a[148:149], v186 offset:8192
    ds_read_b64_tr_b16 a[150:151], v186 offset:12288
    v_mfma_f32_16x16x32_bf16 v[96:99], a[180:183], a[28:31], v[96:99]
    buffer_load_dwordx4 a[12:15], v33, s[44:47], s86 offen offset:1024 sc1
    v_mfma_f32_16x16x32_bf16 v[68:71], a[184:187], a[16:19], v[68:71]
    ds_read_b64_tr_b16 a[152:153], v187 offset:0
    ds_read_b64_tr_b16 a[154:155], v187 offset:4096
    v_mfma_f32_16x16x32_bf16 v[68:71], a[188:191], a[24:27], v[68:71]
    s_add_u32 s86, s86, 131072
    v_mfma_f32_16x16x32_bf16 v[100:103], a[184:187], a[20:23], v[100:103]
    ds_read_b64_tr_b16 a[156:157], v187 offset:8192
    ds_read_b64_tr_b16 a[158:159], v187 offset:12288
    v_mfma_f32_16x16x32_bf16 v[100:103], a[188:191], a[28:31], v[100:103]
    s_waitcnt vmcnt(24)
    s_waitcnt lgkmcnt(8)
    v_mfma_f32_16x16x32_bf16 v[40:43], a[128:131], a[32:35], v[40:43]
    ds_read_b64_tr_b16 a[160:161], v188 offset:0
    ds_read_b64_tr_b16 a[162:163], v188 offset:4096
    v_mfma_f32_16x16x32_bf16 v[40:43], a[132:135], a[40:43], v[40:43]
    s_add_u32 m0, s82, 114688
    v_mfma_f32_16x16x32_bf16 v[72:75], a[128:131], a[36:39], v[72:75]
    ds_read_b64_tr_b16 a[164:165], v188 offset:8192
    ds_read_b64_tr_b16 a[166:167], v188 offset:12288
    v_mfma_f32_16x16x32_bf16 v[72:75], a[132:135], a[44:47], v[72:75]
    buffer_load_dwordx4 v32, s[52:55], s85 offen lds
    v_mfma_f32_16x16x32_bf16 v[44:47], a[136:139], a[32:35], v[44:47]
    ds_read_b64_tr_b16 a[168:169], v189 offset:0
    ds_read_b64_tr_b16 a[170:171], v189 offset:4096
    v_mfma_f32_16x16x32_bf16 v[44:47], a[140:143], a[40:43], v[44:47]
    buffer_load_dwordx4 v34, s[52:55], s85 offen offset:1024 lds
    v_mfma_f32_16x16x32_bf16 v[76:79], a[136:139], a[36:39], v[76:79]
    ds_read_b64_tr_b16 a[172:173], v189 offset:8192
    ds_read_b64_tr_b16 a[174:175], v189 offset:12288
    v_mfma_f32_16x16x32_bf16 v[76:79], a[140:143], a[44:47], v[76:79]
    s_waitcnt lgkmcnt(8)
    v_mfma_f32_16x16x32_bf16 v[48:51], a[144:147], a[32:35], v[48:51]
    ds_read_b64_tr_b16 a[176:177], v190 offset:0
    ds_read_b64_tr_b16 a[178:179], v190 offset:4096
    v_mfma_f32_16x16x32_bf16 v[48:51], a[148:151], a[40:43], v[48:51]
    s_add_u32 s85, s85, 32768
    buffer_load_dwordx4 a[16:19], v33, s[44:47], s86 offen offset:0 sc1
    v_mfma_f32_16x16x32_bf16 v[80:83], a[144:147], a[36:39], v[80:83]
    ds_read_b64_tr_b16 a[180:181], v190 offset:8192
    ds_read_b64_tr_b16 a[182:183], v190 offset:12288
    v_mfma_f32_16x16x32_bf16 v[80:83], a[148:151], a[44:47], v[80:83]
    buffer_load_dwordx4 a[20:23], v33, s[44:47], s86 offen offset:1024 sc1
    v_mfma_f32_16x16x32_bf16 v[52:55], a[152:155], a[32:35], v[52:55]
    ds_read_b64_tr_b16 a[184:185], v191 offset:0
    ds_read_b64_tr_b16 a[186:187], v191 offset:4096
    v_mfma_f32_16x16x32_bf16 v[52:55], a[156:159], a[40:43], v[52:55]
    s_add_u32 s86, s86, 131072
    v_mfma_f32_16x16x32_bf16 v[84:87], a[152:155], a[36:39], v[84:87]
    ds_read_b64_tr_b16 a[188:189], v191 offset:8192
    ds_read_b64_tr_b16 a[190:191], v191 offset:12288
    v_mfma_f32_16x16x32_bf16 v[84:87], a[156:159], a[44:47], v[84:87]
    s_barrier
    s_waitcnt lgkmcnt(8)
    v_mfma_f32_16x16x32_bf16 v[56:59], a[160:163], a[32:35], v[56:59]
    ds_read_b64_tr_b16 a[128:129], v184 offset:16384
    ds_read_b64_tr_b16 a[130:131], v184 offset:20480
    v_mfma_f32_16x16x32_bf16 v[56:59], a[164:167], a[40:43], v[56:59]
    s_add_u32 m0, s82, 122880
    v_mfma_f32_16x16x32_bf16 v[88:91], a[160:163], a[36:39], v[88:91]
    ds_read_b64_tr_b16 a[132:133], v184 offset:40960
    ds_read_b64_tr_b16 a[134:135], v184 offset:45056
    v_mfma_f32_16x16x32_bf16 v[88:91], a[164:167], a[44:47], v[88:91]
    buffer_load_dwordx4 v32, s[52:55], s85 offen lds
    v_mfma_f32_16x16x32_bf16 v[60:63], a[168:171], a[32:35], v[60:63]
    ds_read_b64_tr_b16 a[136:137], v185 offset:16384
    ds_read_b64_tr_b16 a[138:139], v185 offset:20480
    v_mfma_f32_16x16x32_bf16 v[60:63], a[172:175], a[40:43], v[60:63]
    buffer_load_dwordx4 v34, s[52:55], s85 offen offset:1024 lds
    v_mfma_f32_16x16x32_bf16 v[92:95], a[168:171], a[36:39], v[92:95]
    ds_read_b64_tr_b16 a[140:141], v185 offset:40960
    ds_read_b64_tr_b16 a[142:143], v185 offset:45056
    v_mfma_f32_16x16x32_bf16 v[92:95], a[172:175], a[44:47], v[92:95]
    s_waitcnt lgkmcnt(8)
    v_mfma_f32_16x16x32_bf16 v[64:67], a[176:179], a[32:35], v[64:67]
    ds_read_b64_tr_b16 a[144:145], v186 offset:16384
    ds_read_b64_tr_b16 a[146:147], v186 offset:20480
    v_mfma_f32_16x16x32_bf16 v[64:67], a[180:183], a[40:43], v[64:67]
    s_add_u32 s85, s85, 32768
    buffer_load_dwordx4 a[24:27], v33, s[44:47], s86 offen offset:0 sc1
    v_mfma_f32_16x16x32_bf16 v[96:99], a[176:179], a[36:39], v[96:99]
    ds_read_b64_tr_b16 a[148:149], v186 offset:40960
    ds_read_b64_tr_b16 a[150:151], v186 offset:45056
    v_mfma_f32_16x16x32_bf16 v[96:99], a[180:183], a[44:47], v[96:99]
    buffer_load_dwordx4 a[28:31], v33, s[44:47], s86 offen offset:1024 sc1
    v_mfma_f32_16x16x32_bf16 v[68:71], a[184:187], a[32:35], v[68:71]
    ds_read_b64_tr_b16 a[152:153], v187 offset:16384
    ds_read_b64_tr_b16 a[154:155], v187 offset:20480
    v_mfma_f32_16x16x32_bf16 v[68:71], a[188:191], a[40:43], v[68:71]
    s_add_u32 s86, s86, 131072
    v_mfma_f32_16x16x32_bf16 v[100:103], a[184:187], a[36:39], v[100:103]
    ds_read_b64_tr_b16 a[156:157], v187 offset:40960
    ds_read_b64_tr_b16 a[158:159], v187 offset:45056
    v_mfma_f32_16x16x32_bf16 v[100:103], a[188:191], a[44:47], v[100:103]
    s_waitcnt vmcnt(28)
    s_waitcnt lgkmcnt(8)
    v_mfma_f32_16x16x32_bf16 v[40:43], a[128:131], a[48:51], v[40:43]
    ds_read_b64_tr_b16 a[160:161], v188 offset:16384
    ds_read_b64_tr_b16 a[162:163], v188 offset:20480
    v_mfma_f32_16x16x32_bf16 v[40:43], a[132:135], a[56:59], v[40:43]
    s_add_u32 m0, s82, 24576
    v_mfma_f32_16x16x32_bf16 v[72:75], a[128:131], a[52:55], v[72:75]
    ds_read_b64_tr_b16 a[164:165], v188 offset:40960
    ds_read_b64_tr_b16 a[166:167], v188 offset:45056
    v_mfma_f32_16x16x32_bf16 v[72:75], a[132:135], a[60:63], v[72:75]
    buffer_load_dwordx4 v32, s[52:55], s85 offen lds
    v_mfma_f32_16x16x32_bf16 v[44:47], a[136:139], a[48:51], v[44:47]
    ds_read_b64_tr_b16 a[168:169], v189 offset:16384
    ds_read_b64_tr_b16 a[170:171], v189 offset:20480
    v_mfma_f32_16x16x32_bf16 v[44:47], a[140:143], a[56:59], v[44:47]
    buffer_load_dwordx4 v34, s[52:55], s85 offen offset:1024 lds
    v_mfma_f32_16x16x32_bf16 v[76:79], a[136:139], a[52:55], v[76:79]
    ds_read_b64_tr_b16 a[172:173], v189 offset:40960
    ds_read_b64_tr_b16 a[174:175], v189 offset:45056
    v_mfma_f32_16x16x32_bf16 v[76:79], a[140:143], a[60:63], v[76:79]
    s_waitcnt lgkmcnt(8)
    v_mfma_f32_16x16x32_bf16 v[48:51], a[144:147], a[48:51], v[48:51]
    ds_read_b64_tr_b16 a[176:177], v190 offset:16384
    ds_read_b64_tr_b16 a[178:179], v190 offset:20480
    v_mfma_f32_16x16x32_bf16 v[48:51], a[148:151], a[56:59], v[48:51]
    s_add_u32 s85, s85, 32768
    buffer_load_dwordx4 a[32:35], v33, s[44:47], s86 offen offset:0 sc1
    v_mfma_f32_16x16x32_bf16 v[80:83], a[144:147], a[52:55], v[80:83]
    ds_read_b64_tr_b16 a[180:181], v190 offset:40960
    ds_read_b64_tr_b16 a[182:183], v190 offset:45056
    v_mfma_f32_16x16x32_bf16 v[80:83], a[148:151], a[60:63], v[80:83]
    buffer_load_dwordx4 a[36:39], v33, s[44:47], s86 offen offset:1024 sc1
    v_mfma_f32_16x16x32_bf16 v[52:55], a[152:155], a[48:51], v[52:55]
    ds_read_b64_tr_b16 a[184:185], v191 offset:16384
    ds_read_b64_tr_b16 a[186:187], v191 offset:20480
    v_mfma_f32_16x16x32_bf16 v[52:55], a[156:159], a[56:59], v[52:55]
    s_add_u32 s86, s86, 131072
    v_mfma_f32_16x16x32_bf16 v[84:87], a[152:155], a[52:55], v[84:87]
    ds_read_b64_tr_b16 a[188:189], v191 offset:40960
    ds_read_b64_tr_b16 a[190:191], v191 offset:45056
    v_mfma_f32_16x16x32_bf16 v[84:87], a[156:159], a[60:63], v[84:87]
    s_barrier
    s_waitcnt lgkmcnt(8)
    v_mfma_f32_16x16x32_bf16 v[56:59], a[160:163], a[48:51], v[56:59]
    ds_read_b64_tr_b16 a[128:129], v184 offset:49152
    ds_read_b64_tr_b16 a[130:131], v184 offset:53248
    v_mfma_f32_16x16x32_bf16 v[56:59], a[164:167], a[56:59], v[56:59]
    s_add_u32 m0, s82, 32768
    v_mfma_f32_16x16x32_bf16 v[88:91], a[160:163], a[52:55], v[88:91]
    ds_read_b64_tr_b16 a[132:133], v12 offset:16384
    ds_read_b64_tr_b16 a[134:135], v12 offset:20480
    v_mfma_f32_16x16x32_bf16 v[88:91], a[164:167], a[60:63], v[88:91]
    buffer_load_dwordx4 v32, s[52:55], s85 offen lds
    v_mfma_f32_16x16x32_bf16 v[60:63], a[168:171], a[48:51], v[60:63]
    ds_read_b64_tr_b16 a[136:137], v185 offset:49152
    ds_read_b64_tr_b16 a[138:139], v185 offset:53248
    v_mfma_f32_16x16x32_bf16 v[60:63], a[172:175], a[56:59], v[60:63]
    buffer_load_dwordx4 v34, s[52:55], s85 offen offset:1024 lds
    v_mfma_f32_16x16x32_bf16 v[92:95], a[168:171], a[52:55], v[92:95]
    ds_read_b64_tr_b16 a[140:141], v13 offset:16384
    ds_read_b64_tr_b16 a[142:143], v13 offset:20480
    v_mfma_f32_16x16x32_bf16 v[92:95], a[172:175], a[60:63], v[92:95]
    s_waitcnt lgkmcnt(8)
    v_mfma_f32_16x16x32_bf16 v[64:67], a[176:179], a[48:51], v[64:67]
    ds_read_b64_tr_b16 a[144:145], v186 offset:49152
    ds_read_b64_tr_b16 a[146:147], v186 offset:53248
    v_mfma_f32_16x16x32_bf16 v[64:67], a[180:183], a[56:59], v[64:67]
    s_add_u32 s85, s85, 32768
    buffer_load_dwordx4 a[40:43], v33, s[44:47], s86 offen offset:0 sc1
    v_mfma_f32_16x16x32_bf16 v[96:99], a[176:179], a[52:55], v[96:99]
    ds_read_b64_tr_b16 a[148:149], v14 offset:16384
    ds_read_b64_tr_b16 a[150:151], v14 offset:20480
    v_mfma_f32_16x16x32_bf16 v[96:99], a[180:183], a[60:63], v[96:99]
    buffer_load_dwordx4 a[44:47], v33, s[44:47], s86 offen offset:1024 sc1
    v_mfma_f32_16x16x32_bf16 v[68:71], a[184:187], a[48:51], v[68:71]
    ds_read_b64_tr_b16 a[152:153], v187 offset:49152
    ds_read_b64_tr_b16 a[154:155], v187 offset:53248
    v_mfma_f32_16x16x32_bf16 v[68:71], a[188:191], a[56:59], v[68:71]
    s_add_u32 s86, s86, 131072
    v_mfma_f32_16x16x32_bf16 v[100:103], a[184:187], a[52:55], v[100:103]
    ds_read_b64_tr_b16 a[156:157], v15 offset:16384
    ds_read_b64_tr_b16 a[158:159], v15 offset:20480
    v_mfma_f32_16x16x32_bf16 v[100:103], a[188:191], a[60:63], v[100:103]
    s_waitcnt vmcnt(32)
    s_waitcnt lgkmcnt(8)
    v_mfma_f32_16x16x32_bf16 v[40:43], a[128:131], a[64:67], v[40:43]
    ds_read_b64_tr_b16 a[160:161], v188 offset:49152
    ds_read_b64_tr_b16 a[162:163], v188 offset:53248
    v_mfma_f32_16x16x32_bf16 v[40:43], a[132:135], a[72:75], v[40:43]
    s_add_u32 m0, s82, 65536
    v_mfma_f32_16x16x32_bf16 v[72:75], a[128:131], a[68:71], v[72:75]
    ds_read_b64_tr_b16 a[164:165], v16 offset:16384
    ds_read_b64_tr_b16 a[166:167], v16 offset:20480
    v_mfma_f32_16x16x32_bf16 v[72:75], a[132:135], a[76:79], v[72:75]
    buffer_load_dwordx4 v32, s[52:55], s85 offen lds
    v_mfma_f32_16x16x32_bf16 v[44:47], a[136:139], a[64:67], v[44:47]
    ds_read_b64_tr_b16 a[168:169], v189 offset:49152
    ds_read_b64_tr_b16 a[170:171], v189 offset:53248
    v_mfma_f32_16x16x32_bf16 v[44:47], a[140:143], a[72:75], v[44:47]
    buffer_load_dwordx4 v34, s[52:55], s85 offen offset:1024 lds
    v_mfma_f32_16x16x32_bf16 v[76:79], a[136:139], a[68:71], v[76:79]
    ds_read_b64_tr_b16 a[172:173], v17 offset:16384
    ds_read_b64_tr_b16 a[174:175], v17 offset:20480
    v_mfma_f32_16x16x32_bf16 v[76:79], a[140:143], a[76:79], v[76:79]
    s_waitcnt lgkmcnt(8)
    v_mfma_f32_16x16x32_bf16 v[48:51], a[144:147], a[64:67], v[48:51]
    ds_read_b64_tr_b16 a[176:177], v190 offset:49152
    ds_read_b64_tr_b16 a[178:179], v190 offset:53248
    v_mfma_f32_16x16x32_bf16 v[48:51], a[148:151], a[72:75], v[48:51]
    s_add_u32 s85, s85, 32768
    buffer_load_dwordx4 a[48:51], v33, s[44:47], s86 offen offset:0 sc1
    v_mfma_f32_16x16x32_bf16 v[80:83], a[144:147], a[68:71], v[80:83]
    ds_read_b64_tr_b16 a[180:181], v18 offset:16384
    ds_read_b64_tr_b16 a[182:183], v18 offset:20480
    v_mfma_f32_16x16x32_bf16 v[80:83], a[148:151], a[76:79], v[80:83]
    buffer_load_dwordx4 a[52:55], v33, s[44:47], s86 offen offset:1024 sc1
    v_mfma_f32_16x16x32_bf16 v[52:55], a[152:155], a[64:67], v[52:55]
    ds_read_b64_tr_b16 a[184:185], v191 offset:49152
    ds_read_b64_tr_b16 a[186:187], v191 offset:53248
    v_mfma_f32_16x16x32_bf16 v[52:55], a[156:159], a[72:75], v[52:55]
    s_add_u32 s86, s86, 131072
    v_mfma_f32_16x16x32_bf16 v[84:87], a[152:155], a[68:71], v[84:87]
    ds_read_b64_tr_b16 a[188:189], v19 offset:16384
    ds_read_b64_tr_b16 a[190:191], v19 offset:20480
    v_mfma_f32_16x16x32_bf16 v[84:87], a[156:159], a[76:79], v[84:87]
    s_waitcnt vmcnt(30)
    s_barrier
    s_waitcnt lgkmcnt(8)
    v_mfma_f32_16x16x32_bf16 v[56:59], a[160:163], a[64:67], v[56:59]
    ds_read_b64_tr_b16 a[128:129], v12 offset:24576
    ds_read_b64_tr_b16 a[130:131], v12 offset:28672
    v_mfma_f32_16x16x32_bf16 v[56:59], a[164:167], a[72:75], v[56:59]
    s_add_u32 m0, s82, 73728
    v_mfma_f32_16x16x32_bf16 v[88:91], a[160:163], a[68:71], v[88:91]
    ds_read_b64_tr_b16 a[132:133], v184 offset:57344
    ds_read_b64_tr_b16 a[134:135], v184 offset:61440
    v_mfma_f32_16x16x32_bf16 v[88:91], a[164:167], a[76:79], v[88:91]
    buffer_load_dwordx4 v32, s[52:55], s85 offen lds
    v_mfma_f32_16x16x32_bf16 v[60:63], a[168:171], a[64:67], v[60:63]
    ds_read_b64_tr_b16 a[136:137], v13 offset:24576
    ds_read_b64_tr_b16 a[138:139], v13 offset:28672
    v_mfma_f32_16x16x32_bf16 v[60:63], a[172:175], a[72:75], v[60:63]
    buffer_load_dwordx4 v34, s[52:55], s85 offen offset:1024 lds
    v_mfma_f32_16x16x32_bf16 v[92:95], a[168:171], a[68:71], v[92:95]
    ds_read_b64_tr_b16 a[140:141], v185 offset:57344
    ds_read_b64_tr_b16 a[142:143], v185 offset:61440
    v_mfma_f32_16x16x32_bf16 v[92:95], a[172:175], a[76:79], v[92:95]
    s_waitcnt lgkmcnt(8)
    v_mfma_f32_16x16x32_bf16 v[64:67], a[176:179], a[64:67], v[64:67]
    ds_read_b64_tr_b16 a[144:145], v14 offset:24576
    ds_read_b64_tr_b16 a[146:147], v14 offset:28672
    v_mfma_f32_16x16x32_bf16 v[64:67], a[180:183], a[72:75], v[64:67]
    s_add_u32 s85, s85, 32768
    buffer_load_dwordx4 a[56:59], v33, s[44:47], s86 offen offset:0 sc1
    v_mfma_f32_16x16x32_bf16 v[96:99], a[176:179], a[68:71], v[96:99]
    ds_read_b64_tr_b16 a[148:149], v186 offset:57344
    ds_read_b64_tr_b16 a[150:151], v186 offset:61440
    v_mfma_f32_16x16x32_bf16 v[96:99], a[180:183], a[76:79], v[96:99]
    buffer_load_dwordx4 a[60:63], v33, s[44:47], s86 offen offset:1024 sc1
    v_mfma_f32_16x16x32_bf16 v[68:71], a[184:187], a[64:67], v[68:71]
    ds_read_b64_tr_b16 a[152:153], v15 offset:24576
    ds_read_b64_tr_b16 a[154:155], v15 offset:28672
    v_mfma_f32_16x16x32_bf16 v[68:71], a[188:191], a[72:75], v[68:71]
    s_add_u32 s86, s86, 131072
    v_mfma_f32_16x16x32_bf16 v[100:103], a[184:187], a[68:71], v[100:103]
    ds_read_b64_tr_b16 a[156:157], v187 offset:57344
    ds_read_b64_tr_b16 a[158:159], v187 offset:61440
    v_mfma_f32_16x16x32_bf16 v[100:103], a[188:191], a[76:79], v[100:103]
    s_waitcnt vmcnt(32)
    s_waitcnt lgkmcnt(8)
    v_mfma_f32_16x16x32_bf16 v[40:43], a[128:131], a[80:83], v[40:43]
    ds_read_b64_tr_b16 a[160:161], v16 offset:24576
    ds_read_b64_tr_b16 a[162:163], v16 offset:28672
    v_mfma_f32_16x16x32_bf16 v[40:43], a[132:135], a[88:91], v[40:43]
    s_add_u32 m0, s82, 0
    v_mfma_f32_16x16x32_bf16 v[72:75], a[128:131], a[84:87], v[72:75]
    ds_read_b64_tr_b16 a[164:165], v188 offset:57344
    ds_read_b64_tr_b16 a[166:167], v188 offset:61440
    v_mfma_f32_16x16x32_bf16 v[72:75], a[132:135], a[92:95], v[72:75]
    buffer_load_dwordx4 v32, s[52:55], s85 offen lds
    v_mfma_f32_16x16x32_bf16 v[44:47], a[136:139], a[80:83], v[44:47]
    ds_read_b64_tr_b16 a[168:169], v17 offset:24576
    ds_read_b64_tr_b16 a[170:171], v17 offset:28672
    v_mfma_f32_16x16x32_bf16 v[44:47], a[140:143], a[88:91], v[44:47]
    buffer_load_dwordx4 v34, s[52:55], s85 offen offset:1024 lds
    v_mfma_f32_16x16x32_bf16 v[76:79], a[136:139], a[84:87], v[76:79]
    ds_read_b64_tr_b16 a[172:173], v189 offset:57344
    ds_read_b64_tr_b16 a[174:175], v189 offset:61440
    v_mfma_f32_16x16x32_bf16 v[76:79], a[140:143], a[92:95], v[76:79]
    s_waitcnt lgkmcnt(8)
    v_mfma_f32_16x16x32_bf16 v[48:51], a[144:147], a[80:83], v[48:51]
    ds_read_b64_tr_b16 a[176:177], v18 offset:24576
    ds_read_b64_tr_b16 a[178:179], v18 offset:28672
    v_mfma_f32_16x16x32_bf16 v[48:51], a[148:151], a[88:91], v[48:51]
    s_add_u32 s85, s85, 32768
    buffer_load_dwordx4 a[64:67], v33, s[44:47], s86 offen offset:0 sc1
    v_mfma_f32_16x16x32_bf16 v[80:83], a[144:147], a[84:87], v[80:83]
    ds_read_b64_tr_b16 a[180:181], v190 offset:57344
    ds_read_b64_tr_b16 a[182:183], v190 offset:61440
    v_mfma_f32_16x16x32_bf16 v[80:83], a[148:151], a[92:95], v[80:83]
    buffer_load_dwordx4 a[68:71], v33, s[44:47], s86 offen offset:1024 sc1
    v_mfma_f32_16x16x32_bf16 v[52:55], a[152:155], a[80:83], v[52:55]
    ds_read_b64_tr_b16 a[184:185], v19 offset:24576
    ds_read_b64_tr_b16 a[186:187], v19 offset:28672
    v_mfma_f32_16x16x32_bf16 v[52:55], a[156:159], a[88:91], v[52:55]
    s_add_u32 s86, s86, 131072
    v_mfma_f32_16x16x32_bf16 v[84:87], a[152:155], a[84:87], v[84:87]
    ds_read_b64_tr_b16 a[188:189], v191 offset:57344
    ds_read_b64_tr_b16 a[190:191], v191 offset:61440
    v_mfma_f32_16x16x32_bf16 v[84:87], a[156:159], a[92:95], v[84:87]
    s_waitcnt vmcnt(30)
    s_barrier
    s_waitcnt lgkmcnt(8)
    v_mfma_f32_16x16x32_bf16 v[56:59], a[160:163], a[80:83], v[56:59]
    ds_read_b64_tr_b16 a[128:129], v12 offset:32768
    ds_read_b64_tr_b16 a[130:131], v12 offset:36864
    v_mfma_f32_16x16x32_bf16 v[56:59], a[164:167], a[88:91], v[56:59]
    s_add_u32 m0, s82, 8192
    v_mfma_f32_16x16x32_bf16 v[88:91], a[160:163], a[84:87], v[88:91]
    ds_read_b64_tr_b16 a[132:133], v12 offset:40960
    ds_read_b64_tr_b16 a[134:135], v12 offset:45056
    v_mfma_f32_16x16x32_bf16 v[88:91], a[164:167], a[92:95], v[88:91]
    buffer_load_dwordx4 v32, s[52:55], s85 offen lds
    v_mfma_f32_16x16x32_bf16 v[60:63], a[168:171], a[80:83], v[60:63]
    ds_read_b64_tr_b16 a[136:137], v13 offset:32768
    ds_read_b64_tr_b16 a[138:139], v13 offset:36864
    v_mfma_f32_16x16x32_bf16 v[60:63], a[172:175], a[88:91], v[60:63]
    buffer_load_dwordx4 v34, s[52:55], s85 offen offset:1024 lds
    v_mfma_f32_16x16x32_bf16 v[92:95], a[168:171], a[84:87], v[92:95]
    ds_read_b64_tr_b16 a[140:141], v13 offset:40960
    ds_read_b64_tr_b16 a[142:143], v13 offset:45056
    v_mfma_f32_16x16x32_bf16 v[92:95], a[172:175], a[92:95], v[92:95]
    s_waitcnt lgkmcnt(8)
    v_mfma_f32_16x16x32_bf16 v[64:67], a[176:179], a[80:83], v[64:67]
    ds_read_b64_tr_b16 a[144:145], v14 offset:32768
    ds_read_b64_tr_b16 a[146:147], v14 offset:36864
    v_mfma_f32_16x16x32_bf16 v[64:67], a[180:183], a[88:91], v[64:67]
    s_add_u32 s85, s85, 32768
    buffer_load_dwordx4 a[72:75], v33, s[44:47], s86 offen offset:0 sc1
    v_mfma_f32_16x16x32_bf16 v[96:99], a[176:179], a[84:87], v[96:99]
    ds_read_b64_tr_b16 a[148:149], v14 offset:40960
    ds_read_b64_tr_b16 a[150:151], v14 offset:45056
    v_mfma_f32_16x16x32_bf16 v[96:99], a[180:183], a[92:95], v[96:99]
    buffer_load_dwordx4 a[76:79], v33, s[44:47], s86 offen offset:1024 sc1
    v_mfma_f32_16x16x32_bf16 v[68:71], a[184:187], a[80:83], v[68:71]
    ds_read_b64_tr_b16 a[152:153], v15 offset:32768
    ds_read_b64_tr_b16 a[154:155], v15 offset:36864
    v_mfma_f32_16x16x32_bf16 v[68:71], a[188:191], a[88:91], v[68:71]
    s_add_u32 s86, s86, 131072
    v_mfma_f32_16x16x32_bf16 v[100:103], a[184:187], a[84:87], v[100:103]
    ds_read_b64_tr_b16 a[156:157], v15 offset:40960
    ds_read_b64_tr_b16 a[158:159], v15 offset:45056
    v_mfma_f32_16x16x32_bf16 v[100:103], a[188:191], a[92:95], v[100:103]
    s_waitcnt vmcnt(32)
    s_waitcnt lgkmcnt(8)
    v_mfma_f32_16x16x32_bf16 v[40:43], a[128:131], a[0:3], v[40:43]
    ds_read_b64_tr_b16 a[160:161], v16 offset:32768
    ds_read_b64_tr_b16 a[162:163], v16 offset:36864
    v_mfma_f32_16x16x32_bf16 v[40:43], a[132:135], a[8:11], v[40:43]
    s_add_u32 m0, s82, 16384
    v_mfma_f32_16x16x32_bf16 v[72:75], a[128:131], a[4:7], v[72:75]
    ds_read_b64_tr_b16 a[164:165], v16 offset:40960
    ds_read_b64_tr_b16 a[166:167], v16 offset:45056
    v_mfma_f32_16x16x32_bf16 v[72:75], a[132:135], a[12:15], v[72:75]
    buffer_load_dwordx4 v32, s[52:55], s85 offen lds
    v_mfma_f32_16x16x32_bf16 v[44:47], a[136:139], a[0:3], v[44:47]
    ds_read_b64_tr_b16 a[168:169], v17 offset:32768
    ds_read_b64_tr_b16 a[170:171], v17 offset:36864
    v_mfma_f32_16x16x32_bf16 v[44:47], a[140:143], a[8:11], v[44:47]
    buffer_load_dwordx4 v34, s[52:55], s85 offen offset:1024 lds
    v_mfma_f32_16x16x32_bf16 v[76:79], a[136:139], a[4:7], v[76:79]
    ds_read_b64_tr_b16 a[172:173], v17 offset:40960
    ds_read_b64_tr_b16 a[174:175], v17 offset:45056
    v_mfma_f32_16x16x32_bf16 v[76:79], a[140:143], a[12:15], v[76:79]
    s_waitcnt lgkmcnt(8)
    v_mfma_f32_16x16x32_bf16 v[48:51], a[144:147], a[0:3], v[48:51]
    ds_read_b64_tr_b16 a[176:177], v18 offset:32768
    ds_read_b64_tr_b16 a[178:179], v18 offset:36864
    v_mfma_f32_16x16x32_bf16 v[48:51], a[148:151], a[8:11], v[48:51]
    s_add_u32 s85, s85, 32768
    buffer_load_dwordx4 a[80:83], v33, s[44:47], s86 offen offset:0 sc1
    v_mfma_f32_16x16x32_bf16 v[80:83], a[144:147], a[4:7], v[80:83]
    ds_read_b64_tr_b16 a[180:181], v18 offset:40960
    ds_read_b64_tr_b16 a[182:183], v18 offset:45056
    v_mfma_f32_16x16x32_bf16 v[80:83], a[148:151], a[12:15], v[80:83]
    buffer_load_dwordx4 a[84:87], v33, s[44:47], s86 offen offset:1024 sc1
    v_mfma_f32_16x16x32_bf16 v[52:55], a[152:155], a[0:3], v[52:55]
    ds_read_b64_tr_b16 a[184:185], v19 offset:32768
    ds_read_b64_tr_b16 a[186:187], v19 offset:36864
    v_mfma_f32_16x16x32_bf16 v[52:55], a[156:159], a[8:11], v[52:55]
    s_add_u32 s86, s86, 131072
    v_mfma_f32_16x16x32_bf16 v[84:87], a[152:155], a[4:7], v[84:87]
    ds_read_b64_tr_b16 a[188:189], v19 offset:40960
    ds_read_b64_tr_b16 a[190:191], v19 offset:45056
    v_mfma_f32_16x16x32_bf16 v[84:87], a[156:159], a[12:15], v[84:87]
    s_waitcnt vmcnt(30)
    s_barrier
    s_waitcnt lgkmcnt(8)
    v_mfma_f32_16x16x32_bf16 v[56:59], a[160:163], a[0:3], v[56:59]
    ds_read_b64_tr_b16 a[128:129], v12 offset:49152
    ds_read_b64_tr_b16 a[130:131], v12 offset:53248
    v_mfma_f32_16x16x32_bf16 v[56:59], a[164:167], a[8:11], v[56:59]
    s_add_u32 m0, s82, 40960
    v_mfma_f32_16x16x32_bf16 v[88:91], a[160:163], a[4:7], v[88:91]
    ds_read_b64_tr_b16 a[132:133], v12 offset:57344
    ds_read_b64_tr_b16 a[134:135], v12 offset:61440
    v_mfma_f32_16x16x32_bf16 v[88:91], a[164:167], a[12:15], v[88:91]
    buffer_load_dwordx4 v32, s[52:55], s85 offen lds
    v_mfma_f32_16x16x32_bf16 v[60:63], a[168:171], a[0:3], v[60:63]
    ds_read_b64_tr_b16 a[136:137], v13 offset:49152
    ds_read_b64_tr_b16 a[138:139], v13 offset:53248
    v_mfma_f32_16x16x32_bf16 v[60:63], a[172:175], a[8:11], v[60:63]
    buffer_load_dwordx4 v34, s[52:55], s85 offen offset:1024 lds
    v_mfma_f32_16x16x32_bf16 v[92:95], a[168:171], a[4:7], v[92:95]
    ds_read_b64_tr_b16 a[140:141], v13 offset:57344
    ds_read_b64_tr_b16 a[142:143], v13 offset:61440
    v_mfma_f32_16x16x32_bf16 v[92:95], a[172:175], a[12:15], v[92:95]
    s_waitcnt lgkmcnt(8)
    v_mfma_f32_16x16x32_bf16 v[64:67], a[176:179], a[0:3], v[64:67]
    ds_read_b64_tr_b16 a[144:145], v14 offset:49152
    ds_read_b64_tr_b16 a[146:147], v14 offset:53248
    v_mfma_f32_16x16x32_bf16 v[64:67], a[180:183], a[8:11], v[64:67]
    s_add_u32 s85, s85, 32768
    buffer_load_dwordx4 a[88:91], v33, s[44:47], s86 offen offset:0 sc1
    v_mfma_f32_16x16x32_bf16 v[96:99], a[176:179], a[4:7], v[96:99]
    ds_read_b64_tr_b16 a[148:149], v14 offset:57344
    ds_read_b64_tr_b16 a[150:151], v14 offset:61440
    v_mfma_f32_16x16x32_bf16 v[96:99], a[180:183], a[12:15], v[96:99]
    buffer_load_dwordx4 a[92:95], v33, s[44:47], s86 offen offset:1024 sc1
    v_mfma_f32_16x16x32_bf16 v[68:71], a[184:187], a[0:3], v[68:71]
    ds_read_b64_tr_b16 a[152:153], v15 offset:49152
    ds_read_b64_tr_b16 a[154:155], v15 offset:53248
    v_mfma_f32_16x16x32_bf16 v[68:71], a[188:191], a[8:11], v[68:71]
    s_add_u32 s86, s86, 131072
    v_mfma_f32_16x16x32_bf16 v[100:103], a[184:187], a[4:7], v[100:103]
    ds_read_b64_tr_b16 a[156:157], v15 offset:57344
    ds_read_b64_tr_b16 a[158:159], v15 offset:61440
    v_mfma_f32_16x16x32_bf16 v[100:103], a[188:191], a[12:15], v[100:103]
    s_waitcnt vmcnt(32)
    s_waitcnt lgkmcnt(8)
    v_mfma_f32_16x16x32_bf16 v[40:43], a[128:131], a[16:19], v[40:43]
    ds_read_b64_tr_b16 a[160:161], v16 offset:49152
    ds_read_b64_tr_b16 a[162:163], v16 offset:53248
    v_mfma_f32_16x16x32_bf16 v[40:43], a[132:135], a[24:27], v[40:43]
    s_add_u32 m0, s82, 49152
    v_mfma_f32_16x16x32_bf16 v[72:75], a[128:131], a[20:23], v[72:75]
    ds_read_b64_tr_b16 a[164:165], v16 offset:57344
    ds_read_b64_tr_b16 a[166:167], v16 offset:61440
    v_mfma_f32_16x16x32_bf16 v[72:75], a[132:135], a[28:31], v[72:75]
    buffer_load_dwordx4 v32, s[52:55], s85 offen lds
    v_mfma_f32_16x16x32_bf16 v[44:47], a[136:139], a[16:19], v[44:47]
    ds_read_b64_tr_b16 a[168:169], v17 offset:49152
    ds_read_b64_tr_b16 a[170:171], v17 offset:53248
    v_mfma_f32_16x16x32_bf16 v[44:47], a[140:143], a[24:27], v[44:47]
    buffer_load_dwordx4 v34, s[52:55], s85 offen offset:1024 lds
    v_mfma_f32_16x16x32_bf16 v[76:79], a[136:139], a[20:23], v[76:79]
    ds_read_b64_tr_b16 a[172:173], v17 offset:57344
    ds_read_b64_tr_b16 a[174:175], v17 offset:61440
    v_mfma_f32_16x16x32_bf16 v[76:79], a[140:143], a[28:31], v[76:79]
    s_waitcnt lgkmcnt(8)
    v_mfma_f32_16x16x32_bf16 v[48:51], a[144:147], a[16:19], v[48:51]
    ds_read_b64_tr_b16 a[176:177], v18 offset:49152
    ds_read_b64_tr_b16 a[178:179], v18 offset:53248
    v_mfma_f32_16x16x32_bf16 v[48:51], a[148:151], a[24:27], v[48:51]
    s_add_u32 s85, s85, 32768
    buffer_load_dwordx4 a[0:3], v33, s[44:47], s86 offen offset:0 sc1
    v_mfma_f32_16x16x32_bf16 v[80:83], a[144:147], a[20:23], v[80:83]
    ds_read_b64_tr_b16 a[180:181], v18 offset:57344
    ds_read_b64_tr_b16 a[182:183], v18 offset:61440
    v_mfma_f32_16x16x32_bf16 v[80:83], a[148:151], a[28:31], v[80:83]
    buffer_load_dwordx4 a[4:7], v33, s[44:47], s86 offen offset:1024 sc1
    v_mfma_f32_16x16x32_bf16 v[52:55], a[152:155], a[16:19], v[52:55]
    ds_read_b64_tr_b16 a[184:185], v19 offset:49152
    ds_read_b64_tr_b16 a[186:187], v19 offset:53248
    v_mfma_f32_16x16x32_bf16 v[52:55], a[156:159], a[24:27], v[52:55]
    s_add_u32 s86, s86, 131072
    v_mfma_f32_16x16x32_bf16 v[84:87], a[152:155], a[20:23], v[84:87]
    ds_read_b64_tr_b16 a[188:189], v19 offset:57344
    ds_read_b64_tr_b16 a[190:191], v19 offset:61440
    v_mfma_f32_16x16x32_bf16 v[84:87], a[156:159], a[28:31], v[84:87]
    s_waitcnt vmcnt(30)
    s_barrier
    s_waitcnt lgkmcnt(8)
    v_mfma_f32_16x16x32_bf16 v[56:59], a[160:163], a[16:19], v[56:59]
    ds_read_b64_tr_b16 a[128:129], v184 offset:24576
    ds_read_b64_tr_b16 a[130:131], v184 offset:28672
    v_mfma_f32_16x16x32_bf16 v[56:59], a[164:167], a[24:27], v[56:59]
    s_add_u32 m0, s82, 81920
    v_mfma_f32_16x16x32_bf16 v[88:91], a[160:163], a[20:23], v[88:91]
    ds_read_b64_tr_b16 a[132:133], v184 offset:32768
    ds_read_b64_tr_b16 a[134:135], v184 offset:36864
    v_mfma_f32_16x16x32_bf16 v[88:91], a[164:167], a[28:31], v[88:91]
    buffer_load_dwordx4 v32, s[52:55], s85 offen lds
    v_mfma_f32_16x16x32_bf16 v[60:63], a[168:171], a[16:19], v[60:63]
    ds_read_b64_tr_b16 a[136:137], v185 offset:24576
    ds_read_b64_tr_b16 a[138:139], v185 offset:28672
    v_mfma_f32_16x16x32_bf16 v[60:63], a[172:175], a[24:27], v[60:63]
    buffer_load_dwordx4 v34, s[52:55], s85 offen offset:1024 lds
    v_mfma_f32_16x16x32_bf16 v[92:95], a[168:171], a[20:23], v[92:95]
    ds_read_b64_tr_b16 a[140:141], v185 offset:32768
    ds_read_b64_tr_b16 a[142:143], v185 offset:36864
    v_mfma_f32_16x16x32_bf16 v[92:95], a[172:175], a[28:31], v[92:95]
    s_waitcnt lgkmcnt(8)
    v_mfma_f32_16x16x32_bf16 v[64:67], a[176:179], a[16:19], v[64:67]
    ds_read_b64_tr_b16 a[144:145], v186 offset:24576
    ds_read_b64_tr_b16 a[146:147], v186 offset:28672
    v_mfma_f32_16x16x32_bf16 v[64:67], a[180:183], a[24:27], v[64:67]
    s_add_u32 s85, s85, 32768
    buffer_load_dwordx4 a[8:11], v33, s[44:47], s86 offen offset:0 sc1
    v_mfma_f32_16x16x32_bf16 v[96:99], a[176:179], a[20:23], v[96:99]
    ds_read_b64_tr_b16 a[148:149], v186 offset:32768
    ds_read_b64_tr_b16 a[150:151], v186 offset:36864
    v_mfma_f32_16x16x32_bf16 v[96:99], a[180:183], a[28:31], v[96:99]
    buffer_load_dwordx4 a[12:15], v33, s[44:47], s86 offen offset:1024 sc1
    v_mfma_f32_16x16x32_bf16 v[68:71], a[184:187], a[16:19], v[68:71]
    ds_read_b64_tr_b16 a[152:153], v187 offset:24576
    ds_read_b64_tr_b16 a[154:155], v187 offset:28672
    v_mfma_f32_16x16x32_bf16 v[68:71], a[188:191], a[24:27], v[68:71]
    s_add_u32 s86, s86, 131072
    v_mfma_f32_16x16x32_bf16 v[100:103], a[184:187], a[20:23], v[100:103]
    ds_read_b64_tr_b16 a[156:157], v187 offset:32768
    ds_read_b64_tr_b16 a[158:159], v187 offset:36864
    v_mfma_f32_16x16x32_bf16 v[100:103], a[188:191], a[28:31], v[100:103]
    s_waitcnt vmcnt(32)
    s_waitcnt lgkmcnt(8)
    v_mfma_f32_16x16x32_bf16 v[40:43], a[128:131], a[32:35], v[40:43]
    ds_read_b64_tr_b16 a[160:161], v188 offset:24576
    ds_read_b64_tr_b16 a[162:163], v188 offset:28672
    v_mfma_f32_16x16x32_bf16 v[40:43], a[132:135], a[40:43], v[40:43]
    s_add_u32 m0, s82, 90112
    v_mfma_f32_16x16x32_bf16 v[72:75], a[128:131], a[36:39], v[72:75]
    ds_read_b64_tr_b16 a[164:165], v188 offset:32768
    ds_read_b64_tr_b16 a[166:167], v188 offset:36864
    v_mfma_f32_16x16x32_bf16 v[72:75], a[132:135], a[44:47], v[72:75]
    buffer_load_dwordx4 v32, s[52:55], s85 offen lds
    v_mfma_f32_16x16x32_bf16 v[44:47], a[136:139], a[32:35], v[44:47]
    ds_read_b64_tr_b16 a[168:169], v189 offset:24576
    ds_read_b64_tr_b16 a[170:171], v189 offset:28672
    v_mfma_f32_16x16x32_bf16 v[44:47], a[140:143], a[40:43], v[44:47]
    buffer_load_dwordx4 v34, s[52:55], s85 offen offset:1024 lds
    v_mfma_f32_16x16x32_bf16 v[76:79], a[136:139], a[36:39], v[76:79]
    ds_read_b64_tr_b16 a[172:173], v189 offset:32768
    ds_read_b64_tr_b16 a[174:175], v189 offset:36864
    v_mfma_f32_16x16x32_bf16 v[76:79], a[140:143], a[44:47], v[76:79]
    s_waitcnt lgkmcnt(8)
    v_mfma_f32_16x16x32_bf16 v[48:51], a[144:147], a[32:35], v[48:51]
    ds_read_b64_tr_b16 a[176:177], v190 offset:24576
    ds_read_b64_tr_b16 a[178:179], v190 offset:28672
    v_mfma_f32_16x16x32_bf16 v[48:51], a[148:151], a[40:43], v[48:51]
    s_add_u32 s85, s85, 32768
    buffer_load_dwordx4 a[16:19], v33, s[44:47], s86 offen offset:0 sc1
    v_mfma_f32_16x16x32_bf16 v[80:83], a[144:147], a[36:39], v[80:83]
    ds_read_b64_tr_b16 a[180:181], v190 offset:32768
    ds_read_b64_tr_b16 a[182:183], v190 offset:36864
    v_mfma_f32_16x16x32_bf16 v[80:83], a[148:151], a[44:47], v[80:83]
    buffer_load_dwordx4 a[20:23], v33, s[44:47], s86 offen offset:1024 sc1
    v_mfma_f32_16x16x32_bf16 v[52:55], a[152:155], a[32:35], v[52:55]
    ds_read_b64_tr_b16 a[184:185], v191 offset:24576
    ds_read_b64_tr_b16 a[186:187], v191 offset:28672
    v_mfma_f32_16x16x32_bf16 v[52:55], a[156:159], a[40:43], v[52:55]
    s_add_u32 s86, s86, 131072
    v_mfma_f32_16x16x32_bf16 v[84:87], a[152:155], a[36:39], v[84:87]
    ds_read_b64_tr_b16 a[188:189], v191 offset:32768
    ds_read_b64_tr_b16 a[190:191], v191 offset:36864
    v_mfma_f32_16x16x32_bf16 v[84:87], a[156:159], a[44:47], v[84:87]
    s_waitcnt vmcnt(30)
    s_barrier
    s_waitcnt lgkmcnt(8)
    v_mfma_f32_16x16x32_bf16 v[56:59], a[160:163], a[32:35], v[56:59]
    ds_read_b64_tr_b16 a[128:129], v12 offset:0
    ds_read_b64_tr_b16 a[130:131], v12 offset:4096
    v_mfma_f32_16x16x32_bf16 v[56:59], a[164:167], a[40:43], v[56:59]
    s_add_u32 m0, s82, 57344
    v_mfma_f32_16x16x32_bf16 v[88:91], a[160:163], a[36:39], v[88:91]
    ds_read_b64_tr_b16 a[132:133], v12 offset:8192
    ds_read_b64_tr_b16 a[134:135], v12 offset:12288
    v_mfma_f32_16x16x32_bf16 v[88:91], a[164:167], a[44:47], v[88:91]
    buffer_load_dwordx4 v32, s[52:55], s85 offen lds
    v_mfma_f32_16x16x32_bf16 v[60:63], a[168:171], a[32:35], v[60:63]
    ds_read_b64_tr_b16 a[136:137], v13 offset:0
    ds_read_b64_tr_b16 a[138:139], v13 offset:4096
    v_mfma_f32_16x16x32_bf16 v[60:63], a[172:175], a[40:43], v[60:63]
    buffer_load_dwordx4 v34, s[52:55], s85 offen offset:1024 lds
    v_mfma_f32_16x16x32_bf16 v[92:95], a[168:171], a[36:39], v[92:95]
    ds_read_b64_tr_b16 a[140:141], v13 offset:8192
    ds_read_b64_tr_b16 a[142:143], v13 offset:12288
    v_mfma_f32_16x16x32_bf16 v[92:95], a[172:175], a[44:47], v[92:95]
    s_waitcnt lgkmcnt(8)
    v_mfma_f32_16x16x32_bf16 v[64:67], a[176:179], a[32:35], v[64:67]
    ds_read_b64_tr_b16 a[144:145], v14 offset:0
    ds_read_b64_tr_b16 a[146:147], v14 offset:4096
    v_mfma_f32_16x16x32_bf16 v[64:67], a[180:183], a[40:43], v[64:67]
    s_add_u32 s85, s85, 32768
    buffer_load_dwordx4 a[24:27], v33, s[44:47], s86 offen offset:0 sc1
    v_mfma_f32_16x16x32_bf16 v[96:99], a[176:179], a[36:39], v[96:99]
    ds_read_b64_tr_b16 a[148:149], v14 offset:8192
    ds_read_b64_tr_b16 a[150:151], v14 offset:12288
    v_mfma_f32_16x16x32_bf16 v[96:99], a[180:183], a[44:47], v[96:99]
    buffer_load_dwordx4 a[28:31], v33, s[44:47], s86 offen offset:1024 sc1
    v_mfma_f32_16x16x32_bf16 v[68:71], a[184:187], a[32:35], v[68:71]
    ds_read_b64_tr_b16 a[152:153], v15 offset:0
    ds_read_b64_tr_b16 a[154:155], v15 offset:4096
    v_mfma_f32_16x16x32_bf16 v[68:71], a[188:191], a[40:43], v[68:71]
    s_add_u32 s86, s86, 131072
    v_mfma_f32_16x16x32_bf16 v[100:103], a[184:187], a[36:39], v[100:103]
    ds_read_b64_tr_b16 a[156:157], v15 offset:8192
    ds_read_b64_tr_b16 a[158:159], v15 offset:12288
    v_mfma_f32_16x16x32_bf16 v[100:103], a[188:191], a[44:47], v[100:103]
    s_waitcnt vmcnt(32)
    s_waitcnt lgkmcnt(8)
    v_mfma_f32_16x16x32_bf16 v[40:43], a[128:131], a[48:51], v[40:43]
    ds_read_b64_tr_b16 a[160:161], v16 offset:0
    ds_read_b64_tr_b16 a[162:163], v16 offset:4096
    v_mfma_f32_16x16x32_bf16 v[40:43], a[132:135], a[56:59], v[40:43]
    s_add_u32 m0, s82, 98304
    v_mfma_f32_16x16x32_bf16 v[72:75], a[128:131], a[52:55], v[72:75]
    ds_read_b64_tr_b16 a[164:165], v16 offset:8192
    ds_read_b64_tr_b16 a[166:167], v16 offset:12288
    v_mfma_f32_16x16x32_bf16 v[72:75], a[132:135], a[60:63], v[72:75]
    buffer_load_dwordx4 v32, s[52:55], s85 offen lds
    v_mfma_f32_16x16x32_bf16 v[44:47], a[136:139], a[48:51], v[44:47]
    ds_read_b64_tr_b16 a[168:169], v17 offset:0
    ds_read_b64_tr_b16 a[170:171], v17 offset:4096
    v_mfma_f32_16x16x32_bf16 v[44:47], a[140:143], a[56:59], v[44:47]
    buffer_load_dwordx4 v34, s[52:55], s85 offen offset:1024 lds
    v_mfma_f32_16x16x32_bf16 v[76:79], a[136:139], a[52:55], v[76:79]
    ds_read_b64_tr_b16 a[172:173], v17 offset:8192
    ds_read_b64_tr_b16 a[174:175], v17 offset:12288
    v_mfma_f32_16x16x32_bf16 v[76:79], a[140:143], a[60:63], v[76:79]
    s_waitcnt lgkmcnt(8)
    v_mfma_f32_16x16x32_bf16 v[48:51], a[144:147], a[48:51], v[48:51]
    ds_read_b64_tr_b16 a[176:177], v18 offset:0
    ds_read_b64_tr_b16 a[178:179], v18 offset:4096
    v_mfma_f32_16x16x32_bf16 v[48:51], a[148:151], a[56:59], v[48:51]
    s_add_u32 s85, s85, 32768
    buffer_load_dwordx4 a[32:35], v33, s[44:47], s86 offen offset:0 sc1
    v_mfma_f32_16x16x32_bf16 v[80:83], a[144:147], a[52:55], v[80:83]
    ds_read_b64_tr_b16 a[180:181], v18 offset:8192
    ds_read_b64_tr_b16 a[182:183], v18 offset:12288
    v_mfma_f32_16x16x32_bf16 v[80:83], a[148:151], a[60:63], v[80:83]
    buffer_load_dwordx4 a[36:39], v33, s[44:47], s86 offen offset:1024 sc1
    v_mfma_f32_16x16x32_bf16 v[52:55], a[152:155], a[48:51], v[52:55]
    ds_read_b64_tr_b16 a[184:185], v19 offset:0
    ds_read_b64_tr_b16 a[186:187], v19 offset:4096
    v_mfma_f32_16x16x32_bf16 v[52:55], a[156:159], a[56:59], v[52:55]
    s_add_u32 s86, s86, 131072
    v_mfma_f32_16x16x32_bf16 v[84:87], a[152:155], a[52:55], v[84:87]
    ds_read_b64_tr_b16 a[188:189], v19 offset:8192
    ds_read_b64_tr_b16 a[190:191], v19 offset:12288
    v_mfma_f32_16x16x32_bf16 v[84:87], a[156:159], a[60:63], v[84:87]
    s_waitcnt vmcnt(30)
    s_barrier
    s_waitcnt lgkmcnt(8)
    v_mfma_f32_16x16x32_bf16 v[56:59], a[160:163], a[48:51], v[56:59]
    ds_read_b64_tr_b16 a[128:129], v184 offset:0
    ds_read_b64_tr_b16 a[130:131], v184 offset:4096
    v_mfma_f32_16x16x32_bf16 v[56:59], a[164:167], a[56:59], v[56:59]
    s_add_u32 m0, s82, 106496
    v_mfma_f32_16x16x32_bf16 v[88:91], a[160:163], a[52:55], v[88:91]
    ds_read_b64_tr_b16 a[132:133], v184 offset:8192
    ds_read_b64_tr_b16 a[134:135], v184 offset:12288
    v_mfma_f32_16x16x32_bf16 v[88:91], a[164:167], a[60:63], v[88:91]
    buffer_load_dwordx4 v32, s[52:55], s85 offen lds
    v_mfma_f32_16x16x32_bf16 v[60:63], a[168:171], a[48:51], v[60:63]
    ds_read_b64_tr_b16 a[136:137], v185 offset:0
    ds_read_b64_tr_b16 a[138:139], v185 offset:4096
    v_mfma_f32_16x16x32_bf16 v[60:63], a[172:175], a[56:59], v[60:63]
    buffer_load_dwordx4 v34, s[52:55], s85 offen offset:1024 lds
    v_mfma_f32_16x16x32_bf16 v[92:95], a[168:171], a[52:55], v[92:95]
    ds_read_b64_tr_b16 a[140:141], v185 offset:8192
    ds_read_b64_tr_b16 a[142:143], v185 offset:12288
    v_mfma_f32_16x16x32_bf16 v[92:95], a[172:175], a[60:63], v[92:95]
    s_waitcnt lgkmcnt(8)
    v_mfma_f32_16x16x32_bf16 v[64:67], a[176:179], a[48:51], v[64:67]
    ds_read_b64_tr_b16 a[144:145], v186 offset:0
    ds_read_b64_tr_b16 a[146:147], v186 offset:4096
    v_mfma_f32_16x16x32_bf16 v[64:67], a[180:183], a[56:59], v[64:67]
    s_add_u32 s85, s85, 32768
    buffer_load_dwordx4 a[40:43], v33, s[44:47], s86 offen offset:0 sc1
    v_mfma_f32_16x16x32_bf16 v[96:99], a[176:179], a[52:55], v[96:99]
    ds_read_b64_tr_b16 a[148:149], v186 offset:8192
    ds_read_b64_tr_b16 a[150:151], v186 offset:12288
    v_mfma_f32_16x16x32_bf16 v[96:99], a[180:183], a[60:63], v[96:99]
    buffer_load_dwordx4 a[44:47], v33, s[44:47], s86 offen offset:1024 sc1
    v_mfma_f32_16x16x32_bf16 v[68:71], a[184:187], a[48:51], v[68:71]
    ds_read_b64_tr_b16 a[152:153], v187 offset:0
    ds_read_b64_tr_b16 a[154:155], v187 offset:4096
    v_mfma_f32_16x16x32_bf16 v[68:71], a[188:191], a[56:59], v[68:71]
    s_add_u32 s86, s86, 131072
    v_mfma_f32_16x16x32_bf16 v[100:103], a[184:187], a[52:55], v[100:103]
    ds_read_b64_tr_b16 a[156:157], v187 offset:8192
    ds_read_b64_tr_b16 a[158:159], v187 offset:12288
    v_mfma_f32_16x16x32_bf16 v[100:103], a[188:191], a[60:63], v[100:103]
    s_waitcnt vmcnt(32)
    s_waitcnt lgkmcnt(8)
    v_mfma_f32_16x16x32_bf16 v[40:43], a[128:131], a[64:67], v[40:43]
    ds_read_b64_tr_b16 a[160:161], v188 offset:0
    ds_read_b64_tr_b16 a[162:163], v188 offset:4096
    v_mfma_f32_16x16x32_bf16 v[40:43], a[132:135], a[72:75], v[40:43]
    s_add_u32 m0, s82, 114688
    v_mfma_f32_16x16x32_bf16 v[72:75], a[128:131], a[68:71], v[72:75]
    ds_read_b64_tr_b16 a[164:165], v188 offset:8192
    ds_read_b64_tr_b16 a[166:167], v188 offset:12288
    v_mfma_f32_16x16x32_bf16 v[72:75], a[132:135], a[76:79], v[72:75]
    buffer_load_dwordx4 v32, s[52:55], s85 offen lds
    v_mfma_f32_16x16x32_bf16 v[44:47], a[136:139], a[64:67], v[44:47]
    ds_read_b64_tr_b16 a[168:169], v189 offset:0
    ds_read_b64_tr_b16 a[170:171], v189 offset:4096
    v_mfma_f32_16x16x32_bf16 v[44:47], a[140:143], a[72:75], v[44:47]
    buffer_load_dwordx4 v34, s[52:55], s85 offen offset:1024 lds
    v_mfma_f32_16x16x32_bf16 v[76:79], a[136:139], a[68:71], v[76:79]
    ds_read_b64_tr_b16 a[172:173], v189 offset:8192
    ds_read_b64_tr_b16 a[174:175], v189 offset:12288
    v_mfma_f32_16x16x32_bf16 v[76:79], a[140:143], a[76:79], v[76:79]
    s_waitcnt lgkmcnt(8)
    v_mfma_f32_16x16x32_bf16 v[48:51], a[144:147], a[64:67], v[48:51]
    ds_read_b64_tr_b16 a[176:177], v190 offset:0
    ds_read_b64_tr_b16 a[178:179], v190 offset:4096
    v_mfma_f32_16x16x32_bf16 v[48:51], a[148:151], a[72:75], v[48:51]
    s_add_u32 s85, s85, 32768
    buffer_load_dwordx4 a[48:51], v33, s[44:47], s86 offen offset:0 sc1
    v_mfma_f32_16x16x32_bf16 v[80:83], a[144:147], a[68:71], v[80:83]
    ds_read_b64_tr_b16 a[180:181], v190 offset:8192
    ds_read_b64_tr_b16 a[182:183], v190 offset:12288
    v_mfma_f32_16x16x32_bf16 v[80:83], a[148:151], a[76:79], v[80:83]
    buffer_load_dwordx4 a[52:55], v33, s[44:47], s86 offen offset:1024 sc1
    v_mfma_f32_16x16x32_bf16 v[52:55], a[152:155], a[64:67], v[52:55]
    ds_read_b64_tr_b16 a[184:185], v191 offset:0
    ds_read_b64_tr_b16 a[186:187], v191 offset:4096
    v_mfma_f32_16x16x32_bf16 v[52:55], a[156:159], a[72:75], v[52:55]
    s_add_u32 s86, s86, 131072
    v_mfma_f32_16x16x32_bf16 v[84:87], a[152:155], a[68:71], v[84:87]
    ds_read_b64_tr_b16 a[188:189], v191 offset:8192
    ds_read_b64_tr_b16 a[190:191], v191 offset:12288
    v_mfma_f32_16x16x32_bf16 v[84:87], a[156:159], a[76:79], v[84:87]
    s_waitcnt vmcnt(30)
    s_barrier
    s_waitcnt lgkmcnt(8)
    v_mfma_f32_16x16x32_bf16 v[56:59], a[160:163], a[64:67], v[56:59]
    ds_read_b64_tr_b16 a[128:129], v184 offset:16384
    ds_read_b64_tr_b16 a[130:131], v184 offset:20480
    v_mfma_f32_16x16x32_bf16 v[56:59], a[164:167], a[72:75], v[56:59]
    s_add_u32 m0, s82, 122880
    v_mfma_f32_16x16x32_bf16 v[88:91], a[160:163], a[68:71], v[88:91]
    ds_read_b64_tr_b16 a[132:133], v184 offset:40960
    ds_read_b64_tr_b16 a[134:135], v184 offset:45056
    v_mfma_f32_16x16x32_bf16 v[88:91], a[164:167], a[76:79], v[88:91]
    buffer_load_dwordx4 v32, s[52:55], s85 offen lds
    v_mfma_f32_16x16x32_bf16 v[60:63], a[168:171], a[64:67], v[60:63]
    ds_read_b64_tr_b16 a[136:137], v185 offset:16384
    ds_read_b64_tr_b16 a[138:139], v185 offset:20480
    v_mfma_f32_16x16x32_bf16 v[60:63], a[172:175], a[72:75], v[60:63]
    buffer_load_dwordx4 v34, s[52:55], s85 offen offset:1024 lds
    v_mfma_f32_16x16x32_bf16 v[92:95], a[168:171], a[68:71], v[92:95]
    ds_read_b64_tr_b16 a[140:141], v185 offset:40960
    ds_read_b64_tr_b16 a[142:143], v185 offset:45056
    v_mfma_f32_16x16x32_bf16 v[92:95], a[172:175], a[76:79], v[92:95]
    s_waitcnt lgkmcnt(8)
    v_mfma_f32_16x16x32_bf16 v[64:67], a[176:179], a[64:67], v[64:67]
    ds_read_b64_tr_b16 a[144:145], v186 offset:16384
    ds_read_b64_tr_b16 a[146:147], v186 offset:20480
    v_mfma_f32_16x16x32_bf16 v[64:67], a[180:183], a[72:75], v[64:67]
    s_add_u32 s85, s85, 32768
    buffer_load_dwordx4 a[56:59], v33, s[44:47], s86 offen offset:0 sc1
    v_mfma_f32_16x16x32_bf16 v[96:99], a[176:179], a[68:71], v[96:99]
    ds_read_b64_tr_b16 a[148:149], v186 offset:40960
    ds_read_b64_tr_b16 a[150:151], v186 offset:45056
    v_mfma_f32_16x16x32_bf16 v[96:99], a[180:183], a[76:79], v[96:99]
    buffer_load_dwordx4 a[60:63], v33, s[44:47], s86 offen offset:1024 sc1
    v_mfma_f32_16x16x32_bf16 v[68:71], a[184:187], a[64:67], v[68:71]
    ds_read_b64_tr_b16 a[152:153], v187 offset:16384
    ds_read_b64_tr_b16 a[154:155], v187 offset:20480
    v_mfma_f32_16x16x32_bf16 v[68:71], a[188:191], a[72:75], v[68:71]
    s_add_u32 s86, s86, 131072
    v_mfma_f32_16x16x32_bf16 v[100:103], a[184:187], a[68:71], v[100:103]
    ds_read_b64_tr_b16 a[156:157], v187 offset:40960
    ds_read_b64_tr_b16 a[158:159], v187 offset:45056
    v_mfma_f32_16x16x32_bf16 v[100:103], a[188:191], a[76:79], v[100:103]
    s_waitcnt vmcnt(32)
    s_waitcnt lgkmcnt(8)
    v_mfma_f32_16x16x32_bf16 v[40:43], a[128:131], a[80:83], v[40:43]
    ds_read_b64_tr_b16 a[160:161], v188 offset:16384
    ds_read_b64_tr_b16 a[162:163], v188 offset:20480
    v_mfma_f32_16x16x32_bf16 v[40:43], a[132:135], a[88:91], v[40:43]
    v_mfma_f32_16x16x32_bf16 v[72:75], a[128:131], a[84:87], v[72:75]
    ds_read_b64_tr_b16 a[164:165], v188 offset:40960
    ds_read_b64_tr_b16 a[166:167], v188 offset:45056
    v_mfma_f32_16x16x32_bf16 v[72:75], a[132:135], a[92:95], v[72:75]
    buffer_load_dwordx4 v[168:171], v33, s[20:23], s15 offen offset:0
    v_mfma_f32_16x16x32_bf16 v[44:47], a[136:139], a[80:83], v[44:47]
    ds_read_b64_tr_b16 a[168:169], v189 offset:16384
    ds_read_b64_tr_b16 a[170:171], v189 offset:20480
    v_mfma_f32_16x16x32_bf16 v[44:47], a[140:143], a[88:91], v[44:47]
    v_mfma_f32_16x16x32_bf16 v[76:79], a[136:139], a[84:87], v[76:79]
    ds_read_b64_tr_b16 a[172:173], v189 offset:40960
    ds_read_b64_tr_b16 a[174:175], v189 offset:45056
    v_mfma_f32_16x16x32_bf16 v[76:79], a[140:143], a[92:95], v[76:79]
    s_waitcnt lgkmcnt(8)
    buffer_load_dwordx4 v[172:175], v33, s[20:23], s15 offen offset:1024
    v_mfma_f32_16x16x32_bf16 v[48:51], a[144:147], a[80:83], v[48:51]
    ds_read_b64_tr_b16 a[176:177], v190 offset:16384
    ds_read_b64_tr_b16 a[178:179], v190 offset:20480
    v_mfma_f32_16x16x32_bf16 v[48:51], a[148:151], a[88:91], v[48:51]
    v_mfma_f32_16x16x32_bf16 v[80:83], a[144:147], a[84:87], v[80:83]
    ds_read_b64_tr_b16 a[180:181], v190 offset:40960
    ds_read_b64_tr_b16 a[182:183], v190 offset:45056
    v_mfma_f32_16x16x32_bf16 v[80:83], a[148:151], a[92:95], v[80:83]
    buffer_load_dwordx4 v[176:179], v33, s[20:23], s15 offen offset:2048
    v_mfma_f32_16x16x32_bf16 v[52:55], a[152:155], a[80:83], v[52:55]
    ds_read_b64_tr_b16 a[184:185], v191 offset:16384
    ds_read_b64_tr_b16 a[186:187], v191 offset:20480
    v_mfma_f32_16x16x32_bf16 v[52:55], a[156:159], a[88:91], v[52:55]
    v_mfma_f32_16x16x32_bf16 v[84:87], a[152:155], a[84:87], v[84:87]
    ds_read_b64_tr_b16 a[188:189], v191 offset:40960
    ds_read_b64_tr_b16 a[190:191], v191 offset:45056
    v_mfma_f32_16x16x32_bf16 v[84:87], a[156:159], a[92:95], v[84:87]
    s_waitcnt vmcnt(29)
    s_barrier
    s_waitcnt lgkmcnt(8)
    v_mfma_f32_16x16x32_bf16 v[56:59], a[160:163], a[80:83], v[56:59]
    ds_read_b64_tr_b16 a[128:129], v184 offset:49152
    ds_read_b64_tr_b16 a[130:131], v184 offset:53248
    v_mfma_f32_16x16x32_bf16 v[56:59], a[164:167], a[88:91], v[56:59]
    v_mfma_f32_16x16x32_bf16 v[88:91], a[160:163], a[84:87], v[88:91]
    ds_read_b64_tr_b16 a[132:133], v12 offset:16384
    ds_read_b64_tr_b16 a[134:135], v12 offset:20480
    v_mfma_f32_16x16x32_bf16 v[88:91], a[164:167], a[92:95], v[88:91]
    buffer_load_dwordx4 v[180:183], v33, s[20:23], s15 offen offset:3072
    v_mfma_f32_16x16x32_bf16 v[60:63], a[168:171], a[80:83], v[60:63]
    ds_read_b64_tr_b16 a[136:137], v185 offset:49152
    ds_read_b64_tr_b16 a[138:139], v185 offset:53248
    v_mfma_f32_16x16x32_bf16 v[60:63], a[172:175], a[88:91], v[60:63]
    v_mfma_f32_16x16x32_bf16 v[92:95], a[168:171], a[84:87], v[92:95]
    ds_read_b64_tr_b16 a[140:141], v13 offset:16384
    ds_read_b64_tr_b16 a[142:143], v13 offset:20480
    v_mfma_f32_16x16x32_bf16 v[92:95], a[172:175], a[92:95], v[92:95]
    s_waitcnt lgkmcnt(8)
    buffer_load_dwordx2 v[120:121], v197, s[48:51], s9 offen offset:0
    v_mfma_f32_16x16x32_bf16 v[64:67], a[176:179], a[80:83], v[64:67]
    ds_read_b64_tr_b16 a[144:145], v186 offset:49152
    ds_read_b64_tr_b16 a[146:147], v186 offset:53248
    v_mfma_f32_16x16x32_bf16 v[64:67], a[180:183], a[88:91], v[64:67]
    v_mfma_f32_16x16x32_bf16 v[96:99], a[176:179], a[84:87], v[96:99]
    ds_read_b64_tr_b16 a[148:149], v14 offset:16384
    ds_read_b64_tr_b16 a[150:151], v14 offset:20480
    v_mfma_f32_16x16x32_bf16 v[96:99], a[180:183], a[92:95], v[96:99]
    buffer_load_dwordx2 v[122:123], v197, s[48:51], s9 offen offset:32
    v_mfma_f32_16x16x32_bf16 v[68:71], a[184:187], a[80:83], v[68:71]
    ds_read_b64_tr_b16 a[152:153], v187 offset:49152
    ds_read_b64_tr_b16 a[154:155], v187 offset:53248
    v_mfma_f32_16x16x32_bf16 v[68:71], a[188:191], a[88:91], v[68:71]
    v_mfma_f32_16x16x32_bf16 v[100:103], a[184:187], a[84:87], v[100:103]
    ds_read_b64_tr_b16 a[156:157], v15 offset:16384
    ds_read_b64_tr_b16 a[158:159], v15 offset:20480
    v_mfma_f32_16x16x32_bf16 v[100:103], a[188:191], a[92:95], v[100:103]
    s_waitcnt vmcnt(30)
    s_waitcnt lgkmcnt(8)
    v_mfma_f32_16x16x32_bf16 v[40:43], a[128:131], a[0:3], v[40:43]
    ds_read_b64_tr_b16 a[160:161], v188 offset:49152
    ds_read_b64_tr_b16 a[162:163], v188 offset:53248
    v_mfma_f32_16x16x32_bf16 v[40:43], a[132:135], a[8:11], v[40:43]
    v_mfma_f32_16x16x32_bf16 v[72:75], a[128:131], a[4:7], v[72:75]
    ds_read_b64_tr_b16 a[164:165], v16 offset:16384
    ds_read_b64_tr_b16 a[166:167], v16 offset:20480
    v_mfma_f32_16x16x32_bf16 v[72:75], a[132:135], a[12:15], v[72:75]
    buffer_load_dwordx2 v[124:125], v197, s[48:51], s9 offen offset:128
    v_mfma_f32_16x16x32_bf16 v[44:47], a[136:139], a[0:3], v[44:47]
    ds_read_b64_tr_b16 a[168:169], v189 offset:49152
    ds_read_b64_tr_b16 a[170:171], v189 offset:53248
    v_mfma_f32_16x16x32_bf16 v[44:47], a[140:143], a[8:11], v[44:47]
    v_mfma_f32_16x16x32_bf16 v[76:79], a[136:139], a[4:7], v[76:79]
    ds_read_b64_tr_b16 a[172:173], v17 offset:16384
    ds_read_b64_tr_b16 a[174:175], v17 offset:20480
    v_mfma_f32_16x16x32_bf16 v[76:79], a[140:143], a[12:15], v[76:79]
    s_waitcnt lgkmcnt(8)
    buffer_load_dwordx2 v[126:127], v197, s[48:51], s9 offen offset:160
    v_mfma_f32_16x16x32_bf16 v[48:51], a[144:147], a[0:3], v[48:51]
    ds_read_b64_tr_b16 a[176:177], v190 offset:49152
    ds_read_b64_tr_b16 a[178:179], v190 offset:53248
    v_mfma_f32_16x16x32_bf16 v[48:51], a[148:151], a[8:11], v[48:51]
    v_mfma_f32_16x16x32_bf16 v[80:83], a[144:147], a[4:7], v[80:83]
    ds_read_b64_tr_b16 a[180:181], v18 offset:16384
    ds_read_b64_tr_b16 a[182:183], v18 offset:20480
    v_mfma_f32_16x16x32_bf16 v[80:83], a[148:151], a[12:15], v[80:83]
    buffer_load_dwordx2 v[128:129], v31, s[64:67], 0 offen offset:0
    v_mfma_f32_16x16x32_bf16 v[52:55], a[152:155], a[0:3], v[52:55]
    ds_read_b64_tr_b16 a[184:185], v191 offset:49152
    ds_read_b64_tr_b16 a[186:187], v191 offset:53248
    v_mfma_f32_16x16x32_bf16 v[52:55], a[156:159], a[8:11], v[52:55]
    v_mfma_f32_16x16x32_bf16 v[84:87], a[152:155], a[4:7], v[84:87]
    ds_read_b64_tr_b16 a[188:189], v19 offset:16384
    ds_read_b64_tr_b16 a[190:191], v19 offset:20480
    v_mfma_f32_16x16x32_bf16 v[84:87], a[156:159], a[12:15], v[84:87]
    s_waitcnt vmcnt(27)
    s_barrier
    s_waitcnt lgkmcnt(8)
    v_mfma_f32_16x16x32_bf16 v[56:59], a[160:163], a[0:3], v[56:59]
    ds_read_b64_tr_b16 a[128:129], v12 offset:24576
    ds_read_b64_tr_b16 a[130:131], v12 offset:28672
    v_mfma_f32_16x16x32_bf16 v[56:59], a[164:167], a[8:11], v[56:59]
    v_mfma_f32_16x16x32_bf16 v[88:91], a[160:163], a[4:7], v[88:91]
    ds_read_b64_tr_b16 a[132:133], v184 offset:57344
    ds_read_b64_tr_b16 a[134:135], v184 offset:61440
    v_mfma_f32_16x16x32_bf16 v[88:91], a[164:167], a[12:15], v[88:91]
    buffer_load_dwordx2 v[130:131], v31, s[64:67], 0 offen offset:32
    v_mfma_f32_16x16x32_bf16 v[60:63], a[168:171], a[0:3], v[60:63]
    ds_read_b64_tr_b16 a[136:137], v13 offset:24576
    ds_read_b64_tr_b16 a[138:139], v13 offset:28672
    v_mfma_f32_16x16x32_bf16 v[60:63], a[172:175], a[8:11], v[60:63]
    v_mfma_f32_16x16x32_bf16 v[92:95], a[168:171], a[4:7], v[92:95]
    ds_read_b64_tr_b16 a[140:141], v185 offset:57344
    ds_read_b64_tr_b16 a[142:143], v185 offset:61440
    v_mfma_f32_16x16x32_bf16 v[92:95], a[172:175], a[12:15], v[92:95]
    s_waitcnt lgkmcnt(8)
    buffer_load_dwordx2 v[132:133], v31, s[64:67], 0 offen offset:128
    v_mfma_f32_16x16x32_bf16 v[64:67], a[176:179], a[0:3], v[64:67]
    ds_read_b64_tr_b16 a[144:145], v14 offset:24576
    ds_read_b64_tr_b16 a[146:147], v14 offset:28672
    v_mfma_f32_16x16x32_bf16 v[64:67], a[180:183], a[8:11], v[64:67]
    v_mfma_f32_16x16x32_bf16 v[96:99], a[176:179], a[4:7], v[96:99]
    ds_read_b64_tr_b16 a[148:149], v186 offset:57344
    ds_read_b64_tr_b16 a[150:151], v186 offset:61440
    v_mfma_f32_16x16x32_bf16 v[96:99], a[180:183], a[12:15], v[96:99]
    buffer_load_dwordx2 v[134:135], v31, s[64:67], 0 offen offset:160
    v_mfma_f32_16x16x32_bf16 v[68:71], a[184:187], a[0:3], v[68:71]
    ds_read_b64_tr_b16 a[152:153], v15 offset:24576
    ds_read_b64_tr_b16 a[154:155], v15 offset:28672
    v_mfma_f32_16x16x32_bf16 v[68:71], a[188:191], a[8:11], v[68:71]
    v_mfma_f32_16x16x32_bf16 v[100:103], a[184:187], a[4:7], v[100:103]
    ds_read_b64_tr_b16 a[156:157], v187 offset:57344
    ds_read_b64_tr_b16 a[158:159], v187 offset:61440
    v_mfma_f32_16x16x32_bf16 v[100:103], a[188:191], a[12:15], v[100:103]
    s_waitcnt vmcnt(28)
    s_waitcnt lgkmcnt(8)
    v_mfma_f32_16x16x32_bf16 v[40:43], a[128:131], a[16:19], v[40:43]
    ds_read_b64_tr_b16 a[160:161], v16 offset:24576
    ds_read_b64_tr_b16 a[162:163], v16 offset:28672
    v_mfma_f32_16x16x32_bf16 v[40:43], a[132:135], a[24:27], v[40:43]
    v_mfma_f32_16x16x32_bf16 v[72:75], a[128:131], a[20:23], v[72:75]
    ds_read_b64_tr_b16 a[164:165], v188 offset:57344
    ds_read_b64_tr_b16 a[166:167], v188 offset:61440
    v_mfma_f32_16x16x32_bf16 v[72:75], a[132:135], a[28:31], v[72:75]
    v_mfma_f32_16x16x32_bf16 v[44:47], a[136:139], a[16:19], v[44:47]
    ds_read_b64_tr_b16 a[168:169], v17 offset:24576
    ds_read_b64_tr_b16 a[170:171], v17 offset:28672
    v_mfma_f32_16x16x32_bf16 v[44:47], a[140:143], a[24:27], v[44:47]
    v_mfma_f32_16x16x32_bf16 v[76:79], a[136:139], a[20:23], v[76:79]
    ds_read_b64_tr_b16 a[172:173], v189 offset:57344
    ds_read_b64_tr_b16 a[174:175], v189 offset:61440
    v_mfma_f32_16x16x32_bf16 v[76:79], a[140:143], a[28:31], v[76:79]
    s_waitcnt lgkmcnt(8)
    v_mfma_f32_16x16x32_bf16 v[48:51], a[144:147], a[16:19], v[48:51]
    ds_read_b64_tr_b16 a[176:177], v18 offset:24576
    ds_read_b64_tr_b16 a[178:179], v18 offset:28672
    v_mfma_f32_16x16x32_bf16 v[48:51], a[148:151], a[24:27], v[48:51]
    v_mfma_f32_16x16x32_bf16 v[80:83], a[144:147], a[20:23], v[80:83]
    ds_read_b64_tr_b16 a[180:181], v190 offset:57344
    ds_read_b64_tr_b16 a[182:183], v190 offset:61440
    v_mfma_f32_16x16x32_bf16 v[80:83], a[148:151], a[28:31], v[80:83]
    v_mfma_f32_16x16x32_bf16 v[52:55], a[152:155], a[16:19], v[52:55]
    ds_read_b64_tr_b16 a[184:185], v19 offset:24576
    ds_read_b64_tr_b16 a[186:187], v19 offset:28672
    v_mfma_f32_16x16x32_bf16 v[52:55], a[156:159], a[24:27], v[52:55]
    v_mfma_f32_16x16x32_bf16 v[84:87], a[152:155], a[20:23], v[84:87]
    ds_read_b64_tr_b16 a[188:189], v191 offset:57344
    ds_read_b64_tr_b16 a[190:191], v191 offset:61440
    v_mfma_f32_16x16x32_bf16 v[84:87], a[156:159], a[28:31], v[84:87]
    s_waitcnt vmcnt(22)
    s_barrier
    s_waitcnt lgkmcnt(8)
    v_mfma_f32_16x16x32_bf16 v[56:59], a[160:163], a[16:19], v[56:59]
    ds_read_b64_tr_b16 a[128:129], v12 offset:32768
    ds_read_b64_tr_b16 a[130:131], v12 offset:36864
    v_mfma_f32_16x16x32_bf16 v[56:59], a[164:167], a[24:27], v[56:59]
    v_mfma_f32_16x16x32_bf16 v[88:91], a[160:163], a[20:23], v[88:91]
    ds_read_b64_tr_b16 a[132:133], v12 offset:40960
    ds_read_b64_tr_b16 a[134:135], v12 offset:45056
    v_mfma_f32_16x16x32_bf16 v[88:91], a[164:167], a[28:31], v[88:91]
    v_mfma_f32_16x16x32_bf16 v[60:63], a[168:171], a[16:19], v[60:63]
    ds_read_b64_tr_b16 a[136:137], v13 offset:32768
    ds_read_b64_tr_b16 a[138:139], v13 offset:36864
    v_mfma_f32_16x16x32_bf16 v[60:63], a[172:175], a[24:27], v[60:63]
    v_mfma_f32_16x16x32_bf16 v[92:95], a[168:171], a[20:23], v[92:95]
    ds_read_b64_tr_b16 a[140:141], v13 offset:40960
    ds_read_b64_tr_b16 a[142:143], v13 offset:45056
    v_mfma_f32_16x16x32_bf16 v[92:95], a[172:175], a[28:31], v[92:95]
    s_waitcnt lgkmcnt(8)
    v_mfma_f32_16x16x32_bf16 v[64:67], a[176:179], a[16:19], v[64:67]
    ds_read_b64_tr_b16 a[144:145], v14 offset:32768
    ds_read_b64_tr_b16 a[146:147], v14 offset:36864
    v_mfma_f32_16x16x32_bf16 v[64:67], a[180:183], a[24:27], v[64:67]
    v_mfma_f32_16x16x32_bf16 v[96:99], a[176:179], a[20:23], v[96:99]
    ds_read_b64_tr_b16 a[148:149], v14 offset:40960
    ds_read_b64_tr_b16 a[150:151], v14 offset:45056
    v_mfma_f32_16x16x32_bf16 v[96:99], a[180:183], a[28:31], v[96:99]
    v_mfma_f32_16x16x32_bf16 v[68:71], a[184:187], a[16:19], v[68:71]
    ds_read_b64_tr_b16 a[152:153], v15 offset:32768
    ds_read_b64_tr_b16 a[154:155], v15 offset:36864
    v_mfma_f32_16x16x32_bf16 v[68:71], a[188:191], a[24:27], v[68:71]
    v_mfma_f32_16x16x32_bf16 v[100:103], a[184:187], a[20:23], v[100:103]
    ds_read_b64_tr_b16 a[156:157], v15 offset:40960
    ds_read_b64_tr_b16 a[158:159], v15 offset:45056
    v_mfma_f32_16x16x32_bf16 v[100:103], a[188:191], a[28:31], v[100:103]
    s_waitcnt vmcnt(20)
    s_waitcnt lgkmcnt(8)
    v_mfma_f32_16x16x32_bf16 v[40:43], a[128:131], a[32:35], v[40:43]
    ds_read_b64_tr_b16 a[160:161], v16 offset:32768
    ds_read_b64_tr_b16 a[162:163], v16 offset:36864
    v_mfma_f32_16x16x32_bf16 v[40:43], a[132:135], a[40:43], v[40:43]
    v_mfma_f32_16x16x32_bf16 v[72:75], a[128:131], a[36:39], v[72:75]
    ds_read_b64_tr_b16 a[164:165], v16 offset:40960
    ds_read_b64_tr_b16 a[166:167], v16 offset:45056
    v_mfma_f32_16x16x32_bf16 v[72:75], a[132:135], a[44:47], v[72:75]
    v_mfma_f32_16x16x32_bf16 v[44:47], a[136:139], a[32:35], v[44:47]
    ds_read_b64_tr_b16 a[168:169], v17 offset:32768
    ds_read_b64_tr_b16 a[170:171], v17 offset:36864
    v_mfma_f32_16x16x32_bf16 v[44:47], a[140:143], a[40:43], v[44:47]
    v_mfma_f32_16x16x32_bf16 v[76:79], a[136:139], a[36:39], v[76:79]
    ds_read_b64_tr_b16 a[172:173], v17 offset:40960
    ds_read_b64_tr_b16 a[174:175], v17 offset:45056
    v_mfma_f32_16x16x32_bf16 v[76:79], a[140:143], a[44:47], v[76:79]
    s_waitcnt lgkmcnt(8)
    v_mfma_f32_16x16x32_bf16 v[48:51], a[144:147], a[32:35], v[48:51]
    ds_read_b64_tr_b16 a[176:177], v18 offset:32768
    ds_read_b64_tr_b16 a[178:179], v18 offset:36864
    v_mfma_f32_16x16x32_bf16 v[48:51], a[148:151], a[40:43], v[48:51]
    v_mfma_f32_16x16x32_bf16 v[80:83], a[144:147], a[36:39], v[80:83]
    ds_read_b64_tr_b16 a[180:181], v18 offset:40960
    ds_read_b64_tr_b16 a[182:183], v18 offset:45056
    v_mfma_f32_16x16x32_bf16 v[80:83], a[148:151], a[44:47], v[80:83]
    v_mfma_f32_16x16x32_bf16 v[52:55], a[152:155], a[32:35], v[52:55]
    ds_read_b64_tr_b16 a[184:185], v19 offset:32768
    ds_read_b64_tr_b16 a[186:187], v19 offset:36864
    v_mfma_f32_16x16x32_bf16 v[52:55], a[156:159], a[40:43], v[52:55]
    v_mfma_f32_16x16x32_bf16 v[84:87], a[152:155], a[36:39], v[84:87]
    ds_read_b64_tr_b16 a[188:189], v19 offset:40960
    ds_read_b64_tr_b16 a[190:191], v19 offset:45056
    v_mfma_f32_16x16x32_bf16 v[84:87], a[156:159], a[44:47], v[84:87]
    s_waitcnt vmcnt(14)
    s_barrier
    s_waitcnt lgkmcnt(8)
    v_mfma_f32_16x16x32_bf16 v[56:59], a[160:163], a[32:35], v[56:59]
    ds_read_b64_tr_b16 a[128:129], v12 offset:49152
    ds_read_b64_tr_b16 a[130:131], v12 offset:53248
    v_mfma_f32_16x16x32_bf16 v[56:59], a[164:167], a[40:43], v[56:59]
    v_mfma_f32_16x16x32_bf16 v[88:91], a[160:163], a[36:39], v[88:91]
    ds_read_b64_tr_b16 a[132:133], v12 offset:57344
    ds_read_b64_tr_b16 a[134:135], v12 offset:61440
    v_mfma_f32_16x16x32_bf16 v[88:91], a[164:167], a[44:47], v[88:91]
    v_mfma_f32_16x16x32_bf16 v[60:63], a[168:171], a[32:35], v[60:63]
    ds_read_b64_tr_b16 a[136:137], v13 offset:49152
    ds_read_b64_tr_b16 a[138:139], v13 offset:53248
    v_mfma_f32_16x16x32_bf16 v[60:63], a[172:175], a[40:43], v[60:63]
    v_mfma_f32_16x16x32_bf16 v[92:95], a[168:171], a[36:39], v[92:95]
    ds_read_b64_tr_b16 a[140:141], v13 offset:57344
    ds_read_b64_tr_b16 a[142:143], v13 offset:61440
    v_mfma_f32_16x16x32_bf16 v[92:95], a[172:175], a[44:47], v[92:95]
    s_waitcnt lgkmcnt(8)
    v_mfma_f32_16x16x32_bf16 v[64:67], a[176:179], a[32:35], v[64:67]
    ds_read_b64_tr_b16 a[144:145], v14 offset:49152
    ds_read_b64_tr_b16 a[146:147], v14 offset:53248
    v_mfma_f32_16x16x32_bf16 v[64:67], a[180:183], a[40:43], v[64:67]
    v_mfma_f32_16x16x32_bf16 v[96:99], a[176:179], a[36:39], v[96:99]
    ds_read_b64_tr_b16 a[148:149], v14 offset:57344
    ds_read_b64_tr_b16 a[150:151], v14 offset:61440
    v_mfma_f32_16x16x32_bf16 v[96:99], a[180:183], a[44:47], v[96:99]
    v_mfma_f32_16x16x32_bf16 v[68:71], a[184:187], a[32:35], v[68:71]
    ds_read_b64_tr_b16 a[152:153], v15 offset:49152
    ds_read_b64_tr_b16 a[154:155], v15 offset:53248
    v_mfma_f32_16x16x32_bf16 v[68:71], a[188:191], a[40:43], v[68:71]
    v_mfma_f32_16x16x32_bf16 v[100:103], a[184:187], a[36:39], v[100:103]
    ds_read_b64_tr_b16 a[156:157], v15 offset:57344
    ds_read_b64_tr_b16 a[158:159], v15 offset:61440
    v_mfma_f32_16x16x32_bf16 v[100:103], a[188:191], a[44:47], v[100:103]
    s_waitcnt vmcnt(12)
    s_waitcnt lgkmcnt(8)
    v_mfma_f32_16x16x32_bf16 v[40:43], a[128:131], a[48:51], v[40:43]
    ds_read_b64_tr_b16 a[160:161], v16 offset:49152
    ds_read_b64_tr_b16 a[162:163], v16 offset:53248
    v_mfma_f32_16x16x32_bf16 v[40:43], a[132:135], a[56:59], v[40:43]
    v_mfma_f32_16x16x32_bf16 v[72:75], a[128:131], a[52:55], v[72:75]
    ds_read_b64_tr_b16 a[164:165], v16 offset:57344
    ds_read_b64_tr_b16 a[166:167], v16 offset:61440
    v_mfma_f32_16x16x32_bf16 v[72:75], a[132:135], a[60:63], v[72:75]
    v_mfma_f32_16x16x32_bf16 v[44:47], a[136:139], a[48:51], v[44:47]
    ds_read_b64_tr_b16 a[168:169], v17 offset:49152
    ds_read_b64_tr_b16 a[170:171], v17 offset:53248
    v_mfma_f32_16x16x32_bf16 v[44:47], a[140:143], a[56:59], v[44:47]
    v_mfma_f32_16x16x32_bf16 v[76:79], a[136:139], a[52:55], v[76:79]
    ds_read_b64_tr_b16 a[172:173], v17 offset:57344
    ds_read_b64_tr_b16 a[174:175], v17 offset:61440
    v_mfma_f32_16x16x32_bf16 v[76:79], a[140:143], a[60:63], v[76:79]
    s_waitcnt lgkmcnt(8)
    v_mfma_f32_16x16x32_bf16 v[48:51], a[144:147], a[48:51], v[48:51]
    ds_read_b64_tr_b16 a[176:177], v18 offset:49152
    ds_read_b64_tr_b16 a[178:179], v18 offset:53248
    v_mfma_f32_16x16x32_bf16 v[48:51], a[148:151], a[56:59], v[48:51]
    v_mfma_f32_16x16x32_bf16 v[80:83], a[144:147], a[52:55], v[80:83]
    ds_read_b64_tr_b16 a[180:181], v18 offset:57344
    ds_read_b64_tr_b16 a[182:183], v18 offset:61440
    v_mfma_f32_16x16x32_bf16 v[80:83], a[148:151], a[60:63], v[80:83]
    v_mfma_f32_16x16x32_bf16 v[52:55], a[152:155], a[48:51], v[52:55]
    ds_read_b64_tr_b16 a[184:185], v19 offset:49152
    ds_read_b64_tr_b16 a[186:187], v19 offset:53248
    v_mfma_f32_16x16x32_bf16 v[52:55], a[156:159], a[56:59], v[52:55]
    v_mfma_f32_16x16x32_bf16 v[84:87], a[152:155], a[52:55], v[84:87]
    ds_read_b64_tr_b16 a[188:189], v19 offset:57344
    ds_read_b64_tr_b16 a[190:191], v19 offset:61440
    v_mfma_f32_16x16x32_bf16 v[84:87], a[156:159], a[60:63], v[84:87]
    s_waitcnt lgkmcnt(8)
    v_mfma_f32_16x16x32_bf16 v[56:59], a[160:163], a[48:51], v[56:59]
    v_mfma_f32_16x16x32_bf16 v[56:59], a[164:167], a[56:59], v[56:59]
    v_mfma_f32_16x16x32_bf16 v[88:91], a[160:163], a[52:55], v[88:91]
    v_mfma_f32_16x16x32_bf16 v[88:91], a[164:167], a[60:63], v[88:91]
    v_mfma_f32_16x16x32_bf16 v[60:63], a[168:171], a[48:51], v[60:63]
    v_mfma_f32_16x16x32_bf16 v[60:63], a[172:175], a[56:59], v[60:63]
    v_mfma_f32_16x16x32_bf16 v[92:95], a[168:171], a[52:55], v[92:95]
    v_mfma_f32_16x16x32_bf16 v[92:95], a[172:175], a[60:63], v[92:95]
    s_waitcnt lgkmcnt(0)
    v_mfma_f32_16x16x32_bf16 v[64:67], a[176:179], a[48:51], v[64:67]
    v_mfma_f32_16x16x32_bf16 v[64:67], a[180:183], a[56:59], v[64:67]
    v_mfma_f32_16x16x32_bf16 v[96:99], a[176:179], a[52:55], v[96:99]
    v_mfma_f32_16x16x32_bf16 v[96:99], a[180:183], a[60:63], v[96:99]
    v_mfma_f32_16x16x32_bf16 v[68:71], a[184:187], a[48:51], v[68:71]
    v_mfma_f32_16x16x32_bf16 v[68:71], a[188:191], a[56:59], v[68:71]
    v_mfma_f32_16x16x32_bf16 v[100:103], a[184:187], a[52:55], v[100:103]
    v_mfma_f32_16x16x32_bf16 v[100:103], a[188:191], a[60:63], v[100:103]
    s_waitcnt vmcnt(0)
    s_nop 1
    v_cvt_pk_bf16_f32 v104, v40, v41
    v_cvt_pk_bf16_f32 v105, v42, v43
    v_cvt_pk_bf16_f32 v106, v44, v45
    v_cvt_pk_bf16_f32 v107, v46, v47
    buffer_store_dwordx4 v[104:107], v33, s[44:47], s88 offen offset:0 sc1
    v_cvt_pk_bf16_f32 v108, v48, v49
    v_cvt_pk_bf16_f32 v109, v50, v51
    v_cvt_pk_bf16_f32 v110, v52, v53
    v_cvt_pk_bf16_f32 v111, v54, v55
    buffer_store_dwordx4 v[108:111], v33, s[44:47], s88 offen offset:1024 sc1
    v_cvt_pk_bf16_f32 v112, v56, v57
    v_cvt_pk_bf16_f32 v113, v58, v59
    v_cvt_pk_bf16_f32 v114, v60, v61
    v_cvt_pk_bf16_f32 v115, v62, v63
    buffer_store_dwordx4 v[112:115], v33, s[44:47], s88 offen offset:2048 sc1
    v_cvt_pk_bf16_f32 v116, v64, v65
    v_cvt_pk_bf16_f32 v117, v66, v67
    v_cvt_pk_bf16_f32 v118, v68, v69
    v_cvt_pk_bf16_f32 v119, v70, v71
    buffer_store_dwordx4 v[116:119], v33, s[44:47], s88 offen offset:3072 sc1
    v_cvt_pk_bf16_f32 v104, v72, v73
    v_cvt_pk_bf16_f32 v105, v74, v75
    v_cvt_pk_bf16_f32 v106, v76, v77
    v_cvt_pk_bf16_f32 v107, v78, v79
    buffer_store_dwordx4 v[104:107], v33, s[44:47], s89 offen offset:0 sc1
    v_cvt_pk_bf16_f32 v108, v80, v81
    v_cvt_pk_bf16_f32 v109, v82, v83
    v_cvt_pk_bf16_f32 v110, v84, v85
    v_cvt_pk_bf16_f32 v111, v86, v87
    buffer_store_dwordx4 v[108:111], v33, s[44:47], s89 offen offset:1024 sc1
    v_cvt_pk_bf16_f32 v112, v88, v89
    v_cvt_pk_bf16_f32 v113, v90, v91
    v_cvt_pk_bf16_f32 v114, v92, v93
    v_cvt_pk_bf16_f32 v115, v94, v95
    buffer_store_dwordx4 v[112:115], v33, s[44:47], s89 offen offset:2048 sc1
    v_cvt_pk_bf16_f32 v116, v96, v97
    v_cvt_pk_bf16_f32 v117, v98, v99
    v_cvt_pk_bf16_f32 v118, v100, v101
    v_cvt_pk_bf16_f32 v119, v102, v103
    buffer_store_dwordx4 v[116:119], v33, s[44:47], s89 offen offset:3072 sc1
    v_lshlrev_b32 v24, 5, v0
    s_mov_b32 s3, 69632
    buffer_load_dwordx4 v[200:203], v24, s[44:47], s3 offen offset:0 sc1
    buffer_load_dwordx4 v[204:207], v24, s[44:47], s3 offen offset:16 sc1
    s_add_u32 s3, s3, 12288
    buffer_load_dwordx4 v[208:211], v24, s[44:47], s3 offen offset:0 sc1
    buffer_load_dwordx4 v[212:215], v24, s[44:47], s3 offen offset:16 sc1
    s_add_u32 s3, s3, 12288
    buffer_load_dwordx4 v[216:219], v24, s[44:47], s3 offen offset:0 sc1
    buffer_load_dwordx4 v[220:223], v24, s[44:47], s3 offen offset:16 sc1
    s_add_u32 s3, s3, 12288
    buffer_load_dwordx4 v[224:227], v24, s[44:47], s3 offen offset:0 sc1
    buffer_load_dwordx4 v[228:231], v24, s[44:47], s3 offen offset:16 sc1
    v_add_u32 v24, 155648, v24
    s_cmp_eq_u32 s76, 2
    s_cselect_b32 s3, 1.0, 0
    v_lshlrev_b32 v72, 16, v120
    v_and_b32 v73, 0xffff0000, v120
    v_lshlrev_b32 v74, 16, v121
    v_and_b32 v75, 0xffff0000, v121
    v_lshlrev_b32 v76, 16, v122
    v_and_b32 v77, 0xffff0000, v122
    v_lshlrev_b32 v78, 16, v123
    v_and_b32 v79, 0xffff0000, v123
    v_lshlrev_b32 v80, 16, v124
    v_and_b32 v81, 0xffff0000, v124
    v_lshlrev_b32 v82, 16, v125
    v_and_b32 v83, 0xffff0000, v125
    v_lshlrev_b32 v84, 16, v126
    v_and_b32 v85, 0xffff0000, v126
    v_lshlrev_b32 v86, 16, v127
    v_and_b32 v87, 0xffff0000, v127
    v_lshlrev_b32 v88, 16, v128
    v_and_b32 v89, 0xffff0000, v128
    v_lshlrev_b32 v90, 16, v129
    v_and_b32 v91, 0xffff0000, v129
    v_lshlrev_b32 v92, 16, v130
    v_and_b32 v93, 0xffff0000, v130
    v_lshlrev_b32 v94, 16, v131
    v_and_b32 v95, 0xffff0000, v131
    v_lshlrev_b32 v96, 16, v132
    v_and_b32 v97, 0xffff0000, v132
    v_lshlrev_b32 v98, 16, v133
    v_and_b32 v99, 0xffff0000, v133
    v_lshlrev_b32 v100, 16, v134
    v_and_b32 v101, 0xffff0000, v134
    v_lshlrev_b32 v102, 16, v135
    v_and_b32 v103, 0xffff0000, v135
    v_accvgpr_read_b32 v136, a192
    v_accvgpr_read_b32 v137, a193
    v_accvgpr_read_b32 v138, a194
    v_accvgpr_read_b32 v139, a195
    v_accvgpr_read_b32 v140, a196
    v_accvgpr_read_b32 v141, a197
    v_accvgpr_read_b32 v142, a198
    v_accvgpr_read_b32 v143, a199
    v_accvgpr_read_b32 v144, a200
    v_accvgpr_read_b32 v145, a201
    v_accvgpr_read_b32 v146, a202
    v_accvgpr_read_b32 v147, a203
    v_accvgpr_read_b32 v148, a204
    v_accvgpr_read_b32 v149, a205
    v_accvgpr_read_b32 v150, a206
    v_accvgpr_read_b32 v151, a207
    v_accvgpr_read_b32 v152, a208
    v_accvgpr_read_b32 v153, a209
    v_accvgpr_read_b32 v154, a210
    v_accvgpr_read_b32 v155, a211
    v_accvgpr_read_b32 v156, a212
    v_accvgpr_read_b32 v157, a213
    v_accvgpr_read_b32 v158, a214
    v_accvgpr_read_b32 v159, a215
    v_accvgpr_read_b32 v160, a216
    v_accvgpr_read_b32 v161, a217
    v_accvgpr_read_b32 v162, a218
    v_accvgpr_read_b32 v163, a219
    v_accvgpr_read_b32 v164, a220
    v_accvgpr_read_b32 v165, a221
    v_accvgpr_read_b32 v166, a222
    v_accvgpr_read_b32 v167, a223
    s_waitcnt vmcnt(12)
    s_mov_b64 exec, 3
    buffer_store_dword v6, v5, s[44:47], s13 offen sc1
    s_waitcnt vmcnt(9)
    s_mov_b64 exec, 12
    buffer_store_dword v6, v5, s[44:47], s13 offen sc1
    s_mov_b64 exec, -1
    s_waitcnt vmcnt(2)
    v_add_f32 v200, v200, v208
    v_add_f32 v216, v216, v224
    v_add_f32 v201, v201, v209
    v_add_f32 v217, v217, v225
    v_add_f32 v202, v202, v210
    v_add_f32 v218, v218, v226
    v_add_f32 v203, v203, v211
    v_add_f32 v219, v219, v227
    v_add_f32 v204, v204, v212
    v_add_f32 v220, v220, v228
    v_add_f32 v205, v205, v213
    v_add_f32 v221, v221, v229
    v_add_f32 v206, v206, v214
    v_add_f32 v222, v222, v230
    v_add_f32 v207, v207, v215
    v_add_f32 v223, v223, v231
    v_add_f32 v200, v200, v216
    v_add_f32 v201, v201, v217
    v_add_f32 v202, v202, v218
    v_add_f32 v203, v203, v219
    v_add_f32 v204, v204, v220
    v_add_f32 v205, v205, v221
    v_add_f32 v206, v206, v222
    v_add_f32 v207, v207, v223
    v_cvt_pk_bf16_f32 v200, v200, v201
    v_cvt_pk_bf16_f32 v202, v202, v203
    v_cvt_pk_bf16_f32 v204, v204, v205
    v_cvt_pk_bf16_f32 v206, v206, v207
    v_and_b32 v201, 0xffff0000, v200
    v_lshlrev_b32 v200, 16, v200
    v_and_b32 v203, 0xffff0000, v202
    v_lshlrev_b32 v202, 16, v202
    v_and_b32 v205, 0xffff0000, v204
    v_lshlrev_b32 v204, 16, v204
    v_and_b32 v207, 0xffff0000, v206
    v_lshlrev_b32 v206, 16, v206
    v_add_f32 v200, s3, v200
    v_add_f32 v201, s3, v201
    v_add_f32 v202, s3, v202
    v_add_f32 v203, s3, v203
    v_add_f32 v204, s3, v204
    v_add_f32 v205, s3, v205
    v_add_f32 v206, s3, v206
    v_add_f32 v207, s3, v207
    v_cvt_pk_bf16_f32 v200, v200, v201
    v_cvt_pk_bf16_f32 v202, v202, v203
    v_cvt_pk_bf16_f32 v204, v204, v205
    v_cvt_pk_bf16_f32 v206, v206, v207
    v_and_b32 v201, 0xffff0000, v200
    v_lshlrev_b32 v200, 16, v200
    v_and_b32 v203, 0xffff0000, v202
    v_lshlrev_b32 v202, 16, v202
    v_and_b32 v205, 0xffff0000, v204
    v_lshlrev_b32 v204, 16, v204
    v_and_b32 v207, 0xffff0000, v206
    v_lshlrev_b32 v206, 16, v206
    ds_write_b128 v24, v[200:203]
    ds_write_b128 v24, v[204:207] offset:16
    s_waitcnt lgkmcnt(0)
    s_barrier
    ds_read_b128 v[200:203], v7 offset:0
    ds_read_b128 v[204:207], v7 offset:64
    ds_read_b128 v[208:211], v7 offset:256
    ds_read_b128 v[212:215], v7 offset:320
    ds_read_b128 v[216:219], v7 offset:2048
    ds_read_b128 v[220:223], v7 offset:2112
    ds_read_b128 v[224:227], v7 offset:2304
    ds_read_b128 v[228:231], v7 offset:2368
    ds_read_b128 v[232:235], v7 offset:6144
    ds_read_b128 v[236:239], v7 offset:6208
    ds_read_b128 v[240:243], v7 offset:6400
    ds_read_b128 v[244:247], v7 offset:6464
    s_waitcnt lgkmcnt(8)
    ds_read_b128 v[104:107], v7 offset:4096
    ds_read_b128 v[108:111], v7 offset:4160
    ds_read_b128 v[112:115], v7 offset:4352
    ds_read_b128 v[116:119], v7 offset:4416
    v_and_b32 v7, 7, v1
    v_lshlrev_b32 v5, 7, v7
    v_add_u32 v5, 139264, v5
    v_lshl_add_u32 v6, v2, 5, v5
    s_waitcnt lgkmcnt(0)
    v_mul_f32 v30, v216, v88
    v_fmac_f32 v30, v217, v89
    v_fmac_f32 v30, v218, v90
    v_fmac_f32 v30, v219, v91
    v_fmac_f32 v30, v220, v92
    v_fmac_f32 v30, v221, v93
    v_fmac_f32 v30, v222, v94
    v_fmac_f32 v30, v223, v95
    v_fmac_f32 v30, v224, v96
    v_fmac_f32 v30, v225, v97
    v_fmac_f32 v30, v226, v98
    v_fmac_f32 v30, v227, v99
    v_fmac_f32 v30, v228, v100
    v_fmac_f32 v30, v229, v101
    v_fmac_f32 v30, v230, v102
    v_fmac_f32 v30, v231, v103
    v_mul_f32 v88, v88, v104
    v_mul_f32 v89, v89, v105
    v_mul_f32 v90, v90, v106
    v_mul_f32 v91, v91, v107
    v_mul_f32 v92, v92, v108
    v_mul_f32 v93, v93, v109
    v_mul_f32 v94, v94, v110
    v_mul_f32 v95, v95, v111
    v_mul_f32 v96, v96, v112
    v_mul_f32 v97, v97, v113
    v_mul_f32 v98, v98, v114
    v_mul_f32 v99, v99, v115
    v_mul_f32 v100, v100, v116
    v_mul_f32 v101, v101, v117
    v_mul_f32 v102, v102, v118
    v_mul_f32 v103, v103, v119
    v_add_f32 v29, v88, v89
    v_add_f32 v29, v29, v90
    v_add_f32 v29, v29, v91
    v_add_f32 v29, v29, v92
    v_add_f32 v29, v29, v93
    v_add_f32 v29, v29, v94
    v_add_f32 v29, v29, v95
    v_add_f32 v29, v29, v96
    v_add_f32 v29, v29, v97
    v_add_f32 v29, v29, v98
    v_add_f32 v29, v29, v99
    v_add_f32 v29, v29, v100
    v_add_f32 v29, v29, v101
    v_add_f32 v29, v29, v102
    v_add_f32 v29, v29, v103
    s_nop 1
    v_add_f32_dpp v29, v29, v29 row_ror:8 row_mask:0xf bank_mask:0xf
    v_add_f32_dpp v30, v30, v30 row_ror:8 row_mask:0xf bank_mask:0xf
    s_nop 1
    v_mov_b32 v24, v29
    v_mov_b32 v25, v30
    s_nop 0
    v_permlane16_swap_b32 v24, v29
    v_permlane16_swap_b32 v25, v30
    v_add_f32 v29, v29, v24
    v_add_f32 v30, v30, v25
    s_nop 0
    v_mov_b32 v24, v29
    v_mov_b32 v25, v30
    s_nop 0
    v_permlane32_swap_b32 v24, v29
    v_permlane32_swap_b32 v25, v30
    v_add_f32 v29, v29, v24
    v_add_f32 v30, v30, v25
    s_nop 0
    s_cmp_lg_u32 s76, 0
    s_cbranch_scc1 F1_w
    s_mov_b32 s91, 262144
F1W_loop:
    buffer_load_dword v252, v35, s[44:47], s90 offen sc1
    s_waitcnt vmcnt(0)
    v_cmp_ne_u32 vcc, s79, v252
    s_cbranch_vccz F1W_out
    s_sleep 2
    s_sub_u32 s91, s91, 1
    s_cbranch_scc0 F1W_loop
F1W_out:
F1_w:
    s_barrier
    buffer_load_dwordx4 v[40:43], v196, s[44:47], s16 offen offset:0 sc1
    buffer_load_dwordx4 v[44:47], v196, s[44:47], s16 offen offset:2048 sc1
    buffer_load_dwordx4 v[48:51], v196, s[44:47], s17 offen offset:0 sc1
    buffer_load_dwordx4 v[52:55], v196, s[44:47], s17 offen offset:2048 sc1
    buffer_load_dwordx4 v[56:59], v196, s[44:47], s18 offen offset:0 sc1
    buffer_load_dwordx4 v[60:63], v196, s[44:47], s18 offen offset:2048 sc1
    buffer_load_dwordx4 v[64:67], v196, s[44:47], s19 offen offset:0 sc1
    buffer_load_dwordx4 v[68:71], v196, s[44:47], s19 offen offset:2048 sc1
    s_waitcnt vmcnt(6)
    v_lshlrev_b32 v8, 16, v40
    v_and_b32 v9, 0xffff0000, v40
    v_lshlrev_b32 v10, 16, v41
    v_and_b32 v11, 0xffff0000, v41
    v_lshlrev_b32 v12, 16, v42
    v_and_b32 v13, 0xffff0000, v42
    v_lshlrev_b32 v14, 16, v43
    v_and_b32 v15, 0xffff0000, v43
    v_lshlrev_b32 v16, 16, v44
    v_and_b32 v17, 0xffff0000, v44
    v_lshlrev_b32 v18, 16, v45
    v_and_b32 v19, 0xffff0000, v45
    v_lshlrev_b32 v20, 16, v46
    v_and_b32 v21, 0xffff0000, v46
    v_lshlrev_b32 v22, 16, v47
    v_and_b32 v23, 0xffff0000, v47
    s_waitcnt vmcnt(4)
    v_lshlrev_b32 v24, 16, v48
    v_and_b32 v48, 0xffff0000, v48
    v_add_f32 v8, v8, v24
    v_add_f32 v9, v9, v48
    v_lshlrev_b32 v24, 16, v49
    v_and_b32 v49, 0xffff0000, v49
    v_add_f32 v10, v10, v24
    v_add_f32 v11, v11, v49
    v_lshlrev_b32 v24, 16, v50
    v_and_b32 v50, 0xffff0000, v50
    v_add_f32 v12, v12, v24
    v_add_f32 v13, v13, v50
    v_lshlrev_b32 v24, 16, v51
    v_and_b32 v51, 0xffff0000, v51
    v_add_f32 v14, v14, v24
    v_add_f32 v15, v15, v51
    v_lshlrev_b32 v24, 16, v52
    v_and_b32 v52, 0xffff0000, v52
    v_add_f32 v16, v16, v24
    v_add_f32 v17, v17, v52
    v_lshlrev_b32 v24, 16, v53
    v_and_b32 v53, 0xffff0000, v53
    v_add_f32 v18, v18, v24
    v_add_f32 v19, v19, v53
    v_lshlrev_b32 v24, 16, v54
    v_and_b32 v54, 0xffff0000, v54
    v_add_f32 v20, v20, v24
    v_add_f32 v21, v21, v54
    v_lshlrev_b32 v24, 16, v55
    v_and_b32 v55, 0xffff0000, v55
    v_add_f32 v22, v22, v24
    v_add_f32 v23, v23, v55
    s_waitcnt vmcnt(2)
    v_lshlrev_b32 v24, 16, v56
    v_and_b32 v56, 0xffff0000, v56
    v_add_f32 v8, v8, v24
    v_add_f32 v9, v9, v56
    v_lshlrev_b32 v24, 16, v57
    v_and_b32 v57, 0xffff0000, v57
    v_add_f32 v10, v10, v24
    v_add_f32 v11, v11, v57
    v_lshlrev_b32 v24, 16, v58
    v_and_b32 v58, 0xffff0000, v58
    v_add_f32 v12, v12, v24
    v_add_f32 v13, v13, v58
    v_lshlrev_b32 v24, 16, v59
    v_and_b32 v59, 0xffff0000, v59
    v_add_f32 v14, v14, v24
    v_add_f32 v15, v15, v59
    v_lshlrev_b32 v24, 16, v60
    v_and_b32 v60, 0xffff0000, v60
    v_add_f32 v16, v16, v24
    v_add_f32 v17, v17, v60
    v_lshlrev_b32 v24, 16, v61
    v_and_b32 v61, 0xffff0000, v61
    v_add_f32 v18, v18, v24
    v_add_f32 v19, v19, v61
    v_lshlrev_b32 v24, 16, v62
    v_and_b32 v62, 0xffff0000, v62
    v_add_f32 v20, v20, v24
    v_add_f32 v21, v21, v62
    v_lshlrev_b32 v24, 16, v63
    v_and_b32 v63, 0xffff0000, v63
    v_add_f32 v22, v22, v24
    v_add_f32 v23, v23, v63
    s_waitcnt vmcnt(0)
    v_lshlrev_b32 v24, 16, v64
    v_and_b32 v64, 0xffff0000, v64
    v_add_f32 v8, v8, v24
    v_add_f32 v9, v9, v64
    v_lshlrev_b32 v24, 16, v65
    v_and_b32 v65, 0xffff0000, v65
    v_add_f32 v10, v10, v24
    v_add_f32 v11, v11, v65
    v_lshlrev_b32 v24, 16, v66
    v_and_b32 v66, 0xffff0000, v66
    v_add_f32 v12, v12, v24
    v_add_f32 v13, v13, v66
    v_lshlrev_b32 v24, 16, v67
    v_and_b32 v67, 0xffff0000, v67
    v_add_f32 v14, v14, v24
    v_add_f32 v15, v15, v67
    v_lshlrev_b32 v24, 16, v68
    v_and_b32 v68, 0xffff0000, v68
    v_add_f32 v16, v16, v24
    v_add_f32 v17, v17, v68
    v_lshlrev_b32 v24, 16, v69
    v_and_b32 v69, 0xffff0000, v69
    v_add_f32 v18, v18, v24
    v_add_f32 v19, v19, v69
    v_lshlrev_b32 v24, 16, v70
    v_and_b32 v70, 0xffff0000, v70
    v_add_f32 v20, v20, v24
    v_add_f32 v21, v21, v70
    v_lshlrev_b32 v24, 16, v71
    v_and_b32 v71, 0xffff0000, v71
    v_add_f32 v22, v22, v24
    v_add_f32 v23, v23, v71
    s_waitcnt lgkmcnt(0)
    v_fma_f32 v40, v8, v200, v72
    v_fma_f32 v41, v9, v201, v73
    v_fma_f32 v42, v10, v202, v74
    v_fma_f32 v43, v11, v203, v75
    v_fma_f32 v44, v12, v204, v76
    v_fma_f32 v45, v13, v205, v77
    v_fma_f32 v46, v14, v206, v78
    v_fma_f32 v47, v15, v207, v79
    v_fma_f32 v48, v16, v208, v80
    v_fma_f32 v49, v17, v209, v81
    v_fma_f32 v50, v18, v210, v82
    v_fma_f32 v51, v19, v211, v83
    v_fma_f32 v52, v20, v212, v84
    v_fma_f32 v53, v21, v213, v85
    v_fma_f32 v54, v22, v214, v86
    v_fma_f32 v55, v23, v215, v87
    v_cvt_pk_bf16_f32 v120, v40, v41
    v_cvt_pk_bf16_f32 v121, v42, v43
    v_cvt_pk_bf16_f32 v122, v44, v45
    v_cvt_pk_bf16_f32 v123, v46, v47
    v_cvt_pk_bf16_f32 v124, v48, v49
    v_cvt_pk_bf16_f32 v125, v50, v51
    v_cvt_pk_bf16_f32 v126, v52, v53
    v_cvt_pk_bf16_f32 v127, v54, v55
    v_lshlrev_b32 v40, 16, v120
    v_and_b32 v41, 0xffff0000, v120
    v_lshlrev_b32 v42, 16, v121
    v_and_b32 v43, 0xffff0000, v121
    v_lshlrev_b32 v44, 16, v122
    v_and_b32 v45, 0xffff0000, v122
    v_lshlrev_b32 v46, 16, v123
    v_and_b32 v47, 0xffff0000, v123
    v_lshlrev_b32 v48, 16, v124
    v_and_b32 v49, 0xffff0000, v124
    v_lshlrev_b32 v50, 16, v125
    v_and_b32 v51, 0xffff0000, v125
    v_lshlrev_b32 v52, 16, v126
    v_and_b32 v53, 0xffff0000, v126
    v_lshlrev_b32 v54, 16, v127
    v_and_b32 v55, 0xffff0000, v127
    v_add_f32 v26, v40, v41
    v_mul_f32 v27, v40, v40
    v_mul_f32 v28, v40, v88
    v_fmac_f32 v27, v41, v41
    v_fmac_f32 v28, v41, v89
    v_add_f32 v26, v26, v42
    v_fmac_f32 v27, v42, v42
    v_fmac_f32 v28, v42, v90
    v_add_f32 v26, v26, v43
    v_fmac_f32 v27, v43, v43
    v_fmac_f32 v28, v43, v91
    v_add_f32 v26, v26, v44
    v_fmac_f32 v27, v44, v44
    v_fmac_f32 v28, v44, v92
    v_add_f32 v26, v26, v45
    v_fmac_f32 v27, v45, v45
    v_fmac_f32 v28, v45, v93
    v_add_f32 v26, v26, v46
    v_fmac_f32 v27, v46, v46
    v_fmac_f32 v28, v46, v94
    v_add_f32 v26, v26, v47
    v_fmac_f32 v27, v47, v47
    v_fmac_f32 v28, v47, v95
    v_add_f32 v26, v26, v48
    v_fmac_f32 v27, v48, v48
    v_fmac_f32 v28, v48, v96
    v_add_f32 v26, v26, v49
    v_fmac_f32 v27, v49, v49
    v_fmac_f32 v28, v49, v97
    v_add_f32 v26, v26, v50
    v_fmac_f32 v27, v50, v50
    v_fmac_f32 v28, v50, v98
    v_add_f32 v26, v26, v51
    v_fmac_f32 v27, v51, v51
    v_fmac_f32 v28, v51, v99
    v_add_f32 v26, v26, v52
    v_fmac_f32 v27, v52, v52
    v_fmac_f32 v28, v52, v100
    v_add_f32 v26, v26, v53
    v_fmac_f32 v27, v53, v53
    v_fmac_f32 v28, v53, v101
    v_add_f32 v26, v26, v54
    v_fmac_f32 v27, v54, v54
    v_fmac_f32 v28, v54, v102
    v_add_f32 v26, v26, v55
    v_fmac_f32 v27, v55, v55
    v_fmac_f32 v28, v55, v103
    s_nop 1
    v_add_f32_dpp v26, v26, v26 row_ror:8 row_mask:0xf bank_mask:0xf
    v_add_f32_dpp v27, v27, v27 row_ror:8 row_mask:0xf bank_mask:0xf
    v_add_f32_dpp v28, v28, v28 row_ror:8 row_mask:0xf bank_mask:0xf
    s_nop 1
    v_mov_b32 v8, v26
    v_mov_b32 v9, v27
    v_mov_b32 v10, v28
    v_permlane16_swap_b32 v8, v26
    v_permlane16_swap_b32 v9, v27
    v_permlane16_swap_b32 v10, v28
    v_add_f32 v26, v26, v8
    v_add_f32 v27, v27, v9
    v_add_f32 v28, v28, v10
    v_mov_b32 v8, v26
    v_mov_b32 v9, v27
    v_mov_b32 v10, v28
    v_permlane32_swap_b32 v8, v26
    v_permlane32_swap_b32 v9, v27
    v_permlane32_swap_b32 v10, v28
    v_add_f32 v26, v26, v8
    v_add_f32 v27, v27, v9
    v_add_f32 v28, v28, v10
    ds_write_b128 v6, v[26:29]
    ds_write_b32 v6, v30 offset:16
    s_lshl_b32 s88, s8, 3
    s_sub_u32 s88, 2047, s88
    v_sub_u32 v31, s88, v7
    s_lshl_b32 s88, s8, 12
    s_add_u32 s88, s88, 3145728
    s_lshl_b32 s89, s8, 3
    s_add_u32 s89, s89, 32768
    s_waitcnt lgkmcnt(0)
    s_barrier
    ds_read_b128 v[56:59], v5 offset:0
    ds_read_b32 v8, v5 offset:16
    ds_read_b128 v[60:63], v5 offset:32
    ds_read_b32 v9, v5 offset:48
    ds_read_b128 v[64:67], v5 offset:64
    ds_read_b32 v10, v5 offset:80
    ds_read_b128 v[68:71], v5 offset:96
    ds_read_b32 v11, v5 offset:112
    v_lshlrev_b32 v5, 11, v1
    s_waitcnt lgkmcnt(0)
    v_add_f32 v56, v56, v60
    v_add_f32 v64, v64, v68
    v_add_f32 v57, v57, v61
    v_add_f32 v65, v65, v69
    v_add_f32 v58, v58, v62
    v_add_f32 v66, v66, v70
    v_add_f32 v59, v59, v63
    v_add_f32 v67, v67, v71
    v_add_f32 v8, v8, v9
    v_add_f32 v10, v10, v11
    v_add_f32 v26, v56, v64
    v_add_f32 v27, v57, v65
    v_add_f32 v28, v58, v66
    v_add_f32 v29, v59, v67
    v_add_f32 v30, v8, v10
    v_mul_f32 v26, 0x3b000000, v26
    v_mul_f32 v27, 0x3b000000, v27
    v_fma_f32 v27, -v26, v26, v27
    v_max_f32 v27, 0, v27
    v_cvt_pk_bf16_f32 v26, v26, v26
    v_and_b32 v26, 0xffff0000, v26
    v_cvt_pk_bf16_f32 v27, v27, v27
    v_and_b32 v27, 0xffff0000, v27
    v_add_f32 v27, 0x3727c5ac, v27
    v_cvt_pk_bf16_f32 v27, v27, v27
    v_and_b32 v27, 0xffff0000, v27
    v_sqrt_f32 v27, v27
    v_fma_f32 v28, -v26, v29, v28
    v_cvt_pk_bf16_f32 v27, v27, v27
    v_and_b32 v27, 0xffff0000, v27
    v_rcp_f32 v27, v27
    v_mov_b32 v11, s79
    v_fma_f32 v8, v28, v27, v30
    v_mul_f32_e64 v26, -v26, v27
    v_cvt_pk_bf16_f32 v8, v8, v8
    v_and_b32 v8, 0xffff0000, v8
    v_ashrrev_i32 v9, 31, v8
    v_or_b32 v9, 0x80000000, v9
    v_xor_b32 v8, v8, v9
    v_and_b32 v8, 0xffff0000, v8
    v_or_b32 v8, v8, v31
    v_mov_b32 v10, v8
    s_nop 1
    v_max_u32_dpp v10, v10, v10 quad_perm:[1,0,3,2] row_mask:0xf bank_mask:0xf
    s_nop 1
    v_max_u32_dpp v10, v10, v10 quad_perm:[2,3,0,1] row_mask:0xf bank_mask:0xf
    s_nop 1
    v_max_u32_dpp v10, v10, v10 row_half_mirror row_mask:0xf bank_mask:0xf
    s_nop 1
    s_cmp_lg_u32 s76, 0
    s_cbranch_scc1 F2_sig
    s_mov_b64 exec, 0xffff
    buffer_store_dwordx2 v[10:11], v5, s[44:47], s89 offen sc1
    s_mov_b64 exec, -1
F2_sig:
    v_cmp_eq_u32 s[26:27], v8, v10
    v_fma_f32 v56, v40, v27, v26
    v_fma_f32 v57, v41, v27, v26
    v_fma_f32 v58, v42, v27, v26
    v_fma_f32 v59, v43, v27, v26
    v_fma_f32 v60, v44, v27, v26
    v_fma_f32 v61, v45, v27, v26
    v_fma_f32 v62, v46, v27, v26
    v_fma_f32 v63, v47, v27, v26
    v_fma_f32 v64, v48, v27, v26
    v_fma_f32 v65, v49, v27, v26
    v_fma_f32 v66, v50, v27, v26
    v_fma_f32 v67, v51, v27, v26
    v_fma_f32 v68, v52, v27, v26
    v_fma_f32 v69, v53, v27, v26
    v_fma_f32 v70, v54, v27, v26
    v_fma_f32 v71, v55, v27, v26
    v_fma_f32 v56, v56, v104, v216
    v_fma_f32 v57, v57, v105, v217
    v_fma_f32 v58, v58, v106, v218
    v_fma_f32 v59, v59, v107, v219
    v_fma_f32 v60, v60, v108, v220
    v_fma_f32 v61, v61, v109, v221
    v_fma_f32 v62, v62, v110, v222
    v_fma_f32 v63, v63, v111, v223
    v_fma_f32 v64, v64, v112, v224
    v_fma_f32 v65, v65, v113, v225
    v_fma_f32 v66, v66, v114, v226
    v_fma_f32 v67, v67, v115, v227
    v_fma_f32 v68, v68, v116, v228
    v_fma_f32 v69, v69, v117, v229
    v_fma_f32 v70, v70, v118, v230
    v_fma_f32 v71, v71, v119, v231
    v_cvt_pk_bf16_f32 v72, v56, v57
    v_mov_b32 v73, s79
    v_cvt_pk_bf16_f32 v74, v58, v59
    v_mov_b32 v75, s79
    v_cvt_pk_bf16_f32 v76, v60, v61
    v_mov_b32 v77, s79
    v_cvt_pk_bf16_f32 v78, v62, v63
    v_mov_b32 v79, s79
    v_cvt_pk_bf16_f32 v80, v64, v65
    v_mov_b32 v81, s79
    v_cvt_pk_bf16_f32 v82, v66, v67
    v_mov_b32 v83, s79
    v_cvt_pk_bf16_f32 v84, v68, v69
    v_mov_b32 v85, s79
    v_cvt_pk_bf16_f32 v86, v70, v71
    v_mov_b32 v87, s79
    s_mov_b64 exec, s[26:27]
    buffer_store_dwordx4 v[72:75], v198, s[44:47], s88 offen offset:0 sc1
    buffer_store_dwordx4 v[76:79], v198, s[44:47], s88 offen offset:64 sc1
    buffer_store_dwordx4 v[80:83], v198, s[44:47], s88 offen offset:256 sc1
    buffer_store_dwordx4 v[84:87], v198, s[44:47], s88 offen offset:320 sc1
    s_mov_b64 exec, -1
    v_lshlrev_b32 v56, 16, v72
    v_and_b32 v57, 0xffff0000, v72
    v_lshlrev_b32 v58, 16, v74
    v_and_b32 v59, 0xffff0000, v74
    v_lshlrev_b32 v60, 16, v76
    v_and_b32 v61, 0xffff0000, v76
    v_lshlrev_b32 v62, 16, v78
    v_and_b32 v63, 0xffff0000, v78
    v_lshlrev_b32 v64, 16, v80
    v_and_b32 v65, 0xffff0000, v80
    v_lshlrev_b32 v66, 16, v82
    v_and_b32 v67, 0xffff0000, v82
    v_lshlrev_b32 v68, 16, v84
    v_and_b32 v69, 0xffff0000, v84
    v_lshlrev_b32 v70, 16, v86
    v_and_b32 v71, 0xffff0000, v86
    v_fma_f32 v56, v56, v232, v40
    v_fma_f32 v57, v57, v233, v41
    v_fma_f32 v58, v58, v234, v42
    v_fma_f32 v59, v59, v235, v43
    v_fma_f32 v60, v60, v236, v44
    v_fma_f32 v61, v61, v237, v45
    v_fma_f32 v62, v62, v238, v46
    v_fma_f32 v63, v63, v239, v47
    v_fma_f32 v64, v64, v240, v48
    v_fma_f32 v65, v65, v241, v49
    v_fma_f32 v66, v66, v242, v50
    v_fma_f32 v67, v67, v243, v51
    v_fma_f32 v68, v68, v244, v52
    v_fma_f32 v69, v69, v245, v53
    v_fma_f32 v70, v70, v246, v54
    v_fma_f32 v71, v71, v247, v55
    v_cvt_pk_bf16_f32 v200, v56, v57
    v_cvt_pk_bf16_f32 v201, v58, v59
    v_cvt_pk_bf16_f32 v202, v60, v61
    v_cvt_pk_bf16_f32 v203, v62, v63
    v_cvt_pk_bf16_f32 v204, v64, v65
    v_cvt_pk_bf16_f32 v205, v66, v67
    v_cvt_pk_bf16_f32 v206, v68, v69
    v_cvt_pk_bf16_f32 v207, v70, v71
    v_lshrrev_b32 v30, 1, v198
    s_mov_b32 s12, s88
    s_lshl_b32 s3, s8, 2
    s_add_u32 s3, s3, 24576
    v_mov_b32 v6, 0
    v_mov_b32 v29, 139264
    v_mov_b32 v28, s79
    s_cmp_lt_u32 s2, 112
    s_cbranch_scc1 FT_go
    s_mov_b64 exec, s[26:27]
    buffer_store_dwordx2 v[120:121], v30, s[44:47], s12 offen offset:2048 sc1
    buffer_store_dwordx2 v[122:123], v30, s[44:47], s12 offen offset:2080 sc1
    buffer_store_dwordx2 v[124:125], v30, s[44:47], s12 offen offset:2176 sc1
    buffer_store_dwordx2 v[126:127], v30, s[44:47], s12 offen offset:2208 sc1
    buffer_store_dwordx2 v[200:201], v197, s[60:63], s9 offen offset:0 sc1
    buffer_store_dwordx2 v[202:203], v197, s[60:63], s9 offen offset:32 sc1
    buffer_store_dwordx2 v[204:205], v197, s[60:63], s9 offen offset:128 sc1
    buffer_store_dwordx2 v[206:207], v197, s[60:63], s9 offen offset:160 sc1
    s_not_b64 exec, s[26:27]
    buffer_store_dwordx2 v[200:201], v197, s[60:63], s9 offen offset:0
    buffer_store_dwordx2 v[202:203], v197, s[60:63], s9 offen offset:32
    buffer_store_dwordx2 v[204:205], v197, s[60:63], s9 offen offset:128
    buffer_store_dwordx2 v[206:207], v197, s[60:63], s9 offen offset:160
    s_mov_b64 exec, -1
    s_cmp_ge_u32 s2, 224
    s_cbranch_scc1 FT_go
    s_waitcnt vmcnt(0)
    s_barrier
    s_cmp_lg_u32 s76, 0
    s_cbranch_scc1 FD0
    s_mov_b64 exec, 1
    buffer_store_dword v28, v6, s[44:47], s3 offen sc1
    s_mov_b64 exec, -1
FD0:
    s_endpgm
FT_go:
    s_and_b32 s90, s2, 15
    s_lshl_b32 s90, s90, 11
    s_add_u32 s90, s90, 32768
    s_cmp_lg_u32 s76, 0
    s_cbranch_scc1 F2_u
    buffer_load_dwordx4 v[16:19], v33, s[44:47], s90 offen sc1
    buffer_load_dwordx4 v[20:23], v33, s[44:47], s90 offen offset:1024 sc1
F2_u:
    v_lshlrev_b32 v40, 16, v136
    v_and_b32 v41, 0xffff0000, v136
    v_lshlrev_b32 v42, 16, v137
    v_and_b32 v43, 0xffff0000, v137
    v_lshlrev_b32 v44, 16, v138
    v_and_b32 v45, 0xffff0000, v138
    v_lshlrev_b32 v46, 16, v139
    v_and_b32 v47, 0xffff0000, v139
    v_lshlrev_b32 v48, 16, v140
    v_and_b32 v49, 0xffff0000, v140
    v_lshlrev_b32 v50, 16, v141
    v_and_b32 v51, 0xffff0000, v141
    v_lshlrev_b32 v52, 16, v142
    v_and_b32 v53, 0xffff0000, v142
    v_lshlrev_b32 v54, 16, v143
    v_and_b32 v55, 0xffff0000, v143
    v_lshlrev_b32 v56, 16, v144
    v_and_b32 v57, 0xffff0000, v144
    v_lshlrev_b32 v58, 16, v145
    v_and_b32 v59, 0xffff0000, v145
    v_lshlrev_b32 v60, 16, v146
    v_and_b32 v61, 0xffff0000, v146
    v_lshlrev_b32 v62, 16, v147
    v_and_b32 v63, 0xffff0000, v147
    v_lshlrev_b32 v64, 16, v148
    v_and_b32 v65, 0xffff0000, v148
    v_lshlrev_b32 v66, 16, v149
    v_and_b32 v67, 0xffff0000, v149
    v_lshlrev_b32 v68, 16, v150
    v_and_b32 v69, 0xffff0000, v150
    v_lshlrev_b32 v70, 16, v151
    v_and_b32 v71, 0xffff0000, v151
    v_lshlrev_b32 v72, 16, v152
    v_and_b32 v73, 0xffff0000, v152
    v_lshlrev_b32 v74, 16, v153
    v_and_b32 v75, 0xffff0000, v153
    v_lshlrev_b32 v76, 16, v154
    v_and_b32 v77, 0xffff0000, v154
    v_lshlrev_b32 v78, 16, v155
    v_and_b32 v79, 0xffff0000, v155
    v_lshlrev_b32 v80, 16, v156
    v_and_b32 v81, 0xffff0000, v156
    v_lshlrev_b32 v82, 16, v157
    v_and_b32 v83, 0xffff0000, v157
    v_lshlrev_b32 v84, 16, v158
    v_and_b32 v85, 0xffff0000, v158
    v_lshlrev_b32 v86, 16, v159
    v_and_b32 v87, 0xffff0000, v159
    v_lshlrev_b32 v88, 16, v160
    v_and_b32 v89, 0xffff0000, v160
    v_lshlrev_b32 v90, 16, v161
    v_and_b32 v91, 0xffff0000, v161
    v_lshlrev_b32 v92, 16, v162
    v_and_b32 v93, 0xffff0000, v162
    v_lshlrev_b32 v94, 16, v163
    v_and_b32 v95, 0xffff0000, v163
    v_lshlrev_b32 v96, 16, v164
    v_and_b32 v97, 0xffff0000, v164
    v_lshlrev_b32 v98, 16, v165
    v_and_b32 v99, 0xffff0000, v165
    v_lshlrev_b32 v100, 16, v166
    v_and_b32 v101, 0xffff0000, v166
    v_lshlrev_b32 v102, 16, v167
    v_and_b32 v103, 0xffff0000, v167
    v_lshlrev_b32 v104, 16, v168
    v_and_b32 v105, 0xffff0000, v168
    v_lshlrev_b32 v106, 16, v169
    v_and_b32 v107, 0xffff0000, v169
    v_lshlrev_b32 v108, 16, v170
    v_and_b32 v109, 0xffff0000, v170
    v_lshlrev_b32 v110, 16, v171
    v_and_b32 v111, 0xffff0000, v171
    v_lshlrev_b32 v112, 16, v172
    v_and_b32 v113, 0xffff0000, v172
    v_lshlrev_b32 v114, 16, v173
    v_and_b32 v115, 0xffff0000, v173
    v_lshlrev_b32 v116, 16, v174
    v_and_b32 v117, 0xffff0000, v174
    v_lshlrev_b32 v118, 16, v175
    v_and_b32 v119, 0xffff0000, v175
    v_lshlrev_b32 v208, 16, v176
    v_and_b32 v209, 0xffff0000, v176
    v_lshlrev_b32 v210, 16, v177
    v_and_b32 v211, 0xffff0000, v177
    v_lshlrev_b32 v212, 16, v178
    v_and_b32 v213, 0xffff0000, v178
    v_lshlrev_b32 v214, 16, v179
    v_and_b32 v215, 0xffff0000, v179
    v_lshlrev_b32 v216, 16, v180
    v_and_b32 v217, 0xffff0000, v180
    v_lshlrev_b32 v218, 16, v181
    v_and_b32 v219, 0xffff0000, v181
    v_lshlrev_b32 v220, 16, v182
    v_and_b32 v221, 0xffff0000, v182
    v_lshlrev_b32 v222, 16, v183
    v_and_b32 v223, 0xffff0000, v183
    s_cmp_lg_u32 s76, 0
    s_cbranch_scc1 F2_b
    s_mov_b32 s91, 262144
    s_branch F2W_chk
F2W_loop:
    buffer_load_dwordx4 v[16:19], v33, s[44:47], s90 offen sc1
    buffer_load_dwordx4 v[20:23], v33, s[44:47], s90 offen offset:1024 sc1
F2W_chk:
    s_waitcnt vmcnt(0)
    v_min_u32 v14, v17, v19
    v_min3_u32 v14, v14, v21, v23
    v_max_u32 v15, v17, v19
    v_max3_u32 v15, v15, v21, v23
    v_cmp_ne_u32 vcc, s79, v14
    s_mov_b64 s[88:89], vcc
    v_cmp_ne_u32 vcc, s79, v15
    s_or_b64 vcc, vcc, s[88:89]
    s_sub_u32 s91, s91, 1
    s_cbranch_scc1 F2W_out
    s_cbranch_vccz F2W_out
    s_sleep 4
    s_branch F2W_loop
F2W_out:
    v_max_u32 v16, v16, v18
    v_max3_u32 v16, v16, v20, v22
    s_nop 1
    v_max_u32_dpp v16, v16, v16 quad_perm:[1,0,3,2] row_mask:0xf bank_mask:0xf
    s_nop 1
    v_max_u32_dpp v16, v16, v16 quad_perm:[2,3,0,1] row_mask:0xf bank_mask:0xf
    s_nop 1
    v_max_u32_dpp v16, v16, v16 row_half_mirror row_mask:0xf bank_mask:0xf
    s_nop 1
    v_max_u32_dpp v16, v16, v16 row_mirror row_mask:0xf bank_mask:0xf
    s_nop 1
    v_mov_b32 v17, v16
    s_nop 1
    s_nop 0
    v_permlane16_swap_b32 v17, v16
    s_nop 0
    v_max_u32 v16, v16, v17
    s_nop 1
    v_mov_b32 v17, v16
    s_nop 1
    s_nop 0
    v_permlane32_swap_b32 v17, v16
    s_nop 0
    v_max_u32 v16, v16, v17
    s_nop 1
    ds_write_b32 v29, v16 offset:1024
F2_b:
    s_waitcnt vmcnt(0) lgkmcnt(0)
    s_barrier
    ds_read_b32 v4, v29 offset:1024
    v_lshrrev_b32 v5, 1, v0
    v_lshlrev_b32 v5, 4, v5
    s_waitcnt lgkmcnt(0)
    v_readfirstlane_b32 s15, v4
    s_and_b32 s24, s15, 0x7ff
    s_sub_u32 s24, 2047, s24
    s_lshr_b32 s25, s24, 3
    s_lshl_b32 s25, s25, 12
    s_add_u32 s25, s25, 3145728
    s_cmp_ge_u32 s2, 112
    s_cbranch_scc1 FT_FIN
    buffer_load_dwordx4 v[16:19], v5, s[44:47], s25 offen sc1
    s_mov_b64 exec, s[26:27]
    buffer_store_dwordx2 v[120:121], v30, s[44:47], s12 offen offset:2048 sc1
    buffer_store_dwordx2 v[122:123], v30, s[44:47], s12 offen offset:2080 sc1
    buffer_store_dwordx2 v[124:125], v30, s[44:47], s12 offen offset:2176 sc1
    buffer_store_dwordx2 v[126:127], v30, s[44:47], s12 offen offset:2208 sc1
    buffer_store_dwordx2 v[200:201], v197, s[60:63], s9 offen offset:0 sc1
    buffer_store_dwordx2 v[202:203], v197, s[60:63], s9 offen offset:32 sc1
    buffer_store_dwordx2 v[204:205], v197, s[60:63], s9 offen offset:128 sc1
    buffer_store_dwordx2 v[206:207], v197, s[60:63], s9 offen offset:160 sc1
    s_not_b64 exec, s[26:27]
    buffer_store_dwordx2 v[200:201], v197, s[60:63], s9 offen offset:0
    buffer_store_dwordx2 v[202:203], v197, s[60:63], s9 offen offset:32
    buffer_store_dwordx2 v[204:205], v197, s[60:63], s9 offen offset:128
    buffer_store_dwordx2 v[206:207], v197, s[60:63], s9 offen offset:160
    s_mov_b64 exec, -1
    s_waitcnt vmcnt(12)
    v_cmp_ne_u32 vcc, s79, v17
    s_mov_b64 s[88:89], vcc
    v_cmp_ne_u32 vcc, s79, v19
    s_or_b64 vcc, vcc, s[88:89]
    s_cbranch_vccz FRW_ok
    s_mov_b32 s91, 262144
FRW_loop:
    buffer_load_dwordx4 v[16:19], v5, s[44:47], s25 offen sc1
    s_waitcnt vmcnt(0)
    v_cmp_ne_u32 vcc, s79, v17
    s_mov_b64 s[88:89], vcc
    v_cmp_ne_u32 vcc, s79, v19
    s_or_b64 vcc, vcc, s[88:89]
    s_sub_u32 s91, s91, 1
    s_cbranch_scc1 FRW_out
    s_cbranch_vccz FRW_out
    s_sleep 1
    s_branch FRW_loop
FRW_out:
FRW_ok:
    v_lshlrev_b32 v8, 16, v16
    v_and_b32 v9, 0xffff0000, v16
    v_lshlrev_b32 v10, 16, v18
    v_and_b32 v11, 0xffff0000, v18
    v_mul_f32 v136, v8, v40
    v_mul_f32 v137, v8, v41
    v_mul_f32 v138, v8, v42
    v_mul_f32 v139, v8, v43
    v_mul_f32 v140, v8, v44
    v_mul_f32 v141, v8, v45
    v_mul_f32 v142, v8, v46
    v_mul_f32 v143, v8, v47
    v_mul_f32 v144, v8, v72
    v_mul_f32 v145, v8, v73
    v_mul_f32 v146, v8, v74
    v_mul_f32 v147, v8, v75
    v_mul_f32 v148, v8, v76
    v_mul_f32 v149, v8, v77
    v_mul_f32 v150, v8, v78
    v_mul_f32 v151, v8, v79
    v_fmac_f32 v136, v9, v48
    v_fmac_f32 v137, v9, v49
    v_fmac_f32 v138, v9, v50
    v_fmac_f32 v139, v9, v51
    v_fmac_f32 v140, v9, v52
    v_fmac_f32 v141, v9, v53
    v_fmac_f32 v142, v9, v54
    v_fmac_f32 v143, v9, v55
    v_fmac_f32 v144, v9, v80
    v_fmac_f32 v145, v9, v81
    v_fmac_f32 v146, v9, v82
    v_fmac_f32 v147, v9, v83
    v_fmac_f32 v148, v9, v84
    v_fmac_f32 v149, v9, v85
    v_fmac_f32 v150, v9, v86
    v_fmac_f32 v151, v9, v87
    v_fmac_f32 v136, v10, v56
    v_fmac_f32 v137, v10, v57
    v_fmac_f32 v138, v10, v58
    v_fmac_f32 v139, v10, v59
    v_fmac_f32 v140, v10, v60
    v_fmac_f32 v141, v10, v61
    v_fmac_f32 v142, v10, v62
    v_fmac_f32 v143, v10, v63
    v_fmac_f32 v144, v10, v88
    v_fmac_f32 v145, v10, v89
    v_fmac_f32 v146, v10, v90
    v_fmac_f32 v147, v10, v91
    v_fmac_f32 v148, v10, v92
    v_fmac_f32 v149, v10, v93
    v_fmac_f32 v150, v10, v94
    v_fmac_f32 v151, v10, v95
    v_fmac_f32 v136, v11, v64
    v_fmac_f32 v137, v11, v65
    v_fmac_f32 v138, v11, v66
    v_fmac_f32 v139, v11, v67
    v_fmac_f32 v140, v11, v68
    v_fmac_f32 v141, v11, v69
    v_fmac_f32 v142, v11, v70
    v_fmac_f32 v143, v11, v71
    v_fmac_f32 v144, v11, v96
    v_fmac_f32 v145, v11, v97
    v_fmac_f32 v146, v11, v98
    v_fmac_f32 v147, v11, v99
    v_fmac_f32 v148, v11, v100
    v_fmac_f32 v149, v11, v101
    v_fmac_f32 v150, v11, v102
    v_fmac_f32 v151, v11, v103
    v_permlane32_swap_b32 v136, v144
    v_permlane32_swap_b32 v137, v145
    v_permlane32_swap_b32 v138, v146
    v_permlane32_swap_b32 v139, v147
    v_permlane32_swap_b32 v140, v148
    v_permlane32_swap_b32 v141, v149
    v_permlane32_swap_b32 v142, v150
    v_permlane32_swap_b32 v143, v151
    v_add_f32 v136, v136, v144
    v_add_f32 v137, v137, v145
    v_add_f32 v138, v138, v146
    v_add_f32 v139, v139, v147
    v_add_f32 v140, v140, v148
    v_add_f32 v141, v141, v149
    v_add_f32 v142, v142, v150
    v_add_f32 v143, v143, v151
    v_permlane16_swap_b32 v136, v140
    v_permlane16_swap_b32 v137, v141
    v_permlane16_swap_b32 v138, v142
    v_permlane16_swap_b32 v139, v143
    v_add_f32 v136, v136, v140
    v_add_f32 v137, v137, v141
    v_add_f32 v138, v138, v142
    v_add_f32 v139, v139, v143
    v_and_b32 v6, 1, v1
    v_lshlrev_b32 v6, 5, v6
    v_add_f32_dpp v136, v136, v136 quad_perm:[2,3,0,1] row_mask:0xf bank_mask:0xf
    v_add_f32_dpp v137, v137, v137 quad_perm:[2,3,0,1] row_mask:0xf bank_mask:0xf
    v_add_f32_dpp v138, v138, v138 quad_perm:[2,3,0,1] row_mask:0xf bank_mask:0xf
    v_add_f32_dpp v139, v139, v139 quad_perm:[2,3,0,1] row_mask:0xf bank_mask:0xf
    v_add_f32_dpp v136, v136, v136 row_ror:4 row_mask:0xf bank_mask:0xf
    v_add_f32_dpp v137, v137, v137 row_ror:4 row_mask:0xf bank_mask:0xf
    v_add_f32_dpp v138, v138, v138 row_ror:4 row_mask:0xf bank_mask:0xf
    v_add_f32_dpp v139, v139, v139 row_ror:4 row_mask:0xf bank_mask:0xf
    v_add_f32_dpp v136, v136, v136 row_ror:8 row_mask:0xf bank_mask:0xf
    v_add_f32_dpp v137, v137, v137 row_ror:8 row_mask:0xf bank_mask:0xf
    v_add_f32_dpp v138, v138, v138 row_ror:8 row_mask:0xf bank_mask:0xf
    v_add_f32_dpp v139, v139, v139 row_ror:8 row_mask:0xf bank_mask:0xf
    v_lshrrev_b32 v5, 5, v1
    v_lshl_add_u32 v6, v5, 6, v6
    v_bfe_u32 v5, v1, 4, 1
    v_lshl_add_u32 v6, v5, 4, v6
    v_lshl_add_u32 v6, v2, 7, v6
    ds_write_b128 v6, v[136:139] offset:1024
    v_lshlrev_b32 v5, 2, v3
    v_mov_b32 v6, 0
    s_waitcnt vmcnt(0) lgkmcnt(0)
    s_barrier
    ds_read_b32 v8, v5 offset:1024
    ds_read_b32 v12, v5 offset:1088
    ds_read_b32 v9, v5 offset:1152
    ds_read_b32 v13, v5 offset:1216
    ds_read_b32 v10, v5 offset:1280
    ds_read_b32 v14, v5 offset:1344
    ds_read_b32 v11, v5 offset:1408
    ds_read_b32 v15, v5 offset:1472
    s_cmp_lg_u32 s76, 0
    s_cbranch_scc1 FD1
    s_mov_b64 exec, 1
    buffer_store_dword v28, v6, s[44:47], s3 offen sc1
    s_mov_b64 exec, -1
FD1:
    s_lshl_b32 s88, s76, 2
    s_waitcnt lgkmcnt(0)
    v_add_f32 v8, v8, v9
    v_add_f32 v10, v10, v11
    v_add_f32 v12, v12, v13
    v_add_f32 v14, v14, v15
    v_add_f32 v8, v8, v10
    v_add_f32 v12, v12, v14
    v_cvt_pk_bf16_f32 v8, v8, v8
    v_and_b32 v8, 0xffff0000, v8
    v_cvt_pk_bf16_f32 v12, v12, v12
    v_and_b32 v12, 0xffff0000, v12
    v_mul_f32 v9, 0xbfb8aa3b, v8
    v_exp_f32 v9, v9
    s_nop 0
    v_add_f32 v9, 1.0, v9
    v_rcp_f32 v9, v9
    s_nop 0
    v_mul_f32 v8, v8, v9
    v_cvt_pk_bf16_f32 v8, v8, v8
    v_and_b32 v8, 0xffff0000, v8
    v_mul_f32 v8, v8, v12
    v_cvt_pk_bf16_f32 v8, v8, v8
    v_and_b32 v8, 0xffff0000, v8
    s_nop 0
    v_readlane_b32 s16, v8, s88
    s_add_u32 s88, s88, 1
    v_readlane_b32 s17, v8, s88
    s_add_u32 s88, s88, 1
    v_readlane_b32 s18, v8, s88
    s_add_u32 s88, s88, 1
    v_readlane_b32 s19, v8, s88
    s_nop 1
    v_mul_f32 v40, s16, v104
    v_mul_f32 v41, s16, v105
    v_mul_f32 v42, s16, v106
    v_mul_f32 v43, s16, v107
    v_mul_f32 v44, s16, v108
    v_mul_f32 v45, s16, v109
    v_mul_f32 v46, s16, v110
    v_mul_f32 v47, s16, v111
    v_fmac_f32 v40, s17, v112
    v_fmac_f32 v41, s17, v113
    v_fmac_f32 v42, s17, v114
    v_fmac_f32 v43, s17, v115
    v_fmac_f32 v44, s17, v116
    v_fmac_f32 v45, s17, v117
    v_fmac_f32 v46, s17, v118
    v_fmac_f32 v47, s17, v119
    v_fmac_f32 v40, s18, v208
    v_fmac_f32 v41, s18, v209
    v_fmac_f32 v42, s18, v210
    v_fmac_f32 v43, s18, v211
    v_fmac_f32 v44, s18, v212
    v_fmac_f32 v45, s18, v213
    v_fmac_f32 v46, s18, v214
    v_fmac_f32 v47, s18, v215
    v_fmac_f32 v40, s19, v216
    v_fmac_f32 v41, s19, v217
    v_fmac_f32 v42, s19, v218
    v_fmac_f32 v43, s19, v219
    v_fmac_f32 v44, s19, v220
    v_fmac_f32 v45, s19, v221
    v_fmac_f32 v46, s19, v222
    v_fmac_f32 v47, s19, v223
    v_lshlrev_b32 v5, 5, v0
    ds_write_b128 v5, v[40:43] offset:8192
    ds_write_b128 v5, v[44:47] offset:8208
    v_lshlrev_b32 v6, 3, v0
    s_waitcnt lgkmcnt(0)
    s_barrier
    ds_read_b64 v[8:9], v6 offset:8192
    ds_read_b64 v[10:11], v6 offset:10240
    ds_read_b64 v[12:13], v6 offset:12288
    ds_read_b64 v[14:15], v6 offset:14336
    s_lshl_b32 s88, s2, 12
    s_add_u32 s88, s88, 4194304
    v_lshlrev_b32 v6, 4, v0
    v_mov_b32 v17, s79
    v_mov_b32 v19, s79
    s_waitcnt lgkmcnt(0)
    v_add_f32 v8, v8, v10
    v_add_f32 v12, v12, v14
    v_add_f32 v9, v9, v11
    v_add_f32 v13, v13, v15
    v_add_f32 v16, v8, v12
    v_add_f32 v18, v9, v13
    buffer_store_dwordx4 v[16:19], v6, s[44:47], s88 offen sc1
    s_endpgm
FT_FIN:
    s_cmp_lg_u32 s76, 0
    s_cbranch_scc1 FD2
    s_mov_b64 exec, 1
    buffer_store_dword v28, v6, s[44:47], s3 offen sc1
    s_mov_b64 exec, -1
FD2:
    s_sub_u32 s14, s2, 224
    v_and_b32 v5, 7, v0
    v_lshlrev_b32 v7, 2, v5
    v_lshlrev_b32 v24, 3, v5
    v_lshrrev_b32 v25, 3, v0
    v_lshlrev_b32 v25, 12, v25
    v_lshl_add_u32 v25, v5, 4, v25
    s_lshl_b32 s89, s14, 6
    v_add_u32 v26, s89, v24
    v_add_u32 v26, 161792, v26
    ds_read_b64 v[232:233], v26
    s_and_b32 s88, s15, 0xffff0000
    s_ashr_i32 s89, s88, 31
    s_not_b32 s89, s89
    s_or_b32 s89, s89, 0x80000000
    s_xor_b32 s88, s88, s89
    s_and_b32 s88, s88, 0xffff0000
    v_mov_b32 v27, s88
    v_mul_f32 v27, 0xbfb8aa3b, v27
    v_exp_f32 v27, v27
    s_nop 0
    v_add_f32 v27, 1.0, v27
    v_rcp_f32 v27, v27
    s_nop 0
    v_cvt_pk_bf16_f32 v27, v27, v27
    v_and_b32 v27, 0xffff0000, v27
    s_cmp_lg_u32 s76, 0
    s_cbranch_scc1 FDW_done
    s_lshr_b32 s90, s24, 3
    s_lshl_b32 s90, s90, 2
    s_add_u32 s90, s90, 24576
    s_mov_b32 s91, 262144
FDW_loop:
    buffer_load_dword v31, v6, s[44:47], s90 offen sc1
    s_waitcnt vmcnt(0)
    v_cmp_ne_u32 vcc, s79, v31
    s_sub_u32 s91, s91, 1
    s_cbranch_scc1 FDW_out
    s_cbranch_vccz FDW_out
    s_sleep 4
    s_branch FDW_loop
FDW_out:
    s_lshl_b32 s88, s14, 6
    s_add_u32 s88, s88, s25
    s_lshl_b32 s89, s14, 5
    s_add_u32 s89, s89, s25
    buffer_load_dword v120, v24, s[44:47], s88 offen sc1
    buffer_load_dword v121, v7, s[44:47], s89 offen offset:2048 sc1
FDW_done:
    s_lshl_b32 s9, s14, 7
    s_add_u32 s9, s9, 4194304
    s_add_u32 s12, s9, 131072
    s_add_u32 s13, s9, 262144
    s_add_u32 s7, s9, 393216
    s_cmp_lt_u32 s76, 2
    s_cselect_b32 s7, s7, s13
    s_cselect_b32 s6, 1.0, 0
    s_mov_b32 s91, 262144
F3W_loop:
    buffer_load_dwordx4 v[40:43], v25, s[44:47], s9 offen sc1
    buffer_load_dwordx4 v[44:47], v25, s[44:47], s12 offen sc1
    buffer_load_dwordx4 v[48:51], v25, s[44:47], s13 offen sc1
    buffer_load_dwordx4 v[52:55], v25, s[44:47], s7 offen sc1
    s_waitcnt vmcnt(0)
    v_min_u32 v8, v41, v43
    v_min3_u32 v8, v8, v45, v47
    v_min3_u32 v8, v8, v49, v51
    v_min3_u32 v8, v8, v53, v55
    v_max_u32 v9, v41, v43
    v_max3_u32 v9, v9, v45, v47
    v_max3_u32 v9, v9, v49, v51
    v_max3_u32 v9, v9, v53, v55
    v_cmp_ne_u32 vcc, s79, v8
    s_mov_b64 s[88:89], vcc
    v_cmp_ne_u32 vcc, s79, v9
    s_or_b64 vcc, vcc, s[88:89]
    s_sub_u32 s91, s91, 1
    s_cbranch_scc1 F3W_out
    s_cbranch_vccz F3W_out
    s_sleep 2
    s_branch F3W_loop
F3W_out:
    v_add_f32 v40, v40, v44
    v_fma_f32 v48, v52, s6, v48
    v_add_f32 v42, v42, v46
    v_fma_f32 v50, v54, s6, v50
    v_add_f32 v40, v40, v48
    v_add_f32 v41, v42, v50
    s_nop 1
    v_add_f32_dpp v40, v40, v40 row_ror:8 row_mask:0xf bank_mask:0xf
    v_add_f32_dpp v41, v41, v41 row_ror:8 row_mask:0xf bank_mask:0xf
    s_nop 1
    v_mov_b32 v44, v40
    v_mov_b32 v45, v41
    s_nop 0
    v_permlane16_swap_b32 v44, v40
    v_permlane16_swap_b32 v45, v41
    v_add_f32 v40, v40, v44
    v_add_f32 v41, v41, v45
    s_nop 0
    v_mov_b32 v44, v40
    v_mov_b32 v45, v41
    s_nop 0
    v_permlane32_swap_b32 v44, v40
    v_permlane32_swap_b32 v45, v41
    v_add_f32 v40, v40, v44
    v_add_f32 v41, v41, v45
    s_nop 0
    v_lshl_add_u32 v6, v2, 6, v24
    ds_write_b64 v6, v[40:41] offset:1024
    s_waitcnt lgkmcnt(0)
    s_barrier
    v_cmp_gt_u32 vcc, 8, v0
    s_and_saveexec_b64 s[26:27], vcc
    s_cbranch_execz F_END
    ds_read_b64 v[40:41], v24 offset:1024
    ds_read_b64 v[42:43], v24 offset:1088
    ds_read_b64 v[44:45], v24 offset:1152
    ds_read_b64 v[46:47], v24 offset:1216
    v_lshlrev_b32 v56, 16, v120
    v_and_b32 v57, 0xffff0000, v120
    v_lshlrev_b32 v58, 16, v121
    v_and_b32 v59, 0xffff0000, v121
    s_waitcnt lgkmcnt(0)
    v_add_f32 v40, v40, v42
    v_add_f32 v44, v44, v46
    v_add_f32 v41, v41, v43
    v_add_f32 v45, v45, v47
    v_add_f32 v40, v40, v44
    v_add_f32 v41, v41, v45
    v_cvt_pk_bf16_f32 v40, v40, v41
    v_and_b32 v41, 0xffff0000, v40
    v_lshlrev_b32 v40, 16, v40
    v_mul_f32 v40, v40, v27
    v_mul_f32 v41, v41, v27
    v_cvt_pk_bf16_f32 v40, v40, v41
    v_and_b32 v41, 0xffff0000, v40
    v_lshlrev_b32 v40, 16, v40
    v_add_f32 v40, v40, v56
    v_add_f32 v41, v41, v57
    v_cvt_pk_bf16_f32 v40, v40, v41
    v_and_b32 v41, 0xffff0000, v40
    v_lshlrev_b32 v40, 16, v40
    v_mul_f32 v40, v40, v232
    v_mul_f32 v41, v41, v233
    v_cvt_pk_bf16_f32 v40, v40, v41
    v_and_b32 v41, 0xffff0000, v40
    v_lshlrev_b32 v40, 16, v40
    v_add_f32 v40, v40, v58
    v_add_f32 v41, v41, v59
    v_cvt_pk_bf16_f32 v40, v40, v41
    s_lshl_b32 s88, s24, 10
    s_lshl_b32 s89, s14, 5
    s_add_u32 s88, s88, s89
    buffer_store_dword v40, v7, s[60:63], s88 offen
    s_cmp_lg_u32 s2, 255
    s_cbranch_scc1 F_END
    v_mov_b32 v4, s79
    v_mov_b32 v5, 0
    s_mov_b64 exec, 1
    buffer_store_dword v4, v5, s[44:47], 0 offen
F_END:
    s_endpgm
F_SLOW:
    v_accvgpr_write_b32 a0, 0
    v_accvgpr_write_b32 a1, 0
    v_accvgpr_write_b32 a2, 0
    v_accvgpr_write_b32 a3, 0
    v_accvgpr_write_b32 a4, 0
    v_accvgpr_write_b32 a5, 0
    v_accvgpr_write_b32 a6, 0
    v_accvgpr_write_b32 a7, 0
    v_accvgpr_write_b32 a8, 0
    v_accvgpr_write_b32 a9, 0
    v_accvgpr_write_b32 a10, 0
    v_accvgpr_write_b32 a11, 0
    v_accvgpr_write_b32 a12, 0
    v_accvgpr_write_b32 a13, 0
    v_accvgpr_write_b32 a14, 0
    v_accvgpr_write_b32 a15, 0
    v_accvgpr_write_b32 a16, 0
    v_accvgpr_write_b32 a17, 0
    v_accvgpr_write_b32 a18, 0
    v_accvgpr_write_b32 a19, 0
    v_accvgpr_write_b32 a20, 0
    v_accvgpr_write_b32 a21, 0
    v_accvgpr_write_b32 a22, 0
    v_accvgpr_write_b32 a23, 0
    v_accvgpr_write_b32 a24, 0
    v_accvgpr_write_b32 a25, 0
    v_accvgpr_write_b32 a26, 0
    v_accvgpr_write_b32 a27, 0
    v_accvgpr_write_b32 a28, 0
    v_accvgpr_write_b32 a29, 0
    v_accvgpr_write_b32 a30, 0
    v_accvgpr_write_b32 a31, 0
    v_accvgpr_write_b32 a32, 0
    v_accvgpr_write_b32 a33, 0
    v_accvgpr_write_b32 a34, 0
    v_accvgpr_write_b32 a35, 0
    v_accvgpr_write_b32 a36, 0
    v_accvgpr_write_b32 a37, 0
    v_accvgpr_write_b32 a38, 0
    v_accvgpr_write_b32 a39, 0
    v_accvgpr_write_b32 a40, 0
    v_accvgpr_write_b32 a41, 0
    v_accvgpr_write_b32 a42, 0
    v_accvgpr_write_b32 a43, 0
    v_accvgpr_write_b32 a44, 0
    v_accvgpr_write_b32 a45, 0
    v_accvgpr_write_b32 a46, 0
    v_accvgpr_write_b32 a47, 0
    v_accvgpr_write_b32 a48, 0
    v_accvgpr_write_b32 a49, 0
    v_accvgpr_write_b32 a50, 0
    v_accvgpr_write_b32 a51, 0
    v_accvgpr_write_b32 a52, 0
    v_accvgpr_write_b32 a53, 0
    v_accvgpr_write_b32 a54, 0
    v_accvgpr_write_b32 a55, 0
    v_accvgpr_write_b32 a56, 0
    v_accvgpr_write_b32 a57, 0
    v_accvgpr_write_b32 a58, 0
    v_accvgpr_write_b32 a59, 0
    v_accvgpr_write_b32 a60, 0
    v_accvgpr_write_b32 a61, 0
    v_accvgpr_write_b32 a62, 0
    v_accvgpr_write_b32 a63, 0
    v_accvgpr_write_b32 a64, 0
    v_accvgpr_write_b32 a65, 0
    v_accvgpr_write_b32 a66, 0
    v_accvgpr_write_b32 a67, 0
    v_accvgpr_write_b32 a68, 0
    v_accvgpr_write_b32 a69, 0
    v_accvgpr_write_b32 a70, 0
    v_accvgpr_write_b32 a71, 0
    v_accvgpr_write_b32 a72, 0
    v_accvgpr_write_b32 a73, 0
    v_accvgpr_write_b32 a74, 0
    v_accvgpr_write_b32 a75, 0
    v_accvgpr_write_b32 a76, 0
    v_accvgpr_write_b32 a77, 0
    v_accvgpr_write_b32 a78, 0
    v_accvgpr_write_b32 a79, 0
    v_accvgpr_write_b32 a80, 0
    v_accvgpr_write_b32 a81, 0
    v_accvgpr_write_b32 a82, 0
    v_accvgpr_write_b32 a83, 0
    v_accvgpr_write_b32 a84, 0
    v_accvgpr_write_b32 a85, 0
    v_accvgpr_write_b32 a86, 0
    v_accvgpr_write_b32 a87, 0
    v_accvgpr_write_b32 a88, 0
    v_accvgpr_write_b32 a89, 0
    v_accvgpr_write_b32 a90, 0
    v_accvgpr_write_b32 a91, 0
    v_accvgpr_write_b32 a92, 0
    v_accvgpr_write_b32 a93, 0
    v_accvgpr_write_b32 a94, 0
    v_accvgpr_write_b32 a95, 0
    v_accvgpr_write_b32 a96, 0
    v_accvgpr_write_b32 a97, 0
    v_accvgpr_write_b32 a98, 0
    v_accvgpr_write_b32 a99, 0
    v_accvgpr_write_b32 a100, 0
    v_accvgpr_write_b32 a101, 0
    v_accvgpr_write_b32 a102, 0
    v_accvgpr_write_b32 a103, 0
    v_accvgpr_write_b32 a104, 0
    v_accvgpr_write_b32 a105, 0
    v_accvgpr_write_b32 a106, 0
    v_accvgpr_write_b32 a107, 0
    v_accvgpr_write_b32 a108, 0
    v_accvgpr_write_b32 a109, 0
    v_accvgpr_write_b32 a110, 0
    v_accvgpr_write_b32 a111, 0
    v_accvgpr_write_b32 a112, 0
    v_accvgpr_write_b32 a113, 0
    v_accvgpr_write_b32 a114, 0
    v_accvgpr_write_b32 a115, 0
    v_accvgpr_write_b32 a116, 0
    v_accvgpr_write_b32 a117, 0
    v_accvgpr_write_b32 a118, 0
    v_accvgpr_write_b32 a119, 0
    v_accvgpr_write_b32 a120, 0
    v_accvgpr_write_b32 a121, 0
    v_accvgpr_write_b32 a122, 0
    v_accvgpr_write_b32 a123, 0
    v_accvgpr_write_b32 a124, 0
    v_accvgpr_write_b32 a125, 0
    v_accvgpr_write_b32 a126, 0
    v_accvgpr_write_b32 a127, 0
    v_mov_b32 v136, 0
    v_mov_b32 v137, 0
    v_mov_b32 v138, 0
    v_mov_b32 v139, 0
    v_mov_b32 v140, 0
    v_mov_b32 v141, 0
    v_mov_b32 v142, 0
    v_mov_b32 v143, 0
    v_mov_b32 v144, 0
    v_mov_b32 v145, 0
    v_mov_b32 v146, 0
    v_mov_b32 v147, 0
    v_mov_b32 v148, 0
    v_mov_b32 v149, 0
    v_mov_b32 v150, 0
    v_mov_b32 v151, 0
    v_mov_b32 v252, 0xff800000
    v_mov_b32 v253, 0xff800000
    v_mov_b32 v254, 0xff800000
    v_mov_b32 v255, 0xff800000
    s_mov_b32 s80, 0
    s_mov_b32 s81, 0
    s_mov_b32 s84, 0
F_SLOOP:
    s_waitcnt vmcnt(0) lgkmcnt(0)
    s_barrier
    s_add_u32 m0, s82, 57344
    s_nop 0
    buffer_load_dwordx4 v20, s[32:35], s80 offen lds
    buffer_load_dwordx4 v21, s[32:35], s80 offen offset:1024 lds
    s_add_u32 s80, s80, 8192
    s_add_u32 m0, s82, 98304
    s_nop 0
    buffer_load_dwordx4 v22, s[36:39], s81 offen lds
    buffer_load_dwordx4 v23, s[36:39], s81 offen offset:1024 lds
    s_add_u32 s81, s81, 8192
    s_waitcnt vmcnt(0)
    s_barrier
    ds_read_b128 a[128:131], v8 offset:57344
    ds_read_b128 a[132:135], v9 offset:57344
    ds_read_b128 a[136:139], v10 offset:57344
    ds_read_b128 a[140:143], v11 offset:57344
    ds_read_b128 a[144:147], v8 offset:61440
    ds_read_b128 a[148:151], v9 offset:61440
    ds_read_b128 a[152:155], v10 offset:61440
    ds_read_b128 a[156:159], v11 offset:61440
    s_waitcnt lgkmcnt(0)
    ds_read_b64_tr_b16 a[160:161], v12 offset:32768
    ds_read_b64_tr_b16 a[162:163], v12 offset:36864
    ds_read_b64_tr_b16 a[164:165], v13 offset:32768
    ds_read_b64_tr_b16 a[166:167], v13 offset:36864
    ds_read_b64_tr_b16 a[168:169], v14 offset:32768
    ds_read_b64_tr_b16 a[170:171], v14 offset:36864
    ds_read_b64_tr_b16 a[172:173], v15 offset:32768
    ds_read_b64_tr_b16 a[174:175], v15 offset:36864
    ds_read_b64_tr_b16 a[176:177], v16 offset:32768
    ds_read_b64_tr_b16 a[178:179], v16 offset:36864
    ds_read_b64_tr_b16 a[180:181], v17 offset:32768
    ds_read_b64_tr_b16 a[182:183], v17 offset:36864
    s_waitcnt lgkmcnt(0)
    ds_read_b64_tr_b16 a[184:185], v18 offset:32768
    ds_read_b64_tr_b16 a[186:187], v18 offset:36864
    ds_read_b64_tr_b16 a[188:189], v19 offset:32768
    ds_read_b64_tr_b16 a[190:191], v19 offset:36864
    v_mfma_f32_16x16x32_bf16 v[104:107], a[128:131], v[40:43], 0
    v_mfma_f32_16x16x32_bf16 v[104:107], a[132:135], v[44:47], v[104:107]
    v_mfma_f32_16x16x32_bf16 v[104:107], a[136:139], v[48:51], v[104:107]
    v_mfma_f32_16x16x32_bf16 v[104:107], a[140:143], v[52:55], v[104:107]
    v_mfma_f32_16x16x32_bf16 v[112:115], a[128:131], v[56:59], 0
    v_mfma_f32_16x16x32_bf16 v[112:115], a[132:135], v[60:63], v[112:115]
    v_mfma_f32_16x16x32_bf16 v[112:115], a[136:139], v[64:67], v[112:115]
    v_mfma_f32_16x16x32_bf16 v[112:115], a[140:143], v[68:71], v[112:115]
    v_mfma_f32_16x16x32_bf16 v[120:123], a[128:131], v[72:75], 0
    v_mfma_f32_16x16x32_bf16 v[120:123], a[132:135], v[76:79], v[120:123]
    v_mfma_f32_16x16x32_bf16 v[120:123], a[136:139], v[80:83], v[120:123]
    v_mfma_f32_16x16x32_bf16 v[120:123], a[140:143], v[84:87], v[120:123]
    v_mfma_f32_16x16x32_bf16 v[128:131], a[128:131], v[88:91], 0
    v_mfma_f32_16x16x32_bf16 v[128:131], a[132:135], v[92:95], v[128:131]
    v_mfma_f32_16x16x32_bf16 v[128:131], a[136:139], v[96:99], v[128:131]
    v_mfma_f32_16x16x32_bf16 v[128:131], a[140:143], v[100:103], v[128:131]
    v_mfma_f32_16x16x32_bf16 v[108:111], a[144:147], v[40:43], 0
    v_mfma_f32_16x16x32_bf16 v[108:111], a[148:151], v[44:47], v[108:111]
    v_mfma_f32_16x16x32_bf16 v[108:111], a[152:155], v[48:51], v[108:111]
    v_mfma_f32_16x16x32_bf16 v[108:111], a[156:159], v[52:55], v[108:111]
    v_mfma_f32_16x16x32_bf16 v[116:119], a[144:147], v[56:59], 0
    v_mfma_f32_16x16x32_bf16 v[116:119], a[148:151], v[60:63], v[116:119]
    v_mfma_f32_16x16x32_bf16 v[116:119], a[152:155], v[64:67], v[116:119]
    v_mfma_f32_16x16x32_bf16 v[116:119], a[156:159], v[68:71], v[116:119]
    v_mfma_f32_16x16x32_bf16 v[124:127], a[144:147], v[72:75], 0
    v_mfma_f32_16x16x32_bf16 v[124:127], a[148:151], v[76:79], v[124:127]
    v_mfma_f32_16x16x32_bf16 v[124:127], a[152:155], v[80:83], v[124:127]
    v_mfma_f32_16x16x32_bf16 v[124:127], a[156:159], v[84:87], v[124:127]
    v_mfma_f32_16x16x32_bf16 v[132:135], a[144:147], v[88:91], 0
    v_mfma_f32_16x16x32_bf16 v[132:135], a[148:151], v[92:95], v[132:135]
    v_mfma_f32_16x16x32_bf16 v[132:135], a[152:155], v[96:99], v[132:135]
    v_mfma_f32_16x16x32_bf16 v[132:135], a[156:159], v[100:103], v[132:135]
    s_nop 7
    v_max3_f32 v236, v104, v105, v106
    v_max3_f32 v236, v236, v107, v108
    v_max3_f32 v236, v236, v109, v110
    v_max3_f32 v236, v236, v111, v252
    v_max3_f32 v237, v112, v113, v114
    v_max3_f32 v237, v237, v115, v116
    v_max3_f32 v237, v237, v117, v118
    v_max3_f32 v237, v237, v119, v253
    v_max3_f32 v238, v120, v121, v122
    v_max3_f32 v238, v238, v123, v124
    v_max3_f32 v238, v238, v125, v126
    v_max3_f32 v238, v238, v127, v254
    v_max3_f32 v239, v128, v129, v130
    v_max3_f32 v239, v239, v131, v132
    v_max3_f32 v239, v239, v133, v134
    v_max3_f32 v239, v239, v135, v255
    s_nop 1
    v_mov_b32 v240, v236
    v_mov_b32 v241, v237
    v_mov_b32 v242, v238
    v_mov_b32 v243, v239
    v_permlane16_swap_b32 v240, v236
    v_permlane16_swap_b32 v241, v237
    v_permlane16_swap_b32 v242, v238
    v_permlane16_swap_b32 v243, v239
    v_max_f32 v236, v236, v240
    v_max_f32 v237, v237, v241
    v_max_f32 v238, v238, v242
    v_max_f32 v239, v239, v243
    v_mov_b32 v240, v236
    v_mov_b32 v241, v237
    v_mov_b32 v242, v238
    v_mov_b32 v243, v239
    v_permlane32_swap_b32 v240, v236
    v_permlane32_swap_b32 v241, v237
    v_permlane32_swap_b32 v242, v238
    v_permlane32_swap_b32 v243, v239
    v_max_f32 v236, v236, v240
    v_max_f32 v237, v237, v241
    v_max_f32 v238, v238, v242
    v_max_f32 v239, v239, v243
    v_sub_f32 v200, v252, v236
    v_mov_b32 v252, v236
    v_sub_f32 v201, v253, v237
    v_mov_b32 v253, v237
    v_sub_f32 v202, v254, v238
    v_mov_b32 v254, v238
    v_sub_f32 v203, v255, v239
    v_mov_b32 v255, v239
    v_exp_f32 v200, v200
    v_exp_f32 v201, v201
    v_exp_f32 v202, v202
    v_exp_f32 v203, v203
    v_sub_f32 v104, v104, v252
    v_sub_f32 v105, v105, v252
    v_sub_f32 v106, v106, v252
    v_sub_f32 v107, v107, v252
    v_sub_f32 v108, v108, v252
    v_sub_f32 v109, v109, v252
    v_sub_f32 v110, v110, v252
    v_sub_f32 v111, v111, v252
    v_sub_f32 v112, v112, v253
    v_sub_f32 v113, v113, v253
    v_sub_f32 v114, v114, v253
    v_sub_f32 v115, v115, v253
    v_sub_f32 v116, v116, v253
    v_sub_f32 v117, v117, v253
    v_sub_f32 v118, v118, v253
    v_sub_f32 v119, v119, v253
    v_sub_f32 v120, v120, v254
    v_sub_f32 v121, v121, v254
    v_sub_f32 v122, v122, v254
    v_sub_f32 v123, v123, v254
    v_sub_f32 v124, v124, v254
    v_sub_f32 v125, v125, v254
    v_sub_f32 v126, v126, v254
    v_sub_f32 v127, v127, v254
    v_sub_f32 v128, v128, v255
    v_sub_f32 v129, v129, v255
    v_sub_f32 v130, v130, v255
    v_sub_f32 v131, v131, v255
    v_sub_f32 v132, v132, v255
    v_sub_f32 v133, v133, v255
    v_sub_f32 v134, v134, v255
    v_sub_f32 v135, v135, v255
    v_exp_f32 v104, v104
    v_exp_f32 v105, v105
    v_exp_f32 v106, v106
    v_exp_f32 v107, v107
    v_exp_f32 v108, v108
    v_exp_f32 v109, v109
    v_exp_f32 v110, v110
    v_exp_f32 v111, v111
    v_exp_f32 v112, v112
    v_exp_f32 v113, v113
    v_exp_f32 v114, v114
    v_exp_f32 v115, v115
    v_exp_f32 v116, v116
    v_exp_f32 v117, v117
    v_exp_f32 v118, v118
    v_exp_f32 v119, v119
    v_exp_f32 v120, v120
    v_exp_f32 v121, v121
    v_exp_f32 v122, v122
    v_exp_f32 v123, v123
    v_exp_f32 v124, v124
    v_exp_f32 v125, v125
    v_exp_f32 v126, v126
    v_exp_f32 v127, v127
    v_exp_f32 v128, v128
    v_exp_f32 v129, v129
    v_exp_f32 v130, v130
    v_exp_f32 v131, v131
    v_exp_f32 v132, v132
    v_exp_f32 v133, v133
    v_exp_f32 v134, v134
    v_exp_f32 v135, v135
    s_nop 0
    v_cvt_pk_bf16_f32 v168, v104, v105
    v_cvt_pk_bf16_f32 v169, v106, v107
    v_cvt_pk_bf16_f32 v170, v108, v109
    v_cvt_pk_bf16_f32 v171, v110, v111
    v_cvt_pk_bf16_f32 v172, v112, v113
    v_cvt_pk_bf16_f32 v173, v114, v115
    v_cvt_pk_bf16_f32 v174, v116, v117
    v_cvt_pk_bf16_f32 v175, v118, v119
    v_cvt_pk_bf16_f32 v176, v120, v121
    v_cvt_pk_bf16_f32 v177, v122, v123
    v_cvt_pk_bf16_f32 v178, v124, v125
    v_cvt_pk_bf16_f32 v179, v126, v127
    v_cvt_pk_bf16_f32 v180, v128, v129
    v_cvt_pk_bf16_f32 v181, v130, v131
    v_cvt_pk_bf16_f32 v182, v132, v133
    v_cvt_pk_bf16_f32 v183, v134, v135
    v_mul_f32 v136, v136, v200
    v_mul_f32 v137, v137, v200
    v_mul_f32 v138, v138, v200
    v_mul_f32 v139, v139, v200
    v_mul_f32 v140, v140, v201
    v_mul_f32 v141, v141, v201
    v_mul_f32 v142, v142, v201
    v_mul_f32 v143, v143, v201
    v_mul_f32 v144, v144, v202
    v_mul_f32 v145, v145, v202
    v_mul_f32 v146, v146, v202
    v_mul_f32 v147, v147, v202
    v_mul_f32 v148, v148, v203
    v_mul_f32 v149, v149, v203
    v_mul_f32 v150, v150, v203
    v_mul_f32 v151, v151, v203
    v_accvgpr_read_b32 v236, a0
    v_accvgpr_read_b32 v237, a1
    v_accvgpr_read_b32 v238, a2
    v_accvgpr_read_b32 v239, a3
    v_mul_f32 v236, v236, v200
    v_mul_f32 v237, v237, v200
    v_mul_f32 v238, v238, v200
    v_mul_f32 v239, v239, v200
    v_accvgpr_write_b32 a0, v236
    v_accvgpr_write_b32 a1, v237
    v_accvgpr_write_b32 a2, v238
    v_accvgpr_write_b32 a3, v239
    v_accvgpr_read_b32 v236, a4
    v_accvgpr_read_b32 v237, a5
    v_accvgpr_read_b32 v238, a6
    v_accvgpr_read_b32 v239, a7
    v_mul_f32 v236, v236, v201
    v_mul_f32 v237, v237, v201
    v_mul_f32 v238, v238, v201
    v_mul_f32 v239, v239, v201
    v_accvgpr_write_b32 a4, v236
    v_accvgpr_write_b32 a5, v237
    v_accvgpr_write_b32 a6, v238
    v_accvgpr_write_b32 a7, v239
    v_accvgpr_read_b32 v236, a8
    v_accvgpr_read_b32 v237, a9
    v_accvgpr_read_b32 v238, a10
    v_accvgpr_read_b32 v239, a11
    v_mul_f32 v236, v236, v202
    v_mul_f32 v237, v237, v202
    v_mul_f32 v238, v238, v202
    v_mul_f32 v239, v239, v202
    v_accvgpr_write_b32 a8, v236
    v_accvgpr_write_b32 a9, v237
    v_accvgpr_write_b32 a10, v238
    v_accvgpr_write_b32 a11, v239
    v_accvgpr_read_b32 v236, a12
    v_accvgpr_read_b32 v237, a13
    v_accvgpr_read_b32 v238, a14
    v_accvgpr_read_b32 v239, a15
    v_mul_f32 v236, v236, v203
    v_mul_f32 v237, v237, v203
    v_mul_f32 v238, v238, v203
    v_mul_f32 v239, v239, v203
    v_accvgpr_write_b32 a12, v236
    v_accvgpr_write_b32 a13, v237
    v_accvgpr_write_b32 a14, v238
    v_accvgpr_write_b32 a15, v239
    v_accvgpr_read_b32 v236, a16
    v_accvgpr_read_b32 v237, a17
    v_accvgpr_read_b32 v238, a18
    v_accvgpr_read_b32 v239, a19
    v_mul_f32 v236, v236, v200
    v_mul_f32 v237, v237, v200
    v_mul_f32 v238, v238, v200
    v_mul_f32 v239, v239, v200
    v_accvgpr_write_b32 a16, v236
    v_accvgpr_write_b32 a17, v237
    v_accvgpr_write_b32 a18, v238
    v_accvgpr_write_b32 a19, v239
    v_accvgpr_read_b32 v236, a20
    v_accvgpr_read_b32 v237, a21
    v_accvgpr_read_b32 v238, a22
    v_accvgpr_read_b32 v239, a23
    v_mul_f32 v236, v236, v201
    v_mul_f32 v237, v237, v201
    v_mul_f32 v238, v238, v201
    v_mul_f32 v239, v239, v201
    v_accvgpr_write_b32 a20, v236
    v_accvgpr_write_b32 a21, v237
    v_accvgpr_write_b32 a22, v238
    v_accvgpr_write_b32 a23, v239
    v_accvgpr_read_b32 v236, a24
    v_accvgpr_read_b32 v237, a25
    v_accvgpr_read_b32 v238, a26
    v_accvgpr_read_b32 v239, a27
    v_mul_f32 v236, v236, v202
    v_mul_f32 v237, v237, v202
    v_mul_f32 v238, v238, v202
    v_mul_f32 v239, v239, v202
    v_accvgpr_write_b32 a24, v236
    v_accvgpr_write_b32 a25, v237
    v_accvgpr_write_b32 a26, v238
    v_accvgpr_write_b32 a27, v239
    v_accvgpr_read_b32 v236, a28
    v_accvgpr_read_b32 v237, a29
    v_accvgpr_read_b32 v238, a30
    v_accvgpr_read_b32 v239, a31
    v_mul_f32 v236, v236, v203
    v_mul_f32 v237, v237, v203
    v_mul_f32 v238, v238, v203
    v_mul_f32 v239, v239, v203
    v_accvgpr_write_b32 a28, v236
    v_accvgpr_write_b32 a29, v237
    v_accvgpr_write_b32 a30, v238
    v_accvgpr_write_b32 a31, v239
    v_accvgpr_read_b32 v236, a32
    v_accvgpr_read_b32 v237, a33
    v_accvgpr_read_b32 v238, a34
    v_accvgpr_read_b32 v239, a35
    v_mul_f32 v236, v236, v200
    v_mul_f32 v237, v237, v200
    v_mul_f32 v238, v238, v200
    v_mul_f32 v239, v239, v200
    v_accvgpr_write_b32 a32, v236
    v_accvgpr_write_b32 a33, v237
    v_accvgpr_write_b32 a34, v238
    v_accvgpr_write_b32 a35, v239
    v_accvgpr_read_b32 v236, a36
    v_accvgpr_read_b32 v237, a37
    v_accvgpr_read_b32 v238, a38
    v_accvgpr_read_b32 v239, a39
    v_mul_f32 v236, v236, v201
    v_mul_f32 v237, v237, v201
    v_mul_f32 v238, v238, v201
    v_mul_f32 v239, v239, v201
    v_accvgpr_write_b32 a36, v236
    v_accvgpr_write_b32 a37, v237
    v_accvgpr_write_b32 a38, v238
    v_accvgpr_write_b32 a39, v239
    v_accvgpr_read_b32 v236, a40
    v_accvgpr_read_b32 v237, a41
    v_accvgpr_read_b32 v238, a42
    v_accvgpr_read_b32 v239, a43
    v_mul_f32 v236, v236, v202
    v_mul_f32 v237, v237, v202
    v_mul_f32 v238, v238, v202
    v_mul_f32 v239, v239, v202
    v_accvgpr_write_b32 a40, v236
    v_accvgpr_write_b32 a41, v237
    v_accvgpr_write_b32 a42, v238
    v_accvgpr_write_b32 a43, v239
    v_accvgpr_read_b32 v236, a44
    v_accvgpr_read_b32 v237, a45
    v_accvgpr_read_b32 v238, a46
    v_accvgpr_read_b32 v239, a47
    v_mul_f32 v236, v236, v203
    v_mul_f32 v237, v237, v203
    v_mul_f32 v238, v238, v203
    v_mul_f32 v239, v239, v203
    v_accvgpr_write_b32 a44, v236
    v_accvgpr_write_b32 a45, v237
    v_accvgpr_write_b32 a46, v238
    v_accvgpr_write_b32 a47, v239
    v_accvgpr_read_b32 v236, a48
    v_accvgpr_read_b32 v237, a49
    v_accvgpr_read_b32 v238, a50
    v_accvgpr_read_b32 v239, a51
    v_mul_f32 v236, v236, v200
    v_mul_f32 v237, v237, v200
    v_mul_f32 v238, v238, v200
    v_mul_f32 v239, v239, v200
    v_accvgpr_write_b32 a48, v236
    v_accvgpr_write_b32 a49, v237
    v_accvgpr_write_b32 a50, v238
    v_accvgpr_write_b32 a51, v239
    v_accvgpr_read_b32 v236, a52
    v_accvgpr_read_b32 v237, a53
    v_accvgpr_read_b32 v238, a54
    v_accvgpr_read_b32 v239, a55
    v_mul_f32 v236, v236, v201
    v_mul_f32 v237, v237, v201
    v_mul_f32 v238, v238, v201
    v_mul_f32 v239, v239, v201
    v_accvgpr_write_b32 a52, v236
    v_accvgpr_write_b32 a53, v237
    v_accvgpr_write_b32 a54, v238
    v_accvgpr_write_b32 a55, v239
    v_accvgpr_read_b32 v236, a56
    v_accvgpr_read_b32 v237, a57
    v_accvgpr_read_b32 v238, a58
    v_accvgpr_read_b32 v239, a59
    v_mul_f32 v236, v236, v202
    v_mul_f32 v237, v237, v202
    v_mul_f32 v238, v238, v202
    v_mul_f32 v239, v239, v202
    v_accvgpr_write_b32 a56, v236
    v_accvgpr_write_b32 a57, v237
    v_accvgpr_write_b32 a58, v238
    v_accvgpr_write_b32 a59, v239
    v_accvgpr_read_b32 v236, a60
    v_accvgpr_read_b32 v237, a61
    v_accvgpr_read_b32 v238, a62
    v_accvgpr_read_b32 v239, a63
    v_mul_f32 v236, v236, v203
    v_mul_f32 v237, v237, v203
    v_mul_f32 v238, v238, v203
    v_mul_f32 v239, v239, v203
    v_accvgpr_write_b32 a60, v236
    v_accvgpr_write_b32 a61, v237
    v_accvgpr_write_b32 a62, v238
    v_accvgpr_write_b32 a63, v239
    v_accvgpr_read_b32 v236, a64
    v_accvgpr_read_b32 v237, a65
    v_accvgpr_read_b32 v238, a66
    v_accvgpr_read_b32 v239, a67
    v_mul_f32 v236, v236, v200
    v_mul_f32 v237, v237, v200
    v_mul_f32 v238, v238, v200
    v_mul_f32 v239, v239, v200
    v_accvgpr_write_b32 a64, v236
    v_accvgpr_write_b32 a65, v237
    v_accvgpr_write_b32 a66, v238
    v_accvgpr_write_b32 a67, v239
    v_accvgpr_read_b32 v236, a68
    v_accvgpr_read_b32 v237, a69
    v_accvgpr_read_b32 v238, a70
    v_accvgpr_read_b32 v239, a71
    v_mul_f32 v236, v236, v201
    v_mul_f32 v237, v237, v201
    v_mul_f32 v238, v238, v201
    v_mul_f32 v239, v239, v201
    v_accvgpr_write_b32 a68, v236
    v_accvgpr_write_b32 a69, v237
    v_accvgpr_write_b32 a70, v238
    v_accvgpr_write_b32 a71, v239
    v_accvgpr_read_b32 v236, a72
    v_accvgpr_read_b32 v237, a73
    v_accvgpr_read_b32 v238, a74
    v_accvgpr_read_b32 v239, a75
    v_mul_f32 v236, v236, v202
    v_mul_f32 v237, v237, v202
    v_mul_f32 v238, v238, v202
    v_mul_f32 v239, v239, v202
    v_accvgpr_write_b32 a72, v236
    v_accvgpr_write_b32 a73, v237
    v_accvgpr_write_b32 a74, v238
    v_accvgpr_write_b32 a75, v239
    v_accvgpr_read_b32 v236, a76
    v_accvgpr_read_b32 v237, a77
    v_accvgpr_read_b32 v238, a78
    v_accvgpr_read_b32 v239, a79
    v_mul_f32 v236, v236, v203
    v_mul_f32 v237, v237, v203
    v_mul_f32 v238, v238, v203
    v_mul_f32 v239, v239, v203
    v_accvgpr_write_b32 a76, v236
    v_accvgpr_write_b32 a77, v237
    v_accvgpr_write_b32 a78, v238
    v_accvgpr_write_b32 a79, v239
    v_accvgpr_read_b32 v236, a80
    v_accvgpr_read_b32 v237, a81
    v_accvgpr_read_b32 v238, a82
    v_accvgpr_read_b32 v239, a83
    v_mul_f32 v236, v236, v200
    v_mul_f32 v237, v237, v200
    v_mul_f32 v238, v238, v200
    v_mul_f32 v239, v239, v200
    v_accvgpr_write_b32 a80, v236
    v_accvgpr_write_b32 a81, v237
    v_accvgpr_write_b32 a82, v238
    v_accvgpr_write_b32 a83, v239
    v_accvgpr_read_b32 v236, a84
    v_accvgpr_read_b32 v237, a85
    v_accvgpr_read_b32 v238, a86
    v_accvgpr_read_b32 v239, a87
    v_mul_f32 v236, v236, v201
    v_mul_f32 v237, v237, v201
    v_mul_f32 v238, v238, v201
    v_mul_f32 v239, v239, v201
    v_accvgpr_write_b32 a84, v236
    v_accvgpr_write_b32 a85, v237
    v_accvgpr_write_b32 a86, v238
    v_accvgpr_write_b32 a87, v239
    v_accvgpr_read_b32 v236, a88
    v_accvgpr_read_b32 v237, a89
    v_accvgpr_read_b32 v238, a90
    v_accvgpr_read_b32 v239, a91
    v_mul_f32 v236, v236, v202
    v_mul_f32 v237, v237, v202
    v_mul_f32 v238, v238, v202
    v_mul_f32 v239, v239, v202
    v_accvgpr_write_b32 a88, v236
    v_accvgpr_write_b32 a89, v237
    v_accvgpr_write_b32 a90, v238
    v_accvgpr_write_b32 a91, v239
    v_accvgpr_read_b32 v236, a92
    v_accvgpr_read_b32 v237, a93
    v_accvgpr_read_b32 v238, a94
    v_accvgpr_read_b32 v239, a95
    v_mul_f32 v236, v236, v203
    v_mul_f32 v237, v237, v203
    v_mul_f32 v238, v238, v203
    v_mul_f32 v239, v239, v203
    v_accvgpr_write_b32 a92, v236
    v_accvgpr_write_b32 a93, v237
    v_accvgpr_write_b32 a94, v238
    v_accvgpr_write_b32 a95, v239
    v_accvgpr_read_b32 v236, a96
    v_accvgpr_read_b32 v237, a97
    v_accvgpr_read_b32 v238, a98
    v_accvgpr_read_b32 v239, a99
    v_mul_f32 v236, v236, v200
    v_mul_f32 v237, v237, v200
    v_mul_f32 v238, v238, v200
    v_mul_f32 v239, v239, v200
    v_accvgpr_write_b32 a96, v236
    v_accvgpr_write_b32 a97, v237
    v_accvgpr_write_b32 a98, v238
    v_accvgpr_write_b32 a99, v239
    v_accvgpr_read_b32 v236, a100
    v_accvgpr_read_b32 v237, a101
    v_accvgpr_read_b32 v238, a102
    v_accvgpr_read_b32 v239, a103
    v_mul_f32 v236, v236, v201
    v_mul_f32 v237, v237, v201
    v_mul_f32 v238, v238, v201
    v_mul_f32 v239, v239, v201
    v_accvgpr_write_b32 a100, v236
    v_accvgpr_write_b32 a101, v237
    v_accvgpr_write_b32 a102, v238
    v_accvgpr_write_b32 a103, v239
    v_accvgpr_read_b32 v236, a104
    v_accvgpr_read_b32 v237, a105
    v_accvgpr_read_b32 v238, a106
    v_accvgpr_read_b32 v239, a107
    v_mul_f32 v236, v236, v202
    v_mul_f32 v237, v237, v202
    v_mul_f32 v238, v238, v202
    v_mul_f32 v239, v239, v202
    v_accvgpr_write_b32 a104, v236
    v_accvgpr_write_b32 a105, v237
    v_accvgpr_write_b32 a106, v238
    v_accvgpr_write_b32 a107, v239
    v_accvgpr_read_b32 v236, a108
    v_accvgpr_read_b32 v237, a109
    v_accvgpr_read_b32 v238, a110
    v_accvgpr_read_b32 v239, a111
    v_mul_f32 v236, v236, v203
    v_mul_f32 v237, v237, v203
    v_mul_f32 v238, v238, v203
    v_mul_f32 v239, v239, v203
    v_accvgpr_write_b32 a108, v236
    v_accvgpr_write_b32 a109, v237
    v_accvgpr_write_b32 a110, v238
    v_accvgpr_write_b32 a111, v239
    v_accvgpr_read_b32 v236, a112
    v_accvgpr_read_b32 v237, a113
    v_accvgpr_read_b32 v238, a114
    v_accvgpr_read_b32 v239, a115
    v_mul_f32 v236, v236, v200
    v_mul_f32 v237, v237, v200
    v_mul_f32 v238, v238, v200
    v_mul_f32 v239, v239, v200
    v_accvgpr_write_b32 a112, v236
    v_accvgpr_write_b32 a113, v237
    v_accvgpr_write_b32 a114, v238
    v_accvgpr_write_b32 a115, v239
    v_accvgpr_read_b32 v236, a116
    v_accvgpr_read_b32 v237, a117
    v_accvgpr_read_b32 v238, a118
    v_accvgpr_read_b32 v239, a119
    v_mul_f32 v236, v236, v201
    v_mul_f32 v237, v237, v201
    v_mul_f32 v238, v238, v201
    v_mul_f32 v239, v239, v201
    v_accvgpr_write_b32 a116, v236
    v_accvgpr_write_b32 a117, v237
    v_accvgpr_write_b32 a118, v238
    v_accvgpr_write_b32 a119, v239
    v_accvgpr_read_b32 v236, a120
    v_accvgpr_read_b32 v237, a121
    v_accvgpr_read_b32 v238, a122
    v_accvgpr_read_b32 v239, a123
    v_mul_f32 v236, v236, v202
    v_mul_f32 v237, v237, v202
    v_mul_f32 v238, v238, v202
    v_mul_f32 v239, v239, v202
    v_accvgpr_write_b32 a120, v236
    v_accvgpr_write_b32 a121, v237
    v_accvgpr_write_b32 a122, v238
    v_accvgpr_write_b32 a123, v239
    v_accvgpr_read_b32 v236, a124
    v_accvgpr_read_b32 v237, a125
    v_accvgpr_read_b32 v238, a126
    v_accvgpr_read_b32 v239, a127
    v_mul_f32 v236, v236, v203
    v_mul_f32 v237, v237, v203
    v_mul_f32 v238, v238, v203
    v_mul_f32 v239, v239, v203
    v_accvgpr_write_b32 a124, v236
    v_accvgpr_write_b32 a125, v237
    v_accvgpr_write_b32 a126, v238
    v_accvgpr_write_b32 a127, v239
    s_waitcnt lgkmcnt(0)
    s_nop 1
    v_mfma_f32_16x16x32_bf16 a[0:3], a[160:163], v[168:171], a[0:3]
    v_mfma_f32_16x16x32_bf16 a[4:7], a[160:163], v[172:175], a[4:7]
    v_mfma_f32_16x16x32_bf16 a[8:11], a[160:163], v[176:179], a[8:11]
    v_mfma_f32_16x16x32_bf16 a[12:15], a[160:163], v[180:183], a[12:15]
    v_mfma_f32_16x16x32_bf16 a[16:19], a[164:167], v[168:171], a[16:19]
    v_mfma_f32_16x16x32_bf16 a[20:23], a[164:167], v[172:175], a[20:23]
    v_mfma_f32_16x16x32_bf16 a[24:27], a[164:167], v[176:179], a[24:27]
    v_mfma_f32_16x16x32_bf16 a[28:31], a[164:167], v[180:183], a[28:31]
    v_mfma_f32_16x16x32_bf16 a[32:35], a[168:171], v[168:171], a[32:35]
    v_mfma_f32_16x16x32_bf16 a[36:39], a[168:171], v[172:175], a[36:39]
    v_mfma_f32_16x16x32_bf16 a[40:43], a[168:171], v[176:179], a[40:43]
    v_mfma_f32_16x16x32_bf16 a[44:47], a[168:171], v[180:183], a[44:47]
    v_mfma_f32_16x16x32_bf16 a[48:51], a[172:175], v[168:171], a[48:51]
    v_mfma_f32_16x16x32_bf16 a[52:55], a[172:175], v[172:175], a[52:55]
    v_mfma_f32_16x16x32_bf16 a[56:59], a[172:175], v[176:179], a[56:59]
    v_mfma_f32_16x16x32_bf16 a[60:63], a[172:175], v[180:183], a[60:63]
    v_mfma_f32_16x16x32_bf16 a[64:67], a[176:179], v[168:171], a[64:67]
    v_mfma_f32_16x16x32_bf16 a[68:71], a[176:179], v[172:175], a[68:71]
    v_mfma_f32_16x16x32_bf16 a[72:75], a[176:179], v[176:179], a[72:75]
    v_mfma_f32_16x16x32_bf16 a[76:79], a[176:179], v[180:183], a[76:79]
    v_mfma_f32_16x16x32_bf16 a[80:83], a[180:183], v[168:171], a[80:83]
    v_mfma_f32_16x16x32_bf16 a[84:87], a[180:183], v[172:175], a[84:87]
    v_mfma_f32_16x16x32_bf16 a[88:91], a[180:183], v[176:179], a[88:91]
    v_mfma_f32_16x16x32_bf16 a[92:95], a[180:183], v[180:183], a[92:95]
    v_mfma_f32_16x16x32_bf16 a[96:99], a[184:187], v[168:171], a[96:99]
    v_mfma_f32_16x16x32_bf16 a[100:103], a[184:187], v[172:175], a[100:103]
    v_mfma_f32_16x16x32_bf16 a[104:107], a[184:187], v[176:179], a[104:107]
    v_mfma_f32_16x16x32_bf16 a[108:111], a[184:187], v[180:183], a[108:111]
    v_mfma_f32_16x16x32_bf16 a[112:115], a[188:191], v[168:171], a[112:115]
    v_mfma_f32_16x16x32_bf16 a[116:119], a[188:191], v[172:175], a[116:119]
    v_mfma_f32_16x16x32_bf16 a[120:123], a[188:191], v[176:179], a[120:123]
    v_mfma_f32_16x16x32_bf16 a[124:127], a[188:191], v[180:183], a[124:127]
    v_mfma_f32_16x16x32_bf16 v[136:139], a[252:255], v[168:171], v[136:139]
    v_mfma_f32_16x16x32_bf16 v[140:143], a[252:255], v[172:175], v[140:143]
    v_mfma_f32_16x16x32_bf16 v[144:147], a[252:255], v[176:179], v[144:147]
    v_mfma_f32_16x16x32_bf16 v[148:151], a[252:255], v[180:183], v[148:151]
    s_nop 7
    s_add_u32 s84, s84, 1
    s_cmp_lt_u32 s84, 64
    s_cbranch_scc1 F_SLOOP
    v_rcp_f32 v200, v136
    v_rcp_f32 v201, v140
    v_rcp_f32 v202, v144
    v_rcp_f32 v203, v148
    s_sub_u32 s11, s11, 393216
    v_accvgpr_read_b32 v104, a0
    v_accvgpr_read_b32 v105, a1
    v_accvgpr_read_b32 v106, a2
    v_accvgpr_read_b32 v107, a3
    v_accvgpr_read_b32 v108, a16
    v_accvgpr_read_b32 v109, a17
    v_accvgpr_read_b32 v110, a18
    v_accvgpr_read_b32 v111, a19
    v_mul_f32 v104, v104, v200
    v_mul_f32 v105, v105, v200
    v_mul_f32 v106, v106, v200
    v_mul_f32 v107, v107, v200
    v_mul_f32 v108, v108, v200
    v_mul_f32 v109, v109, v200
    v_mul_f32 v110, v110, v200
    v_mul_f32 v111, v111, v200
    v_cvt_pk_bf16_f32 v112, v104, v105
    v_cvt_pk_bf16_f32 v113, v106, v107
    v_cvt_pk_bf16_f32 v114, v108, v109
    v_cvt_pk_bf16_f32 v115, v110, v111
    buffer_store_dwordx4 v[112:115], v33, s[44:47], s11 offen offset:0 sc1
    v_accvgpr_read_b32 v116, a4
    v_accvgpr_read_b32 v117, a5
    v_accvgpr_read_b32 v118, a6
    v_accvgpr_read_b32 v119, a7
    v_accvgpr_read_b32 v120, a20
    v_accvgpr_read_b32 v121, a21
    v_accvgpr_read_b32 v122, a22
    v_accvgpr_read_b32 v123, a23
    v_mul_f32 v116, v116, v201
    v_mul_f32 v117, v117, v201
    v_mul_f32 v118, v118, v201
    v_mul_f32 v119, v119, v201
    v_mul_f32 v120, v120, v201
    v_mul_f32 v121, v121, v201
    v_mul_f32 v122, v122, v201
    v_mul_f32 v123, v123, v201
    v_cvt_pk_bf16_f32 v124, v116, v117
    v_cvt_pk_bf16_f32 v125, v118, v119
    v_cvt_pk_bf16_f32 v126, v120, v121
    v_cvt_pk_bf16_f32 v127, v122, v123
    buffer_store_dwordx4 v[124:127], v33, s[44:47], s11 offen offset:1024 sc1
    v_accvgpr_read_b32 v128, a8
    v_accvgpr_read_b32 v129, a9
    v_accvgpr_read_b32 v130, a10
    v_accvgpr_read_b32 v131, a11
    v_accvgpr_read_b32 v132, a24
    v_accvgpr_read_b32 v133, a25
    v_accvgpr_read_b32 v134, a26
    v_accvgpr_read_b32 v135, a27
    v_mul_f32 v128, v128, v202
    v_mul_f32 v129, v129, v202
    v_mul_f32 v130, v130, v202
    v_mul_f32 v131, v131, v202
    v_mul_f32 v132, v132, v202
    v_mul_f32 v133, v133, v202
    v_mul_f32 v134, v134, v202
    v_mul_f32 v135, v135, v202
    v_cvt_pk_bf16_f32 v136, v128, v129
    v_cvt_pk_bf16_f32 v137, v130, v131
    v_cvt_pk_bf16_f32 v138, v132, v133
    v_cvt_pk_bf16_f32 v139, v134, v135
    buffer_store_dwordx4 v[136:139], v33, s[44:47], s11 offen offset:2048 sc1
    v_accvgpr_read_b32 v140, a12
    v_accvgpr_read_b32 v141, a13
    v_accvgpr_read_b32 v142, a14
    v_accvgpr_read_b32 v143, a15
    v_accvgpr_read_b32 v144, a28
    v_accvgpr_read_b32 v145, a29
    v_accvgpr_read_b32 v146, a30
    v_accvgpr_read_b32 v147, a31
    v_mul_f32 v140, v140, v203
    v_mul_f32 v141, v141, v203
    v_mul_f32 v142, v142, v203
    v_mul_f32 v143, v143, v203
    v_mul_f32 v144, v144, v203
    v_mul_f32 v145, v145, v203
    v_mul_f32 v146, v146, v203
    v_mul_f32 v147, v147, v203
    v_cvt_pk_bf16_f32 v148, v140, v141
    v_cvt_pk_bf16_f32 v149, v142, v143
    v_cvt_pk_bf16_f32 v150, v144, v145
    v_cvt_pk_bf16_f32 v151, v146, v147
    buffer_store_dwordx4 v[148:151], v33, s[44:47], s11 offen offset:3072 sc1
    s_add_u32 s11, s11, 131072
    v_accvgpr_read_b32 v104, a32
    v_accvgpr_read_b32 v105, a33
    v_accvgpr_read_b32 v106, a34
    v_accvgpr_read_b32 v107, a35
    v_accvgpr_read_b32 v108, a48
    v_accvgpr_read_b32 v109, a49
    v_accvgpr_read_b32 v110, a50
    v_accvgpr_read_b32 v111, a51
    v_mul_f32 v104, v104, v200
    v_mul_f32 v105, v105, v200
    v_mul_f32 v106, v106, v200
    v_mul_f32 v107, v107, v200
    v_mul_f32 v108, v108, v200
    v_mul_f32 v109, v109, v200
    v_mul_f32 v110, v110, v200
    v_mul_f32 v111, v111, v200
    v_cvt_pk_bf16_f32 v112, v104, v105
    v_cvt_pk_bf16_f32 v113, v106, v107
    v_cvt_pk_bf16_f32 v114, v108, v109
    v_cvt_pk_bf16_f32 v115, v110, v111
    buffer_store_dwordx4 v[112:115], v33, s[44:47], s11 offen offset:0 sc1
    v_accvgpr_read_b32 v116, a36
    v_accvgpr_read_b32 v117, a37
    v_accvgpr_read_b32 v118, a38
    v_accvgpr_read_b32 v119, a39
    v_accvgpr_read_b32 v120, a52
    v_accvgpr_read_b32 v121, a53
    v_accvgpr_read_b32 v122, a54
    v_accvgpr_read_b32 v123, a55
    v_mul_f32 v116, v116, v201
    v_mul_f32 v117, v117, v201
    v_mul_f32 v118, v118, v201
    v_mul_f32 v119, v119, v201
    v_mul_f32 v120, v120, v201
    v_mul_f32 v121, v121, v201
    v_mul_f32 v122, v122, v201
    v_mul_f32 v123, v123, v201
    v_cvt_pk_bf16_f32 v124, v116, v117
    v_cvt_pk_bf16_f32 v125, v118, v119
    v_cvt_pk_bf16_f32 v126, v120, v121
    v_cvt_pk_bf16_f32 v127, v122, v123
    buffer_store_dwordx4 v[124:127], v33, s[44:47], s11 offen offset:1024 sc1
    v_accvgpr_read_b32 v128, a40
    v_accvgpr_read_b32 v129, a41
    v_accvgpr_read_b32 v130, a42
    v_accvgpr_read_b32 v131, a43
    v_accvgpr_read_b32 v132, a56
    v_accvgpr_read_b32 v133, a57
    v_accvgpr_read_b32 v134, a58
    v_accvgpr_read_b32 v135, a59
    v_mul_f32 v128, v128, v202
    v_mul_f32 v129, v129, v202
    v_mul_f32 v130, v130, v202
    v_mul_f32 v131, v131, v202
    v_mul_f32 v132, v132, v202
    v_mul_f32 v133, v133, v202
    v_mul_f32 v134, v134, v202
    v_mul_f32 v135, v135, v202
    v_cvt_pk_bf16_f32 v136, v128, v129
    v_cvt_pk_bf16_f32 v137, v130, v131
    v_cvt_pk_bf16_f32 v138, v132, v133
    v_cvt_pk_bf16_f32 v139, v134, v135
    buffer_store_dwordx4 v[136:139], v33, s[44:47], s11 offen offset:2048 sc1
    v_accvgpr_read_b32 v140, a44
    v_accvgpr_read_b32 v141, a45
    v_accvgpr_read_b32 v142, a46
    v_accvgpr_read_b32 v143, a47
    v_accvgpr_read_b32 v144, a60
    v_accvgpr_read_b32 v145, a61
    v_accvgpr_read_b32 v146, a62
    v_accvgpr_read_b32 v147, a63
    v_mul_f32 v140, v140, v203
    v_mul_f32 v141, v141, v203
    v_mul_f32 v142, v142, v203
    v_mul_f32 v143, v143, v203
    v_mul_f32 v144, v144, v203
    v_mul_f32 v145, v145, v203
    v_mul_f32 v146, v146, v203
    v_mul_f32 v147, v147, v203
    v_cvt_pk_bf16_f32 v148, v140, v141
    v_cvt_pk_bf16_f32 v149, v142, v143
    v_cvt_pk_bf16_f32 v150, v144, v145
    v_cvt_pk_bf16_f32 v151, v146, v147
    buffer_store_dwordx4 v[148:151], v33, s[44:47], s11 offen offset:3072 sc1
    s_add_u32 s11, s11, 131072
    v_accvgpr_read_b32 v104, a64
    v_accvgpr_read_b32 v105, a65
    v_accvgpr_read_b32 v106, a66
    v_accvgpr_read_b32 v107, a67
    v_accvgpr_read_b32 v108, a80
    v_accvgpr_read_b32 v109, a81
    v_accvgpr_read_b32 v110, a82
    v_accvgpr_read_b32 v111, a83
    v_mul_f32 v104, v104, v200
    v_mul_f32 v105, v105, v200
    v_mul_f32 v106, v106, v200
    v_mul_f32 v107, v107, v200
    v_mul_f32 v108, v108, v200
    v_mul_f32 v109, v109, v200
    v_mul_f32 v110, v110, v200
    v_mul_f32 v111, v111, v200
    v_cvt_pk_bf16_f32 v112, v104, v105
    v_cvt_pk_bf16_f32 v113, v106, v107
    v_cvt_pk_bf16_f32 v114, v108, v109
    v_cvt_pk_bf16_f32 v115, v110, v111
    buffer_store_dwordx4 v[112:115], v33, s[44:47], s11 offen offset:0 sc1
    v_accvgpr_read_b32 v116, a68
    v_accvgpr_read_b32 v117, a69
    v_accvgpr_read_b32 v118, a70
    v_accvgpr_read_b32 v119, a71
    v_accvgpr_read_b32 v120, a84
    v_accvgpr_read_b32 v121, a85
    v_accvgpr_read_b32 v122, a86
    v_accvgpr_read_b32 v123, a87
    v_mul_f32 v116, v116, v201
    v_mul_f32 v117, v117, v201
    v_mul_f32 v118, v118, v201
    v_mul_f32 v119, v119, v201
    v_mul_f32 v120, v120, v201
    v_mul_f32 v121, v121, v201
    v_mul_f32 v122, v122, v201
    v_mul_f32 v123, v123, v201
    v_cvt_pk_bf16_f32 v124, v116, v117
    v_cvt_pk_bf16_f32 v125, v118, v119
    v_cvt_pk_bf16_f32 v126, v120, v121
    v_cvt_pk_bf16_f32 v127, v122, v123
    buffer_store_dwordx4 v[124:127], v33, s[44:47], s11 offen offset:1024 sc1
    v_accvgpr_read_b32 v128, a72
    v_accvgpr_read_b32 v129, a73
    v_accvgpr_read_b32 v130, a74
    v_accvgpr_read_b32 v131, a75
    v_accvgpr_read_b32 v132, a88
    v_accvgpr_read_b32 v133, a89
    v_accvgpr_read_b32 v134, a90
    v_accvgpr_read_b32 v135, a91
    v_mul_f32 v128, v128, v202
    v_mul_f32 v129, v129, v202
    v_mul_f32 v130, v130, v202
    v_mul_f32 v131, v131, v202
    v_mul_f32 v132, v132, v202
    v_mul_f32 v133, v133, v202
    v_mul_f32 v134, v134, v202
    v_mul_f32 v135, v135, v202
    v_cvt_pk_bf16_f32 v136, v128, v129
    v_cvt_pk_bf16_f32 v137, v130, v131
    v_cvt_pk_bf16_f32 v138, v132, v133
    v_cvt_pk_bf16_f32 v139, v134, v135
    buffer_store_dwordx4 v[136:139], v33, s[44:47], s11 offen offset:2048 sc1
    v_accvgpr_read_b32 v140, a76
    v_accvgpr_read_b32 v141, a77
    v_accvgpr_read_b32 v142, a78
    v_accvgpr_read_b32 v143, a79
    v_accvgpr_read_b32 v144, a92
    v_accvgpr_read_b32 v145, a93
    v_accvgpr_read_b32 v146, a94
    v_accvgpr_read_b32 v147, a95
    v_mul_f32 v140, v140, v203
    v_mul_f32 v141, v141, v203
    v_mul_f32 v142, v142, v203
    v_mul_f32 v143, v143, v203
    v_mul_f32 v144, v144, v203
    v_mul_f32 v145, v145, v203
    v_mul_f32 v146, v146, v203
    v_mul_f32 v147, v147, v203
    v_cvt_pk_bf16_f32 v148, v140, v141
    v_cvt_pk_bf16_f32 v149, v142, v143
    v_cvt_pk_bf16_f32 v150, v144, v145
    v_cvt_pk_bf16_f32 v151, v146, v147
    buffer_store_dwordx4 v[148:151], v33, s[44:47], s11 offen offset:3072 sc1
    s_add_u32 s11, s11, 131072
    v_accvgpr_read_b32 v104, a96
    v_accvgpr_read_b32 v105, a97
    v_accvgpr_read_b32 v106, a98
    v_accvgpr_read_b32 v107, a99
    v_accvgpr_read_b32 v108, a112
    v_accvgpr_read_b32 v109, a113
    v_accvgpr_read_b32 v110, a114
    v_accvgpr_read_b32 v111, a115
    v_mul_f32 v104, v104, v200
    v_mul_f32 v105, v105, v200
    v_mul_f32 v106, v106, v200
    v_mul_f32 v107, v107, v200
    v_mul_f32 v108, v108, v200
    v_mul_f32 v109, v109, v200
    v_mul_f32 v110, v110, v200
    v_mul_f32 v111, v111, v200
    v_cvt_pk_bf16_f32 v112, v104, v105
    v_cvt_pk_bf16_f32 v113, v106, v107
    v_cvt_pk_bf16_f32 v114, v108, v109
    v_cvt_pk_bf16_f32 v115, v110, v111
    buffer_store_dwordx4 v[112:115], v33, s[44:47], s11 offen offset:0 sc1
    v_accvgpr_read_b32 v116, a100
    v_accvgpr_read_b32 v117, a101
    v_accvgpr_read_b32 v118, a102
    v_accvgpr_read_b32 v119, a103
    v_accvgpr_read_b32 v120, a116
    v_accvgpr_read_b32 v121, a117
    v_accvgpr_read_b32 v122, a118
    v_accvgpr_read_b32 v123, a119
    v_mul_f32 v116, v116, v201
    v_mul_f32 v117, v117, v201
    v_mul_f32 v118, v118, v201
    v_mul_f32 v119, v119, v201
    v_mul_f32 v120, v120, v201
    v_mul_f32 v121, v121, v201
    v_mul_f32 v122, v122, v201
    v_mul_f32 v123, v123, v201
    v_cvt_pk_bf16_f32 v124, v116, v117
    v_cvt_pk_bf16_f32 v125, v118, v119
    v_cvt_pk_bf16_f32 v126, v120, v121
    v_cvt_pk_bf16_f32 v127, v122, v123
    buffer_store_dwordx4 v[124:127], v33, s[44:47], s11 offen offset:1024 sc1
    v_accvgpr_read_b32 v128, a104
    v_accvgpr_read_b32 v129, a105
    v_accvgpr_read_b32 v130, a106
    v_accvgpr_read_b32 v131, a107
    v_accvgpr_read_b32 v132, a120
    v_accvgpr_read_b32 v133, a121
    v_accvgpr_read_b32 v134, a122
    v_accvgpr_read_b32 v135, a123
    v_mul_f32 v128, v128, v202
    v_mul_f32 v129, v129, v202
    v_mul_f32 v130, v130, v202
    v_mul_f32 v131, v131, v202
    v_mul_f32 v132, v132, v202
    v_mul_f32 v133, v133, v202
    v_mul_f32 v134, v134, v202
    v_mul_f32 v135, v135, v202
    v_cvt_pk_bf16_f32 v136, v128, v129
    v_cvt_pk_bf16_f32 v137, v130, v131
    v_cvt_pk_bf16_f32 v138, v132, v133
    v_cvt_pk_bf16_f32 v139, v134, v135
    buffer_store_dwordx4 v[136:139], v33, s[44:47], s11 offen offset:2048 sc1
    v_accvgpr_read_b32 v140, a108
    v_accvgpr_read_b32 v141, a109
    v_accvgpr_read_b32 v142, a110
    v_accvgpr_read_b32 v143, a111
    v_accvgpr_read_b32 v144, a124
    v_accvgpr_read_b32 v145, a125
    v_accvgpr_read_b32 v146, a126
    v_accvgpr_read_b32 v147, a127
    v_mul_f32 v140, v140, v203
    v_mul_f32 v141, v141, v203
    v_mul_f32 v142, v142, v203
    v_mul_f32 v143, v143, v203
    v_mul_f32 v144, v144, v203
    v_mul_f32 v145, v145, v203
    v_mul_f32 v146, v146, v203
    v_mul_f32 v147, v147, v203
    v_cvt_pk_bf16_f32 v148, v140, v141
    v_cvt_pk_bf16_f32 v149, v142, v143
    v_cvt_pk_bf16_f32 v150, v144, v145
    v_cvt_pk_bf16_f32 v151, v146, v147
    buffer_store_dwordx4 v[148:151], v33, s[44:47], s11 offen offset:3072 sc1
    s_mov_b64 s[88:89], 0
    v_mov_b32 v252, s79
    v_not_b32 v252, v252
    s_barrier
    s_branch F_PUB
F_CODE_END:
.section .rodata,"a"
.p2align 6
.amdhsa_kernel adaLN_cond__mha_block_cached__moe_arch_mod__prompt_kernel
  .amdhsa_next_free_vgpr 512
  .amdhsa_next_free_sgpr 92
  .amdhsa_accum_offset 256
  .amdhsa_group_segment_fixed_size 0
  .amdhsa_kernarg_size 120
  .amdhsa_user_sgpr_count 2
  .amdhsa_user_sgpr_kernarg_segment_ptr 1
  .amdhsa_system_sgpr_workgroup_id_x 1
.end_amdhsa_kernel
```
